```python
import torch

def _softmax(x, axis=-1):
    return torch.softmax(x, dim=axis)
def _gelu(x):
    return torch.nn.functional.gelu(x, approximate="tanh")
def _silu(x):
    return torch.nn.functional.silu(x)
def _sigmoid(x):
    return torch.sigmoid(x)
def _layernorm(x, axis=-1, eps=1e-5):
    m = x.mean(dim=axis, keepdim=True)
    v = x.var(dim=axis, keepdim=True, unbiased=False)
    return (x - m) / torch.sqrt(v + eps)
def _scatter_add(tgt, idx, src, axis=0):
    return tgt.clone().index_add_(axis, idx, src)
def _segment_sum(src, seg, n):
    out = torch.zeros((n,) + src.shape[1:], dtype=src.dtype)
    return out.index_add_(0, seg, src)
def _pad(x, pw):
    flat = tuple(v for pair in reversed(pw) for v in pair)
    return torch.nn.functional.pad(x, flat)

kernel_name = 'interleave_layers__sliding_local_dilated__ssm_conv_s4__prompt'

def setup_inputs():

    _w = (lambda a: (lambda t: t.to(torch.bfloat16) if t.is_floating_point() else t)(torch.as_tensor(a)))
    def _A_setup():
        B, S, D = 1, 2048, 512
        return {
            "x": _w((lambda *s: torch.randn(*s, dtype=torch.bfloat16) * 0.05)(B, S, D)),
            "wqkv": _w((lambda *s: torch.randn(*s, dtype=torch.bfloat16) * 0.05)(D, 3 * D)),
            "wo": _w((lambda *s: torch.randn(*s, dtype=torch.bfloat16) * 0.05)(D, D)),
        }
    _A_in = _A_setup()

    def _B_setup():
        B, L, D, N = 1, 2048, 512, 128
        A_re = -(lambda _x: torch.exp(torch.as_tensor(_x)))((lambda *s: torch.randn(*s, dtype=torch.bfloat16) * 3.2)(D, N))
        A_im = torch.pi * (lambda *s: torch.randn(*s, dtype=torch.bfloat16) * 0.1)(D, N)
        B_re = (lambda *s: torch.randn(*s, dtype=torch.bfloat16) * 0.1)(D, N)
        B_im = (lambda *s: torch.randn(*s, dtype=torch.bfloat16) * 0.1)(D, N)
        C_re = (lambda *s: torch.randn(*s, dtype=torch.bfloat16) * 0.1)(D, N)
        C_im = (lambda *s: torch.randn(*s, dtype=torch.bfloat16) * 0.1)(D, N)
        log_dt = (lambda *s: torch.randn(*s, dtype=torch.bfloat16) * 0.1)(D) * 0.5 - 4.0
        Dskip = (lambda *s: torch.randn(*s, dtype=torch.bfloat16) * 0.1)(D)
        return {
            "u": _w((lambda *s: torch.randn(*s, dtype=torch.bfloat16) * 0.05)(B, L, D)),
            "A_re": _w(A_re),
            "A_im": _w(A_im),
            "B_re": _w(B_re),
            "B_im": _w(B_im),
            "C_re": _w(C_re),
            "C_im": _w(C_im),
            "log_dt": _w(log_dt),
            "Dskip": _w(Dskip),
        }
    _B_in = _B_setup()

    return {
        "A_x": _A_in["x"],
        "A_wqkv": _A_in["wqkv"],
        "A_wo": _A_in["wo"],
        "B_u": _B_in["u"],
        "B_A_re": _B_in["A_re"],
        "B_A_im": _B_in["A_im"],
        "B_B_re": _B_in["B_re"],
        "B_B_im": _B_in["B_im"],
        "B_C_re": _B_in["C_re"],
        "B_C_im": _B_in["C_im"],
        "B_log_dt": _B_in["log_dt"],
        "B_Dskip": _B_in["Dskip"],
    }

def reference(A_x, A_wqkv, A_wo, B_u, B_A_re, B_A_im, B_B_re, B_B_im, B_C_re, B_C_im, B_log_dt, B_Dskip):
    def _A_ref(x, wqkv, wo):
        B, S, D = x.shape
        H = 32; Dh = D // H
        W, dil = 8, 2
        qkv = (lambda x, *d: x.permute(*d))((x @ wqkv).reshape(B, S, 3, H, Dh), 2, 0, 3, 1, 4)
        q, k, v = qkv[0], qkv[1], qkv[2]
        scale = Dh ** -0.5
        pos = torch.arange(S)
        off = torch.arange(W) * dil
        idx = pos[:, None] - off[None, :]
        mask = idx >= 0
        idx_c = torch.where(mask, idx, 0).reshape(-1)
        kg = k[:, :, idx_c, :].reshape(B, H, S, W, Dh)
        vg = v[:, :, idx_c, :].reshape(B, H, S, W, Dh)
        logits = torch.einsum("bhsd,bhswd->bhsw", q, kg) * scale
        logits = torch.where(mask[None, None, :, :], logits, -1e9)
        attn = _softmax(logits, axis=-1)
        o = torch.einsum("bhsw,bhswd->bhsd", attn, vg)
        return (lambda x, *d: x.permute(*d))(o, 0, 2, 1, 3).reshape(B, S, D) @ wo

    def _B_ref(u, A_re, A_im, B_re, B_im, C_re, C_im, log_dt, Dskip):
        Bsz, L, D = u.shape
        dt = torch.exp(log_dt)[:, None]
        A = A_re + 1j * A_im
        Bc = B_re + 1j * B_im
        Cc = C_re + 1j * C_im
        logdA = dt * A
        dB = dt * Bc
        l = (lambda x, dt: x.to(dt))(torch.arange(L), A_re.dtype)
        P = torch.exp(logdA[:, :, None] * l[None, None, :])
        K = torch.einsum("dn,dnl,dn->dl", Cc, P, dB).real
        L2 = 2 * L
        Kp = _pad(K, ((0, 0), (0, L)))
        up = (lambda x, *d: x.permute(*d))(u, 0, 2, 1)
        up = _pad(up, ((0, 0), (0, 0), (0, L)))
        Kf = (lambda x, axes=(-2,-1): torch.fft.rfft2(x.float(), dim=axes))(Kp[:, None, :], axes=(-2, -1))
        Uf = (lambda x, axes=(-2,-1): torch.fft.rfft2(x.float(), dim=axes))(up[:, :, None, :], axes=(-2, -1))
        Yf = Uf * Kf[None, :, :, :]
        y = (lambda x, s, axes=(-2,-1): torch.fft.irfft2(x, s=s, dim=axes).to(torch.bfloat16))(Yf, (1, L2), axes=(-2, -1))[:, :, 0, :L]
        y = (lambda x, *d: x.permute(*d))(y, 0, 2, 1) + u * Dskip[None, None, :]
        return y

    x = A_x
    x = x + _A_ref(_layernorm(x, axis=-1), A_wqkv, A_wo)
    x = x + _B_ref(_layernorm(x, axis=-1), B_A_re, B_A_im, B_B_re, B_B_im, B_C_re, B_C_im, B_log_dt, B_Dskip)
    x = x + _A_ref(_layernorm(x, axis=-1), A_wqkv, A_wo)
    x = x + _B_ref(_layernorm(x, axis=-1), B_A_re, B_A_im, B_B_re, B_B_im, B_C_re, B_C_im, B_log_dt, B_Dskip)
    return x
```

```asm
; @launch grid=(256,1,1) block=(512,1,1) lds=163840
.amdgcn_target "amdgcn-amd-amdhsa--gfx950"
.text
.globl interleave_layers__sliding_local_dilated__ssm_conv_s4__prompt_kernel
.p2align 8
.type interleave_layers__sliding_local_dilated__ssm_conv_s4__prompt_kernel,@function
interleave_layers__sliding_local_dilated__ssm_conv_s4__prompt_kernel:
    s_cmp_ge_u32 s2, 256
    s_cbranch_scc1 k_exit
    s_load_dwordx4 s[60:63], s[0:1], 0
    s_load_dwordx2 s[64:65], s[0:1], 16
    s_load_dwordx16 s[40:55], s[0:1], 32
    s_load_dwordx4 s[56:59], s[0:1], 96
    s_load_dwordx2 s[66:67], s[0:1], 112
    v_lshrrev_b32 v2, 6, v0
    v_and_b32 v1, 63, v0
    v_lshlrev_b32 v3, 4, v0
    v_readfirstlane_b32 s28, v2
    v_lshlrev_b32 v0, 4, v1
    s_and_b32 s38, s2, 7
    s_lshr_b32 s39, s2, 3
    s_lshl_b32 s30, s38, 2
    s_lshr_b32 s31, s39, 3
    s_add_u32 s30, s30, s31
    s_and_b32 s31, s39, 7
    s_lshl_b32 s32, s38, 4
    s_lshr_b32 s33, s39, 1
    s_add_u32 s32, s32, s33
    s_and_b32 s33, s39, 1
    s_and_b32 s29, s28, 3
    s_mov_b32 s34, 0
    s_mov_b32 s35, 0
    s_mov_b32 s36, 4194304
    s_mov_b32 s37, 10485760
    v_mov_b32 v4, 0
    v_mov_b32 v5, 0
    v_mov_b32 v6, 0
    v_mov_b32 v7, 0
    v_add_u32 v3, 155648, v3
    ds_write_b128 v3, v[4:7]
    v_mov_b32 v4, 0x3f803f80
    v_mov_b32 v5, 0x3f803f80
    v_mov_b32 v6, 0x3f803f80
    v_mov_b32 v7, 0x3f803f80
    v_lshrrev_b32 v3, 3, v1
    v_lshlrev_b32 v3, 11, v3
    v_and_b32 v8, 7, v1
    v_lshl_add_u32 v3, v8, 4, v3
    ds_write_b128 v3, v[4:7]
    s_lshl_b32 s38, s32, 1
    s_add_u32 s38, s38, s33
    s_lshl_b32 s69, s38, 2
    s_lshl_b32 s38, s38, 1
    s_lshr_b32 s39, s28, 2
    s_add_u32 s38, s38, s39
    s_lshl_b32 s38, s38, 8
    s_lshl_b32 s39, s29, 6
    s_add_u32 s38, s38, s39
    v_lshrrev_b32 v2, 4, v1
    v_lshl_add_u32 v7, v8, 1, s38
    v_lshl_add_u32 v7, v2, 4, v7
    s_and_b32 s39, s28, 1
    s_lshl_b32 s38, s39, 2
    v_xor_b32 v5, v8, v2
    v_xor_b32 v5, s38, v5
    v_lshlrev_b32 v5, 4, v5
    s_lshl_b32 s38, s30, 3
    s_add_u32 s38, s38, s39
    s_lshl_b32 s38, s38, 3
    v_lshrrev_b32 v6, 3, v1
    v_add_u32 v6, s38, v6
    v_lshl_add_u32 v5, v6, 10, v5
    v_subrev_u32 v6, 16384, v5
    v_lshrrev_b32 v9, 5, v1
    v_bfe_u32 v8, v1, 3, 2
    v_lshl_add_u32 v4, v9, 3, v8
    s_lshr_b32 s39, s29, 1
    s_lshl_b32 s38, s39, 4
    s_and_b32 s39, s29, 1
    s_lshl_b32 s39, s39, 2
    s_add_u32 s38, s38, s39
    v_add_u32 v4, s38, v4
    v_mul_u32_u24 v4, 3072, v4
    v_bfe_u32 v8, v1, 1, 2
    v_xor_b32 v8, v8, v2
    v_lshl_add_u32 v4, v8, 5, v4
    v_and_b32 v8, 1, v1
    v_lshl_add_u32 v4, v8, 4, v4
    s_lshl_b32 s38, s31, 7
    v_add_u32 v4, s38, v4
    s_lshr_b32 s3, s28, 1
    s_lshl_b32 s3, s3, 7
    s_waitcnt lgkmcnt(0)
    s_cmp_lt_u32 s28, 4
    s_cbranch_scc0 v_role
    v_mov_b32 v216, 0
    v_mov_b32 v217, 0
    v_mov_b32 v218, 0
    v_mov_b32 v219, 0
    v_mov_b32 v220, 0
    v_mov_b32 v221, 0
    global_load_short_d16_hi v216, v7, s[40:41]
    global_load_short_d16_hi v217, v7, s[42:43]
    global_load_short_d16_hi v218, v7, s[44:45]
    global_load_short_d16_hi v219, v7, s[46:47]
    global_load_short_d16_hi v220, v7, s[48:49]
    global_load_short_d16_hi v221, v7, s[50:51]
    s_load_dword s68, s[52:53], s69
    s_mov_b32 s12, s62
    s_mov_b32 s13, s63
    s_mov_b32 s14, 0x00180000
    s_mov_b32 s15, 0x00020000
    s_mov_b32 s8, s60
    s_mov_b32 s9, s61
    s_mov_b32 s10, 0x00200000
    s_mov_b32 s11, 0x00020000
    s_mul_i32 s69, s29, 3072
    s_add_u32 s69, s69, 81920
    s_add_u32 m0, s69, 0
    s_mov_b32 s38, 0
    buffer_load_dwordx4 v4, s[12:15], s38 offen offset:0 lds
    s_add_u32 m0, s69, 0
    s_mov_b32 s38, 0
    buffer_load_dwordx4 v4, s[12:15], s38 offen offset:1024 lds
    s_add_u32 m0, s69, 0
    s_mov_b32 s38, 0
    buffer_load_dwordx4 v4, s[12:15], s38 offen offset:2048 lds
    s_lshl_b32 m0, s28, 10
    s_add_u32 m0, m0, 0
    s_add_u32 s38, s3, 0
    s_bitcmp1_b32 s28, 0
    s_cselect_b32 exec_lo, -1, 0xffffff00
    buffer_load_dwordx4 v6, s[8:11], s38 offen lds
    s_mov_b32 exec_lo, -1
    s_lshl_b32 m0, s28, 10
    s_add_u32 m0, m0, 16384
    s_add_u32 s38, s3, 0
    buffer_load_dwordx4 v5, s[8:11], s38 offen lds
    s_lshl_b32 m0, s28, 10
    s_add_u32 m0, m0, 32768
    s_add_u32 s38, s3, 16384
    buffer_load_dwordx4 v5, s[8:11], s38 offen lds
    s_lshl_b32 m0, s28, 10
    s_add_u32 m0, m0, 49152
    s_add_u32 s38, s3, 32768
    buffer_load_dwordx4 v5, s[8:11], s38 offen lds
    s_lshl_b32 m0, s28, 10
    s_add_u32 m0, m0, 65536
    s_add_u32 s38, s3, 49152
    buffer_load_dwordx4 v5, s[8:11], s38 offen lds
    s_mov_b32 s4, s66
    s_mov_b32 s5, s67
    s_mov_b32 s6, 0x02000000
    s_mov_b32 s7, 0x00020000
    s_mov_b32 s16, s64
    s_mov_b32 s17, s65
    s_mov_b32 s18, 0x00080000
    s_mov_b32 s19, 0x00020000
    s_mov_b32 s20, s56
    s_mov_b32 s21, s57
    s_mov_b32 s22, 0x00200000
    s_mov_b32 s23, 0x00020000
    s_mov_b32 s24, s58
    s_mov_b32 s25, s59
    s_mov_b32 s26, 0x00000100
    s_mov_b32 s27, 0x00020000
    s_lshl_b32 s38, s32, 3
    s_load_dwordx2 s[66:67], s[54:55], s38
    v_bfe_u32 v8, v1, 1, 3
    v_lshrrev_b32 v9, 4, v1
    v_xor_b32 v8, v8, v9
    v_and_b32 v9, 15, v1
    v_lshlrev_b32 v9, 7, v9
    v_lshl_add_u32 v2, v8, 4, v9
    v_add_u32 v3, 0x10000, v2
    v_xor_b32 v10, 64, v2
    v_xor_b32 v11, 64, v3
    v_lshrrev_b32 v14, 5, v1
    v_mul_u32_u24 v14, 6144, v14
    v_bfe_u32 v8, v1, 2, 3
    v_lshl_add_u32 v14, v8, 7, v14
    v_bfe_u32 v8, v1, 3, 2
    v_xor_b32 v8, s28, v8
    v_lshl_add_u32 v14, v8, 5, v14
    v_and_b32 v8, 3, v1
    v_lshl_add_u32 v14, v8, 3, v14
    v_add_u32 v14, 81920, v14
    v_add_u32 v15, 49152, v14
    v_and_b32 v224, 15, v1
    v_lshlrev_b32 v225, 3, v224
    v_cvt_f32_u32 v111, v225
    v_lshlrev_b32 v225, 7, v224
    v_add_u32 v225, 1024, v225
    v_cvt_f32_u32 v110, v225
    v_lshrrev_b32 v225, 3, v224
    v_and_b32 v226, 7, v224
    v_lshl_add_u32 v225, v225, 7, v226
    v_cvt_f32_u32 v108, v225
    v_lshrrev_b32 v225, 2, v224
    v_and_b32 v226, 3, v224
    v_lshl_add_u32 v225, v225, 6, v226
    v_add_u32 v225, 128, v225
    v_bfe_u32 v226, v224, 1, 2
    v_and_b32 v227, 1, v224
    v_lshl_add_u32 v226, v226, 5, v227
    v_add_u32 v226, 128, v226
    v_lshlrev_b32 v226, 1, v226
    v_cmp_gt_u32 s[44:45], 8, v224
    s_nop 1
    v_cndmask_b32 v225, v226, v225, s[44:45]
    v_cvt_f32_u32 v109, v225
    v_add_f32 v109, v109, v109
    s_waitcnt lgkmcnt(0)
    v_mov_b32 v208, -1
    v_mov_b32 v209, -1
    v_mov_b32 v210, -1
    v_mov_b32 v211, -1
    v_lshrrev_b32 v212, 4, v1
    v_lshlrev_b32 v212, 14, v212
    v_and_b32 v213, 15, v1
    v_lshl_add_u32 v212, v213, 4, v212
    s_lshr_b32 s44, s28, 2
    s_add_u32 s40, s28, 0
    s_lshr_b32 s42, s40, 2
    s_and_b32 s43, s40, 3
    s_lshl_b32 s39, s31, 2
    s_add_u32 s39, s39, s43
    s_lshl_b32 s39, s39, 10
    s_lshl_b32 s41, s30, 16
    s_add_u32 s39, s39, s41
    s_lshl_b32 s41, s42, 15
    s_add_u32 s39, s39, s41
    s_add_u32 s39, s39, 0
    buffer_store_dwordx4 v[208:211], v0, s[4:7], s39 offen sc1
    s_lshl_b32 s44, s44, 4
    s_and_b32 s39, s31, 3
    s_lshl_b32 s39, s39, 19
    s_lshl_b32 s41, s30, 9
    s_add_u32 s39, s39, s41
    s_lshr_b32 s41, s31, 2
    s_lshl_b32 s41, s41, 8
    s_add_u32 s39, s39, s41
    s_add_u32 s39, s39, 4194304
    s_add_u32 s40, s28, 0
    s_lshl_b32 s42, s40, 16
    s_add_u32 s39, s39, s42
    buffer_store_dwordx4 v[208:211], v212, s[4:7], s39 offen sc1
    s_lshr_b32 s44, s68, s44
    s_and_b32 s39, s31, 3
    s_lshl_b32 s39, s39, 14
    s_lshl_b32 s41, s30, 9
    s_add_u32 s39, s39, s41
    s_lshr_b32 s41, s31, 2
    s_lshl_b32 s41, s41, 8
    s_add_u32 s39, s39, s41
    s_add_u32 s39, s39, 10485760
    s_lshl_b32 s42, s28, 5
    s_add_u32 s39, s39, s42
    s_mov_b64 exec, 3
    buffer_store_dwordx4 v[208:211], v0, s[4:7], s39 offen sc1
    s_mov_b64 exec, -1
    s_lshl_b32 s44, s44, 16
    s_add_u32 m0, s69, 24576
    s_mov_b32 s38, 196608
    buffer_load_dwordx4 v4, s[12:15], s38 offen offset:0 lds
    v_mov_b32 v225, s44
    s_add_u32 m0, s69, 24576
    s_mov_b32 s38, 196608
    buffer_load_dwordx4 v4, s[12:15], s38 offen offset:1024 lds
    v_mul_f32 v224, 0x3fb8aa3b, v225
    s_add_u32 m0, s69, 24576
    s_mov_b32 s38, 196608
    buffer_load_dwordx4 v4, s[12:15], s38 offen offset:2048 lds
    v_mov_b32 v227, 0x3fb8aa3b
    s_add_u32 m0, s69, 49152
    s_mov_b32 s38, 393216
    buffer_load_dwordx4 v4, s[12:15], s38 offen offset:0 lds
    v_fma_f32 v226, v225, v227, -v224
    s_add_u32 m0, s69, 49152
    s_mov_b32 s38, 393216
    buffer_load_dwordx4 v4, s[12:15], s38 offen offset:1024 lds
    v_mov_b32 v227, 0x32a57060
    s_add_u32 m0, s69, 49152
    s_mov_b32 s38, 393216
    buffer_load_dwordx4 v4, s[12:15], s38 offen offset:2048 lds
    v_fma_f32 v226, v225, v227, v226
    s_lshl_b32 m0, s28, 10
    s_add_u32 m0, m0, 8192
    s_add_u32 s38, s3, 512
    s_bitcmp1_b32 s28, 0
    s_cselect_b32 exec_lo, -1, 0xffffff00
    buffer_load_dwordx4 v6, s[8:11], s38 offen lds
    s_mov_b32 exec_lo, -1
    v_exp_f32 v224, v224
    s_lshl_b32 m0, s28, 10
    s_add_u32 m0, m0, 24576
    s_add_u32 s38, s3, 512
    buffer_load_dwordx4 v5, s[8:11], s38 offen lds
    v_mul_f32 v226, 0x3f317218, v226
    s_lshl_b32 m0, s28, 10
    s_add_u32 m0, m0, 40960
    s_add_u32 s38, s3, 16896
    buffer_load_dwordx4 v5, s[8:11], s38 offen lds
    v_fma_f32 v224, v224, v226, v224
    s_lshl_b32 m0, s28, 10
    s_add_u32 m0, m0, 57344
    s_add_u32 s38, s3, 33280
    buffer_load_dwordx4 v5, s[8:11], s38 offen lds
    v_cvt_pk_bf16_f32 v224, v224, v224
    s_lshl_b32 m0, s28, 10
    s_add_u32 m0, m0, 73728
    s_add_u32 s38, s3, 49664
    buffer_load_dwordx4 v5, s[8:11], s38 offen lds
    v_lshlrev_b32 v224, 16, v224
    s_waitcnt vmcnt(22)
    v_mul_f32 v216, v224, v216
    v_mul_f32 v217, v224, v217
    v_mul_f32 v218, v224, v218
    v_mul_f32 v219, v224, v219
    v_mul_f32 v104, 0x3fb8aa3b, v216
    v_mul_f32 v105, 0x3e22f983, v217
    v_mul_f32 v106, v220, v218
    v_mul_f32 v107, v220, v219
    v_fma_f32 v106, -v221, v219, v106
    v_fma_f32 v107, v221, v218, v107
    v_mov_b32 v113, 0x02081cea
    v_mov_b32 v112, v104
    v_max3_f32 v113, abs(v106), abs(v107), v113
    s_nop 0
    v_max_f32_dpp v112, v112, v112 row_ror:1 row_mask:0xf bank_mask:0xf
    v_max_f32_dpp v113, v113, v113 row_ror:1 row_mask:0xf bank_mask:0xf
    s_nop 0
    v_max_f32_dpp v112, v112, v112 row_ror:2 row_mask:0xf bank_mask:0xf
    v_max_f32_dpp v113, v113, v113 row_ror:2 row_mask:0xf bank_mask:0xf
    s_nop 0
    v_max_f32_dpp v112, v112, v112 row_ror:4 row_mask:0xf bank_mask:0xf
    v_max_f32_dpp v113, v113, v113 row_ror:4 row_mask:0xf bank_mask:0xf
    v_mov_b32 v225, v112
    v_mov_b32 v226, v113
    s_nop 0
    v_permlane16_swap_b32 v112, v225
    v_permlane16_swap_b32 v113, v226
    v_max_f32 v112, v112, v225
    v_max_f32 v113, v113, v226
    v_mov_b32 v225, v112
    v_mov_b32 v226, v113
    s_nop 0
    v_permlane32_swap_b32 v112, v225
    v_permlane32_swap_b32 v113, v226
    v_max_f32 v112, v112, v225
    v_max_f32 v113, v113, v226
    v_frexp_exp_i32_f32 v225, v113
    v_sub_f32 v104, v104, v112
    v_sub_u32 v226, 0, v225
    v_cvt_f32_i32 v113, v225
    v_ldexp_f32 v106, v106, v226
    v_ldexp_f32 v107, v107, v226
    v_mul_f32_dpp v216, v104, v111 row_newbcast:0 row_mask:0xf bank_mask:0xf
    v_mul_f32_dpp v224, v105, v111 row_newbcast:0 row_mask:0xf bank_mask:0xf
    v_mul_f32_dpp v217, v104, v111 row_newbcast:1 row_mask:0xf bank_mask:0xf
    v_mul_f32_dpp v225, v105, v111 row_newbcast:1 row_mask:0xf bank_mask:0xf
    v_mul_f32_dpp v218, v104, v111 row_newbcast:2 row_mask:0xf bank_mask:0xf
    v_mul_f32_dpp v226, v105, v111 row_newbcast:2 row_mask:0xf bank_mask:0xf
    v_mul_f32_dpp v219, v104, v111 row_newbcast:3 row_mask:0xf bank_mask:0xf
    v_mul_f32_dpp v227, v105, v111 row_newbcast:3 row_mask:0xf bank_mask:0xf
    v_exp_f32 v216, v216
    v_fract_f32 v224, v224
    v_exp_f32 v217, v217
    v_fract_f32 v225, v225
    v_exp_f32 v218, v218
    v_fract_f32 v226, v226
    v_exp_f32 v219, v219
    v_fract_f32 v227, v227
    v_sin_f32 v220, v224
    v_cos_f32 v224, v224
    v_sin_f32 v221, v225
    v_cos_f32 v225, v225
    v_sin_f32 v222, v226
    v_cos_f32 v226, v226
    v_sin_f32 v223, v227
    v_cos_f32 v227, v227
    v_mul_f32_dpp v228, v106, v216 row_newbcast:0 row_mask:0xf bank_mask:0xf
    v_mul_f32_dpp v232, v107, v216 row_newbcast:0 row_mask:0xf bank_mask:0xf
    v_mul_f32_dpp v229, v106, v217 row_newbcast:1 row_mask:0xf bank_mask:0xf
    v_mul_f32_dpp v233, v107, v217 row_newbcast:1 row_mask:0xf bank_mask:0xf
    v_mul_f32_dpp v230, v106, v218 row_newbcast:2 row_mask:0xf bank_mask:0xf
    v_mul_f32_dpp v234, v107, v218 row_newbcast:2 row_mask:0xf bank_mask:0xf
    v_mul_f32_dpp v231, v106, v219 row_newbcast:3 row_mask:0xf bank_mask:0xf
    v_mul_f32_dpp v235, v107, v219 row_newbcast:3 row_mask:0xf bank_mask:0xf
    v_mul_f32 v216, v232, v220
    v_mul_f32 v232, v232, v224
    v_mul_f32 v217, v233, v221
    v_mul_f32 v233, v233, v225
    v_mul_f32 v218, v234, v222
    v_mul_f32 v234, v234, v226
    v_mul_f32 v219, v235, v223
    v_mul_f32 v235, v235, v227
    v_fma_mixlo_f16 v236, v228, v224, -v216
    v_fma_mixlo_f16 v237, v229, v225, -v217
    v_fma_mixlo_f16 v238, v230, v226, -v218
    v_fma_mixlo_f16 v239, v231, v227, -v219
    v_fma_mixhi_f16 v236, -v228, v220, -v232
    v_fma_mixhi_f16 v237, -v229, v221, -v233
    v_fma_mixhi_f16 v238, -v230, v222, -v234
    v_fma_mixhi_f16 v239, -v231, v223, -v235
    v_mul_f32_dpp v216, v104, v108 row_newbcast:0 row_mask:0xf bank_mask:0xf
    v_mul_f32_dpp v224, v105, v108 row_newbcast:0 row_mask:0xf bank_mask:0xf
    v_mul_f32_dpp v217, v104, v108 row_newbcast:1 row_mask:0xf bank_mask:0xf
    v_mul_f32_dpp v225, v105, v108 row_newbcast:1 row_mask:0xf bank_mask:0xf
    v_mul_f32_dpp v218, v104, v108 row_newbcast:2 row_mask:0xf bank_mask:0xf
    v_mul_f32_dpp v226, v105, v108 row_newbcast:2 row_mask:0xf bank_mask:0xf
    v_mul_f32_dpp v219, v104, v108 row_newbcast:3 row_mask:0xf bank_mask:0xf
    v_mul_f32_dpp v227, v105, v108 row_newbcast:3 row_mask:0xf bank_mask:0xf
    v_exp_f32 v216, v216
    v_fract_f32 v224, v224
    v_exp_f32 v217, v217
    v_fract_f32 v225, v225
    v_exp_f32 v218, v218
    v_fract_f32 v226, v226
    v_exp_f32 v219, v219
    v_fract_f32 v227, v227
    v_sin_f32 v220, v224
    v_cos_f32 v224, v224
    v_sin_f32 v221, v225
    v_cos_f32 v225, v225
    v_sin_f32 v222, v226
    v_cos_f32 v226, v226
    v_sin_f32 v223, v227
    v_cos_f32 v227, v227
    v_fma_mixlo_f16 v240, v216, v224, 0
    v_fma_mixlo_f16 v241, v217, v225, 0
    v_fma_mixlo_f16 v242, v218, v226, 0
    v_fma_mixlo_f16 v243, v219, v227, 0
    v_fma_mixhi_f16 v240, v216, v220, 0
    v_fma_mixhi_f16 v241, v217, v221, 0
    v_fma_mixhi_f16 v242, v218, v222, 0
    v_fma_mixhi_f16 v243, v219, v223, 0
    s_nop 1
    v_mfma_f32_16x16x32_f16 v[92:95], v[240:243], v[236:239], 0
    v_mul_f32_dpp v216, v104, v109 row_newbcast:0 row_mask:0xf bank_mask:0xf
    v_mul_f32_dpp v224, v105, v109 row_newbcast:0 row_mask:0xf bank_mask:0xf
    v_mul_f32_dpp v217, v104, v109 row_newbcast:1 row_mask:0xf bank_mask:0xf
    v_mul_f32_dpp v225, v105, v109 row_newbcast:1 row_mask:0xf bank_mask:0xf
    v_mul_f32_dpp v218, v104, v109 row_newbcast:2 row_mask:0xf bank_mask:0xf
    v_mul_f32_dpp v226, v105, v109 row_newbcast:2 row_mask:0xf bank_mask:0xf
    v_mul_f32_dpp v219, v104, v109 row_newbcast:3 row_mask:0xf bank_mask:0xf
    v_mul_f32_dpp v227, v105, v109 row_newbcast:3 row_mask:0xf bank_mask:0xf
    v_exp_f32 v216, v216
    v_fract_f32 v224, v224
    v_exp_f32 v217, v217
    v_fract_f32 v225, v225
    v_exp_f32 v218, v218
    v_fract_f32 v226, v226
    v_exp_f32 v219, v219
    v_fract_f32 v227, v227
    v_sin_f32 v220, v224
    v_cos_f32 v224, v224
    v_sin_f32 v221, v225
    v_cos_f32 v225, v225
    v_sin_f32 v222, v226
    v_cos_f32 v226, v226
    v_sin_f32 v223, v227
    v_cos_f32 v227, v227
    v_fma_mixlo_f16 v244, v216, v224, 0
    v_fma_mixlo_f16 v245, v217, v225, 0
    v_fma_mixlo_f16 v246, v218, v226, 0
    v_fma_mixlo_f16 v247, v219, v227, 0
    v_fma_mixhi_f16 v244, v216, v220, 0
    v_fma_mixhi_f16 v245, v217, v221, 0
    v_fma_mixhi_f16 v246, v218, v222, 0
    v_fma_mixhi_f16 v247, v219, v223, 0
    s_nop 1
    v_mfma_f32_16x16x32_f16 v[96:99], v[244:247], v[236:239], 0
    v_mul_f32_dpp v216, v104, v110 row_newbcast:0 row_mask:0xf bank_mask:0xf
    v_mul_f32_dpp v224, v105, v110 row_newbcast:0 row_mask:0xf bank_mask:0xf
    v_mul_f32_dpp v217, v104, v110 row_newbcast:1 row_mask:0xf bank_mask:0xf
    v_mul_f32_dpp v225, v105, v110 row_newbcast:1 row_mask:0xf bank_mask:0xf
    v_mul_f32_dpp v218, v104, v110 row_newbcast:2 row_mask:0xf bank_mask:0xf
    v_mul_f32_dpp v226, v105, v110 row_newbcast:2 row_mask:0xf bank_mask:0xf
    v_mul_f32_dpp v219, v104, v110 row_newbcast:3 row_mask:0xf bank_mask:0xf
    v_mul_f32_dpp v227, v105, v110 row_newbcast:3 row_mask:0xf bank_mask:0xf
    v_exp_f32 v216, v216
    v_fract_f32 v224, v224
    v_exp_f32 v217, v217
    v_fract_f32 v225, v225
    v_exp_f32 v218, v218
    v_fract_f32 v226, v226
    v_exp_f32 v219, v219
    v_fract_f32 v227, v227
    v_sin_f32 v220, v224
    v_cos_f32 v224, v224
    v_sin_f32 v221, v225
    v_cos_f32 v225, v225
    v_sin_f32 v222, v226
    v_cos_f32 v226, v226
    v_sin_f32 v223, v227
    v_cos_f32 v227, v227
    v_fma_mixlo_f16 v240, v216, v224, 0
    v_fma_mixlo_f16 v241, v217, v225, 0
    v_fma_mixlo_f16 v242, v218, v226, 0
    v_fma_mixlo_f16 v243, v219, v227, 0
    v_fma_mixhi_f16 v240, v216, v220, 0
    v_fma_mixhi_f16 v241, v217, v221, 0
    v_fma_mixhi_f16 v242, v218, v222, 0
    v_fma_mixhi_f16 v243, v219, v223, 0
    s_nop 1
    v_mfma_f32_16x16x32_f16 v[100:103], v[240:243], v[236:239], 0
    s_lshl_b32 s56, s66, 16
    s_and_b32 s57, s66, 0xffff0000
    s_lshl_b32 s58, s67, 16
    s_and_b32 s59, s67, 0xffff0000
    s_waitcnt vmcnt(14)
    s_barrier
    ds_read_b64_tr_b16 v[120:121], v14 offset:0
    ds_read_b64_tr_b16 v[122:123], v14 offset:3072
    ds_read_b64_tr_b16 v[124:125], v14 offset:1024
    ds_read_b64_tr_b16 v[126:127], v14 offset:4096
    ds_read_b64_tr_b16 v[128:129], v14 offset:12288
    ds_read_b64_tr_b16 v[130:131], v14 offset:15360
    ds_read_b64_tr_b16 v[132:133], v14 offset:13312
    ds_read_b64_tr_b16 v[134:135], v14 offset:16384
    ds_read_b128 v[52:55], v2 offset:0
    v_mul_f32_dpp v216, v104, v111 row_newbcast:4 row_mask:0xf bank_mask:0xf
    v_mul_f32_dpp v224, v105, v111 row_newbcast:4 row_mask:0xf bank_mask:0xf
    ds_read_b128 v[56:59], v2 offset:16384
    v_mul_f32_dpp v217, v104, v111 row_newbcast:5 row_mask:0xf bank_mask:0xf
    v_mul_f32_dpp v225, v105, v111 row_newbcast:5 row_mask:0xf bank_mask:0xf
    ds_read_b128 v[60:63], v2 offset:32768
    v_mul_f32_dpp v218, v104, v111 row_newbcast:6 row_mask:0xf bank_mask:0xf
    v_mul_f32_dpp v226, v105, v111 row_newbcast:6 row_mask:0xf bank_mask:0xf
    ds_read_b128 v[64:67], v2 offset:49152
    v_mul_f32_dpp v219, v104, v111 row_newbcast:7 row_mask:0xf bank_mask:0xf
    v_mul_f32_dpp v227, v105, v111 row_newbcast:7 row_mask:0xf bank_mask:0xf
    ds_read_b128 v[68:71], v3 offset:0
    v_exp_f32 v216, v216
    v_fract_f32 v224, v224
    s_waitcnt lgkmcnt(4)
    v_mfma_f32_16x16x32_bf16 v[16:19], v[124:127], v[52:55], 0
    v_exp_f32 v217, v217
    v_fract_f32 v225, v225
    v_mfma_f32_16x16x32_bf16 v[248:251], v[120:123], v[52:55], 0
    v_exp_f32 v218, v218
    v_fract_f32 v226, v226
    ds_read_b128 v[72:75], v10 offset:0
    v_exp_f32 v219, v219
    v_fract_f32 v227, v227
    s_waitcnt lgkmcnt(4)
    v_mfma_f32_16x16x32_bf16 v[20:23], v[124:127], v[56:59], 0
    v_sin_f32 v220, v224
    v_cos_f32 v224, v224
    ds_read_b128 v[76:79], v10 offset:16384
    v_sin_f32 v221, v225
    v_cos_f32 v225, v225
    v_mfma_f32_16x16x32_bf16 v[36:39], v[120:123], v[56:59], 0
    v_sin_f32 v222, v226
    v_cos_f32 v226, v226
    ds_read_b128 v[80:83], v10 offset:32768
    v_sin_f32 v223, v227
    v_cos_f32 v227, v227
    s_waitcnt lgkmcnt(5)
    v_mfma_f32_16x16x32_bf16 v[24:27], v[124:127], v[60:63], 0
    v_mul_f32_dpp v228, v106, v216 row_newbcast:4 row_mask:0xf bank_mask:0xf
    v_mul_f32_dpp v232, v107, v216 row_newbcast:4 row_mask:0xf bank_mask:0xf
    ds_read_b128 v[84:87], v10 offset:49152
    v_mul_f32_dpp v229, v106, v217 row_newbcast:5 row_mask:0xf bank_mask:0xf
    v_mul_f32_dpp v233, v107, v217 row_newbcast:5 row_mask:0xf bank_mask:0xf
    v_mfma_f32_16x16x32_bf16 v[40:43], v[120:123], v[60:63], 0
    v_mul_f32_dpp v230, v106, v218 row_newbcast:6 row_mask:0xf bank_mask:0xf
    v_mul_f32_dpp v234, v107, v218 row_newbcast:6 row_mask:0xf bank_mask:0xf
    ds_read_b128 v[88:91], v11 offset:0
    v_mul_f32_dpp v231, v106, v219 row_newbcast:7 row_mask:0xf bank_mask:0xf
    v_mul_f32_dpp v235, v107, v219 row_newbcast:7 row_mask:0xf bank_mask:0xf
    s_waitcnt lgkmcnt(6)
    v_mfma_f32_16x16x32_bf16 v[28:31], v[124:127], v[64:67], 0
    v_mul_f32 v216, v232, v220
    v_mul_f32 v232, v232, v224
    v_mfma_f32_16x16x32_bf16 v[44:47], v[120:123], v[64:67], 0
    v_mul_f32 v217, v233, v221
    v_mul_f32 v233, v233, v225
    s_waitcnt lgkmcnt(5)
    v_mfma_f32_16x16x32_bf16 v[32:35], v[124:127], v[68:71], 0
    v_mul_f32 v218, v234, v222
    v_mfma_f32_16x16x32_bf16 v[48:51], v[120:123], v[68:71], 0
    v_mul_f32 v234, v234, v226
    s_waitcnt lgkmcnt(4)
    v_mfma_f32_16x16x32_bf16 v[16:19], v[132:135], v[72:75], v[16:19]
    v_mul_f32 v219, v235, v223
    v_mfma_f32_16x16x32_bf16 v[248:251], v[128:131], v[72:75], v[248:251]
    v_mul_f32 v235, v235, v227
    s_waitcnt lgkmcnt(3)
    v_mfma_f32_16x16x32_bf16 v[20:23], v[132:135], v[76:79], v[20:23]
    v_fma_mixlo_f16 v236, v228, v224, -v216
    v_mfma_f32_16x16x32_bf16 v[36:39], v[128:131], v[76:79], v[36:39]
    v_fma_mixlo_f16 v237, v229, v225, -v217
    s_waitcnt lgkmcnt(2)
    v_mfma_f32_16x16x32_bf16 v[24:27], v[132:135], v[80:83], v[24:27]
    v_fma_mixlo_f16 v238, v230, v226, -v218
    v_mfma_f32_16x16x32_bf16 v[40:43], v[128:131], v[80:83], v[40:43]
    v_fma_mixlo_f16 v239, v231, v227, -v219
    s_waitcnt lgkmcnt(1)
    v_mfma_f32_16x16x32_bf16 v[28:31], v[132:135], v[84:87], v[28:31]
    v_fma_mixhi_f16 v236, -v228, v220, -v232
    v_mfma_f32_16x16x32_bf16 v[44:47], v[128:131], v[84:87], v[44:47]
    v_fma_mixhi_f16 v237, -v229, v221, -v233
    s_waitcnt lgkmcnt(0)
    v_mfma_f32_16x16x32_bf16 v[32:35], v[132:135], v[88:91], v[32:35]
    v_fma_mixhi_f16 v238, -v230, v222, -v234
    v_mfma_f32_16x16x32_bf16 v[48:51], v[128:131], v[88:91], v[48:51]
    v_fma_mixhi_f16 v239, -v231, v223, -v235
    s_waitcnt vmcnt(8)
    s_barrier
    ds_read_b64_tr_b16 v[136:137], v14 offset:24576
    ds_read_b64_tr_b16 v[138:139], v14 offset:27648
    ds_read_b64_tr_b16 v[140:141], v14 offset:25600
    ds_read_b64_tr_b16 v[142:143], v14 offset:28672
    ds_read_b64_tr_b16 v[144:145], v14 offset:36864
    ds_read_b64_tr_b16 v[146:147], v14 offset:39936
    ds_read_b64_tr_b16 v[148:149], v14 offset:37888
    ds_read_b64_tr_b16 v[150:151], v14 offset:40960
    s_lshl_b32 s38, s30, 3
    s_add_u32 s38, s38, s31
    v_mov_b32 v8, 1
    s_cmp_eq_u32 s28, 0
    s_cselect_b64 exec, 1, 0
    buffer_store_byte v8, off, s[24:27], s38 sc1
    s_mov_b64 exec, -1
    ds_read_b128 v[52:55], v2 offset:2048
    v_mul_f32_dpp v216, v104, v108 row_newbcast:4 row_mask:0xf bank_mask:0xf
    v_mul_f32_dpp v224, v105, v108 row_newbcast:4 row_mask:0xf bank_mask:0xf
    ds_read_b128 v[56:59], v2 offset:18432
    v_mul_f32_dpp v217, v104, v108 row_newbcast:5 row_mask:0xf bank_mask:0xf
    v_mul_f32_dpp v225, v105, v108 row_newbcast:5 row_mask:0xf bank_mask:0xf
    ds_read_b128 v[60:63], v2 offset:34816
    v_mul_f32_dpp v218, v104, v108 row_newbcast:6 row_mask:0xf bank_mask:0xf
    v_mul_f32_dpp v226, v105, v108 row_newbcast:6 row_mask:0xf bank_mask:0xf
    ds_read_b128 v[64:67], v2 offset:51200
    v_mul_f32_dpp v219, v104, v108 row_newbcast:7 row_mask:0xf bank_mask:0xf
    ds_read_b128 v[68:71], v3 offset:2048
    v_mul_f32_dpp v227, v105, v108 row_newbcast:7 row_mask:0xf bank_mask:0xf
    s_waitcnt lgkmcnt(4)
    v_mfma_f32_16x16x32_bf16 v[16:19], v[140:143], v[52:55], v[16:19]
    v_exp_f32 v216, v216
    v_mfma_f32_16x16x32_bf16 v[248:251], v[136:139], v[52:55], v[248:251]
    v_fract_f32 v224, v224
    ds_read_b128 v[72:75], v10 offset:2048
    v_exp_f32 v217, v217
    s_waitcnt lgkmcnt(4)
    v_mfma_f32_16x16x32_bf16 v[20:23], v[140:143], v[56:59], v[20:23]
    v_fract_f32 v225, v225
    ds_read_b128 v[76:79], v10 offset:18432
    v_exp_f32 v218, v218
    v_mfma_f32_16x16x32_bf16 v[36:39], v[136:139], v[56:59], v[36:39]
    v_fract_f32 v226, v226
    ds_read_b128 v[80:83], v10 offset:34816
    v_exp_f32 v219, v219
    s_waitcnt lgkmcnt(5)
    v_mfma_f32_16x16x32_bf16 v[24:27], v[140:143], v[60:63], v[24:27]
    v_fract_f32 v227, v227
    ds_read_b128 v[84:87], v10 offset:51200
    v_sin_f32 v220, v224
    v_mfma_f32_16x16x32_bf16 v[40:43], v[136:139], v[60:63], v[40:43]
    v_cos_f32 v224, v224
    ds_read_b128 v[88:91], v11 offset:2048
    v_sin_f32 v221, v225
    s_waitcnt lgkmcnt(6)
    v_mfma_f32_16x16x32_bf16 v[28:31], v[140:143], v[64:67], v[28:31]
    v_cos_f32 v225, v225
    v_mfma_f32_16x16x32_bf16 v[44:47], v[136:139], v[64:67], v[44:47]
    v_sin_f32 v222, v226
    s_waitcnt lgkmcnt(5)
    v_mfma_f32_16x16x32_bf16 v[32:35], v[140:143], v[68:71], v[32:35]
    v_cos_f32 v226, v226
    v_mfma_f32_16x16x32_bf16 v[48:51], v[136:139], v[68:71], v[48:51]
    v_sin_f32 v223, v227
    s_waitcnt lgkmcnt(4)
    v_mfma_f32_16x16x32_bf16 v[16:19], v[148:151], v[72:75], v[16:19]
    v_cos_f32 v227, v227
    v_mfma_f32_16x16x32_bf16 v[248:251], v[144:147], v[72:75], v[248:251]
    v_fma_mixlo_f16 v240, v216, v224, 0
    s_waitcnt lgkmcnt(3)
    v_mfma_f32_16x16x32_bf16 v[20:23], v[148:151], v[76:79], v[20:23]
    v_fma_mixlo_f16 v241, v217, v225, 0
    v_mfma_f32_16x16x32_bf16 v[36:39], v[144:147], v[76:79], v[36:39]
    v_fma_mixlo_f16 v242, v218, v226, 0
    s_waitcnt lgkmcnt(2)
    v_mfma_f32_16x16x32_bf16 v[24:27], v[148:151], v[80:83], v[24:27]
    v_fma_mixlo_f16 v243, v219, v227, 0
    v_mfma_f32_16x16x32_bf16 v[40:43], v[144:147], v[80:83], v[40:43]
    v_fma_mixhi_f16 v240, v216, v220, 0
    s_waitcnt lgkmcnt(1)
    v_mfma_f32_16x16x32_bf16 v[28:31], v[148:151], v[84:87], v[28:31]
    v_fma_mixhi_f16 v241, v217, v221, 0
    v_mfma_f32_16x16x32_bf16 v[44:47], v[144:147], v[84:87], v[44:47]
    v_fma_mixhi_f16 v242, v218, v222, 0
    s_waitcnt lgkmcnt(0)
    v_mfma_f32_16x16x32_bf16 v[32:35], v[148:151], v[88:91], v[32:35]
    v_fma_mixhi_f16 v243, v219, v223, 0
    v_mfma_f32_16x16x32_bf16 v[48:51], v[144:147], v[88:91], v[48:51]
    s_nop 0
    v_mfma_f32_16x16x32_f16 v[92:95], v[240:243], v[236:239], v[92:95]
    s_waitcnt vmcnt(6)
    s_barrier
    ds_read_b64_tr_b16 v[152:153], v15 offset:0
    ds_read_b64_tr_b16 v[154:155], v15 offset:3072
    ds_read_b64_tr_b16 v[156:157], v15 offset:1024
    ds_read_b64_tr_b16 v[158:159], v15 offset:4096
    ds_read_b64_tr_b16 v[160:161], v15 offset:12288
    ds_read_b64_tr_b16 v[162:163], v15 offset:15360
    ds_read_b64_tr_b16 v[164:165], v15 offset:13312
    ds_read_b64_tr_b16 v[166:167], v15 offset:16384
    ds_read_b128 v[52:55], v2 offset:4096
    v_mul_f32_dpp v216, v104, v109 row_newbcast:4 row_mask:0xf bank_mask:0xf
    v_mul_f32_dpp v224, v105, v109 row_newbcast:4 row_mask:0xf bank_mask:0xf
    ds_read_b128 v[56:59], v2 offset:20480
    v_mul_f32_dpp v217, v104, v109 row_newbcast:5 row_mask:0xf bank_mask:0xf
    v_mul_f32_dpp v225, v105, v109 row_newbcast:5 row_mask:0xf bank_mask:0xf
    ds_read_b128 v[60:63], v2 offset:36864
    v_mul_f32_dpp v218, v104, v109 row_newbcast:6 row_mask:0xf bank_mask:0xf
    v_mul_f32_dpp v226, v105, v109 row_newbcast:6 row_mask:0xf bank_mask:0xf
    ds_read_b128 v[64:67], v2 offset:53248
    v_mul_f32_dpp v219, v104, v109 row_newbcast:7 row_mask:0xf bank_mask:0xf
    ds_read_b128 v[68:71], v3 offset:4096
    v_mul_f32_dpp v227, v105, v109 row_newbcast:7 row_mask:0xf bank_mask:0xf
    s_waitcnt lgkmcnt(4)
    v_mfma_f32_16x16x32_bf16 v[16:19], v[156:159], v[52:55], v[16:19]
    v_exp_f32 v216, v216
    v_mfma_f32_16x16x32_bf16 v[248:251], v[152:155], v[52:55], v[248:251]
    v_fract_f32 v224, v224
    ds_read_b128 v[72:75], v10 offset:4096
    v_exp_f32 v217, v217
    s_waitcnt lgkmcnt(4)
    v_mfma_f32_16x16x32_bf16 v[20:23], v[156:159], v[56:59], v[20:23]
    v_fract_f32 v225, v225
    ds_read_b128 v[76:79], v10 offset:20480
    v_exp_f32 v218, v218
    v_mfma_f32_16x16x32_bf16 v[36:39], v[152:155], v[56:59], v[36:39]
    v_fract_f32 v226, v226
    ds_read_b128 v[80:83], v10 offset:36864
    v_exp_f32 v219, v219
    s_waitcnt lgkmcnt(5)
    v_mfma_f32_16x16x32_bf16 v[24:27], v[156:159], v[60:63], v[24:27]
    v_fract_f32 v227, v227
    ds_read_b128 v[84:87], v10 offset:53248
    v_sin_f32 v220, v224
    v_mfma_f32_16x16x32_bf16 v[40:43], v[152:155], v[60:63], v[40:43]
    v_cos_f32 v224, v224
    ds_read_b128 v[88:91], v11 offset:4096
    v_sin_f32 v221, v225
    s_waitcnt lgkmcnt(6)
    v_mfma_f32_16x16x32_bf16 v[28:31], v[156:159], v[64:67], v[28:31]
    v_cos_f32 v225, v225
    v_mfma_f32_16x16x32_bf16 v[44:47], v[152:155], v[64:67], v[44:47]
    v_sin_f32 v222, v226
    s_waitcnt lgkmcnt(5)
    v_mfma_f32_16x16x32_bf16 v[32:35], v[156:159], v[68:71], v[32:35]
    v_cos_f32 v226, v226
    v_mfma_f32_16x16x32_bf16 v[48:51], v[152:155], v[68:71], v[48:51]
    v_sin_f32 v223, v227
    s_waitcnt lgkmcnt(4)
    v_mfma_f32_16x16x32_bf16 v[16:19], v[164:167], v[72:75], v[16:19]
    v_cos_f32 v227, v227
    v_mfma_f32_16x16x32_bf16 v[248:251], v[160:163], v[72:75], v[248:251]
    v_fma_mixlo_f16 v244, v216, v224, 0
    s_waitcnt lgkmcnt(3)
    v_mfma_f32_16x16x32_bf16 v[20:23], v[164:167], v[76:79], v[20:23]
    v_fma_mixlo_f16 v245, v217, v225, 0
    v_mfma_f32_16x16x32_bf16 v[36:39], v[160:163], v[76:79], v[36:39]
    v_fma_mixlo_f16 v246, v218, v226, 0
    s_waitcnt lgkmcnt(2)
    v_mfma_f32_16x16x32_bf16 v[24:27], v[164:167], v[80:83], v[24:27]
    v_fma_mixlo_f16 v247, v219, v227, 0
    v_mfma_f32_16x16x32_bf16 v[40:43], v[160:163], v[80:83], v[40:43]
    v_fma_mixhi_f16 v244, v216, v220, 0
    s_waitcnt lgkmcnt(1)
    v_mfma_f32_16x16x32_bf16 v[28:31], v[164:167], v[84:87], v[28:31]
    v_fma_mixhi_f16 v245, v217, v221, 0
    v_mfma_f32_16x16x32_bf16 v[44:47], v[160:163], v[84:87], v[44:47]
    v_fma_mixhi_f16 v246, v218, v222, 0
    s_waitcnt lgkmcnt(0)
    v_mfma_f32_16x16x32_bf16 v[32:35], v[164:167], v[88:91], v[32:35]
    v_fma_mixhi_f16 v247, v219, v223, 0
    v_mfma_f32_16x16x32_bf16 v[48:51], v[160:163], v[88:91], v[48:51]
    s_nop 0
    v_mfma_f32_16x16x32_f16 v[96:99], v[244:247], v[236:239], v[96:99]
    s_barrier
    ds_read_b64_tr_b16 v[168:169], v14 offset:0
    ds_read_b64_tr_b16 v[170:171], v14 offset:3072
    ds_read_b64_tr_b16 v[172:173], v14 offset:1024
    ds_read_b64_tr_b16 v[174:175], v14 offset:4096
    ds_read_b64_tr_b16 v[176:177], v14 offset:12288
    ds_read_b64_tr_b16 v[178:179], v14 offset:15360
    ds_read_b64_tr_b16 v[180:181], v14 offset:13312
    ds_read_b64_tr_b16 v[182:183], v14 offset:16384
    ds_read_b128 v[52:55], v2 offset:6144
    v_mul_f32_dpp v216, v104, v110 row_newbcast:4 row_mask:0xf bank_mask:0xf
    v_mul_f32_dpp v224, v105, v110 row_newbcast:4 row_mask:0xf bank_mask:0xf
    ds_read_b128 v[56:59], v2 offset:22528
    v_mul_f32_dpp v217, v104, v110 row_newbcast:5 row_mask:0xf bank_mask:0xf
    v_mul_f32_dpp v225, v105, v110 row_newbcast:5 row_mask:0xf bank_mask:0xf
    ds_read_b128 v[60:63], v2 offset:38912
    v_mul_f32_dpp v218, v104, v110 row_newbcast:6 row_mask:0xf bank_mask:0xf
    v_mul_f32_dpp v226, v105, v110 row_newbcast:6 row_mask:0xf bank_mask:0xf
    ds_read_b128 v[64:67], v2 offset:55296
    v_mul_f32_dpp v219, v104, v110 row_newbcast:7 row_mask:0xf bank_mask:0xf
    ds_read_b128 v[68:71], v3 offset:6144
    v_mul_f32_dpp v227, v105, v110 row_newbcast:7 row_mask:0xf bank_mask:0xf
    s_waitcnt lgkmcnt(4)
    v_mfma_f32_16x16x32_bf16 v[16:19], v[172:175], v[52:55], v[16:19]
    v_exp_f32 v216, v216
    v_mfma_f32_16x16x32_bf16 v[248:251], v[168:171], v[52:55], v[248:251]
    v_fract_f32 v224, v224
    ds_read_b128 v[72:75], v10 offset:6144
    v_exp_f32 v217, v217
    s_waitcnt lgkmcnt(4)
    v_mfma_f32_16x16x32_bf16 v[20:23], v[172:175], v[56:59], v[20:23]
    v_fract_f32 v225, v225
    ds_read_b128 v[76:79], v10 offset:22528
    v_exp_f32 v218, v218
    v_mfma_f32_16x16x32_bf16 v[36:39], v[168:171], v[56:59], v[36:39]
    v_fract_f32 v226, v226
    ds_read_b128 v[80:83], v10 offset:38912
    v_exp_f32 v219, v219
    s_waitcnt lgkmcnt(5)
    v_mfma_f32_16x16x32_bf16 v[24:27], v[172:175], v[60:63], v[24:27]
    v_fract_f32 v227, v227
    ds_read_b128 v[84:87], v10 offset:55296
    v_sin_f32 v220, v224
    v_mfma_f32_16x16x32_bf16 v[40:43], v[168:171], v[60:63], v[40:43]
    v_cos_f32 v224, v224
    ds_read_b128 v[88:91], v11 offset:6144
    v_sin_f32 v221, v225
    s_waitcnt lgkmcnt(6)
    v_mfma_f32_16x16x32_bf16 v[28:31], v[172:175], v[64:67], v[28:31]
    v_cos_f32 v225, v225
    v_mfma_f32_16x16x32_bf16 v[44:47], v[168:171], v[64:67], v[44:47]
    v_sin_f32 v222, v226
    s_waitcnt lgkmcnt(5)
    v_mfma_f32_16x16x32_bf16 v[32:35], v[172:175], v[68:71], v[32:35]
    v_cos_f32 v226, v226
    v_mfma_f32_16x16x32_bf16 v[48:51], v[168:171], v[68:71], v[48:51]
    v_sin_f32 v223, v227
    s_waitcnt lgkmcnt(4)
    v_mfma_f32_16x16x32_bf16 v[16:19], v[180:183], v[72:75], v[16:19]
    v_cos_f32 v227, v227
    v_mfma_f32_16x16x32_bf16 v[248:251], v[176:179], v[72:75], v[248:251]
    v_fma_mixlo_f16 v240, v216, v224, 0
    s_waitcnt lgkmcnt(3)
    v_mfma_f32_16x16x32_bf16 v[20:23], v[180:183], v[76:79], v[20:23]
    v_fma_mixlo_f16 v241, v217, v225, 0
    v_mfma_f32_16x16x32_bf16 v[36:39], v[176:179], v[76:79], v[36:39]
    v_fma_mixlo_f16 v242, v218, v226, 0
    s_waitcnt lgkmcnt(2)
    v_mfma_f32_16x16x32_bf16 v[24:27], v[180:183], v[80:83], v[24:27]
    v_fma_mixlo_f16 v243, v219, v227, 0
    v_mfma_f32_16x16x32_bf16 v[40:43], v[176:179], v[80:83], v[40:43]
    v_fma_mixhi_f16 v240, v216, v220, 0
    s_waitcnt lgkmcnt(1)
    v_mfma_f32_16x16x32_bf16 v[28:31], v[180:183], v[84:87], v[28:31]
    v_fma_mixhi_f16 v241, v217, v221, 0
    v_mfma_f32_16x16x32_bf16 v[44:47], v[176:179], v[84:87], v[44:47]
    v_fma_mixhi_f16 v242, v218, v222, 0
    s_waitcnt lgkmcnt(0)
    v_mfma_f32_16x16x32_bf16 v[32:35], v[180:183], v[88:91], v[32:35]
    v_fma_mixhi_f16 v243, v219, v223, 0
    v_mfma_f32_16x16x32_bf16 v[48:51], v[176:179], v[88:91], v[48:51]
    s_nop 0
    v_mfma_f32_16x16x32_f16 v[100:103], v[240:243], v[236:239], v[100:103]
    s_waitcnt vmcnt(1)
    s_barrier
    ds_read_b64_tr_b16 v[184:185], v14 offset:24576
    ds_read_b64_tr_b16 v[186:187], v14 offset:27648
    ds_read_b64_tr_b16 v[188:189], v14 offset:25600
    ds_read_b64_tr_b16 v[190:191], v14 offset:28672
    ds_read_b64_tr_b16 v[192:193], v14 offset:36864
    ds_read_b64_tr_b16 v[194:195], v14 offset:39936
    ds_read_b64_tr_b16 v[196:197], v14 offset:37888
    ds_read_b64_tr_b16 v[198:199], v14 offset:40960
    ds_read_b128 v[52:55], v2 offset:8192
    v_lshrrev_b32 v228, 4, v1
    v_and_b32 v229, 15, v1
    ds_read_b128 v[56:59], v2 offset:24576
    v_lshrrev_b32 v230, 5, v1
    v_and_b32 v231, 1, v228
    ds_read_b128 v[60:63], v2 offset:40960
    v_lshl_add_u32 v230, v230, 5, v231
    v_lshlrev_b32 v230, 2, v230
    ds_read_b128 v[64:67], v2 offset:57344
    v_lshl_add_u32 v230, v229, 3, v230
    s_mul_i32 s46, s28, 2624
    ds_read_b128 v[68:71], v3 offset:8192
    s_add_u32 s46, s46, 131072
    v_cvt_f32_u32 v216, v230
    s_waitcnt lgkmcnt(4)
    v_mfma_f32_16x16x32_bf16 v[16:19], v[188:191], v[52:55], v[16:19]
    v_lshl_add_u32 v108, v230, 2, s46
    v_lshlrev_b32 v230, 7, v228
    v_mfma_f32_16x16x32_bf16 v[248:251], v[184:187], v[52:55], v[248:251]
    v_add_u32 v230, 256, v230
    v_lshlrev_b32 v231, 8, v228
    ds_read_b128 v[72:75], v10 offset:8192
    v_max_u32 v230, v230, v231
    v_cvt_f32_u32 v220, v230
    s_waitcnt lgkmcnt(4)
    v_mfma_f32_16x16x32_bf16 v[20:23], v[188:191], v[56:59], v[20:23]
    v_add_f32 v220, v220, v111
    v_lshlrev_b32 v230, 9, v228
    ds_read_b128 v[76:79], v10 offset:24576
    v_add_u32 v230, 1024, v230
    v_cvt_f32_u32 v224, v230
    v_mfma_f32_16x16x32_bf16 v[36:39], v[184:187], v[56:59], v[36:39]
    v_add_f32 v224, v224, v111
    v_cmp_gt_u32 s[44:45], 32, v1
    ds_read_b128 v[80:83], v10 offset:40960
    s_mov_b32 s47, 0x43000000
    v_mov_b32 v232, 4.0
    s_waitcnt lgkmcnt(5)
    v_mfma_f32_16x16x32_bf16 v[24:27], v[188:191], v[60:63], v[24:27]
    v_mov_b32 v233, s47
    v_cndmask_b32 v233, v233, v232, s[44:45]
    ds_read_b128 v[84:87], v10 offset:57344
    v_cndmask_b32 v232, v232, 2.0, s[44:45]
    v_add_u32 v110, s46, v231
    v_mfma_f32_16x16x32_bf16 v[40:43], v[184:187], v[60:63], v[40:43]
    v_lshlrev_b32 v230, 3, v229
    v_lshlrev_b32 v234, 4, v229
    ds_read_b128 v[88:91], v11 offset:8192
    v_cndmask_b32 v230, v230, v234, s[44:45]
    v_add_u32 v109, v110, v230
    s_waitcnt lgkmcnt(6)
    v_mfma_f32_16x16x32_bf16 v[28:31], v[188:191], v[64:67], v[28:31]
    v_mov_b32 v234, 128
    v_cndmask_b32 v234, v234, 8, s[44:45]
    v_mfma_f32_16x16x32_bf16 v[44:47], v[184:187], v[64:67], v[44:47]
    v_add_u32 v105, v109, v234
    v_lshl_add_u32 v110, v229, 2, v110
    s_waitcnt lgkmcnt(5)
    v_mfma_f32_16x16x32_bf16 v[32:35], v[188:191], v[68:71], v[32:35]
    v_mul_f32 v234, s47, v112
    v_fma_f32 v216, v216, v112, v113
    v_mfma_f32_16x16x32_bf16 v[48:51], v[184:187], v[68:71], v[48:51]
    v_fma_f32 v220, v220, v112, v113
    s_waitcnt lgkmcnt(4)
    v_mfma_f32_16x16x32_bf16 v[16:19], v[196:199], v[72:75], v[16:19]
    v_fma_f32 v224, v224, v112, v113
    v_mfma_f32_16x16x32_bf16 v[248:251], v[192:195], v[72:75], v[248:251]
    v_add_f32 v217, v216, v112
    s_waitcnt lgkmcnt(3)
    v_mfma_f32_16x16x32_bf16 v[20:23], v[196:199], v[76:79], v[20:23]
    v_fma_f32 v218, 2.0, v112, v216
    v_mfma_f32_16x16x32_bf16 v[36:39], v[192:195], v[76:79], v[36:39]
    v_fma_f32 v221, v232, v112, v220
    s_waitcnt lgkmcnt(2)
    v_mfma_f32_16x16x32_bf16 v[24:27], v[196:199], v[80:83], v[24:27]
    v_fma_f32 v222, v233, v112, v220
    v_mfma_f32_16x16x32_bf16 v[40:43], v[192:195], v[80:83], v[40:43]
    v_add_f32 v225, v224, v234
    s_waitcnt lgkmcnt(1)
    v_mfma_f32_16x16x32_bf16 v[28:31], v[196:199], v[84:87], v[28:31]
    v_fma_f32 v226, 2.0, v234, v224
    v_mfma_f32_16x16x32_bf16 v[44:47], v[192:195], v[84:87], v[44:47]
    v_add_f32 v219, v218, v112
    s_waitcnt lgkmcnt(0)
    v_mfma_f32_16x16x32_bf16 v[32:35], v[196:199], v[88:91], v[32:35]
    v_fma_f32 v223, v232, v112, v222
    v_mfma_f32_16x16x32_bf16 v[48:51], v[192:195], v[88:91], v[48:51]
    v_add_f32 v227, v226, v234
    s_barrier
    ds_read_b64_tr_b16 v[200:201], v15 offset:0
    ds_read_b64_tr_b16 v[202:203], v15 offset:3072
    ds_read_b64_tr_b16 v[204:205], v15 offset:1024
    ds_read_b64_tr_b16 v[206:207], v15 offset:4096
    ds_read_b64_tr_b16 v[208:209], v15 offset:12288
    ds_read_b64_tr_b16 v[210:211], v15 offset:15360
    ds_read_b64_tr_b16 v[212:213], v15 offset:13312
    ds_read_b64_tr_b16 v[214:215], v15 offset:16384
    ds_read_b128 v[52:55], v2 offset:10240
    v_exp_f32 v216, v216
    ds_read_b128 v[56:59], v2 offset:26624
    v_exp_f32 v217, v217
    ds_read_b128 v[60:63], v2 offset:43008
    v_exp_f32 v218, v218
    ds_read_b128 v[64:67], v2 offset:59392
    v_exp_f32 v219, v219
    ds_read_b128 v[68:71], v3 offset:10240
    v_exp_f32 v220, v220
    s_waitcnt lgkmcnt(4)
    v_mfma_f32_16x16x32_bf16 v[16:19], v[204:207], v[52:55], v[16:19]
    v_exp_f32 v221, v221
    v_mfma_f32_16x16x32_bf16 v[248:251], v[200:203], v[52:55], v[248:251]
    v_exp_f32 v222, v222
    ds_read_b128 v[72:75], v10 offset:10240
    v_exp_f32 v223, v223
    s_waitcnt lgkmcnt(4)
    v_mfma_f32_16x16x32_bf16 v[20:23], v[204:207], v[56:59], v[20:23]
    v_exp_f32 v224, v224
    ds_read_b128 v[76:79], v10 offset:26624
    v_exp_f32 v225, v225
    v_mfma_f32_16x16x32_bf16 v[36:39], v[200:203], v[56:59], v[36:39]
    v_exp_f32 v226, v226
    ds_read_b128 v[80:83], v10 offset:43008
    v_exp_f32 v227, v227
    s_waitcnt lgkmcnt(5)
    v_mfma_f32_16x16x32_bf16 v[24:27], v[204:207], v[60:63], v[24:27]
    v_mul_f32 v92, v92, v216
    ds_read_b128 v[84:87], v10 offset:59392
    v_mul_f32 v93, v93, v217
    v_mfma_f32_16x16x32_bf16 v[40:43], v[200:203], v[60:63], v[40:43]
    v_mul_f32 v94, v94, v218
    ds_read_b128 v[88:91], v11 offset:10240
    v_mul_f32 v95, v95, v219
    s_waitcnt lgkmcnt(6)
    v_mfma_f32_16x16x32_bf16 v[28:31], v[204:207], v[64:67], v[28:31]
    v_mul_f32 v96, v96, v220
    v_mfma_f32_16x16x32_bf16 v[44:47], v[200:203], v[64:67], v[44:47]
    v_mul_f32 v97, v97, v221
    s_waitcnt lgkmcnt(5)
    v_mfma_f32_16x16x32_bf16 v[32:35], v[204:207], v[68:71], v[32:35]
    v_mul_f32 v98, v98, v222
    v_mfma_f32_16x16x32_bf16 v[48:51], v[200:203], v[68:71], v[48:51]
    v_mul_f32 v99, v99, v223
    s_waitcnt lgkmcnt(4)
    v_mfma_f32_16x16x32_bf16 v[16:19], v[212:215], v[72:75], v[16:19]
    v_mul_f32 v100, v100, v224
    v_mfma_f32_16x16x32_bf16 v[248:251], v[208:211], v[72:75], v[248:251]
    v_mul_f32 v101, v101, v225
    s_waitcnt lgkmcnt(3)
    v_mfma_f32_16x16x32_bf16 v[20:23], v[212:215], v[76:79], v[20:23]
    v_mul_f32 v102, v102, v226
    v_mfma_f32_16x16x32_bf16 v[36:39], v[208:211], v[76:79], v[36:39]
    v_mul_f32 v103, v103, v227
    s_waitcnt lgkmcnt(2)
    v_mfma_f32_16x16x32_bf16 v[24:27], v[212:215], v[80:83], v[24:27]
    v_mfma_f32_16x16x32_bf16 v[40:43], v[208:211], v[80:83], v[40:43]
    s_waitcnt lgkmcnt(1)
    v_mfma_f32_16x16x32_bf16 v[28:31], v[212:215], v[84:87], v[28:31]
    v_mfma_f32_16x16x32_bf16 v[44:47], v[208:211], v[84:87], v[44:47]
    s_waitcnt lgkmcnt(0)
    v_mfma_f32_16x16x32_bf16 v[32:35], v[212:215], v[88:91], v[32:35]
    v_mfma_f32_16x16x32_bf16 v[48:51], v[208:211], v[88:91], v[48:51]
    s_barrier
    ds_read_b64_tr_b16 v[216:217], v14 offset:0
    ds_read_b64_tr_b16 v[218:219], v14 offset:3072
    ds_read_b64_tr_b16 v[220:221], v14 offset:1024
    ds_read_b64_tr_b16 v[222:223], v14 offset:4096
    ds_read_b64_tr_b16 v[224:225], v14 offset:12288
    ds_read_b64_tr_b16 v[226:227], v14 offset:15360
    ds_read_b64_tr_b16 v[228:229], v14 offset:13312
    ds_read_b64_tr_b16 v[230:231], v14 offset:16384
    ds_write_b128 v108, v[92:95]
    ds_write_b64 v109, v[96:97] offset:1024
    ds_write_b64 v105, v[98:99] offset:1024
    s_mov_b32 exec_hi, 1
    ds_write_b32 v110, v100 offset:2048
    s_mov_b32 exec_hi, 0
    ds_write_b32 v110, v101 offset:2112
    ds_write_b32 v110, v102 offset:2176
    ds_write_b32 v110, v103 offset:2240
    s_mov_b32 exec_hi, -1
    ds_read_b128 v[52:55], v2 offset:12288
    ds_read_b128 v[56:59], v2 offset:28672
    ds_read_b128 v[60:63], v2 offset:45056
    ds_read_b128 v[64:67], v2 offset:61440
    ds_read_b128 v[68:71], v3 offset:12288
    s_waitcnt lgkmcnt(4)
    v_mfma_f32_16x16x32_bf16 v[16:19], v[220:223], v[52:55], v[16:19]
    v_mfma_f32_16x16x32_bf16 v[248:251], v[216:219], v[52:55], v[248:251]
    ds_read_b128 v[72:75], v10 offset:12288
    s_waitcnt lgkmcnt(4)
    v_mfma_f32_16x16x32_bf16 v[20:23], v[220:223], v[56:59], v[20:23]
    ds_read_b128 v[76:79], v10 offset:28672
    v_mfma_f32_16x16x32_bf16 v[36:39], v[216:219], v[56:59], v[36:39]
    ds_read_b128 v[80:83], v10 offset:45056
    s_waitcnt lgkmcnt(5)
    v_mfma_f32_16x16x32_bf16 v[24:27], v[220:223], v[60:63], v[24:27]
    ds_read_b128 v[84:87], v10 offset:61440
    v_mfma_f32_16x16x32_bf16 v[40:43], v[216:219], v[60:63], v[40:43]
    ds_read_b128 v[88:91], v11 offset:12288
    s_waitcnt lgkmcnt(6)
    v_mfma_f32_16x16x32_bf16 v[28:31], v[220:223], v[64:67], v[28:31]
    v_mfma_f32_16x16x32_bf16 v[44:47], v[216:219], v[64:67], v[44:47]
    s_waitcnt lgkmcnt(5)
    v_mfma_f32_16x16x32_bf16 v[32:35], v[220:223], v[68:71], v[32:35]
    v_mfma_f32_16x16x32_bf16 v[48:51], v[216:219], v[68:71], v[48:51]
    s_waitcnt lgkmcnt(4)
    v_mfma_f32_16x16x32_bf16 v[16:19], v[228:231], v[72:75], v[16:19]
    v_mfma_f32_16x16x32_bf16 v[248:251], v[224:227], v[72:75], v[248:251]
    s_waitcnt lgkmcnt(3)
    v_mfma_f32_16x16x32_bf16 v[20:23], v[228:231], v[76:79], v[20:23]
    v_mfma_f32_16x16x32_bf16 v[36:39], v[224:227], v[76:79], v[36:39]
    s_waitcnt lgkmcnt(2)
    v_mfma_f32_16x16x32_bf16 v[24:27], v[228:231], v[80:83], v[24:27]
    v_mfma_f32_16x16x32_bf16 v[40:43], v[224:227], v[80:83], v[40:43]
    s_waitcnt lgkmcnt(1)
    v_mfma_f32_16x16x32_bf16 v[28:31], v[228:231], v[84:87], v[28:31]
    v_mfma_f32_16x16x32_bf16 v[44:47], v[224:227], v[84:87], v[44:47]
    s_waitcnt lgkmcnt(0)
    v_mfma_f32_16x16x32_bf16 v[32:35], v[228:231], v[88:91], v[32:35]
    v_mfma_f32_16x16x32_bf16 v[48:51], v[224:227], v[88:91], v[48:51]
    s_barrier
    ds_read_b64_tr_b16 v[232:233], v14 offset:24576
    ds_read_b64_tr_b16 v[234:235], v14 offset:27648
    ds_read_b64_tr_b16 v[236:237], v14 offset:25600
    ds_read_b64_tr_b16 v[238:239], v14 offset:28672
    ds_read_b64_tr_b16 v[240:241], v14 offset:36864
    ds_read_b64_tr_b16 v[242:243], v14 offset:39936
    ds_read_b64_tr_b16 v[244:245], v14 offset:37888
    ds_read_b64_tr_b16 v[246:247], v14 offset:40960
    ds_read_b128 v[52:55], v2 offset:14336
    ds_read_b128 v[56:59], v2 offset:30720
    ds_read_b128 v[60:63], v2 offset:47104
    ds_read_b128 v[64:67], v2 offset:63488
    ds_read_b128 v[68:71], v3 offset:14336
    s_waitcnt lgkmcnt(4)
    v_mfma_f32_16x16x32_bf16 v[16:19], v[236:239], v[52:55], v[16:19]
    v_mfma_f32_16x16x32_bf16 v[248:251], v[232:235], v[52:55], v[248:251]
    ds_read_b128 v[72:75], v10 offset:14336
    s_waitcnt lgkmcnt(4)
    v_mfma_f32_16x16x32_bf16 v[20:23], v[236:239], v[56:59], v[20:23]
    ds_read_b128 v[76:79], v10 offset:30720
    v_mfma_f32_16x16x32_bf16 v[36:39], v[232:235], v[56:59], v[36:39]
    ds_read_b128 v[80:83], v10 offset:47104
    s_waitcnt lgkmcnt(5)
    v_mfma_f32_16x16x32_bf16 v[24:27], v[236:239], v[60:63], v[24:27]
    ds_read_b128 v[84:87], v10 offset:63488
    v_mfma_f32_16x16x32_bf16 v[40:43], v[232:235], v[60:63], v[40:43]
    ds_read_b128 v[88:91], v11 offset:14336
    s_waitcnt lgkmcnt(6)
    v_mfma_f32_16x16x32_bf16 v[28:31], v[236:239], v[64:67], v[28:31]
    v_mfma_f32_16x16x32_bf16 v[44:47], v[232:235], v[64:67], v[44:47]
    s_waitcnt lgkmcnt(5)
    v_mfma_f32_16x16x32_bf16 v[32:35], v[236:239], v[68:71], v[32:35]
    v_mfma_f32_16x16x32_bf16 v[48:51], v[232:235], v[68:71], v[48:51]
    s_waitcnt lgkmcnt(4)
    v_mfma_f32_16x16x32_bf16 v[16:19], v[244:247], v[72:75], v[16:19]
    v_mfma_f32_16x16x32_bf16 v[248:251], v[240:243], v[72:75], v[248:251]
    s_waitcnt lgkmcnt(3)
    v_mfma_f32_16x16x32_bf16 v[20:23], v[244:247], v[76:79], v[20:23]
    v_mfma_f32_16x16x32_bf16 v[36:39], v[240:243], v[76:79], v[36:39]
    s_waitcnt lgkmcnt(2)
    v_mfma_f32_16x16x32_bf16 v[24:27], v[244:247], v[80:83], v[24:27]
    v_mfma_f32_16x16x32_bf16 v[40:43], v[240:243], v[80:83], v[40:43]
    s_waitcnt lgkmcnt(1)
    v_mfma_f32_16x16x32_bf16 v[28:31], v[244:247], v[84:87], v[28:31]
    v_mfma_f32_16x16x32_bf16 v[44:47], v[240:243], v[84:87], v[44:47]
    s_waitcnt lgkmcnt(0)
    v_mfma_f32_16x16x32_bf16 v[32:35], v[244:247], v[88:91], v[32:35]
    v_mfma_f32_16x16x32_bf16 v[48:51], v[240:243], v[88:91], v[48:51]
    v_mov_b32_dpp v248, v248 row_newbcast:0 row_mask:0xf bank_mask:0xf
    v_mov_b32_dpp v116, v16 row_newbcast:0 row_mask:0xf bank_mask:0xf
    v_mov_b32_dpp v249, v249 row_newbcast:0 row_mask:0xf bank_mask:0xf
    v_mov_b32_dpp v117, v17 row_newbcast:0 row_mask:0xf bank_mask:0xf
    v_mov_b32_dpp v250, v250 row_newbcast:0 row_mask:0xf bank_mask:0xf
    v_mov_b32_dpp v118, v18 row_newbcast:0 row_mask:0xf bank_mask:0xf
    v_mov_b32_dpp v251, v251 row_newbcast:0 row_mask:0xf bank_mask:0xf
    v_mov_b32_dpp v119, v19 row_newbcast:0 row_mask:0xf bank_mask:0xf
    s_lshr_b32 s38, s28, 1
    s_mul_i32 s39, s38, 10496
    s_and_b32 s40, s28, 1
    s_mul_i32 s40, s40, 1312
    s_add_u32 s39, s39, s40
    s_add_u32 s39, s39, 131072
    v_add_u32 v8, s39, v0
    ds_read_b128 v[52:55], v8 offset:0
    ds_read_b128 v[56:59], v8 offset:2624
    ds_read_b128 v[60:63], v8 offset:5248
    ds_read_b128 v[64:67], v8 offset:7872
    ds_read_b128 v[68:71], v8 offset:1024
    ds_read_b128 v[72:75], v8 offset:3648
    ds_read_b128 v[76:79], v8 offset:6272
    ds_read_b128 v[80:83], v8 offset:8896
    s_lshl_b32 s39, s32, 1
    s_add_u32 s39, s39, s33
    s_lshl_b32 s39, s39, 1
    s_add_u32 s39, s39, s38
    s_mul_i32 s39, s39, 2624
    s_add_u32 s39, s39, s40
    s_add_u32 s44, s39, 11534336
    s_waitcnt lgkmcnt(4)
    v_add_f32 v52, v52, v56
    v_add_f32 v60, v60, v64
    v_add_f32 v53, v53, v57
    v_add_f32 v61, v61, v65
    v_add_f32 v54, v54, v58
    v_add_f32 v62, v62, v66
    v_add_f32 v55, v55, v59
    v_add_f32 v63, v63, v67
    v_add_f32 v52, v52, v60
    v_add_f32 v53, v53, v61
    v_add_f32 v54, v54, v62
    v_add_f32 v55, v55, v63
    buffer_store_dwordx4 v[52:55], v0, s[4:7], s44 offen offset:0 sc1
    s_waitcnt lgkmcnt(0)
    v_add_f32 v68, v68, v72
    v_add_f32 v76, v76, v80
    v_add_f32 v69, v69, v73
    v_add_f32 v77, v77, v81
    v_add_f32 v70, v70, v74
    v_add_f32 v78, v78, v82
    v_add_f32 v71, v71, v75
    v_add_f32 v79, v79, v83
    v_add_f32 v68, v68, v76
    v_add_f32 v69, v69, v77
    v_add_f32 v70, v70, v78
    v_add_f32 v71, v71, v79
    s_mov_b64 exec, 262143
    buffer_store_dwordx4 v[68:71], v0, s[4:7], s44 offen offset:1024 sc1
    s_mov_b64 exec, -1
    s_lshl_b32 s44, s28, 1
    v_mov_b32 v92, -1
    v_mov_b32 v93, -1
    v_mov_b32 v94, -1
    v_mov_b32 v95, -1
    v_lshrrev_b32 v96, 4, v1
    v_lshlrev_b32 v96, 14, v96
    v_and_b32 v97, 15, v1
    v_lshl_add_u32 v96, v97, 4, v96
    s_add_u32 s40, s44, 0
    s_lshr_b32 s42, s40, 2
    s_and_b32 s43, s40, 3
    s_lshl_b32 s39, s31, 2
    s_add_u32 s39, s39, s43
    s_lshl_b32 s39, s39, 10
    s_lshl_b32 s41, s30, 16
    s_add_u32 s39, s39, s41
    s_lshl_b32 s41, s42, 15
    s_add_u32 s39, s39, s41
    s_add_u32 s39, s39, 2097152
    buffer_store_dwordx4 v[92:95], v0, s[4:7], s39 offen sc1
    s_and_b32 s39, s31, 3
    s_lshl_b32 s39, s39, 19
    s_lshl_b32 s41, s30, 9
    s_add_u32 s39, s39, s41
    s_lshr_b32 s41, s31, 2
    s_lshl_b32 s41, s41, 8
    s_add_u32 s39, s39, s41
    s_add_u32 s39, s39, 6291456
    s_add_u32 s40, s44, 0
    s_lshl_b32 s42, s40, 16
    s_add_u32 s39, s39, s42
    buffer_store_dwordx4 v[92:95], v96, s[4:7], s39 offen sc1
    s_add_u32 s40, s44, 1
    s_lshr_b32 s42, s40, 2
    s_and_b32 s43, s40, 3
    s_lshl_b32 s39, s31, 2
    s_add_u32 s39, s39, s43
    s_lshl_b32 s39, s39, 10
    s_lshl_b32 s41, s30, 16
    s_add_u32 s39, s39, s41
    s_lshl_b32 s41, s42, 15
    s_add_u32 s39, s39, s41
    s_add_u32 s39, s39, 2097152
    buffer_store_dwordx4 v[92:95], v0, s[4:7], s39 offen sc1
    s_and_b32 s39, s31, 3
    s_lshl_b32 s39, s39, 19
    s_lshl_b32 s41, s30, 9
    s_add_u32 s39, s39, s41
    s_lshr_b32 s41, s31, 2
    s_lshl_b32 s41, s41, 8
    s_add_u32 s39, s39, s41
    s_add_u32 s39, s39, 6291456
    s_add_u32 s40, s44, 1
    s_lshl_b32 s42, s40, 16
    s_add_u32 s39, s39, s42
    buffer_store_dwordx4 v[92:95], v96, s[4:7], s39 offen sc1
    s_and_b32 s39, s31, 3
    s_lshl_b32 s39, s39, 14
    s_lshl_b32 s41, s30, 9
    s_add_u32 s39, s39, s41
    s_lshr_b32 s41, s31, 2
    s_lshl_b32 s41, s41, 8
    s_add_u32 s39, s39, s41
    s_add_u32 s39, s39, 10551296
    s_lshl_b32 s42, s44, 5
    s_add_u32 s39, s39, s42
    s_mov_b64 exec, 15
    buffer_store_dwordx4 v[92:95], v0, s[4:7], s39 offen sc1
    s_mov_b64 exec, -1
    v_lshrrev_b32 v96, 3, v1
    v_lshlrev_b32 v96, 14, v96
    v_and_b32 v97, 7, v1
    v_lshl_add_u32 v96, v97, 4, v96
    s_and_b32 s39, s28, 1
    s_xor_b32 s39, s39, s33
    s_add_u32 s39, s39, s44
    s_lshl_b32 s39, s39, 18
    s_lshl_b32 s40, s32, 7
    s_add_u32 s39, s39, s40
    s_add_u32 s39, s39, 8388608
    buffer_store_dwordx4 v[92:95], v96, s[4:7], s39 offen sc1
    s_add_u32 s39, s39, 131072
    buffer_store_dwordx4 v[92:95], v96, s[4:7], s39 offen sc1
    v_and_b32 v10, 15, v1
    v_lshrrev_b32 v11, 4, v1
    v_and_b32 v8, 1, v10
    v_lshl_add_u32 v9, v11, 2, v8
    v_cmp_eq_u32 s[60:61], 1, v8
    v_cmp_le_u32 s[62:63], v9, v10
    v_add_u32 v9, 2, v9
    v_cmp_le_u32 s[64:65], v9, v10
    v_mov_b32 v8, 0x0c0c0100
    v_mov_b32 v9, 0x01000c0c
    v_mov_b32 v7, 0x0c0c0c0c
    v_cndmask_b32 v8, v8, v9, s[60:61]
    v_cndmask_b32 v12, v8, v7, s[62:63]
    v_cndmask_b32 v14, v7, v8, s[62:63]
    v_mov_b32 v8, 0x0c0c0302
    v_mov_b32 v9, 0x03020c0c
    v_cndmask_b32 v8, v8, v9, s[60:61]
    v_cndmask_b32 v13, v8, v7, s[64:65]
    v_cndmask_b32 v15, v7, v8, s[64:65]
    v_and_b32 v7, 1, v10
    v_lshlrev_b32 v7, 4, v7
    v_lshrrev_b32 v8, 1, v10
    v_add_u32 v7, v7, v8
    v_and_b32 v8, 1, v11
    v_lshl_add_u32 v7, v8, 3, v7
    v_lshlrev_b32 v7, 4, v7
    v_lshrrev_b32 v8, 1, v11
    v_lshl_add_u32 v7, v8, 9, v7
    v_lshlrev_b32 v8, 3, v10
    v_add_u32 v8, 155648, v8
    s_mul_i32 s38, s28, 2560
    s_add_u32 s38, s38, 81920
    v_lshl_add_u32 v9, v1, 3, s38
    s_nop 2
p_common:
    s_barrier
    v_lshlrev_b32 v115, 2, v1
    buffer_load_dword v114, v115, s[24:27], 0 offen sc1
    ds_read_b64 v[52:53], v8 offset:0
    ds_read_b64 v[54:55], v8 offset:128
    ds_read_b64 v[56:57], v8 offset:256
    ds_read_b64 v[58:59], v8 offset:384
    ds_read_b64 v[60:61], v8 offset:512
    ds_read_b64 v[88:89], v9 offset:0
    ds_read_b64 v[90:91], v9 offset:512
    ds_read_b64 v[92:93], v9 offset:1024
    ds_read_b64 v[94:95], v9 offset:1536
    ds_read_b64 v[96:97], v9 offset:2048
    s_cmp_eq_u32 s30, 0
    s_cselect_b64 s[66:67], -1, 0
    s_waitcnt lgkmcnt(9)
    v_pk_fma_f32 v[16:17], v[116:117], v[52:53], v[16:17] op_sel_hi:[1,0,1] neg_lo:[0,1,0] neg_hi:[0,1,0]
    v_pk_fma_f32 v[18:19], v[118:119], v[52:53], v[18:19] op_sel_hi:[1,0,1] neg_lo:[0,1,0] neg_hi:[0,1,0]
    s_waitcnt lgkmcnt(8)
    v_pk_fma_f32 v[20:21], v[116:117], v[54:55], v[20:21] op_sel_hi:[1,0,1] neg_lo:[0,1,0] neg_hi:[0,1,0]
    v_pk_fma_f32 v[22:23], v[118:119], v[54:55], v[22:23] op_sel_hi:[1,0,1] neg_lo:[0,1,0] neg_hi:[0,1,0]
    v_pk_fma_f32 v[36:37], v[248:249], v[54:55], v[36:37] op_sel_hi:[1,0,1] neg_lo:[0,1,0] neg_hi:[0,1,0]
    v_pk_fma_f32 v[38:39], v[250:251], v[54:55], v[38:39] op_sel_hi:[1,0,1] neg_lo:[0,1,0] neg_hi:[0,1,0]
    s_waitcnt lgkmcnt(7)
    v_pk_fma_f32 v[24:25], v[116:117], v[56:57], v[24:25] op_sel_hi:[1,0,1] neg_lo:[0,1,0] neg_hi:[0,1,0]
    v_pk_fma_f32 v[26:27], v[118:119], v[56:57], v[26:27] op_sel_hi:[1,0,1] neg_lo:[0,1,0] neg_hi:[0,1,0]
    v_pk_fma_f32 v[40:41], v[248:249], v[56:57], v[40:41] op_sel_hi:[1,0,1] neg_lo:[0,1,0] neg_hi:[0,1,0]
    v_pk_fma_f32 v[42:43], v[250:251], v[56:57], v[42:43] op_sel_hi:[1,0,1] neg_lo:[0,1,0] neg_hi:[0,1,0]
    s_waitcnt lgkmcnt(6)
    v_pk_fma_f32 v[28:29], v[116:117], v[58:59], v[28:29] op_sel_hi:[1,0,1] neg_lo:[0,1,0] neg_hi:[0,1,0]
    v_pk_fma_f32 v[30:31], v[118:119], v[58:59], v[30:31] op_sel_hi:[1,0,1] neg_lo:[0,1,0] neg_hi:[0,1,0]
    v_pk_fma_f32 v[44:45], v[248:249], v[58:59], v[44:45] op_sel_hi:[1,0,1] neg_lo:[0,1,0] neg_hi:[0,1,0]
    v_pk_fma_f32 v[46:47], v[250:251], v[58:59], v[46:47] op_sel_hi:[1,0,1] neg_lo:[0,1,0] neg_hi:[0,1,0]
    s_waitcnt lgkmcnt(5)
    v_pk_fma_f32 v[32:33], v[116:117], v[60:61], v[32:33] op_sel_hi:[1,0,1] neg_lo:[0,1,0] neg_hi:[0,1,0]
    v_pk_fma_f32 v[34:35], v[118:119], v[60:61], v[34:35] op_sel_hi:[1,0,1] neg_lo:[0,1,0] neg_hi:[0,1,0]
    v_pk_fma_f32 v[48:49], v[248:249], v[60:61], v[48:49] op_sel_hi:[1,0,1] neg_lo:[0,1,0] neg_hi:[0,1,0]
    v_pk_fma_f32 v[50:51], v[250:251], v[60:61], v[50:51] op_sel_hi:[1,0,1] neg_lo:[0,1,0] neg_hi:[0,1,0]
    v_pk_mul_f32 v[16:17], v[16:17], v[52:53] op_sel:[0,1] op_sel_hi:[1,1]
    v_pk_mul_f32 v[18:19], v[18:19], v[52:53] op_sel:[0,1] op_sel_hi:[1,1]
    v_pk_mul_f32 v[20:21], v[20:21], v[54:55] op_sel:[0,1] op_sel_hi:[1,1]
    v_pk_mul_f32 v[22:23], v[22:23], v[54:55] op_sel:[0,1] op_sel_hi:[1,1]
    v_pk_mul_f32 v[36:37], v[36:37], v[54:55] op_sel:[0,1] op_sel_hi:[1,1]
    v_pk_mul_f32 v[38:39], v[38:39], v[54:55] op_sel:[0,1] op_sel_hi:[1,1]
    v_pk_mul_f32 v[24:25], v[24:25], v[56:57] op_sel:[0,1] op_sel_hi:[1,1]
    v_pk_mul_f32 v[26:27], v[26:27], v[56:57] op_sel:[0,1] op_sel_hi:[1,1]
    v_pk_mul_f32 v[40:41], v[40:41], v[56:57] op_sel:[0,1] op_sel_hi:[1,1]
    v_pk_mul_f32 v[42:43], v[42:43], v[56:57] op_sel:[0,1] op_sel_hi:[1,1]
    v_pk_mul_f32 v[28:29], v[28:29], v[58:59] op_sel:[0,1] op_sel_hi:[1,1]
    v_pk_mul_f32 v[30:31], v[30:31], v[58:59] op_sel:[0,1] op_sel_hi:[1,1]
    v_pk_mul_f32 v[44:45], v[44:45], v[58:59] op_sel:[0,1] op_sel_hi:[1,1]
    v_pk_mul_f32 v[46:47], v[46:47], v[58:59] op_sel:[0,1] op_sel_hi:[1,1]
    v_pk_mul_f32 v[32:33], v[32:33], v[60:61] op_sel:[0,1] op_sel_hi:[1,1]
    v_pk_mul_f32 v[34:35], v[34:35], v[60:61] op_sel:[0,1] op_sel_hi:[1,1]
    v_pk_mul_f32 v[48:49], v[48:49], v[60:61] op_sel:[0,1] op_sel_hi:[1,1]
    v_pk_mul_f32 v[50:51], v[50:51], v[60:61] op_sel:[0,1] op_sel_hi:[1,1]
    v_cvt_pk_bf16_f32 v16, v16, v17
    v_cvt_pk_bf16_f32 v17, v18, v19
    v_cvt_pk_bf16_f32 v20, v20, v21
    v_cvt_pk_bf16_f32 v21, v22, v23
    v_cvt_pk_bf16_f32 v62, v36, v37
    v_cvt_pk_bf16_f32 v63, v38, v39
    v_cvt_pk_bf16_f32 v24, v24, v25
    v_cvt_pk_bf16_f32 v25, v26, v27
    v_cvt_pk_bf16_f32 v64, v40, v41
    v_cvt_pk_bf16_f32 v65, v42, v43
    v_cvt_pk_bf16_f32 v28, v28, v29
    v_cvt_pk_bf16_f32 v29, v30, v31
    v_cvt_pk_bf16_f32 v66, v44, v45
    v_cvt_pk_bf16_f32 v67, v46, v47
    v_cvt_pk_bf16_f32 v32, v32, v33
    v_cvt_pk_bf16_f32 v33, v34, v35
    v_cvt_pk_bf16_f32 v68, v48, v49
    v_cvt_pk_bf16_f32 v69, v50, v51
    v_mfma_f32_16x16x16_bf16 v[36:39], v[20:21], v[62:63], 0
    v_mfma_f32_16x16x16_bf16 v[72:75], v[16:17], v[62:63], 0
    v_mfma_f32_16x16x16_bf16 v[40:43], v[24:25], v[64:65], 0
    v_mfma_f32_16x16x16_bf16 v[76:79], v[20:21], v[64:65], 0
    v_mfma_f32_16x16x16_bf16 v[44:47], v[28:29], v[66:67], 0
    v_mfma_f32_16x16x16_bf16 v[80:83], v[24:25], v[66:67], 0
    v_mfma_f32_16x16x16_bf16 v[48:51], v[32:33], v[68:69], 0
    v_mfma_f32_16x16x16_bf16 v[84:87], v[28:29], v[68:69], 0
    v_mov_b32 v10, 0xcf6e6b28
    s_mov_b32 s38, 0xffff0000
    s_mov_b32 s39, 0x3eb8aa3b
    v_cndmask_b32 v98, v36, v37, s[60:61]
    v_cndmask_b32 v99, v38, v39, s[60:61]
    v_cndmask_b32 v100, v72, v73, s[60:61]
    v_cndmask_b32 v101, v74, v75, s[60:61]
    v_cndmask_b32 v100, v100, v10, s[66:67]
    v_cndmask_b32 v101, v101, v10, s[66:67]
    v_cndmask_b32 v102, v40, v41, s[60:61]
    v_cndmask_b32 v103, v42, v43, s[60:61]
    v_cndmask_b32 v104, v76, v77, s[60:61]
    v_cndmask_b32 v105, v78, v79, s[60:61]
    v_cndmask_b32 v106, v44, v45, s[60:61]
    v_cndmask_b32 v107, v46, v47, s[60:61]
    v_cndmask_b32 v108, v80, v81, s[60:61]
    v_cndmask_b32 v109, v82, v83, s[60:61]
    v_cndmask_b32 v110, v48, v49, s[60:61]
    v_cndmask_b32 v111, v50, v51, s[60:61]
    v_cndmask_b32 v112, v84, v85, s[60:61]
    v_cndmask_b32 v113, v86, v87, s[60:61]
    v_cndmask_b32 v98, v100, v98, s[62:63]
    v_cndmask_b32 v99, v101, v99, s[64:65]
    v_cndmask_b32 v102, v104, v102, s[62:63]
    v_cndmask_b32 v103, v105, v103, s[64:65]
    v_cndmask_b32 v106, v108, v106, s[62:63]
    v_cndmask_b32 v107, v109, v107, s[64:65]
    v_cndmask_b32 v110, v112, v110, s[62:63]
    v_cndmask_b32 v111, v113, v111, s[64:65]
    v_cvt_pk_bf16_f32 v100, v98, v99
    v_cvt_pk_bf16_f32 v104, v102, v103
    v_cvt_pk_bf16_f32 v108, v106, v107
    v_cvt_pk_bf16_f32 v112, v110, v111
    v_lshlrev_b32 v98, 16, v100
    v_and_b32 v99, s38, v100
    v_lshlrev_b32 v102, 16, v104
    v_and_b32 v103, s38, v104
    v_lshlrev_b32 v106, 16, v108
    v_and_b32 v107, s38, v108
    v_lshlrev_b32 v110, 16, v112
    v_and_b32 v111, s38, v112
    v_max_f32 v100, v98, v99
    v_max_f32 v104, v102, v103
    v_max_f32 v108, v106, v107
    v_max_f32 v112, v110, v111
    v_mov_b32 v101, v100
    v_mov_b32 v105, v104
    v_mov_b32 v109, v108
    v_mov_b32 v113, v112
    v_permlane16_swap_b32 v100, v101
    v_permlane16_swap_b32 v104, v105
    v_permlane16_swap_b32 v108, v109
    v_permlane16_swap_b32 v112, v113
    v_max_f32 v100, v100, v101
    v_max_f32 v104, v104, v105
    v_max_f32 v108, v108, v109
    v_max_f32 v112, v112, v113
    v_mov_b32 v101, v100
    v_mov_b32 v105, v104
    v_mov_b32 v109, v108
    v_mov_b32 v113, v112
    v_permlane32_swap_b32 v100, v101
    v_permlane32_swap_b32 v104, v105
    v_permlane32_swap_b32 v108, v109
    v_permlane32_swap_b32 v112, v113
    v_max_f32 v100, v100, v101
    v_max_f32 v104, v104, v105
    v_max_f32 v108, v108, v109
    v_max_f32 v112, v112, v113
    v_sub_f32 v98, v98, v100
    v_sub_f32 v99, v99, v100
    v_sub_f32 v102, v102, v104
    v_sub_f32 v103, v103, v104
    v_sub_f32 v106, v106, v108
    v_sub_f32 v107, v107, v108
    v_sub_f32 v110, v110, v112
    v_sub_f32 v111, v111, v112
    v_mul_f32 v98, s39, v98
    v_mul_f32 v99, s39, v99
    v_mul_f32 v102, s39, v102
    v_mul_f32 v103, s39, v103
    v_mul_f32 v106, s39, v106
    v_mul_f32 v107, s39, v107
    v_mul_f32 v110, s39, v110
    v_mul_f32 v111, s39, v111
    v_exp_f32 v98, v98
    v_exp_f32 v99, v99
    v_exp_f32 v102, v102
    v_exp_f32 v103, v103
    v_exp_f32 v106, v106
    v_exp_f32 v107, v107
    v_exp_f32 v110, v110
    v_exp_f32 v111, v111
    v_add_f32 v100, v98, v99
    v_add_f32 v104, v102, v103
    v_add_f32 v108, v106, v107
    v_add_f32 v112, v110, v111
    v_mov_b32 v101, v100
    v_mov_b32 v105, v104
    v_mov_b32 v109, v108
    v_mov_b32 v113, v112
    v_permlane16_swap_b32 v100, v101
    v_permlane16_swap_b32 v104, v105
    v_permlane16_swap_b32 v108, v109
    v_permlane16_swap_b32 v112, v113
    v_add_f32 v100, v100, v101
    v_add_f32 v104, v104, v105
    v_add_f32 v108, v108, v109
    v_add_f32 v112, v112, v113
    v_mov_b32 v101, v100
    v_mov_b32 v105, v104
    v_mov_b32 v109, v108
    v_mov_b32 v113, v112
    v_permlane32_swap_b32 v100, v101
    v_permlane32_swap_b32 v104, v105
    v_permlane32_swap_b32 v108, v109
    v_permlane32_swap_b32 v112, v113
    v_add_f32 v100, v100, v101
    v_add_f32 v104, v104, v105
    v_add_f32 v108, v108, v109
    v_add_f32 v112, v112, v113
    v_rcp_f32 v100, v100
    v_rcp_f32 v104, v104
    v_rcp_f32 v108, v108
    v_rcp_f32 v112, v112
    v_mul_f32 v98, v98, v100
    v_mul_f32 v99, v99, v100
    v_mul_f32 v102, v102, v104
    v_mul_f32 v103, v103, v104
    v_mul_f32 v106, v106, v108
    v_mul_f32 v107, v107, v108
    v_mul_f32 v110, v110, v112
    v_mul_f32 v111, v111, v112
    v_cvt_pk_bf16_f32 v100, v98, v99
    v_cvt_pk_bf16_f32 v104, v102, v103
    v_cvt_pk_bf16_f32 v108, v106, v107
    v_cvt_pk_bf16_f32 v112, v110, v111
    s_lshl_b32 s40, s31, 2
    s_add_u32 s40, s40, s28
    s_lshl_b32 s40, s40, 10
    s_lshl_b32 s41, s30, 16
    s_add_u32 s40, s40, s41
    s_add_u32 s40, s40, s35
    v_perm_b32 v72, v100, v100, v12
    v_perm_b32 v73, v100, v100, v13
    v_perm_b32 v74, v100, v100, v14
    v_perm_b32 v75, v100, v100, v15
    v_perm_b32 v76, v104, v104, v12
    v_perm_b32 v77, v104, v104, v13
    v_perm_b32 v78, v104, v104, v14
    v_perm_b32 v79, v104, v104, v15
    v_perm_b32 v80, v108, v108, v12
    v_perm_b32 v81, v108, v108, v13
    v_perm_b32 v82, v108, v108, v14
    v_perm_b32 v83, v108, v108, v15
    v_perm_b32 v84, v112, v112, v12
    v_perm_b32 v85, v112, v112, v13
    v_perm_b32 v86, v112, v112, v14
    v_perm_b32 v87, v112, v112, v15
    s_waitcnt lgkmcnt(0)
    v_mfma_f32_16x16x32_bf16 v[36:39], v[88:91], v[72:75], 0
    v_mfma_f32_16x16x32_bf16 v[40:43], v[90:93], v[76:79], 0
    v_mfma_f32_16x16x32_bf16 v[44:47], v[92:95], v[80:83], 0
    v_mfma_f32_16x16x32_bf16 v[48:51], v[94:97], v[84:87], 0
    s_add_u32 s42, s40, 32768
    s_waitcnt vmcnt(8)
    s_nop 2
    v_cvt_pk_bf16_f32 v52, v36, v37
    v_cvt_pk_bf16_f32 v53, v38, v39
    v_cvt_pk_bf16_f32 v54, v40, v41
    v_cvt_pk_bf16_f32 v55, v42, v43
    v_cvt_pk_bf16_f32 v56, v44, v45
    v_cvt_pk_bf16_f32 v57, v46, v47
    v_cvt_pk_bf16_f32 v58, v48, v49
    v_cvt_pk_bf16_f32 v59, v50, v51
    v_permlane16_swap_b32 v52, v54
    v_permlane16_swap_b32 v53, v55
    v_min_u32 v55, -2, v55
    buffer_store_dwordx4 v[52:55], v7, s[4:7], s40 offen sc1
    v_permlane16_swap_b32 v56, v58
    v_permlane16_swap_b32 v57, v59
    v_min_u32 v59, -2, v59
    buffer_store_dwordx4 v[56:59], v7, s[4:7], s42 offen sc1
    s_lshl_b32 s40, s30, 16
    s_lshr_b32 s41, s31, 2
    s_lshl_b32 s41, s41, 15
    s_add_u32 s40, s40, s41
    s_lshl_b32 s41, s28, 13
    s_add_u32 s40, s40, s41
    s_add_u32 s40, s40, s35
    s_add_u32 s42, s40, 4096
    s_add_u32 s41, s41, 81920
    v_add_u32 v10, s41, v0
    s_lshl_b32 s44, s30, 1
    s_lshl_b64 s[44:45], 3, s44
    s_lshl_b32 s48, s28, 3
    s_lshr_b32 s48, 0x00050708, s48
    s_and_b32 s48, s48, 15
    s_lshl_b32 s48, s48, 8
    s_mul_i32 s49, s28, 8448
    s_add_u32 s49, s49, 114752
    s_waitcnt vmcnt(2)
    s_mov_b32 s39, 0x01010101
    v_cmp_ne_u32 vcc, s39, v114
    s_and_b64 vcc, vcc, s[44:45]
    s_cbranch_vccz p_flag1_x
    s_mov_b32 s38, 0
    v_lshlrev_b32 v115, 2, v1
p_flag1:
    s_sleep 4
    buffer_load_dword v114, v115, s[24:27], 0 offen sc1
    s_add_u32 s38, s38, 1
    s_waitcnt vmcnt(0)
    s_mov_b32 s39, 0x01010101
    v_cmp_ne_u32 vcc, s39, v114
    s_and_b64 vcc, vcc, s[44:45]
    s_cmp_gt_u32 s38, 131072
    s_cbranch_scc1 p_flag1_x
    s_cbranch_vccnz p_flag1
    s_nop 0
p_flag1_x:
    s_waitcnt vmcnt(0)
    s_barrier
    s_cmp_eq_u32 s34, 1
    s_cbranch_scc0 p_tap2
    s_mul_i32 s46, s32, 10496
    s_add_u32 s46, s46, 11534336
    s_add_u32 s46, s46, s48
    s_add_u32 m0, s49, 0
    s_add_u32 s47, s46, 0
    buffer_load_dwordx4 v0, s[4:7], s47 offen sc1 lds
    s_add_u32 m0, s49, 2112
    s_add_u32 s47, s46, 2624
    buffer_load_dwordx4 v0, s[4:7], s47 offen sc1 lds
    s_add_u32 m0, s49, 4224
    s_add_u32 s47, s46, 5248
    buffer_load_dwordx4 v0, s[4:7], s47 offen sc1 lds
    s_add_u32 m0, s49, 6336
    s_add_u32 s47, s46, 7872
    buffer_load_dwordx4 v0, s[4:7], s47 offen sc1 lds
    s_cmp_eq_u32 s28, 3
    s_cbranch_scc0 p_tap2
    s_add_u32 m0, s49, 0
    s_add_u32 s47, s46, 0
    buffer_load_dwordx4 v0, s[4:7], s47 offen offset:1024 sc1 lds
    s_add_u32 m0, s49, 2112
    s_add_u32 s47, s46, 2624
    buffer_load_dwordx4 v0, s[4:7], s47 offen offset:1024 sc1 lds
    s_add_u32 m0, s49, 4224
    s_add_u32 s47, s46, 5248
    buffer_load_dwordx4 v0, s[4:7], s47 offen offset:1024 sc1 lds
    s_add_u32 m0, s49, 6336
    s_add_u32 s47, s46, 7872
    buffer_load_dwordx4 v0, s[4:7], s47 offen offset:1024 sc1 lds
p_tap2:
    s_mov_b32 s38, 0
p_opoll:
    buffer_load_dwordx4 v[16:19], v0, s[4:7], s40 offen offset:0 sc1
    buffer_load_dwordx4 v[20:23], v0, s[4:7], s40 offen offset:1024 sc1
    buffer_load_dwordx4 v[24:27], v0, s[4:7], s40 offen offset:2048 sc1
    buffer_load_dwordx4 v[28:31], v0, s[4:7], s40 offen offset:3072 sc1
    buffer_load_dwordx4 v[32:35], v0, s[4:7], s42 offen offset:0 sc1
    buffer_load_dwordx4 v[36:39], v0, s[4:7], s42 offen offset:1024 sc1
    buffer_load_dwordx4 v[40:43], v0, s[4:7], s42 offen offset:2048 sc1
    buffer_load_dwordx4 v[44:47], v0, s[4:7], s42 offen offset:3072 sc1
    s_add_u32 s38, s38, 1
    s_waitcnt vmcnt(0)
    v_max3_u32 v11, v19, v23, v27
    v_max3_u32 v11, v11, v31, v35
    v_max3_u32 v11, v11, v39, v43
    v_max_u32 v11, v11, v47
    v_cmp_eq_u32 vcc, -1, v11
    s_cmp_gt_u32 s38, 131072
    s_cbranch_scc1 p_opoll_x
    s_cbranch_vccnz p_opoll
p_opoll_x:
    ds_write_b128 v10, v[16:19] offset:0
    ds_write_b128 v10, v[20:23] offset:1024
    ds_write_b128 v10, v[24:27] offset:2048
    ds_write_b128 v10, v[28:31] offset:3072
    ds_write_b128 v10, v[32:35] offset:4096
    ds_write_b128 v10, v[36:39] offset:5120
    ds_write_b128 v10, v[40:43] offset:6144
    ds_write_b128 v10, v[44:47] offset:7168
    s_waitcnt lgkmcnt(0)
    s_barrier
    s_cmp_eq_u32 s34, 0
    s_cbranch_scc0 p_tap1
    s_mul_i32 s46, s32, 10496
    s_add_u32 s46, s46, 11534336
    s_add_u32 s46, s46, s48
    s_add_u32 m0, s49, 0
    s_add_u32 s47, s46, 0
    buffer_load_dwordx4 v0, s[4:7], s47 offen sc1 lds
    s_add_u32 m0, s49, 2112
    s_add_u32 s47, s46, 2624
    buffer_load_dwordx4 v0, s[4:7], s47 offen sc1 lds
    s_add_u32 m0, s49, 4224
    s_add_u32 s47, s46, 5248
    buffer_load_dwordx4 v0, s[4:7], s47 offen sc1 lds
    s_add_u32 m0, s49, 6336
    s_add_u32 s47, s46, 7872
    buffer_load_dwordx4 v0, s[4:7], s47 offen sc1 lds
    s_cmp_eq_u32 s28, 3
    s_cbranch_scc0 p_tap1
    s_add_u32 m0, s49, 0
    s_add_u32 s47, s46, 0
    buffer_load_dwordx4 v0, s[4:7], s47 offen offset:1024 sc1 lds
    s_add_u32 m0, s49, 2112
    s_add_u32 s47, s46, 2624
    buffer_load_dwordx4 v0, s[4:7], s47 offen offset:1024 sc1 lds
    s_add_u32 m0, s49, 4224
    s_add_u32 s47, s46, 5248
    buffer_load_dwordx4 v0, s[4:7], s47 offen offset:1024 sc1 lds
    s_add_u32 m0, s49, 6336
    s_add_u32 s47, s46, 7872
    buffer_load_dwordx4 v0, s[4:7], s47 offen offset:1024 sc1 lds
p_tap1:
    buffer_load_dword v114, v115, s[24:27], 0 offen sc1
    v_lshl_or_b32 v108, s28, 6, v1
    v_lshlrev_b32 v108, 3, v108
    v_sub_u32 v108, 2047, v108
    s_sub_u32 s43, s49, s48
    s_sub_u32 s41, s43, 68096
    v_mov_b32 v76, 0
    v_mov_b32 v77, 0
    v_mov_b32 v78, 0
    v_mov_b32 v79, 0
    v_mul_u32_u24 v109, 2112, v1
    v_add3_u32 v109, v109, s43, -16
    v_lshrrev_b32 v110, 1, v1
    v_mul_u32_u24 v110, 4160, v110
    v_and_b32 v111, 1, v1
    v_lshl_add_u32 v110, v111, 4, v110
    s_cmp_eq_u32 s28, 3
    s_cselect_b64 exec, 15, 0
    ds_write_b128 v109, v[76:79]
    s_cselect_b32 exec_lo, 0, -1
    ds_write_b128 v110, v[76:79] offset:4096
    s_mov_b64 exec, -1
    v_subrev_u32 v28, 0, v108
    v_cvt_f32_i32 v80, v28
    v_subrev_u32 v29, 1, v108
    v_cvt_f32_i32 v81, v29
    v_cvt_pk_bf16_f32 v82, v80, v81
    v_and_b32 v80, 0xffff, v82
    v_lshrrev_b32 v81, 16, v82
    v_lshl_add_u32 v16, v80, 2, s41
    v_lshl_add_u32 v83, v28, 2, s43
    v_cmp_gt_i32 vcc, 0x80, v28
    s_nop 1
    v_cndmask_b32 v16, v16, v83, vcc
    v_lshl_add_u32 v17, v81, 2, s41
    v_lshl_add_u32 v83, v29, 2, s43
    v_cmp_gt_i32 vcc, 0x80, v29
    s_nop 1
    v_cndmask_b32 v17, v17, v83, vcc
    v_subrev_u32 v30, 2, v108
    v_cvt_f32_i32 v80, v30
    v_subrev_u32 v31, 3, v108
    v_cvt_f32_i32 v81, v31
    v_cvt_pk_bf16_f32 v82, v80, v81
    v_and_b32 v80, 0xffff, v82
    v_lshrrev_b32 v81, 16, v82
    v_lshl_add_u32 v18, v80, 2, s41
    v_lshl_add_u32 v83, v30, 2, s43
    v_cmp_gt_i32 vcc, 0x80, v30
    s_nop 1
    v_cndmask_b32 v18, v18, v83, vcc
    v_lshl_add_u32 v19, v81, 2, s41
    v_lshl_add_u32 v83, v31, 2, s43
    v_cmp_gt_i32 vcc, 0x80, v31
    s_nop 1
    v_cndmask_b32 v19, v19, v83, vcc
    v_subrev_u32 v32, 4, v108
    v_cvt_f32_i32 v80, v32
    v_subrev_u32 v33, 5, v108
    v_cvt_f32_i32 v81, v33
    v_cvt_pk_bf16_f32 v82, v80, v81
    v_and_b32 v80, 0xffff, v82
    v_lshrrev_b32 v81, 16, v82
    v_lshl_add_u32 v20, v80, 2, s41
    v_lshl_add_u32 v83, v32, 2, s43
    v_cmp_gt_i32 vcc, 0x80, v32
    s_nop 1
    v_cndmask_b32 v20, v20, v83, vcc
    v_lshl_add_u32 v21, v81, 2, s41
    v_lshl_add_u32 v83, v33, 2, s43
    v_cmp_gt_i32 vcc, 0x80, v33
    s_nop 1
    v_cndmask_b32 v21, v21, v83, vcc
    v_subrev_u32 v34, 6, v108
    v_cvt_f32_i32 v80, v34
    v_subrev_u32 v35, 7, v108
    v_cvt_f32_i32 v81, v35
    v_cvt_pk_bf16_f32 v82, v80, v81
    v_and_b32 v80, 0xffff, v82
    v_lshrrev_b32 v81, 16, v82
    v_lshl_add_u32 v22, v80, 2, s41
    v_lshl_add_u32 v83, v34, 2, s43
    v_cmp_gt_i32 vcc, 0x80, v34
    s_nop 1
    v_cndmask_b32 v22, v22, v83, vcc
    v_lshl_add_u32 v23, v81, 2, s41
    v_lshl_add_u32 v83, v35, 2, s43
    v_cmp_gt_i32 vcc, 0x80, v35
    s_nop 1
    v_cndmask_b32 v23, v23, v83, vcc
    v_subrev_u32 v36, 8, v108
    v_cvt_f32_i32 v80, v36
    v_subrev_u32 v37, 9, v108
    v_cvt_f32_i32 v81, v37
    v_cvt_pk_bf16_f32 v82, v80, v81
    v_and_b32 v80, 0xffff, v82
    v_lshrrev_b32 v81, 16, v82
    v_lshl_add_u32 v24, v80, 2, s41
    v_lshl_add_u32 v83, v36, 2, s43
    v_cmp_gt_i32 vcc, 0x80, v36
    s_nop 1
    v_cndmask_b32 v24, v24, v83, vcc
    v_lshl_add_u32 v25, v81, 2, s41
    v_lshl_add_u32 v83, v37, 2, s43
    v_cmp_gt_i32 vcc, 0x80, v37
    s_nop 1
    v_cndmask_b32 v25, v25, v83, vcc
    v_subrev_u32 v38, 10, v108
    v_cvt_f32_i32 v80, v38
    v_cvt_pk_bf16_f32 v82, v80, v81
    v_and_b32 v80, 0xffff, v82
    v_lshrrev_b32 v81, 16, v82
    v_lshl_add_u32 v26, v80, 2, s41
    v_lshl_add_u32 v83, v38, 2, s43
    v_cmp_gt_i32 vcc, 0x80, v38
    s_nop 1
    v_cndmask_b32 v26, v26, v83, vcc
    s_lshl_b32 s41, s28, 10
    v_add_u32 v108, s41, v0
    s_waitcnt vmcnt(1) lgkmcnt(0)
    ds_read_b32 v28, v16 offset:0
    ds_read_b32 v29, v17 offset:0
    ds_read_b32 v30, v18 offset:0
    ds_read_b32 v31, v19 offset:0
    ds_read_b32 v32, v20 offset:0
    ds_read_b32 v33, v21 offset:0
    ds_read_b32 v34, v22 offset:0
    ds_read_b32 v35, v23 offset:0
    ds_read_b32 v36, v24 offset:0
    ds_read_b32 v37, v25 offset:0
    ds_read_b32 v38, v26 offset:0
    ds_read_b32 v40, v16 offset:2112
    ds_read_b32 v41, v17 offset:2112
    ds_read_b32 v42, v18 offset:2112
    ds_read_b32 v43, v19 offset:2112
    ds_read_b32 v44, v20 offset:2112
    ds_read_b32 v45, v21 offset:2112
    ds_read_b32 v46, v22 offset:2112
    ds_read_b32 v47, v23 offset:2112
    ds_read_b32 v48, v24 offset:2112
    ds_read_b32 v49, v25 offset:2112
    ds_read_b32 v50, v26 offset:2112
    ds_read_b32 v52, v16 offset:4224
    ds_read_b32 v53, v17 offset:4224
    ds_read_b32 v54, v18 offset:4224
    ds_read_b32 v55, v19 offset:4224
    ds_read_b32 v56, v20 offset:4224
    ds_read_b32 v57, v21 offset:4224
    ds_read_b32 v58, v22 offset:4224
    ds_read_b32 v59, v23 offset:4224
    ds_read_b32 v60, v24 offset:4224
    ds_read_b32 v61, v25 offset:4224
    ds_read_b32 v62, v26 offset:4224
    ds_read_b32 v64, v16 offset:6336
    ds_read_b32 v65, v17 offset:6336
    ds_read_b32 v66, v18 offset:6336
    ds_read_b32 v67, v19 offset:6336
    ds_read_b32 v68, v20 offset:6336
    ds_read_b32 v69, v21 offset:6336
    ds_read_b32 v70, v22 offset:6336
    ds_read_b32 v71, v23 offset:6336
    ds_read_b32 v72, v24 offset:6336
    ds_read_b32 v73, v25 offset:6336
    ds_read_b32 v74, v26 offset:6336
    s_waitcnt lgkmcnt(15)
    v_cvt_pk_bf16_f32 v76, v31, v32
    v_cvt_pk_bf16_f32 v77, v33, v34
    v_cvt_pk_bf16_f32 v78, v35, v36
    v_cvt_pk_bf16_f32 v79, v37, v38
    ds_write_b128 v108, v[76:79] offset:0
    v_cvt_pk_bf16_f32 v80, v30, v31
    v_cvt_pk_bf16_f32 v81, v32, v33
    v_cvt_pk_bf16_f32 v82, v34, v35
    v_cvt_pk_bf16_f32 v83, v36, v37
    ds_write_b128 v108, v[80:83] offset:4160
    v_cvt_pk_bf16_f32 v84, v29, v30
    v_cvt_pk_bf16_f32 v85, v31, v32
    v_cvt_pk_bf16_f32 v86, v33, v34
    v_cvt_pk_bf16_f32 v87, v35, v36
    ds_write_b128 v108, v[84:87] offset:8320
    v_cvt_pk_bf16_f32 v88, v28, v29
    v_cvt_pk_bf16_f32 v89, v30, v31
    v_cvt_pk_bf16_f32 v90, v32, v33
    v_cvt_pk_bf16_f32 v91, v34, v35
    ds_write_b128 v108, v[88:91] offset:12480
    v_cvt_pk_bf16_f32 v92, v43, v44
    v_cvt_pk_bf16_f32 v93, v45, v46
    v_cvt_pk_bf16_f32 v94, v47, v48
    v_cvt_pk_bf16_f32 v95, v49, v50
    ds_write_b128 v108, v[92:95] offset:16640
    v_cvt_pk_bf16_f32 v96, v42, v43
    v_cvt_pk_bf16_f32 v97, v44, v45
    v_cvt_pk_bf16_f32 v98, v46, v47
    v_cvt_pk_bf16_f32 v99, v48, v49
    ds_write_b128 v108, v[96:99] offset:20800
    v_cvt_pk_bf16_f32 v100, v41, v42
    v_cvt_pk_bf16_f32 v101, v43, v44
    v_cvt_pk_bf16_f32 v102, v45, v46
    v_cvt_pk_bf16_f32 v103, v47, v48
    ds_write_b128 v108, v[100:103] offset:24960
    v_cvt_pk_bf16_f32 v104, v40, v41
    v_cvt_pk_bf16_f32 v105, v42, v43
    v_cvt_pk_bf16_f32 v106, v44, v45
    v_cvt_pk_bf16_f32 v107, v46, v47
    ds_write_b128 v108, v[104:107] offset:29120
    s_waitcnt lgkmcnt(4)
    v_cvt_pk_bf16_f32 v76, v55, v56
    v_cvt_pk_bf16_f32 v77, v57, v58
    v_cvt_pk_bf16_f32 v78, v59, v60
    v_cvt_pk_bf16_f32 v79, v61, v62
    ds_write_b128 v108, v[76:79] offset:33280
    v_cvt_pk_bf16_f32 v80, v54, v55
    v_cvt_pk_bf16_f32 v81, v56, v57
    v_cvt_pk_bf16_f32 v82, v58, v59
    v_cvt_pk_bf16_f32 v83, v60, v61
    ds_write_b128 v108, v[80:83] offset:37440
    v_cvt_pk_bf16_f32 v84, v53, v54
    v_cvt_pk_bf16_f32 v85, v55, v56
    v_cvt_pk_bf16_f32 v86, v57, v58
    v_cvt_pk_bf16_f32 v87, v59, v60
    ds_write_b128 v108, v[84:87] offset:41600
    v_cvt_pk_bf16_f32 v88, v52, v53
    v_cvt_pk_bf16_f32 v89, v54, v55
    v_cvt_pk_bf16_f32 v90, v56, v57
    v_cvt_pk_bf16_f32 v91, v58, v59
    ds_write_b128 v108, v[88:91] offset:45760
    s_waitcnt lgkmcnt(4)
    v_cvt_pk_bf16_f32 v92, v67, v68
    v_cvt_pk_bf16_f32 v93, v69, v70
    v_cvt_pk_bf16_f32 v94, v71, v72
    v_cvt_pk_bf16_f32 v95, v73, v74
    ds_write_b128 v108, v[92:95] offset:49920
    v_cvt_pk_bf16_f32 v96, v66, v67
    v_cvt_pk_bf16_f32 v97, v68, v69
    v_cvt_pk_bf16_f32 v98, v70, v71
    v_cvt_pk_bf16_f32 v99, v72, v73
    ds_write_b128 v108, v[96:99] offset:54080
    v_cvt_pk_bf16_f32 v100, v65, v66
    v_cvt_pk_bf16_f32 v101, v67, v68
    v_cvt_pk_bf16_f32 v102, v69, v70
    v_cvt_pk_bf16_f32 v103, v71, v72
    ds_write_b128 v108, v[100:103] offset:58240
    v_cvt_pk_bf16_f32 v104, v64, v65
    v_cvt_pk_bf16_f32 v105, v66, v67
    v_cvt_pk_bf16_f32 v106, v68, v69
    v_cvt_pk_bf16_f32 v107, v70, v71
    ds_write_b128 v108, v[104:107] offset:62400
    s_waitcnt lgkmcnt(4)
    s_waitcnt vmcnt(0)
    s_mov_b32 s39, 0x01010101
    v_cmp_ne_u32 vcc, s39, v114
    s_cbranch_vccz p_flag2_x
    s_mov_b32 s38, 0
    v_lshlrev_b32 v115, 2, v1
p_flag2:
    s_sleep 4
    buffer_load_dword v114, v115, s[24:27], 0 offen sc1
    s_add_u32 s38, s38, 1
    s_waitcnt vmcnt(0)
    s_mov_b32 s39, 0x01010101
    v_cmp_ne_u32 vcc, s39, v114
    s_cmp_gt_u32 s38, 131072
    s_cbranch_scc1 p_flag2_x
    s_cbranch_vccnz p_flag2
    s_nop 1
p_flag2_x:
    v_lshl_or_b32 v10, s28, 6, v1
    v_lshlrev_b32 v4, 4, v10
    v_lshl_add_u32 v5, v10, 2, 0
    v_add_u32 v5, 67072, v5
    v_and_b32 v6, 127, v10
    v_lshlrev_b32 v6, 2, v6
    v_add_u32 v6, 84992, v6
    s_cmp_eq_u32 s34, 0
    s_cbranch_scc0 p_oaddr2
    v_lshrrev_b32 v11, 3, v10
    v_lshlrev_b32 v11, 14, v11
    v_and_b32 v10, 7, v10
    v_lshl_add_u32 v11, v10, 4, v11
    s_lshl_b32 s44, s32, 7
    s_add_u32 s44, s44, 8388608
    s_branch p_oaddr3
p_oaddr2:
    v_lshlrev_b32 v11, 11, v10
    s_lshl_b32 s44, s32, 3
p_oaddr3:
    s_lshl_b32 s45, s32, 14
    s_add_u32 s45, s45, s36
    s_lshr_b32 s46, s28, 1
    s_xor_b32 s46, s46, s33
    s_lshr_b32 s47, s28, 1
    s_and_b32 s47, s47, s33
    s_mov_b32 s48, 0xffff0000
    s_mov_b32 s49, 0x3b000000
    v_mov_b32 v115, 0x3727c5ac
    v_mov_b32 v96, 0
    v_mov_b32 v97, 0
    v_mov_b32 v98, 0
    v_mov_b32 v99, 0
    s_mul_i32 s41, s28, 4608
    s_add_u32 s41, s41, 66560
    v_add_u32 v10, s41, v0
    s_waitcnt lgkmcnt(0)
    s_barrier
    s_mov_b32 exec_hi, 0
    ds_write_b128 v10, v[96:99]
    s_mov_b32 exec_hi, -1
    s_add_u32 s40, s45, 0
    buffer_load_dwordx4 v[16:19], v4, s[4:7], s40 offen sc1
    s_add_u32 s40, s37, 0
    buffer_load_dwordx4 v[32:35], v4, s[4:7], s40 offen sc1
    s_add_u32 s40, s40, 16384
    buffer_load_dwordx4 v[36:39], v4, s[4:7], s40 offen sc1
    s_add_u32 s40, s40, 16384
    buffer_load_dwordx4 v[40:43], v4, s[4:7], s40 offen sc1
    s_add_u32 s40, s40, 16384
    buffer_load_dwordx4 v[44:47], v4, s[4:7], s40 offen sc1
    s_add_u32 s40, s45, 4096
    buffer_load_dwordx4 v[20:23], v4, s[4:7], s40 offen sc1
    s_add_u32 s40, s37, 4096
    buffer_load_dwordx4 v[48:51], v4, s[4:7], s40 offen sc1
    s_add_u32 s40, s40, 16384
    buffer_load_dwordx4 v[52:55], v4, s[4:7], s40 offen sc1
    s_add_u32 s40, s40, 16384
    buffer_load_dwordx4 v[56:59], v4, s[4:7], s40 offen sc1
    s_add_u32 s40, s40, 16384
    buffer_load_dwordx4 v[60:63], v4, s[4:7], s40 offen sc1
    s_waitcnt vmcnt(5)
    v_max3_u32 v96, v19, v35, v39
    v_max3_u32 v96, v96, v43, v47
    v_cmp_eq_u32 vcc, -1, v96
    s_cbranch_vccz p_rdy0
    s_mov_b32 s38, 0
p_xpoll0:
    s_add_u32 s40, s45, 0
    buffer_load_dwordx4 v[16:19], v4, s[4:7], s40 offen sc1
    s_add_u32 s40, s37, 0
    buffer_load_dwordx4 v[32:35], v4, s[4:7], s40 offen sc1
    s_add_u32 s40, s40, 16384
    buffer_load_dwordx4 v[36:39], v4, s[4:7], s40 offen sc1
    s_add_u32 s40, s40, 16384
    buffer_load_dwordx4 v[40:43], v4, s[4:7], s40 offen sc1
    s_add_u32 s40, s40, 16384
    buffer_load_dwordx4 v[44:47], v4, s[4:7], s40 offen sc1
    s_add_u32 s38, s38, 1
    s_waitcnt vmcnt(0)
    v_max3_u32 v96, v19, v35, v39
    v_max3_u32 v96, v96, v43, v47
    v_cmp_eq_u32 vcc, -1, v96
    s_cmp_gt_u32 s38, 131072
    s_cbranch_scc1 p_xpoll0_x
    s_cbranch_vccnz p_xpoll0
p_xpoll0_x:
    s_nop 1
p_rdy0:
    v_add_f32 v32, v32, v36
    v_add_f32 v40, v40, v44
    v_add_f32 v33, v33, v37
    v_add_f32 v41, v41, v45
    v_add_f32 v34, v34, v38
    v_add_f32 v42, v42, v46
    v_add_f32 v35, v35, v39
    v_add_f32 v43, v43, v47
    v_add_f32 v32, v32, v40
    v_add_f32 v33, v33, v41
    v_add_f32 v34, v34, v42
    v_add_f32 v35, v35, v43
    v_mul_f32 v32, s49, v32
    v_fma_f32 v33, v33, s49, v115
    v_mul_f32 v34, s49, v34
    v_fma_f32 v35, v35, s49, v115
    v_fma_f32 v33, -v32, v32, v33
    v_fma_f32 v35, -v34, v34, v35
    v_max_f32 v33, v115, v33
    v_max_f32 v35, v115, v35
    v_sqrt_f32 v33, v33
    v_sqrt_f32 v35, v35
    v_lshlrev_b32 v64, 16, v16
    v_and_b32 v65, s48, v16
    v_lshlrev_b32 v66, 16, v17
    v_and_b32 v67, s48, v17
    v_lshlrev_b32 v68, 16, v18
    v_and_b32 v69, s48, v18
    v_lshlrev_b32 v70, 16, v19
    v_and_b32 v71, s48, v19
    v_cvt_pk_bf16_f32 v36, v33, v35
    v_lshlrev_b32 v33, 16, v36
    v_and_b32 v35, s48, v36
    v_rcp_f32 v33, v33
    v_rcp_f32 v35, v35
    v_sub_f32 v96, v64, v32
    v_sub_f32 v97, v65, v32
    v_sub_f32 v98, v66, v32
    v_sub_f32 v99, v67, v32
    v_sub_f32 v100, v68, v34
    v_sub_f32 v101, v69, v34
    v_sub_f32 v102, v70, v34
    v_sub_f32 v103, v71, v34
    v_mul_f32 v96, v96, v33
    v_mul_f32 v97, v97, v33
    v_mul_f32 v98, v98, v33
    v_mul_f32 v99, v99, v33
    v_mul_f32 v100, v100, v35
    v_mul_f32 v101, v101, v35
    v_mul_f32 v102, v102, v35
    v_mul_f32 v103, v103, v35
    v_cvt_pk_bf16_f32 v36, v96, v100
    v_cvt_pk_bf16_f32 v37, v97, v101
    v_cvt_pk_bf16_f32 v38, v98, v102
    v_cvt_pk_bf16_f32 v39, v99, v103
    ds_write_b32 v5, v36 offset:0
    ds_write_b32 v5, v37 offset:4608
    ds_write_b32 v5, v38 offset:9216
    ds_write_b32 v5, v39 offset:13824
    v_lshlrev_b32 v96, 16, v36
    v_and_b32 v100, s48, v36
    v_lshlrev_b32 v97, 16, v37
    v_and_b32 v101, s48, v37
    v_lshlrev_b32 v98, 16, v38
    v_and_b32 v102, s48, v38
    v_lshlrev_b32 v99, 16, v39
    v_and_b32 v103, s48, v39
    v_fma_f32 v64, v96, s56, v64
    v_fma_f32 v65, v97, s57, v65
    v_fma_f32 v66, v98, s58, v66
    v_fma_f32 v67, v99, s59, v67
    v_fma_f32 v68, v100, s56, v68
    v_fma_f32 v69, v101, s57, v69
    v_fma_f32 v70, v102, s58, v70
    v_fma_f32 v71, v103, s59, v71
    s_add_u32 s40, s45, 8192
    buffer_load_dwordx4 v[24:27], v4, s[4:7], s40 offen sc1
    s_add_u32 s40, s37, 8192
    buffer_load_dwordx4 v[32:35], v4, s[4:7], s40 offen sc1
    s_add_u32 s40, s40, 16384
    buffer_load_dwordx4 v[36:39], v4, s[4:7], s40 offen sc1
    s_add_u32 s40, s40, 16384
    buffer_load_dwordx4 v[40:43], v4, s[4:7], s40 offen sc1
    s_add_u32 s40, s40, 16384
    buffer_load_dwordx4 v[44:47], v4, s[4:7], s40 offen sc1
    s_waitcnt lgkmcnt(0)
    s_barrier
    s_waitcnt vmcnt(5)
    v_max3_u32 v96, v23, v51, v55
    v_max3_u32 v96, v96, v59, v63
    v_cmp_eq_u32 vcc, -1, v96
    s_cbranch_vccz p_rdy1
    s_mov_b32 s38, 0
p_xpoll1:
    s_add_u32 s40, s45, 4096
    buffer_load_dwordx4 v[20:23], v4, s[4:7], s40 offen sc1
    s_add_u32 s40, s37, 4096
    buffer_load_dwordx4 v[48:51], v4, s[4:7], s40 offen sc1
    s_add_u32 s40, s40, 16384
    buffer_load_dwordx4 v[52:55], v4, s[4:7], s40 offen sc1
    s_add_u32 s40, s40, 16384
    buffer_load_dwordx4 v[56:59], v4, s[4:7], s40 offen sc1
    s_add_u32 s40, s40, 16384
    buffer_load_dwordx4 v[60:63], v4, s[4:7], s40 offen sc1
    s_add_u32 s38, s38, 1
    s_waitcnt vmcnt(0)
    v_max3_u32 v96, v23, v51, v55
    v_max3_u32 v96, v96, v59, v63
    v_cmp_eq_u32 vcc, -1, v96
    s_cmp_gt_u32 s38, 131072
    s_cbranch_scc1 p_xpoll1_x
    s_cbranch_vccnz p_xpoll1
p_xpoll1_x:
    s_nop 1
p_rdy1:
    v_add_f32 v48, v48, v52
    v_add_f32 v56, v56, v60
    v_add_f32 v49, v49, v53
    v_add_f32 v57, v57, v61
    v_add_f32 v50, v50, v54
    v_add_f32 v58, v58, v62
    v_add_f32 v51, v51, v55
    v_add_f32 v59, v59, v63
    v_add_f32 v48, v48, v56
    v_add_f32 v49, v49, v57
    v_add_f32 v50, v50, v58
    v_add_f32 v51, v51, v59
    v_mul_f32 v48, s49, v48
    v_fma_f32 v49, v49, s49, v115
    v_mul_f32 v50, s49, v50
    v_fma_f32 v51, v51, s49, v115
    v_fma_f32 v49, -v48, v48, v49
    v_fma_f32 v51, -v50, v50, v51
    v_max_f32 v49, v115, v49
    v_max_f32 v51, v115, v51
    v_sqrt_f32 v49, v49
    v_sqrt_f32 v51, v51
    v_lshlrev_b32 v72, 16, v20
    v_and_b32 v73, s48, v20
    v_lshlrev_b32 v74, 16, v21
    v_and_b32 v75, s48, v21
    v_lshlrev_b32 v76, 16, v22
    v_and_b32 v77, s48, v22
    v_lshlrev_b32 v78, 16, v23
    v_and_b32 v79, s48, v23
    v_cvt_pk_bf16_f32 v52, v49, v51
    v_lshlrev_b32 v49, 16, v52
    v_and_b32 v51, s48, v52
    v_rcp_f32 v49, v49
    v_rcp_f32 v51, v51
    v_sub_f32 v96, v72, v48
    v_sub_f32 v97, v73, v48
    v_sub_f32 v98, v74, v48
    v_sub_f32 v99, v75, v48
    v_sub_f32 v100, v76, v50
    v_sub_f32 v101, v77, v50
    v_sub_f32 v102, v78, v50
    v_sub_f32 v103, v79, v50
    v_mul_f32 v96, v96, v49
    v_mul_f32 v97, v97, v49
    v_mul_f32 v98, v98, v49
    v_mul_f32 v99, v99, v49
    v_mul_f32 v100, v100, v51
    v_mul_f32 v101, v101, v51
    v_mul_f32 v102, v102, v51
    v_mul_f32 v103, v103, v51
    v_cvt_pk_bf16_f32 v52, v96, v100
    v_cvt_pk_bf16_f32 v53, v97, v101
    v_cvt_pk_bf16_f32 v54, v98, v102
    v_cvt_pk_bf16_f32 v55, v99, v103
    ds_write_b32 v5, v52 offset:1024
    ds_write_b32 v5, v53 offset:5632
    ds_write_b32 v5, v54 offset:10240
    ds_write_b32 v5, v55 offset:14848
    v_lshlrev_b32 v96, 16, v52
    v_and_b32 v100, s48, v52
    v_lshlrev_b32 v97, 16, v53
    v_and_b32 v101, s48, v53
    v_lshlrev_b32 v98, 16, v54
    v_and_b32 v102, s48, v54
    v_lshlrev_b32 v99, 16, v55
    v_and_b32 v103, s48, v55
    v_fma_f32 v72, v96, s56, v72
    v_fma_f32 v73, v97, s57, v73
    v_fma_f32 v74, v98, s58, v74
    v_fma_f32 v75, v99, s59, v75
    v_fma_f32 v76, v100, s56, v76
    v_fma_f32 v77, v101, s57, v77
    v_fma_f32 v78, v102, s58, v78
    v_fma_f32 v79, v103, s59, v79
    s_add_u32 s40, s45, 12288
    buffer_load_dwordx4 v[28:31], v4, s[4:7], s40 offen sc1
    s_add_u32 s40, s37, 12288
    buffer_load_dwordx4 v[48:51], v4, s[4:7], s40 offen sc1
    s_add_u32 s40, s40, 16384
    buffer_load_dwordx4 v[52:55], v4, s[4:7], s40 offen sc1
    s_add_u32 s40, s40, 16384
    buffer_load_dwordx4 v[56:59], v4, s[4:7], s40 offen sc1
    s_add_u32 s40, s40, 16384
    buffer_load_dwordx4 v[60:63], v4, s[4:7], s40 offen sc1
    s_waitcnt lgkmcnt(0)
    s_barrier
    s_waitcnt vmcnt(5)
    v_max3_u32 v96, v27, v35, v39
    v_max3_u32 v96, v96, v43, v47
    v_cmp_eq_u32 vcc, -1, v96
    s_cbranch_vccz p_rdy2
    s_mov_b32 s38, 0
p_xpoll2:
    s_add_u32 s40, s45, 8192
    buffer_load_dwordx4 v[24:27], v4, s[4:7], s40 offen sc1
    s_add_u32 s40, s37, 8192
    buffer_load_dwordx4 v[32:35], v4, s[4:7], s40 offen sc1
    s_add_u32 s40, s40, 16384
    buffer_load_dwordx4 v[36:39], v4, s[4:7], s40 offen sc1
    s_add_u32 s40, s40, 16384
    buffer_load_dwordx4 v[40:43], v4, s[4:7], s40 offen sc1
    s_add_u32 s40, s40, 16384
    buffer_load_dwordx4 v[44:47], v4, s[4:7], s40 offen sc1
    s_add_u32 s38, s38, 1
    s_waitcnt vmcnt(0)
    v_max3_u32 v96, v27, v35, v39
    v_max3_u32 v96, v96, v43, v47
    v_cmp_eq_u32 vcc, -1, v96
    s_cmp_gt_u32 s38, 131072
    s_cbranch_scc1 p_xpoll2_x
    s_cbranch_vccnz p_xpoll2
p_xpoll2_x:
    s_nop 1
p_rdy2:
    v_add_f32 v32, v32, v36
    v_add_f32 v40, v40, v44
    v_add_f32 v33, v33, v37
    v_add_f32 v41, v41, v45
    v_add_f32 v34, v34, v38
    v_add_f32 v42, v42, v46
    v_add_f32 v35, v35, v39
    v_add_f32 v43, v43, v47
    v_add_f32 v32, v32, v40
    v_add_f32 v33, v33, v41
    v_add_f32 v34, v34, v42
    v_add_f32 v35, v35, v43
    v_mul_f32 v32, s49, v32
    v_fma_f32 v33, v33, s49, v115
    v_mul_f32 v34, s49, v34
    v_fma_f32 v35, v35, s49, v115
    v_fma_f32 v33, -v32, v32, v33
    v_fma_f32 v35, -v34, v34, v35
    v_max_f32 v33, v115, v33
    v_max_f32 v35, v115, v35
    v_sqrt_f32 v33, v33
    v_sqrt_f32 v35, v35
    v_lshlrev_b32 v80, 16, v24
    v_and_b32 v81, s48, v24
    v_lshlrev_b32 v82, 16, v25
    v_and_b32 v83, s48, v25
    v_lshlrev_b32 v84, 16, v26
    v_and_b32 v85, s48, v26
    v_lshlrev_b32 v86, 16, v27
    v_and_b32 v87, s48, v27
    v_cvt_pk_bf16_f32 v36, v33, v35
    v_lshlrev_b32 v33, 16, v36
    v_and_b32 v35, s48, v36
    v_rcp_f32 v33, v33
    v_rcp_f32 v35, v35
    v_sub_f32 v96, v80, v32
    v_sub_f32 v97, v81, v32
    v_sub_f32 v98, v82, v32
    v_sub_f32 v99, v83, v32
    v_sub_f32 v100, v84, v34
    v_sub_f32 v101, v85, v34
    v_sub_f32 v102, v86, v34
    v_sub_f32 v103, v87, v34
    v_mul_f32 v96, v96, v33
    v_mul_f32 v97, v97, v33
    v_mul_f32 v98, v98, v33
    v_mul_f32 v99, v99, v33
    v_mul_f32 v100, v100, v35
    v_mul_f32 v101, v101, v35
    v_mul_f32 v102, v102, v35
    v_mul_f32 v103, v103, v35
    v_cvt_pk_bf16_f32 v36, v96, v100
    v_cvt_pk_bf16_f32 v37, v97, v101
    v_cvt_pk_bf16_f32 v38, v98, v102
    v_cvt_pk_bf16_f32 v39, v99, v103
    ds_write_b32 v5, v36 offset:2048
    ds_write_b32 v5, v37 offset:6656
    ds_write_b32 v5, v38 offset:11264
    ds_write_b32 v5, v39 offset:15872
    v_lshlrev_b32 v96, 16, v36
    v_and_b32 v100, s48, v36
    v_lshlrev_b32 v97, 16, v37
    v_and_b32 v101, s48, v37
    v_lshlrev_b32 v98, 16, v38
    v_and_b32 v102, s48, v38
    v_lshlrev_b32 v99, 16, v39
    v_and_b32 v103, s48, v39
    v_fma_f32 v80, v96, s56, v80
    v_fma_f32 v81, v97, s57, v81
    v_fma_f32 v82, v98, s58, v82
    v_fma_f32 v83, v99, s59, v83
    v_fma_f32 v84, v100, s56, v84
    v_fma_f32 v85, v101, s57, v85
    v_fma_f32 v86, v102, s58, v86
    v_fma_f32 v87, v103, s59, v87
    s_waitcnt vmcnt(0)
    s_xor_b32 s40, s46, 0
    s_bitcmp1_b32 s40, 0
    s_cbranch_scc1 p_noepi0
    ds_read_b32 v104, v6 offset:0
    ds_read_b32 v105, v6 offset:512
    ds_read_b32 v106, v6 offset:1024
    ds_read_b32 v107, v6 offset:1536
    s_add_u32 s40, s44, 0
    s_waitcnt lgkmcnt(0)
    v_lshlrev_b32 v96, 16, v104
    v_and_b32 v100, s48, v104
    v_lshlrev_b32 v97, 16, v105
    v_and_b32 v101, s48, v105
    v_lshlrev_b32 v98, 16, v106
    v_and_b32 v102, s48, v106
    v_lshlrev_b32 v99, 16, v107
    v_and_b32 v103, s48, v107
    v_add_f32 v96, v96, v64
    v_add_f32 v97, v97, v65
    v_add_f32 v98, v98, v66
    v_add_f32 v99, v99, v67
    v_add_f32 v100, v100, v68
    v_add_f32 v101, v101, v69
    v_add_f32 v102, v102, v70
    v_add_f32 v103, v103, v71
    v_cvt_pk_bf16_f32 v104, v96, v97
    v_cvt_pk_bf16_f32 v105, v98, v99
    v_cvt_pk_bf16_f32 v106, v100, v101
    v_cvt_pk_bf16_f32 v107, v102, v103
    s_cmp_eq_u32 s34, 0
    s_cbranch_scc0 p_epo0
    v_min_u32 v107, -2, v107
    buffer_store_dwordx4 v[104:107], v11, s[4:7], s40 offen sc1
    s_branch p_noepi0
p_epo0:
    buffer_store_dwordx2 v[104:105], v11, s[20:23], s40 offen
    buffer_store_dwordx2 v[106:107], v11, s[20:23], s40 offen offset:1024
p_noepi0:
    s_waitcnt lgkmcnt(0)
    s_barrier
    v_max3_u32 v96, v31, v51, v55
    v_max3_u32 v96, v96, v59, v63
    v_cmp_eq_u32 vcc, -1, v96
    s_cbranch_vccz p_rdy3
    s_mov_b32 s38, 0
p_xpoll3:
    s_add_u32 s40, s45, 12288
    buffer_load_dwordx4 v[28:31], v4, s[4:7], s40 offen sc1
    s_add_u32 s40, s37, 12288
    buffer_load_dwordx4 v[48:51], v4, s[4:7], s40 offen sc1
    s_add_u32 s40, s40, 16384
    buffer_load_dwordx4 v[52:55], v4, s[4:7], s40 offen sc1
    s_add_u32 s40, s40, 16384
    buffer_load_dwordx4 v[56:59], v4, s[4:7], s40 offen sc1
    s_add_u32 s40, s40, 16384
    buffer_load_dwordx4 v[60:63], v4, s[4:7], s40 offen sc1
    s_add_u32 s38, s38, 1
    s_waitcnt vmcnt(0)
    v_max3_u32 v96, v31, v51, v55
    v_max3_u32 v96, v96, v59, v63
    v_cmp_eq_u32 vcc, -1, v96
    s_cmp_gt_u32 s38, 131072
    s_cbranch_scc1 p_xpoll3_x
    s_cbranch_vccnz p_xpoll3
p_xpoll3_x:
    s_nop 1
p_rdy3:
    s_cmp_eq_u32 s47, 1
    s_cbranch_scc1 p_noq3b
    v_add_f32 v48, v48, v52
    v_add_f32 v56, v56, v60
    v_add_f32 v49, v49, v53
    v_add_f32 v57, v57, v61
    v_add_f32 v50, v50, v54
    v_add_f32 v58, v58, v62
    v_add_f32 v51, v51, v55
    v_add_f32 v59, v59, v63
    v_add_f32 v48, v48, v56
    v_add_f32 v49, v49, v57
    v_add_f32 v50, v50, v58
    v_add_f32 v51, v51, v59
    v_mul_f32 v48, s49, v48
    v_fma_f32 v49, v49, s49, v115
    v_mul_f32 v50, s49, v50
    v_fma_f32 v51, v51, s49, v115
    v_fma_f32 v49, -v48, v48, v49
    v_fma_f32 v51, -v50, v50, v51
    v_max_f32 v49, v115, v49
    v_max_f32 v51, v115, v51
    v_sqrt_f32 v49, v49
    v_sqrt_f32 v51, v51
    v_lshlrev_b32 v88, 16, v28
    v_and_b32 v89, s48, v28
    v_lshlrev_b32 v90, 16, v29
    v_and_b32 v91, s48, v29
    v_lshlrev_b32 v92, 16, v30
    v_and_b32 v93, s48, v30
    v_lshlrev_b32 v94, 16, v31
    v_and_b32 v95, s48, v31
    v_cvt_pk_bf16_f32 v52, v49, v51
    v_lshlrev_b32 v49, 16, v52
    v_and_b32 v51, s48, v52
    v_rcp_f32 v49, v49
    v_rcp_f32 v51, v51
    v_sub_f32 v96, v88, v48
    v_sub_f32 v97, v89, v48
    v_sub_f32 v98, v90, v48
    v_sub_f32 v99, v91, v48
    v_sub_f32 v100, v92, v50
    v_sub_f32 v101, v93, v50
    v_sub_f32 v102, v94, v50
    v_sub_f32 v103, v95, v50
    v_mul_f32 v96, v96, v49
    v_mul_f32 v97, v97, v49
    v_mul_f32 v98, v98, v49
    v_mul_f32 v99, v99, v49
    v_mul_f32 v100, v100, v51
    v_mul_f32 v101, v101, v51
    v_mul_f32 v102, v102, v51
    v_mul_f32 v103, v103, v51
    v_cvt_pk_bf16_f32 v52, v96, v100
    v_cvt_pk_bf16_f32 v53, v97, v101
    v_cvt_pk_bf16_f32 v54, v98, v102
    v_cvt_pk_bf16_f32 v55, v99, v103
    ds_write_b32 v5, v52 offset:3072
    ds_write_b32 v5, v53 offset:7680
    ds_write_b32 v5, v54 offset:12288
    ds_write_b32 v5, v55 offset:16896
    v_lshlrev_b32 v96, 16, v52
    v_and_b32 v100, s48, v52
    v_lshlrev_b32 v97, 16, v53
    v_and_b32 v101, s48, v53
    v_lshlrev_b32 v98, 16, v54
    v_and_b32 v102, s48, v54
    v_lshlrev_b32 v99, 16, v55
    v_and_b32 v103, s48, v55
    v_fma_f32 v88, v96, s56, v88
    v_fma_f32 v89, v97, s57, v89
    v_fma_f32 v90, v98, s58, v90
    v_fma_f32 v91, v99, s59, v91
    v_fma_f32 v92, v100, s56, v92
    v_fma_f32 v93, v101, s57, v93
    v_fma_f32 v94, v102, s58, v94
    v_fma_f32 v95, v103, s59, v95
    s_nop 2
p_noq3b:
    s_xor_b32 s40, s46, 1
    s_bitcmp1_b32 s40, 0
    s_cbranch_scc1 p_noepi1
    ds_read_b32 v104, v6 offset:2048
    ds_read_b32 v105, v6 offset:2560
    ds_read_b32 v106, v6 offset:3072
    ds_read_b32 v107, v6 offset:3584
    s_add_u32 s40, s44, 524288
    s_waitcnt lgkmcnt(0)
    v_lshlrev_b32 v96, 16, v104
    v_and_b32 v100, s48, v104
    v_lshlrev_b32 v97, 16, v105
    v_and_b32 v101, s48, v105
    v_lshlrev_b32 v98, 16, v106
    v_and_b32 v102, s48, v106
    v_lshlrev_b32 v99, 16, v107
    v_and_b32 v103, s48, v107
    v_add_f32 v96, v96, v72
    v_add_f32 v97, v97, v73
    v_add_f32 v98, v98, v74
    v_add_f32 v99, v99, v75
    v_add_f32 v100, v100, v76
    v_add_f32 v101, v101, v77
    v_add_f32 v102, v102, v78
    v_add_f32 v103, v103, v79
    v_cvt_pk_bf16_f32 v104, v96, v97
    v_cvt_pk_bf16_f32 v105, v98, v99
    v_cvt_pk_bf16_f32 v106, v100, v101
    v_cvt_pk_bf16_f32 v107, v102, v103
    s_cmp_eq_u32 s34, 0
    s_cbranch_scc0 p_epo1
    v_min_u32 v107, -2, v107
    buffer_store_dwordx4 v[104:107], v11, s[4:7], s40 offen sc1
    s_branch p_noepi1
p_epo1:
    buffer_store_dwordx2 v[104:105], v11, s[20:23], s40 offen
    buffer_store_dwordx2 v[106:107], v11, s[20:23], s40 offen offset:1024
p_noepi1:
    s_waitcnt lgkmcnt(0)
    s_barrier
    s_xor_b32 s40, s46, 0
    s_bitcmp1_b32 s40, 0
    s_cbranch_scc1 p_noepi2
    ds_read_b32 v104, v6 offset:4096
    ds_read_b32 v105, v6 offset:4608
    ds_read_b32 v106, v6 offset:5120
    ds_read_b32 v107, v6 offset:5632
    s_add_u32 s40, s44, 1048576
    s_waitcnt lgkmcnt(0)
    v_lshlrev_b32 v96, 16, v104
    v_and_b32 v100, s48, v104
    v_lshlrev_b32 v97, 16, v105
    v_and_b32 v101, s48, v105
    v_lshlrev_b32 v98, 16, v106
    v_and_b32 v102, s48, v106
    v_lshlrev_b32 v99, 16, v107
    v_and_b32 v103, s48, v107
    v_add_f32 v96, v96, v80
    v_add_f32 v97, v97, v81
    v_add_f32 v98, v98, v82
    v_add_f32 v99, v99, v83
    v_add_f32 v100, v100, v84
    v_add_f32 v101, v101, v85
    v_add_f32 v102, v102, v86
    v_add_f32 v103, v103, v87
    v_cvt_pk_bf16_f32 v104, v96, v97
    v_cvt_pk_bf16_f32 v105, v98, v99
    v_cvt_pk_bf16_f32 v106, v100, v101
    v_cvt_pk_bf16_f32 v107, v102, v103
    s_cmp_eq_u32 s34, 0
    s_cbranch_scc0 p_epo2
    v_min_u32 v107, -2, v107
    buffer_store_dwordx4 v[104:107], v11, s[4:7], s40 offen sc1
    s_branch p_noepi2
p_epo2:
    buffer_store_dwordx2 v[104:105], v11, s[20:23], s40 offen
    buffer_store_dwordx2 v[106:107], v11, s[20:23], s40 offen offset:1024
p_noepi2:
    s_barrier
    s_xor_b32 s40, s46, 1
    s_bitcmp1_b32 s40, 0
    s_cbranch_scc1 p_noepi3
    ds_read_b32 v104, v6 offset:6144
    ds_read_b32 v105, v6 offset:6656
    ds_read_b32 v106, v6 offset:7168
    ds_read_b32 v107, v6 offset:7680
    s_add_u32 s40, s44, 1572864
    s_waitcnt lgkmcnt(0)
    v_lshlrev_b32 v96, 16, v104
    v_and_b32 v100, s48, v104
    v_lshlrev_b32 v97, 16, v105
    v_and_b32 v101, s48, v105
    v_lshlrev_b32 v98, 16, v106
    v_and_b32 v102, s48, v106
    v_lshlrev_b32 v99, 16, v107
    v_and_b32 v103, s48, v107
    v_add_f32 v96, v96, v88
    v_add_f32 v97, v97, v89
    v_add_f32 v98, v98, v90
    v_add_f32 v99, v99, v91
    v_add_f32 v100, v100, v92
    v_add_f32 v101, v101, v93
    v_add_f32 v102, v102, v94
    v_add_f32 v103, v103, v95
    v_cvt_pk_bf16_f32 v104, v96, v97
    v_cvt_pk_bf16_f32 v105, v98, v99
    v_cvt_pk_bf16_f32 v106, v100, v101
    v_cvt_pk_bf16_f32 v107, v102, v103
    s_cmp_eq_u32 s34, 0
    s_cbranch_scc0 p_epo3
    v_min_u32 v107, -2, v107
    buffer_store_dwordx4 v[104:107], v11, s[4:7], s40 offen sc1
    s_branch p_noepi3
p_epo3:
    buffer_store_dwordx2 v[104:105], v11, s[20:23], s40 offen
    buffer_store_dwordx2 v[106:107], v11, s[20:23], s40 offen offset:1024
p_noepi3:
    s_cmp_eq_u32 s34, 1
    s_cbranch_scc1 k_done
    s_mov_b32 s34, 1
    s_mov_b32 s35, 2097152
    s_mov_b32 s36, 6291456
    s_mov_b32 s37, 10551296
    v_xor_b32 v10, 64, v2
    v_xor_b32 v11, 64, v3
    s_lshl_b32 s40, s30, 16
    s_lshl_b32 s41, s28, 10
    s_add_u32 s40, s40, s41
    s_add_u32 s40, s40, 8372224
    s_cmp_eq_u32 s30, 0
    s_cselect_b32 s42, 0x7f000000, 0
    v_add_u32 v56, s42, v0
    v_and_b32 v59, 7, v1
    s_and_b32 s43, s28, 1
    s_lshl_b32 s43, s43, 2
    v_lshrrev_b32 v58, 4, v1
    v_xor_b32 v58, v58, v59
    v_xor_b32 v58, s43, v58
    v_lshlrev_b32 v57, 8, v59
    v_lshl_add_u32 v57, v58, 4, v57
    v_bfe_u32 v58, v1, 3, 1
    v_lshl_add_u32 v57, v58, 3, v57
    s_lshr_b32 s43, s28, 1
    s_lshl_b32 s43, s43, 11
    v_add_u32 v57, s43, v57
    v_add_u32 v58, 0x10000, v57
    v_cmp_eq_u32 s[44:45], 0, v59
    s_waitcnt vmcnt(0)
    s_mov_b32 s38, 0
p_x2poll:
    s_add_u32 s43, s40, 0
    buffer_load_dwordx4 v[16:19], v56, s[4:7], s43 offen sc1
    s_add_u32 s43, s40, 16384
    buffer_load_dwordx4 v[20:23], v0, s[4:7], s43 offen sc1
    s_add_u32 s43, s40, 32768
    buffer_load_dwordx4 v[24:27], v0, s[4:7], s43 offen sc1
    s_add_u32 s43, s40, 49152
    buffer_load_dwordx4 v[28:31], v0, s[4:7], s43 offen sc1
    s_add_u32 s43, s40, 65536
    buffer_load_dwordx4 v[32:35], v0, s[4:7], s43 offen sc1
    s_add_u32 s43, s40, 8192
    buffer_load_dwordx4 v[36:39], v56, s[4:7], s43 offen sc1
    s_add_u32 s43, s40, 24576
    buffer_load_dwordx4 v[40:43], v0, s[4:7], s43 offen sc1
    s_add_u32 s43, s40, 40960
    buffer_load_dwordx4 v[44:47], v0, s[4:7], s43 offen sc1
    s_add_u32 s43, s40, 57344
    buffer_load_dwordx4 v[48:51], v0, s[4:7], s43 offen sc1
    s_add_u32 s43, s40, 73728
    buffer_load_dwordx4 v[52:55], v0, s[4:7], s43 offen sc1
    s_add_u32 s38, s38, 1
    s_waitcnt vmcnt(0)
    v_max3_u32 v59, v19, v23, v27
    v_max3_u32 v59, v59, v31, v35
    v_max3_u32 v59, v59, v39, v43
    v_max3_u32 v59, v59, v47, v51
    v_max_u32 v59, v59, v55
    v_cmp_eq_u32 vcc, -1, v59
    s_cmp_gt_u32 s38, 131072
    s_cbranch_scc1 p_x2poll_x
    s_cbranch_vccnz p_x2poll
p_x2poll_x:
    v_mov_b32 v59, 0x3f803f80
    v_cndmask_b32 v16, v16, v59, s[44:45]
    v_cndmask_b32 v17, v17, v59, s[44:45]
    v_cndmask_b32 v36, v36, v59, s[44:45]
    v_cndmask_b32 v37, v37, v59, s[44:45]
    ds_write_b64 v57, v[16:17] offset:0
    ds_write_b64 v57, v[18:19] offset:128
    ds_write_b64 v57, v[20:21] offset:16384
    ds_write_b64 v57, v[22:23] offset:16512
    ds_write_b64 v57, v[24:25] offset:32768
    ds_write_b64 v57, v[26:27] offset:32896
    ds_write_b64 v57, v[28:29] offset:49152
    ds_write_b64 v57, v[30:31] offset:49280
    ds_write_b64 v58, v[32:33] offset:0
    ds_write_b64 v58, v[34:35] offset:128
    ds_write_b64 v57, v[36:37] offset:8192
    ds_write_b64 v57, v[38:39] offset:8320
    ds_write_b64 v57, v[40:41] offset:24576
    ds_write_b64 v57, v[42:43] offset:24704
    ds_write_b64 v57, v[44:45] offset:40960
    ds_write_b64 v57, v[46:47] offset:41088
    ds_write_b64 v57, v[48:49] offset:57344
    ds_write_b64 v57, v[50:51] offset:57472
    ds_write_b64 v58, v[52:53] offset:8192
    ds_write_b64 v58, v[54:55] offset:8320
    s_waitcnt lgkmcnt(0)
    s_barrier
    ds_read_b128 v[52:55], v2 offset:0
    ds_read_b128 v[56:59], v2 offset:16384
    ds_read_b128 v[60:63], v2 offset:32768
    ds_read_b128 v[64:67], v2 offset:49152
    ds_read_b128 v[68:71], v3 offset:0
    s_waitcnt lgkmcnt(4)
    v_mfma_f32_16x16x32_bf16 v[16:19], v[124:127], v[52:55], 0
    s_waitcnt lgkmcnt(3)
    v_mfma_f32_16x16x32_bf16 v[20:23], v[124:127], v[56:59], 0
    ds_read_b128 v[72:75], v10 offset:0
    v_mfma_f32_16x16x32_bf16 v[36:39], v[120:123], v[56:59], 0
    ds_read_b128 v[76:79], v10 offset:16384
    s_waitcnt lgkmcnt(4)
    v_mfma_f32_16x16x32_bf16 v[24:27], v[124:127], v[60:63], 0
    ds_read_b128 v[80:83], v10 offset:32768
    v_mfma_f32_16x16x32_bf16 v[40:43], v[120:123], v[60:63], 0
    ds_read_b128 v[84:87], v10 offset:49152
    s_waitcnt lgkmcnt(5)
    v_mfma_f32_16x16x32_bf16 v[28:31], v[124:127], v[64:67], 0
    ds_read_b128 v[88:91], v11 offset:0
    v_mfma_f32_16x16x32_bf16 v[44:47], v[120:123], v[64:67], 0
    s_waitcnt lgkmcnt(5)
    v_mfma_f32_16x16x32_bf16 v[32:35], v[124:127], v[68:71], 0
    v_mfma_f32_16x16x32_bf16 v[48:51], v[120:123], v[68:71], 0
    s_waitcnt lgkmcnt(4)
    v_mfma_f32_16x16x32_bf16 v[16:19], v[132:135], v[72:75], v[16:19]
    s_waitcnt lgkmcnt(3)
    v_mfma_f32_16x16x32_bf16 v[20:23], v[132:135], v[76:79], v[20:23]
    ds_read_b128 v[52:55], v2 offset:2048
    v_mfma_f32_16x16x32_bf16 v[36:39], v[128:131], v[76:79], v[36:39]
    ds_read_b128 v[56:59], v2 offset:18432
    s_waitcnt lgkmcnt(4)
    v_mfma_f32_16x16x32_bf16 v[24:27], v[132:135], v[80:83], v[24:27]
    ds_read_b128 v[60:63], v2 offset:34816
    v_mfma_f32_16x16x32_bf16 v[40:43], v[128:131], v[80:83], v[40:43]
    ds_read_b128 v[64:67], v2 offset:51200
    s_waitcnt lgkmcnt(5)
    v_mfma_f32_16x16x32_bf16 v[28:31], v[132:135], v[84:87], v[28:31]
    ds_read_b128 v[68:71], v3 offset:2048
    v_mfma_f32_16x16x32_bf16 v[44:47], v[128:131], v[84:87], v[44:47]
    s_waitcnt lgkmcnt(5)
    v_mfma_f32_16x16x32_bf16 v[32:35], v[132:135], v[88:91], v[32:35]
    v_mfma_f32_16x16x32_bf16 v[48:51], v[128:131], v[88:91], v[48:51]
    s_waitcnt lgkmcnt(4)
    v_mfma_f32_16x16x32_bf16 v[16:19], v[140:143], v[52:55], v[16:19]
    s_waitcnt lgkmcnt(3)
    v_mfma_f32_16x16x32_bf16 v[20:23], v[140:143], v[56:59], v[20:23]
    ds_read_b128 v[72:75], v10 offset:2048
    v_mfma_f32_16x16x32_bf16 v[36:39], v[136:139], v[56:59], v[36:39]
    ds_read_b128 v[76:79], v10 offset:18432
    s_waitcnt lgkmcnt(4)
    v_mfma_f32_16x16x32_bf16 v[24:27], v[140:143], v[60:63], v[24:27]
    ds_read_b128 v[80:83], v10 offset:34816
    v_mfma_f32_16x16x32_bf16 v[40:43], v[136:139], v[60:63], v[40:43]
    ds_read_b128 v[84:87], v10 offset:51200
    s_waitcnt lgkmcnt(5)
    v_mfma_f32_16x16x32_bf16 v[28:31], v[140:143], v[64:67], v[28:31]
    ds_read_b128 v[88:91], v11 offset:2048
    v_mfma_f32_16x16x32_bf16 v[44:47], v[136:139], v[64:67], v[44:47]
    s_waitcnt lgkmcnt(5)
    v_mfma_f32_16x16x32_bf16 v[32:35], v[140:143], v[68:71], v[32:35]
    v_mfma_f32_16x16x32_bf16 v[48:51], v[136:139], v[68:71], v[48:51]
    s_waitcnt lgkmcnt(4)
    v_mfma_f32_16x16x32_bf16 v[16:19], v[148:151], v[72:75], v[16:19]
    s_waitcnt lgkmcnt(3)
    v_mfma_f32_16x16x32_bf16 v[20:23], v[148:151], v[76:79], v[20:23]
    ds_read_b128 v[52:55], v2 offset:4096
    v_mfma_f32_16x16x32_bf16 v[36:39], v[144:147], v[76:79], v[36:39]
    ds_read_b128 v[56:59], v2 offset:20480
    s_waitcnt lgkmcnt(4)
    v_mfma_f32_16x16x32_bf16 v[24:27], v[148:151], v[80:83], v[24:27]
    ds_read_b128 v[60:63], v2 offset:36864
    v_mfma_f32_16x16x32_bf16 v[40:43], v[144:147], v[80:83], v[40:43]
    ds_read_b128 v[64:67], v2 offset:53248
    s_waitcnt lgkmcnt(5)
    v_mfma_f32_16x16x32_bf16 v[28:31], v[148:151], v[84:87], v[28:31]
    ds_read_b128 v[68:71], v3 offset:4096
    v_mfma_f32_16x16x32_bf16 v[44:47], v[144:147], v[84:87], v[44:47]
    s_waitcnt lgkmcnt(5)
    v_mfma_f32_16x16x32_bf16 v[32:35], v[148:151], v[88:91], v[32:35]
    v_mfma_f32_16x16x32_bf16 v[48:51], v[144:147], v[88:91], v[48:51]
    s_waitcnt lgkmcnt(4)
    v_mfma_f32_16x16x32_bf16 v[16:19], v[156:159], v[52:55], v[16:19]
    s_waitcnt lgkmcnt(3)
    v_mfma_f32_16x16x32_bf16 v[20:23], v[156:159], v[56:59], v[20:23]
    ds_read_b128 v[72:75], v10 offset:4096
    v_mfma_f32_16x16x32_bf16 v[36:39], v[152:155], v[56:59], v[36:39]
    ds_read_b128 v[76:79], v10 offset:20480
    s_waitcnt lgkmcnt(4)
    v_mfma_f32_16x16x32_bf16 v[24:27], v[156:159], v[60:63], v[24:27]
    ds_read_b128 v[80:83], v10 offset:36864
    v_mfma_f32_16x16x32_bf16 v[40:43], v[152:155], v[60:63], v[40:43]
    ds_read_b128 v[84:87], v10 offset:53248
    s_waitcnt lgkmcnt(5)
    v_mfma_f32_16x16x32_bf16 v[28:31], v[156:159], v[64:67], v[28:31]
    ds_read_b128 v[88:91], v11 offset:4096
    v_mfma_f32_16x16x32_bf16 v[44:47], v[152:155], v[64:67], v[44:47]
    s_waitcnt lgkmcnt(5)
    v_mfma_f32_16x16x32_bf16 v[32:35], v[156:159], v[68:71], v[32:35]
    v_mfma_f32_16x16x32_bf16 v[48:51], v[152:155], v[68:71], v[48:51]
    s_waitcnt lgkmcnt(4)
    v_mfma_f32_16x16x32_bf16 v[16:19], v[164:167], v[72:75], v[16:19]
    s_waitcnt lgkmcnt(3)
    v_mfma_f32_16x16x32_bf16 v[20:23], v[164:167], v[76:79], v[20:23]
    ds_read_b128 v[52:55], v2 offset:6144
    v_mfma_f32_16x16x32_bf16 v[36:39], v[160:163], v[76:79], v[36:39]
    ds_read_b128 v[56:59], v2 offset:22528
    s_waitcnt lgkmcnt(4)
    v_mfma_f32_16x16x32_bf16 v[24:27], v[164:167], v[80:83], v[24:27]
    ds_read_b128 v[60:63], v2 offset:38912
    v_mfma_f32_16x16x32_bf16 v[40:43], v[160:163], v[80:83], v[40:43]
    ds_read_b128 v[64:67], v2 offset:55296
    s_waitcnt lgkmcnt(5)
    v_mfma_f32_16x16x32_bf16 v[28:31], v[164:167], v[84:87], v[28:31]
    ds_read_b128 v[68:71], v3 offset:6144
    v_mfma_f32_16x16x32_bf16 v[44:47], v[160:163], v[84:87], v[44:47]
    s_waitcnt lgkmcnt(5)
    v_mfma_f32_16x16x32_bf16 v[32:35], v[164:167], v[88:91], v[32:35]
    v_mfma_f32_16x16x32_bf16 v[48:51], v[160:163], v[88:91], v[48:51]
    s_waitcnt lgkmcnt(4)
    v_mfma_f32_16x16x32_bf16 v[16:19], v[172:175], v[52:55], v[16:19]
    s_waitcnt lgkmcnt(3)
    v_mfma_f32_16x16x32_bf16 v[20:23], v[172:175], v[56:59], v[20:23]
    ds_read_b128 v[72:75], v10 offset:6144
    v_mfma_f32_16x16x32_bf16 v[36:39], v[168:171], v[56:59], v[36:39]
    ds_read_b128 v[76:79], v10 offset:22528
    s_waitcnt lgkmcnt(4)
    v_mfma_f32_16x16x32_bf16 v[24:27], v[172:175], v[60:63], v[24:27]
    ds_read_b128 v[80:83], v10 offset:38912
    v_mfma_f32_16x16x32_bf16 v[40:43], v[168:171], v[60:63], v[40:43]
    ds_read_b128 v[84:87], v10 offset:55296
    s_waitcnt lgkmcnt(5)
    v_mfma_f32_16x16x32_bf16 v[28:31], v[172:175], v[64:67], v[28:31]
    ds_read_b128 v[88:91], v11 offset:6144
    v_mfma_f32_16x16x32_bf16 v[44:47], v[168:171], v[64:67], v[44:47]
    s_waitcnt lgkmcnt(5)
    v_mfma_f32_16x16x32_bf16 v[32:35], v[172:175], v[68:71], v[32:35]
    v_mfma_f32_16x16x32_bf16 v[48:51], v[168:171], v[68:71], v[48:51]
    s_waitcnt lgkmcnt(4)
    v_mfma_f32_16x16x32_bf16 v[16:19], v[180:183], v[72:75], v[16:19]
    s_waitcnt lgkmcnt(3)
    v_mfma_f32_16x16x32_bf16 v[20:23], v[180:183], v[76:79], v[20:23]
    ds_read_b128 v[52:55], v2 offset:8192
    v_mfma_f32_16x16x32_bf16 v[36:39], v[176:179], v[76:79], v[36:39]
    ds_read_b128 v[56:59], v2 offset:24576
    s_waitcnt lgkmcnt(4)
    v_mfma_f32_16x16x32_bf16 v[24:27], v[180:183], v[80:83], v[24:27]
    ds_read_b128 v[60:63], v2 offset:40960
    v_mfma_f32_16x16x32_bf16 v[40:43], v[176:179], v[80:83], v[40:43]
    ds_read_b128 v[64:67], v2 offset:57344
    s_waitcnt lgkmcnt(5)
    v_mfma_f32_16x16x32_bf16 v[28:31], v[180:183], v[84:87], v[28:31]
    ds_read_b128 v[68:71], v3 offset:8192
    v_mfma_f32_16x16x32_bf16 v[44:47], v[176:179], v[84:87], v[44:47]
    s_waitcnt lgkmcnt(5)
    v_mfma_f32_16x16x32_bf16 v[32:35], v[180:183], v[88:91], v[32:35]
    v_mfma_f32_16x16x32_bf16 v[48:51], v[176:179], v[88:91], v[48:51]
    s_waitcnt lgkmcnt(4)
    v_mfma_f32_16x16x32_bf16 v[16:19], v[188:191], v[52:55], v[16:19]
    s_waitcnt lgkmcnt(3)
    v_mfma_f32_16x16x32_bf16 v[20:23], v[188:191], v[56:59], v[20:23]
    ds_read_b128 v[72:75], v10 offset:8192
    v_mfma_f32_16x16x32_bf16 v[36:39], v[184:187], v[56:59], v[36:39]
    ds_read_b128 v[76:79], v10 offset:24576
    s_waitcnt lgkmcnt(4)
    v_mfma_f32_16x16x32_bf16 v[24:27], v[188:191], v[60:63], v[24:27]
    ds_read_b128 v[80:83], v10 offset:40960
    v_mfma_f32_16x16x32_bf16 v[40:43], v[184:187], v[60:63], v[40:43]
    ds_read_b128 v[84:87], v10 offset:57344
    s_waitcnt lgkmcnt(5)
    v_mfma_f32_16x16x32_bf16 v[28:31], v[188:191], v[64:67], v[28:31]
    ds_read_b128 v[88:91], v11 offset:8192
    v_mfma_f32_16x16x32_bf16 v[44:47], v[184:187], v[64:67], v[44:47]
    s_waitcnt lgkmcnt(5)
    v_mfma_f32_16x16x32_bf16 v[32:35], v[188:191], v[68:71], v[32:35]
    v_mfma_f32_16x16x32_bf16 v[48:51], v[184:187], v[68:71], v[48:51]
    s_waitcnt lgkmcnt(4)
    v_mfma_f32_16x16x32_bf16 v[16:19], v[196:199], v[72:75], v[16:19]
    s_waitcnt lgkmcnt(3)
    v_mfma_f32_16x16x32_bf16 v[20:23], v[196:199], v[76:79], v[20:23]
    ds_read_b128 v[52:55], v2 offset:10240
    v_mfma_f32_16x16x32_bf16 v[36:39], v[192:195], v[76:79], v[36:39]
    ds_read_b128 v[56:59], v2 offset:26624
    s_waitcnt lgkmcnt(4)
    v_mfma_f32_16x16x32_bf16 v[24:27], v[196:199], v[80:83], v[24:27]
    ds_read_b128 v[60:63], v2 offset:43008
    v_mfma_f32_16x16x32_bf16 v[40:43], v[192:195], v[80:83], v[40:43]
    ds_read_b128 v[64:67], v2 offset:59392
    s_waitcnt lgkmcnt(5)
    v_mfma_f32_16x16x32_bf16 v[28:31], v[196:199], v[84:87], v[28:31]
    ds_read_b128 v[68:71], v3 offset:10240
    v_mfma_f32_16x16x32_bf16 v[44:47], v[192:195], v[84:87], v[44:47]
    s_waitcnt lgkmcnt(5)
    v_mfma_f32_16x16x32_bf16 v[32:35], v[196:199], v[88:91], v[32:35]
    v_mfma_f32_16x16x32_bf16 v[48:51], v[192:195], v[88:91], v[48:51]
    s_waitcnt lgkmcnt(4)
    v_mfma_f32_16x16x32_bf16 v[16:19], v[204:207], v[52:55], v[16:19]
    s_waitcnt lgkmcnt(3)
    v_mfma_f32_16x16x32_bf16 v[20:23], v[204:207], v[56:59], v[20:23]
    ds_read_b128 v[72:75], v10 offset:10240
    v_mfma_f32_16x16x32_bf16 v[36:39], v[200:203], v[56:59], v[36:39]
    ds_read_b128 v[76:79], v10 offset:26624
    s_waitcnt lgkmcnt(4)
    v_mfma_f32_16x16x32_bf16 v[24:27], v[204:207], v[60:63], v[24:27]
    ds_read_b128 v[80:83], v10 offset:43008
    v_mfma_f32_16x16x32_bf16 v[40:43], v[200:203], v[60:63], v[40:43]
    ds_read_b128 v[84:87], v10 offset:59392
    s_waitcnt lgkmcnt(5)
    v_mfma_f32_16x16x32_bf16 v[28:31], v[204:207], v[64:67], v[28:31]
    ds_read_b128 v[88:91], v11 offset:10240
    v_mfma_f32_16x16x32_bf16 v[44:47], v[200:203], v[64:67], v[44:47]
    s_waitcnt lgkmcnt(5)
    v_mfma_f32_16x16x32_bf16 v[32:35], v[204:207], v[68:71], v[32:35]
    v_mfma_f32_16x16x32_bf16 v[48:51], v[200:203], v[68:71], v[48:51]
    s_waitcnt lgkmcnt(4)
    v_mfma_f32_16x16x32_bf16 v[16:19], v[212:215], v[72:75], v[16:19]
    s_waitcnt lgkmcnt(3)
    v_mfma_f32_16x16x32_bf16 v[20:23], v[212:215], v[76:79], v[20:23]
    ds_read_b128 v[52:55], v2 offset:12288
    v_mfma_f32_16x16x32_bf16 v[36:39], v[208:211], v[76:79], v[36:39]
    ds_read_b128 v[56:59], v2 offset:28672
    s_waitcnt lgkmcnt(4)
    v_mfma_f32_16x16x32_bf16 v[24:27], v[212:215], v[80:83], v[24:27]
    ds_read_b128 v[60:63], v2 offset:45056
    v_mfma_f32_16x16x32_bf16 v[40:43], v[208:211], v[80:83], v[40:43]
    ds_read_b128 v[64:67], v2 offset:61440
    s_waitcnt lgkmcnt(5)
    v_mfma_f32_16x16x32_bf16 v[28:31], v[212:215], v[84:87], v[28:31]
    ds_read_b128 v[68:71], v3 offset:12288
    v_mfma_f32_16x16x32_bf16 v[44:47], v[208:211], v[84:87], v[44:47]
    s_waitcnt lgkmcnt(5)
    v_mfma_f32_16x16x32_bf16 v[32:35], v[212:215], v[88:91], v[32:35]
    v_mfma_f32_16x16x32_bf16 v[48:51], v[208:211], v[88:91], v[48:51]
    s_waitcnt lgkmcnt(4)
    v_mfma_f32_16x16x32_bf16 v[16:19], v[220:223], v[52:55], v[16:19]
    s_waitcnt lgkmcnt(3)
    v_mfma_f32_16x16x32_bf16 v[20:23], v[220:223], v[56:59], v[20:23]
    ds_read_b128 v[72:75], v10 offset:12288
    v_mfma_f32_16x16x32_bf16 v[36:39], v[216:219], v[56:59], v[36:39]
    ds_read_b128 v[76:79], v10 offset:28672
    s_waitcnt lgkmcnt(4)
    v_mfma_f32_16x16x32_bf16 v[24:27], v[220:223], v[60:63], v[24:27]
    ds_read_b128 v[80:83], v10 offset:45056
    v_mfma_f32_16x16x32_bf16 v[40:43], v[216:219], v[60:63], v[40:43]
    ds_read_b128 v[84:87], v10 offset:61440
    s_waitcnt lgkmcnt(5)
    v_mfma_f32_16x16x32_bf16 v[28:31], v[220:223], v[64:67], v[28:31]
    ds_read_b128 v[88:91], v11 offset:12288
    v_mfma_f32_16x16x32_bf16 v[44:47], v[216:219], v[64:67], v[44:47]
    s_waitcnt lgkmcnt(5)
    v_mfma_f32_16x16x32_bf16 v[32:35], v[220:223], v[68:71], v[32:35]
    v_mfma_f32_16x16x32_bf16 v[48:51], v[216:219], v[68:71], v[48:51]
    s_waitcnt lgkmcnt(4)
    v_mfma_f32_16x16x32_bf16 v[16:19], v[228:231], v[72:75], v[16:19]
    s_waitcnt lgkmcnt(3)
    v_mfma_f32_16x16x32_bf16 v[20:23], v[228:231], v[76:79], v[20:23]
    ds_read_b128 v[52:55], v2 offset:14336
    v_mfma_f32_16x16x32_bf16 v[36:39], v[224:227], v[76:79], v[36:39]
    ds_read_b128 v[56:59], v2 offset:30720
    s_waitcnt lgkmcnt(4)
    v_mfma_f32_16x16x32_bf16 v[24:27], v[228:231], v[80:83], v[24:27]
    ds_read_b128 v[60:63], v2 offset:47104
    v_mfma_f32_16x16x32_bf16 v[40:43], v[224:227], v[80:83], v[40:43]
    ds_read_b128 v[64:67], v2 offset:63488
    s_waitcnt lgkmcnt(5)
    v_mfma_f32_16x16x32_bf16 v[28:31], v[228:231], v[84:87], v[28:31]
    ds_read_b128 v[68:71], v3 offset:14336
    v_mfma_f32_16x16x32_bf16 v[44:47], v[224:227], v[84:87], v[44:47]
    s_waitcnt lgkmcnt(5)
    v_mfma_f32_16x16x32_bf16 v[32:35], v[228:231], v[88:91], v[32:35]
    v_mfma_f32_16x16x32_bf16 v[48:51], v[224:227], v[88:91], v[48:51]
    s_waitcnt lgkmcnt(4)
    v_mfma_f32_16x16x32_bf16 v[16:19], v[236:239], v[52:55], v[16:19]
    s_waitcnt lgkmcnt(3)
    v_mfma_f32_16x16x32_bf16 v[20:23], v[236:239], v[56:59], v[20:23]
    ds_read_b128 v[72:75], v10 offset:14336
    v_mfma_f32_16x16x32_bf16 v[36:39], v[232:235], v[56:59], v[36:39]
    ds_read_b128 v[76:79], v10 offset:30720
    s_waitcnt lgkmcnt(4)
    v_mfma_f32_16x16x32_bf16 v[24:27], v[236:239], v[60:63], v[24:27]
    ds_read_b128 v[80:83], v10 offset:47104
    v_mfma_f32_16x16x32_bf16 v[40:43], v[232:235], v[60:63], v[40:43]
    ds_read_b128 v[84:87], v10 offset:63488
    s_waitcnt lgkmcnt(5)
    v_mfma_f32_16x16x32_bf16 v[28:31], v[236:239], v[64:67], v[28:31]
    ds_read_b128 v[88:91], v11 offset:14336
    v_mfma_f32_16x16x32_bf16 v[44:47], v[232:235], v[64:67], v[44:47]
    s_waitcnt lgkmcnt(5)
    v_mfma_f32_16x16x32_bf16 v[32:35], v[236:239], v[68:71], v[32:35]
    v_mfma_f32_16x16x32_bf16 v[48:51], v[232:235], v[68:71], v[48:51]
    s_waitcnt lgkmcnt(4)
    v_mfma_f32_16x16x32_bf16 v[16:19], v[244:247], v[72:75], v[16:19]
    s_waitcnt lgkmcnt(3)
    v_mfma_f32_16x16x32_bf16 v[20:23], v[244:247], v[76:79], v[20:23]
    v_mfma_f32_16x16x32_bf16 v[36:39], v[240:243], v[76:79], v[36:39]
    s_waitcnt lgkmcnt(2)
    v_mfma_f32_16x16x32_bf16 v[24:27], v[244:247], v[80:83], v[24:27]
    v_mfma_f32_16x16x32_bf16 v[40:43], v[240:243], v[80:83], v[40:43]
    s_waitcnt lgkmcnt(1)
    v_mfma_f32_16x16x32_bf16 v[28:31], v[244:247], v[84:87], v[28:31]
    v_mfma_f32_16x16x32_bf16 v[44:47], v[240:243], v[84:87], v[44:47]
    s_waitcnt lgkmcnt(0)
    v_mfma_f32_16x16x32_bf16 v[32:35], v[244:247], v[88:91], v[32:35]
    v_mfma_f32_16x16x32_bf16 v[48:51], v[240:243], v[88:91], v[48:51]
    s_nop 7
    s_branch p_common
v_role:
    v_mov_b32 v116, 0
    v_mov_b32 v117, 0
    v_mov_b32 v118, 0
    v_mov_b32 v119, 0
    v_mov_b32 v120, 0
    v_mov_b32 v121, 0
    global_load_short_d16_hi v116, v7, s[40:41]
    global_load_short_d16_hi v117, v7, s[42:43]
    global_load_short_d16_hi v118, v7, s[44:45]
    global_load_short_d16_hi v119, v7, s[46:47]
    global_load_short_d16_hi v120, v7, s[48:49]
    global_load_short_d16_hi v121, v7, s[50:51]
    s_load_dword s68, s[52:53], s69
    s_mov_b32 s12, s62
    s_mov_b32 s13, s63
    s_mov_b32 s14, 0x00180000
    s_mov_b32 s15, 0x00020000
    s_mov_b32 s8, s60
    s_mov_b32 s9, s61
    s_mov_b32 s10, 0x00200000
    s_mov_b32 s11, 0x00020000
    s_mul_i32 s69, s29, 3072
    s_add_u32 s69, s69, 81920
    s_add_u32 m0, s69, 12288
    s_mov_b32 s38, 98304
    buffer_load_dwordx4 v4, s[12:15], s38 offen offset:0 lds
    s_add_u32 m0, s69, 12288
    s_mov_b32 s38, 98304
    buffer_load_dwordx4 v4, s[12:15], s38 offen offset:1024 lds
    s_add_u32 m0, s69, 12288
    s_mov_b32 s38, 98304
    buffer_load_dwordx4 v4, s[12:15], s38 offen offset:2048 lds
    s_lshl_b32 m0, s28, 10
    s_add_u32 m0, m0, 0
    s_add_u32 s38, s3, 0
    s_bitcmp1_b32 s28, 0
    s_cselect_b32 exec_lo, -1, 0xffffff00
    buffer_load_dwordx4 v6, s[8:11], s38 offen lds
    s_mov_b32 exec_lo, -1
    s_lshl_b32 m0, s28, 10
    s_add_u32 m0, m0, 16384
    s_add_u32 s38, s3, 0
    buffer_load_dwordx4 v5, s[8:11], s38 offen lds
    s_lshl_b32 m0, s28, 10
    s_add_u32 m0, m0, 32768
    s_add_u32 s38, s3, 16384
    buffer_load_dwordx4 v5, s[8:11], s38 offen lds
    s_lshl_b32 m0, s28, 10
    s_add_u32 m0, m0, 49152
    s_add_u32 s38, s3, 32768
    buffer_load_dwordx4 v5, s[8:11], s38 offen lds
    s_lshl_b32 m0, s28, 10
    s_add_u32 m0, m0, 65536
    s_add_u32 s38, s3, 49152
    buffer_load_dwordx4 v5, s[8:11], s38 offen lds
    s_mov_b32 s4, s66
    s_mov_b32 s5, s67
    s_mov_b32 s6, 0x02000000
    s_mov_b32 s7, 0x00020000
    s_mov_b32 s16, s64
    s_mov_b32 s17, s65
    s_mov_b32 s18, 0x00080000
    s_mov_b32 s19, 0x00020000
    s_mov_b32 s20, s56
    s_mov_b32 s21, s57
    s_mov_b32 s22, 0x00200000
    s_mov_b32 s23, 0x00020000
    s_mov_b32 s24, s58
    s_mov_b32 s25, s59
    s_mov_b32 s26, 0x00000100
    s_mov_b32 s27, 0x00020000
    s_lshl_b32 s38, s32, 3
    s_load_dwordx2 s[66:67], s[54:55], s38
    v_lshrrev_b32 v15, 5, v1
    v_mul_u32_u24 v15, 6144, v15
    v_bfe_u32 v8, v1, 2, 3
    v_lshl_add_u32 v15, v8, 7, v15
    v_bfe_u32 v8, v1, 3, 2
    v_xor_b32 v8, s29, v8
    v_lshl_add_u32 v15, v8, 5, v15
    v_and_b32 v8, 3, v1
    v_lshl_add_u32 v15, v8, 3, v15
    v_add_u32 v15, 81920, v15
    v_add_u32 v156, 49152, v15
    v_bfe_u32 v8, v1, 1, 3
    v_lshrrev_b32 v9, 4, v1
    v_xor_b32 v8, v8, v9
    v_and_b32 v9, 15, v1
    v_lshlrev_b32 v9, 7, v9
    v_lshl_add_u32 v2, v8, 4, v9
    s_add_u32 s38, s29, 0
    s_and_b32 s38, s38, 3
    s_add_u32 s38, s38, 1
    s_mov_b32 s52, s38
    s_lshl_b32 s38, s38, 14
    v_add_u32 v3, s38, v2
    s_add_u32 s38, s29, 1
    s_and_b32 s38, s38, 3
    s_add_u32 s38, s38, 1
    s_mov_b32 s53, s38
    s_lshl_b32 s38, s38, 14
    v_add_u32 v7, s38, v2
    s_add_u32 s38, s29, 2
    s_and_b32 s38, s38, 3
    s_add_u32 s38, s38, 1
    s_mov_b32 s54, s38
    s_lshl_b32 s38, s38, 14
    v_add_u32 v8, s38, v2
    s_add_u32 s38, s29, 3
    s_and_b32 s38, s38, 3
    s_add_u32 s38, s38, 1
    s_mov_b32 s55, s38
    s_lshl_b32 s38, s38, 14
    v_add_u32 v9, s38, v2
    v_xor_b32 v10, 64, v2
    v_xor_b32 v11, 64, v3
    v_xor_b32 v12, 64, v7
    v_xor_b32 v13, 64, v8
    v_xor_b32 v14, 64, v9
    v_mov_b32 v48, 0x3f803f80
    v_mov_b32 v49, 0x3f803f80
    v_mov_b32 v50, 0x3f803f80
    v_mov_b32 v51, 0x3f803f80
    v_and_b32 v124, 15, v1
    v_lshlrev_b32 v125, 3, v124
    v_cvt_f32_u32 v111, v125
    v_lshlrev_b32 v125, 7, v124
    v_add_u32 v125, 1024, v125
    v_cvt_f32_u32 v110, v125
    v_lshrrev_b32 v125, 3, v124
    v_and_b32 v126, 7, v124
    v_lshl_add_u32 v125, v125, 7, v126
    v_cvt_f32_u32 v108, v125
    v_lshrrev_b32 v125, 2, v124
    v_and_b32 v126, 3, v124
    v_lshl_add_u32 v125, v125, 6, v126
    v_add_u32 v125, 128, v125
    v_bfe_u32 v126, v124, 1, 2
    v_and_b32 v127, 1, v124
    v_lshl_add_u32 v126, v126, 5, v127
    v_add_u32 v126, 128, v126
    v_lshlrev_b32 v126, 1, v126
    v_cmp_gt_u32 s[44:45], 8, v124
    s_nop 1
    v_cndmask_b32 v125, v126, v125, s[44:45]
    v_cvt_f32_u32 v109, v125
    v_add_f32 v109, v109, v109
    s_waitcnt lgkmcnt(0)
    v_mov_b32 v148, -1
    v_mov_b32 v149, -1
    v_mov_b32 v150, -1
    v_mov_b32 v151, -1
    v_lshrrev_b32 v152, 4, v1
    v_lshlrev_b32 v152, 14, v152
    v_and_b32 v153, 15, v1
    v_lshl_add_u32 v152, v153, 4, v152
    s_lshr_b32 s44, s28, 2
    s_add_u32 s40, s28, 0
    s_lshr_b32 s42, s40, 2
    s_and_b32 s43, s40, 3
    s_lshl_b32 s39, s31, 2
    s_add_u32 s39, s39, s43
    s_lshl_b32 s39, s39, 10
    s_lshl_b32 s41, s30, 16
    s_add_u32 s39, s39, s41
    s_lshl_b32 s41, s42, 15
    s_add_u32 s39, s39, s41
    s_add_u32 s39, s39, 0
    buffer_store_dwordx4 v[148:151], v0, s[4:7], s39 offen sc1
    s_lshl_b32 s44, s44, 4
    s_and_b32 s39, s31, 3
    s_lshl_b32 s39, s39, 19
    s_lshl_b32 s41, s30, 9
    s_add_u32 s39, s39, s41
    s_lshr_b32 s41, s31, 2
    s_lshl_b32 s41, s41, 8
    s_add_u32 s39, s39, s41
    s_add_u32 s39, s39, 4194304
    s_add_u32 s40, s28, 0
    s_lshl_b32 s42, s40, 16
    s_add_u32 s39, s39, s42
    buffer_store_dwordx4 v[148:151], v152, s[4:7], s39 offen sc1
    s_lshr_b32 s44, s68, s44
    s_and_b32 s39, s31, 3
    s_lshl_b32 s39, s39, 14
    s_lshl_b32 s41, s30, 9
    s_add_u32 s39, s39, s41
    s_lshr_b32 s41, s31, 2
    s_lshl_b32 s41, s41, 8
    s_add_u32 s39, s39, s41
    s_add_u32 s39, s39, 10485760
    s_lshl_b32 s42, s28, 5
    s_add_u32 s39, s39, s42
    s_mov_b64 exec, 3
    buffer_store_dwordx4 v[148:151], v0, s[4:7], s39 offen sc1
    s_mov_b64 exec, -1
    s_lshl_b32 s44, s44, 16
    s_add_u32 m0, s69, 36864
    s_mov_b32 s38, 294912
    buffer_load_dwordx4 v4, s[12:15], s38 offen offset:0 lds
    v_mov_b32 v125, s44
    s_add_u32 m0, s69, 36864
    s_mov_b32 s38, 294912
    buffer_load_dwordx4 v4, s[12:15], s38 offen offset:1024 lds
    v_mul_f32 v124, 0x3fb8aa3b, v125
    s_add_u32 m0, s69, 36864
    s_mov_b32 s38, 294912
    buffer_load_dwordx4 v4, s[12:15], s38 offen offset:2048 lds
    v_mov_b32 v127, 0x3fb8aa3b
    s_add_u32 m0, s69, 61440
    s_mov_b32 s38, 491520
    buffer_load_dwordx4 v4, s[12:15], s38 offen offset:0 lds
    v_fma_f32 v126, v125, v127, -v124
    s_add_u32 m0, s69, 61440
    s_mov_b32 s38, 491520
    buffer_load_dwordx4 v4, s[12:15], s38 offen offset:1024 lds
    v_mov_b32 v127, 0x32a57060
    s_add_u32 m0, s69, 61440
    s_mov_b32 s38, 491520
    buffer_load_dwordx4 v4, s[12:15], s38 offen offset:2048 lds
    v_fma_f32 v126, v125, v127, v126
    s_lshl_b32 m0, s28, 10
    s_add_u32 m0, m0, 8192
    s_add_u32 s38, s3, 512
    s_bitcmp1_b32 s28, 0
    s_cselect_b32 exec_lo, -1, 0xffffff00
    buffer_load_dwordx4 v6, s[8:11], s38 offen lds
    s_mov_b32 exec_lo, -1
    v_exp_f32 v124, v124
    s_lshl_b32 m0, s28, 10
    s_add_u32 m0, m0, 24576
    s_add_u32 s38, s3, 512
    buffer_load_dwordx4 v5, s[8:11], s38 offen lds
    v_mul_f32 v126, 0x3f317218, v126
    s_lshl_b32 m0, s28, 10
    s_add_u32 m0, m0, 40960
    s_add_u32 s38, s3, 16896
    buffer_load_dwordx4 v5, s[8:11], s38 offen lds
    v_fma_f32 v124, v124, v126, v124
    s_lshl_b32 m0, s28, 10
    s_add_u32 m0, m0, 57344
    s_add_u32 s38, s3, 33280
    buffer_load_dwordx4 v5, s[8:11], s38 offen lds
    v_cvt_pk_bf16_f32 v124, v124, v124
    s_lshl_b32 m0, s28, 10
    s_add_u32 m0, m0, 73728
    s_add_u32 s38, s3, 49664
    buffer_load_dwordx4 v5, s[8:11], s38 offen lds
    v_lshlrev_b32 v124, 16, v124
    s_waitcnt vmcnt(22)
    v_mul_f32 v116, v124, v116
    v_mul_f32 v117, v124, v117
    v_mul_f32 v118, v124, v118
    v_mul_f32 v119, v124, v119
    v_mul_f32 v104, 0x3fb8aa3b, v116
    v_mul_f32 v105, 0x3e22f983, v117
    v_mul_f32 v106, v120, v118
    v_mul_f32 v107, v120, v119
    v_fma_f32 v106, -v121, v119, v106
    v_fma_f32 v107, v121, v118, v107
    v_mov_b32 v113, 0x02081cea
    v_mov_b32 v112, v104
    v_max3_f32 v113, abs(v106), abs(v107), v113
    s_nop 0
    v_max_f32_dpp v112, v112, v112 row_ror:1 row_mask:0xf bank_mask:0xf
    v_max_f32_dpp v113, v113, v113 row_ror:1 row_mask:0xf bank_mask:0xf
    s_nop 0
    v_max_f32_dpp v112, v112, v112 row_ror:2 row_mask:0xf bank_mask:0xf
    v_max_f32_dpp v113, v113, v113 row_ror:2 row_mask:0xf bank_mask:0xf
    s_nop 0
    v_max_f32_dpp v112, v112, v112 row_ror:4 row_mask:0xf bank_mask:0xf
    v_max_f32_dpp v113, v113, v113 row_ror:4 row_mask:0xf bank_mask:0xf
    v_mov_b32 v125, v112
    v_mov_b32 v126, v113
    s_nop 0
    v_permlane16_swap_b32 v112, v125
    v_permlane16_swap_b32 v113, v126
    v_max_f32 v112, v112, v125
    v_max_f32 v113, v113, v126
    v_mov_b32 v125, v112
    v_mov_b32 v126, v113
    s_nop 0
    v_permlane32_swap_b32 v112, v125
    v_permlane32_swap_b32 v113, v126
    v_max_f32 v112, v112, v125
    v_max_f32 v113, v113, v126
    v_frexp_exp_i32_f32 v125, v113
    v_sub_f32 v104, v104, v112
    v_sub_u32 v126, 0, v125
    v_cvt_f32_i32 v113, v125
    v_ldexp_f32 v106, v106, v126
    v_ldexp_f32 v107, v107, v126
    v_mul_f32_dpp v116, v104, v111 row_newbcast:0 row_mask:0xf bank_mask:0xf
    v_mul_f32_dpp v124, v105, v111 row_newbcast:0 row_mask:0xf bank_mask:0xf
    v_mul_f32_dpp v117, v104, v111 row_newbcast:1 row_mask:0xf bank_mask:0xf
    v_mul_f32_dpp v125, v105, v111 row_newbcast:1 row_mask:0xf bank_mask:0xf
    v_mul_f32_dpp v118, v104, v111 row_newbcast:2 row_mask:0xf bank_mask:0xf
    v_mul_f32_dpp v126, v105, v111 row_newbcast:2 row_mask:0xf bank_mask:0xf
    v_mul_f32_dpp v119, v104, v111 row_newbcast:3 row_mask:0xf bank_mask:0xf
    v_mul_f32_dpp v127, v105, v111 row_newbcast:3 row_mask:0xf bank_mask:0xf
    v_exp_f32 v116, v116
    v_fract_f32 v124, v124
    v_exp_f32 v117, v117
    v_fract_f32 v125, v125
    v_exp_f32 v118, v118
    v_fract_f32 v126, v126
    v_exp_f32 v119, v119
    v_fract_f32 v127, v127
    v_sin_f32 v120, v124
    v_cos_f32 v124, v124
    v_sin_f32 v121, v125
    v_cos_f32 v125, v125
    v_sin_f32 v122, v126
    v_cos_f32 v126, v126
    v_sin_f32 v123, v127
    v_cos_f32 v127, v127
    v_mul_f32_dpp v128, v106, v116 row_newbcast:0 row_mask:0xf bank_mask:0xf
    v_mul_f32_dpp v132, v107, v116 row_newbcast:0 row_mask:0xf bank_mask:0xf
    v_mul_f32_dpp v129, v106, v117 row_newbcast:1 row_mask:0xf bank_mask:0xf
    v_mul_f32_dpp v133, v107, v117 row_newbcast:1 row_mask:0xf bank_mask:0xf
    v_mul_f32_dpp v130, v106, v118 row_newbcast:2 row_mask:0xf bank_mask:0xf
    v_mul_f32_dpp v134, v107, v118 row_newbcast:2 row_mask:0xf bank_mask:0xf
    v_mul_f32_dpp v131, v106, v119 row_newbcast:3 row_mask:0xf bank_mask:0xf
    v_mul_f32_dpp v135, v107, v119 row_newbcast:3 row_mask:0xf bank_mask:0xf
    v_mul_f32 v116, v132, v120
    v_mul_f32 v132, v132, v124
    v_mul_f32 v117, v133, v121
    v_mul_f32 v133, v133, v125
    v_mul_f32 v118, v134, v122
    v_mul_f32 v134, v134, v126
    v_mul_f32 v119, v135, v123
    v_mul_f32 v135, v135, v127
    v_fma_mixlo_f16 v136, v128, v124, -v116
    v_fma_mixlo_f16 v137, v129, v125, -v117
    v_fma_mixlo_f16 v138, v130, v126, -v118
    v_fma_mixlo_f16 v139, v131, v127, -v119
    v_fma_mixhi_f16 v136, -v128, v120, -v132
    v_fma_mixhi_f16 v137, -v129, v121, -v133
    v_fma_mixhi_f16 v138, -v130, v122, -v134
    v_fma_mixhi_f16 v139, -v131, v123, -v135
    v_mul_f32_dpp v116, v104, v108 row_newbcast:0 row_mask:0xf bank_mask:0xf
    v_mul_f32_dpp v124, v105, v108 row_newbcast:0 row_mask:0xf bank_mask:0xf
    v_mul_f32_dpp v117, v104, v108 row_newbcast:1 row_mask:0xf bank_mask:0xf
    v_mul_f32_dpp v125, v105, v108 row_newbcast:1 row_mask:0xf bank_mask:0xf
    v_mul_f32_dpp v118, v104, v108 row_newbcast:2 row_mask:0xf bank_mask:0xf
    v_mul_f32_dpp v126, v105, v108 row_newbcast:2 row_mask:0xf bank_mask:0xf
    v_mul_f32_dpp v119, v104, v108 row_newbcast:3 row_mask:0xf bank_mask:0xf
    v_mul_f32_dpp v127, v105, v108 row_newbcast:3 row_mask:0xf bank_mask:0xf
    v_exp_f32 v116, v116
    v_fract_f32 v124, v124
    v_exp_f32 v117, v117
    v_fract_f32 v125, v125
    v_exp_f32 v118, v118
    v_fract_f32 v126, v126
    v_exp_f32 v119, v119
    v_fract_f32 v127, v127
    v_sin_f32 v120, v124
    v_cos_f32 v124, v124
    v_sin_f32 v121, v125
    v_cos_f32 v125, v125
    v_sin_f32 v122, v126
    v_cos_f32 v126, v126
    v_sin_f32 v123, v127
    v_cos_f32 v127, v127
    v_fma_mixlo_f16 v140, v116, v124, 0
    v_fma_mixlo_f16 v141, v117, v125, 0
    v_fma_mixlo_f16 v142, v118, v126, 0
    v_fma_mixlo_f16 v143, v119, v127, 0
    v_fma_mixhi_f16 v140, v116, v120, 0
    v_fma_mixhi_f16 v141, v117, v121, 0
    v_fma_mixhi_f16 v142, v118, v122, 0
    v_fma_mixhi_f16 v143, v119, v123, 0
    s_nop 1
    v_mfma_f32_16x16x32_f16 v[92:95], v[140:143], v[136:139], 0
    v_mul_f32_dpp v116, v104, v109 row_newbcast:0 row_mask:0xf bank_mask:0xf
    v_mul_f32_dpp v124, v105, v109 row_newbcast:0 row_mask:0xf bank_mask:0xf
    v_mul_f32_dpp v117, v104, v109 row_newbcast:1 row_mask:0xf bank_mask:0xf
    v_mul_f32_dpp v125, v105, v109 row_newbcast:1 row_mask:0xf bank_mask:0xf
    v_mul_f32_dpp v118, v104, v109 row_newbcast:2 row_mask:0xf bank_mask:0xf
    v_mul_f32_dpp v126, v105, v109 row_newbcast:2 row_mask:0xf bank_mask:0xf
    v_mul_f32_dpp v119, v104, v109 row_newbcast:3 row_mask:0xf bank_mask:0xf
    v_mul_f32_dpp v127, v105, v109 row_newbcast:3 row_mask:0xf bank_mask:0xf
    v_exp_f32 v116, v116
    v_fract_f32 v124, v124
    v_exp_f32 v117, v117
    v_fract_f32 v125, v125
    v_exp_f32 v118, v118
    v_fract_f32 v126, v126
    v_exp_f32 v119, v119
    v_fract_f32 v127, v127
    v_sin_f32 v120, v124
    v_cos_f32 v124, v124
    v_sin_f32 v121, v125
    v_cos_f32 v125, v125
    v_sin_f32 v122, v126
    v_cos_f32 v126, v126
    v_sin_f32 v123, v127
    v_cos_f32 v127, v127
    v_fma_mixlo_f16 v144, v116, v124, 0
    v_fma_mixlo_f16 v145, v117, v125, 0
    v_fma_mixlo_f16 v146, v118, v126, 0
    v_fma_mixlo_f16 v147, v119, v127, 0
    v_fma_mixhi_f16 v144, v116, v120, 0
    v_fma_mixhi_f16 v145, v117, v121, 0
    v_fma_mixhi_f16 v146, v118, v122, 0
    v_fma_mixhi_f16 v147, v119, v123, 0
    s_nop 1
    v_mfma_f32_16x16x32_f16 v[96:99], v[144:147], v[136:139], 0
    v_mul_f32_dpp v116, v104, v110 row_newbcast:0 row_mask:0xf bank_mask:0xf
    v_mul_f32_dpp v124, v105, v110 row_newbcast:0 row_mask:0xf bank_mask:0xf
    v_mul_f32_dpp v117, v104, v110 row_newbcast:1 row_mask:0xf bank_mask:0xf
    v_mul_f32_dpp v125, v105, v110 row_newbcast:1 row_mask:0xf bank_mask:0xf
    v_mul_f32_dpp v118, v104, v110 row_newbcast:2 row_mask:0xf bank_mask:0xf
    v_mul_f32_dpp v126, v105, v110 row_newbcast:2 row_mask:0xf bank_mask:0xf
    v_mul_f32_dpp v119, v104, v110 row_newbcast:3 row_mask:0xf bank_mask:0xf
    v_mul_f32_dpp v127, v105, v110 row_newbcast:3 row_mask:0xf bank_mask:0xf
    v_exp_f32 v116, v116
    v_fract_f32 v124, v124
    v_exp_f32 v117, v117
    v_fract_f32 v125, v125
    v_exp_f32 v118, v118
    v_fract_f32 v126, v126
    v_exp_f32 v119, v119
    v_fract_f32 v127, v127
    v_sin_f32 v120, v124
    v_cos_f32 v124, v124
    v_sin_f32 v121, v125
    v_cos_f32 v125, v125
    v_sin_f32 v122, v126
    v_cos_f32 v126, v126
    v_sin_f32 v123, v127
    v_cos_f32 v127, v127
    v_fma_mixlo_f16 v140, v116, v124, 0
    v_fma_mixlo_f16 v141, v117, v125, 0
    v_fma_mixlo_f16 v142, v118, v126, 0
    v_fma_mixlo_f16 v143, v119, v127, 0
    v_fma_mixhi_f16 v140, v116, v120, 0
    v_fma_mixhi_f16 v141, v117, v121, 0
    v_fma_mixhi_f16 v142, v118, v122, 0
    v_fma_mixhi_f16 v143, v119, v123, 0
    s_nop 1
    v_mfma_f32_16x16x32_f16 v[100:103], v[140:143], v[136:139], 0
    s_waitcnt vmcnt(14)
    s_barrier
    ds_read_b64_tr_b16 v[188:189], v15 offset:2048
    ds_read_b64_tr_b16 v[190:191], v15 offset:5120
    ds_read_b64_tr_b16 v[192:193], v15 offset:14336
    ds_read_b64_tr_b16 v[194:195], v15 offset:17408
    ds_read_b128 v[52:55], v2 offset:0
    v_mul_f32_dpp v116, v104, v111 row_newbcast:4 row_mask:0xf bank_mask:0xf
    v_mul_f32_dpp v124, v105, v111 row_newbcast:4 row_mask:0xf bank_mask:0xf
    ds_read_b128 v[56:59], v3 offset:0
    v_mul_f32_dpp v117, v104, v111 row_newbcast:5 row_mask:0xf bank_mask:0xf
    v_mul_f32_dpp v125, v105, v111 row_newbcast:5 row_mask:0xf bank_mask:0xf
    ds_read_b128 v[60:63], v7 offset:0
    v_mul_f32_dpp v118, v104, v111 row_newbcast:6 row_mask:0xf bank_mask:0xf
    v_mul_f32_dpp v126, v105, v111 row_newbcast:6 row_mask:0xf bank_mask:0xf
    ds_read_b128 v[64:67], v8 offset:0
    v_mul_f32_dpp v119, v104, v111 row_newbcast:7 row_mask:0xf bank_mask:0xf
    v_mul_f32_dpp v127, v105, v111 row_newbcast:7 row_mask:0xf bank_mask:0xf
    ds_read_b128 v[68:71], v9 offset:0
    v_exp_f32 v116, v116
    v_fract_f32 v124, v124
    s_waitcnt lgkmcnt(4)
    v_mfma_f32_16x16x32_bf16 v[16:19], v[52:55], v[188:191], 0
    v_exp_f32 v117, v117
    v_fract_f32 v125, v125
    v_mfma_f32_16x16x32_bf16 v[44:47], v[52:55], v[52:55], 0
    v_exp_f32 v118, v118
    v_fract_f32 v126, v126
    ds_read_b128 v[72:75], v10 offset:0
    v_exp_f32 v119, v119
    v_fract_f32 v127, v127
    s_waitcnt lgkmcnt(4)
    v_mfma_f32_16x16x32_bf16 v[20:23], v[56:59], v[188:191], 0
    v_sin_f32 v120, v124
    v_cos_f32 v124, v124
    ds_read_b128 v[76:79], v11 offset:0
    v_sin_f32 v121, v125
    v_cos_f32 v125, v125
    v_mfma_f32_16x16x32_bf16 v[36:39], v[56:59], v[56:59], 0
    v_sin_f32 v122, v126
    v_cos_f32 v126, v126
    ds_read_b128 v[80:83], v12 offset:0
    v_sin_f32 v123, v127
    v_cos_f32 v127, v127
    v_mfma_f32_16x16x32_bf16 v[40:43], v[48:51], v[56:59], 0
    v_mul_f32_dpp v128, v106, v116 row_newbcast:4 row_mask:0xf bank_mask:0xf
    v_mul_f32_dpp v132, v107, v116 row_newbcast:4 row_mask:0xf bank_mask:0xf
    ds_read_b128 v[84:87], v13 offset:0
    v_mul_f32_dpp v129, v106, v117 row_newbcast:5 row_mask:0xf bank_mask:0xf
    v_mul_f32_dpp v133, v107, v117 row_newbcast:5 row_mask:0xf bank_mask:0xf
    s_waitcnt lgkmcnt(6)
    v_mfma_f32_16x16x32_bf16 v[24:27], v[60:63], v[188:191], 0
    v_mul_f32_dpp v130, v106, v118 row_newbcast:6 row_mask:0xf bank_mask:0xf
    v_mul_f32_dpp v134, v107, v118 row_newbcast:6 row_mask:0xf bank_mask:0xf
    ds_read_b128 v[88:91], v14 offset:0
    v_mul_f32_dpp v131, v106, v119 row_newbcast:7 row_mask:0xf bank_mask:0xf
    v_mul_f32_dpp v135, v107, v119 row_newbcast:7 row_mask:0xf bank_mask:0xf
    s_waitcnt lgkmcnt(6)
    v_mfma_f32_16x16x32_bf16 v[28:31], v[64:67], v[188:191], 0
    v_mul_f32 v116, v132, v120
    v_mul_f32 v132, v132, v124
    s_waitcnt lgkmcnt(5)
    v_mfma_f32_16x16x32_bf16 v[32:35], v[68:71], v[188:191], 0
    v_mul_f32 v117, v133, v121
    v_mul_f32 v133, v133, v125
    s_waitcnt lgkmcnt(4)
    v_mfma_f32_16x16x32_bf16 v[16:19], v[72:75], v[192:195], v[16:19]
    v_mul_f32 v118, v134, v122
    v_mul_f32 v134, v134, v126
    v_mfma_f32_16x16x32_bf16 v[44:47], v[72:75], v[72:75], v[44:47]
    v_mul_f32 v119, v135, v123
    v_mul_f32 v135, v135, v127
    s_waitcnt lgkmcnt(3)
    v_mfma_f32_16x16x32_bf16 v[20:23], v[76:79], v[192:195], v[20:23]
    v_fma_mixlo_f16 v136, v128, v124, -v116
    v_fma_mixlo_f16 v137, v129, v125, -v117
    v_mfma_f32_16x16x32_bf16 v[36:39], v[76:79], v[76:79], v[36:39]
    v_fma_mixlo_f16 v138, v130, v126, -v118
    v_fma_mixlo_f16 v139, v131, v127, -v119
    v_mfma_f32_16x16x32_bf16 v[40:43], v[48:51], v[76:79], v[40:43]
    v_fma_mixhi_f16 v136, -v128, v120, -v132
    s_waitcnt lgkmcnt(2)
    v_mfma_f32_16x16x32_bf16 v[24:27], v[80:83], v[192:195], v[24:27]
    v_fma_mixhi_f16 v137, -v129, v121, -v133
    s_waitcnt lgkmcnt(1)
    v_mfma_f32_16x16x32_bf16 v[28:31], v[84:87], v[192:195], v[28:31]
    v_fma_mixhi_f16 v138, -v130, v122, -v134
    s_waitcnt lgkmcnt(0)
    v_mfma_f32_16x16x32_bf16 v[32:35], v[88:91], v[192:195], v[32:35]
    v_fma_mixhi_f16 v139, -v131, v123, -v135
    s_waitcnt vmcnt(8)
    s_barrier
    ds_read_b64_tr_b16 v[196:197], v15 offset:26624
    ds_read_b64_tr_b16 v[198:199], v15 offset:29696
    ds_read_b64_tr_b16 v[200:201], v15 offset:38912
    ds_read_b64_tr_b16 v[202:203], v15 offset:41984
    ds_read_b128 v[52:55], v2 offset:2048
    s_add_u32 m0, s69, 0
    s_mov_b32 s38, 589824
    buffer_load_dwordx4 v4, s[12:15], s38 offen offset:0 lds
    v_mul_f32_dpp v116, v104, v108 row_newbcast:4 row_mask:0xf bank_mask:0xf
    ds_read_b128 v[56:59], v3 offset:2048
    v_mul_f32_dpp v124, v105, v108 row_newbcast:4 row_mask:0xf bank_mask:0xf
    v_mul_f32_dpp v117, v104, v108 row_newbcast:5 row_mask:0xf bank_mask:0xf
    ds_read_b128 v[60:63], v7 offset:2048
    s_add_u32 m0, s69, 0
    s_mov_b32 s38, 589824
    buffer_load_dwordx4 v4, s[12:15], s38 offen offset:1024 lds
    v_mul_f32_dpp v125, v105, v108 row_newbcast:5 row_mask:0xf bank_mask:0xf
    ds_read_b128 v[64:67], v8 offset:2048
    v_mul_f32_dpp v118, v104, v108 row_newbcast:6 row_mask:0xf bank_mask:0xf
    v_mul_f32_dpp v126, v105, v108 row_newbcast:6 row_mask:0xf bank_mask:0xf
    ds_read_b128 v[68:71], v9 offset:2048
    s_add_u32 m0, s69, 0
    s_mov_b32 s38, 589824
    buffer_load_dwordx4 v4, s[12:15], s38 offen offset:2048 lds
    v_mul_f32_dpp v119, v104, v108 row_newbcast:7 row_mask:0xf bank_mask:0xf
    s_waitcnt lgkmcnt(4)
    v_mfma_f32_16x16x32_bf16 v[16:19], v[52:55], v[196:199], v[16:19]
    v_mul_f32_dpp v127, v105, v108 row_newbcast:7 row_mask:0xf bank_mask:0xf
    v_exp_f32 v116, v116
    v_mfma_f32_16x16x32_bf16 v[44:47], v[52:55], v[52:55], v[44:47]
    s_add_u32 m0, s69, 12288
    s_mov_b32 s38, 688128
    buffer_load_dwordx4 v4, s[12:15], s38 offen offset:0 lds
    v_fract_f32 v124, v124
    ds_read_b128 v[72:75], v10 offset:2048
    v_exp_f32 v117, v117
    v_fract_f32 v125, v125
    s_waitcnt lgkmcnt(4)
    v_mfma_f32_16x16x32_bf16 v[20:23], v[56:59], v[196:199], v[20:23]
    s_add_u32 m0, s69, 12288
    s_mov_b32 s38, 688128
    buffer_load_dwordx4 v4, s[12:15], s38 offen offset:1024 lds
    v_exp_f32 v118, v118
    ds_read_b128 v[76:79], v11 offset:2048
    v_fract_f32 v126, v126
    v_exp_f32 v119, v119
    v_mfma_f32_16x16x32_bf16 v[36:39], v[56:59], v[56:59], v[36:39]
    s_add_u32 m0, s69, 12288
    s_mov_b32 s38, 688128
    buffer_load_dwordx4 v4, s[12:15], s38 offen offset:2048 lds
    v_fract_f32 v127, v127
    ds_read_b128 v[80:83], v12 offset:2048
    v_sin_f32 v120, v124
    v_cos_f32 v124, v124
    v_mfma_f32_16x16x32_bf16 v[40:43], v[48:51], v[56:59], v[40:43]
    v_sin_f32 v121, v125
    v_cos_f32 v125, v125
    ds_read_b128 v[84:87], v13 offset:2048
    v_sin_f32 v122, v126
    s_waitcnt lgkmcnt(6)
    v_mfma_f32_16x16x32_bf16 v[24:27], v[60:63], v[196:199], v[24:27]
    v_cos_f32 v126, v126
    ds_read_b128 v[88:91], v14 offset:2048
    v_sin_f32 v123, v127
    s_waitcnt lgkmcnt(6)
    v_mfma_f32_16x16x32_bf16 v[28:31], v[64:67], v[196:199], v[28:31]
    v_cos_f32 v127, v127
    s_waitcnt lgkmcnt(5)
    v_mfma_f32_16x16x32_bf16 v[32:35], v[68:71], v[196:199], v[32:35]
    v_fma_mixlo_f16 v140, v116, v124, 0
    s_waitcnt lgkmcnt(4)
    v_mfma_f32_16x16x32_bf16 v[16:19], v[72:75], v[200:203], v[16:19]
    v_fma_mixlo_f16 v141, v117, v125, 0
    v_mfma_f32_16x16x32_bf16 v[44:47], v[72:75], v[72:75], v[44:47]
    v_fma_mixlo_f16 v142, v118, v126, 0
    s_waitcnt lgkmcnt(3)
    v_mfma_f32_16x16x32_bf16 v[20:23], v[76:79], v[200:203], v[20:23]
    v_fma_mixlo_f16 v143, v119, v127, 0
    v_mfma_f32_16x16x32_bf16 v[36:39], v[76:79], v[76:79], v[36:39]
    v_fma_mixhi_f16 v140, v116, v120, 0
    v_mfma_f32_16x16x32_bf16 v[40:43], v[48:51], v[76:79], v[40:43]
    v_fma_mixhi_f16 v141, v117, v121, 0
    s_waitcnt lgkmcnt(2)
    v_mfma_f32_16x16x32_bf16 v[24:27], v[80:83], v[200:203], v[24:27]
    v_fma_mixhi_f16 v142, v118, v122, 0
    s_waitcnt lgkmcnt(1)
    v_mfma_f32_16x16x32_bf16 v[28:31], v[84:87], v[200:203], v[28:31]
    v_fma_mixhi_f16 v143, v119, v123, 0
    s_waitcnt lgkmcnt(0)
    v_mfma_f32_16x16x32_bf16 v[32:35], v[88:91], v[200:203], v[32:35]
    v_mfma_f32_16x16x32_f16 v[92:95], v[140:143], v[136:139], v[92:95]
    s_waitcnt vmcnt(11)
    s_barrier
    ds_read_b64_tr_b16 v[204:205], v156 offset:2048
    ds_read_b64_tr_b16 v[206:207], v156 offset:5120
    ds_read_b64_tr_b16 v[208:209], v156 offset:14336
    ds_read_b64_tr_b16 v[210:211], v156 offset:17408
    ds_read_b128 v[52:55], v2 offset:4096
    s_add_u32 m0, s69, 24576
    s_mov_b32 s38, 786432
    buffer_load_dwordx4 v4, s[12:15], s38 offen offset:0 lds
    v_mul_f32_dpp v116, v104, v109 row_newbcast:4 row_mask:0xf bank_mask:0xf
    ds_read_b128 v[56:59], v3 offset:4096
    v_mul_f32_dpp v124, v105, v109 row_newbcast:4 row_mask:0xf bank_mask:0xf
    v_mul_f32_dpp v117, v104, v109 row_newbcast:5 row_mask:0xf bank_mask:0xf
    ds_read_b128 v[60:63], v7 offset:4096
    s_add_u32 m0, s69, 24576
    s_mov_b32 s38, 786432
    buffer_load_dwordx4 v4, s[12:15], s38 offen offset:1024 lds
    v_mul_f32_dpp v125, v105, v109 row_newbcast:5 row_mask:0xf bank_mask:0xf
    ds_read_b128 v[64:67], v8 offset:4096
    v_mul_f32_dpp v118, v104, v109 row_newbcast:6 row_mask:0xf bank_mask:0xf
    v_mul_f32_dpp v126, v105, v109 row_newbcast:6 row_mask:0xf bank_mask:0xf
    ds_read_b128 v[68:71], v9 offset:4096
    s_add_u32 m0, s69, 24576
    s_mov_b32 s38, 786432
    buffer_load_dwordx4 v4, s[12:15], s38 offen offset:2048 lds
    v_mul_f32_dpp v119, v104, v109 row_newbcast:7 row_mask:0xf bank_mask:0xf
    s_waitcnt lgkmcnt(4)
    v_mfma_f32_16x16x32_bf16 v[16:19], v[52:55], v[204:207], v[16:19]
    v_mul_f32_dpp v127, v105, v109 row_newbcast:7 row_mask:0xf bank_mask:0xf
    v_exp_f32 v116, v116
    v_mfma_f32_16x16x32_bf16 v[44:47], v[52:55], v[52:55], v[44:47]
    s_add_u32 m0, s69, 36864
    s_mov_b32 s38, 884736
    buffer_load_dwordx4 v4, s[12:15], s38 offen offset:0 lds
    v_fract_f32 v124, v124
    ds_read_b128 v[72:75], v10 offset:4096
    v_exp_f32 v117, v117
    v_fract_f32 v125, v125
    s_waitcnt lgkmcnt(4)
    v_mfma_f32_16x16x32_bf16 v[20:23], v[56:59], v[204:207], v[20:23]
    s_add_u32 m0, s69, 36864
    s_mov_b32 s38, 884736
    buffer_load_dwordx4 v4, s[12:15], s38 offen offset:1024 lds
    v_exp_f32 v118, v118
    ds_read_b128 v[76:79], v11 offset:4096
    v_fract_f32 v126, v126
    v_exp_f32 v119, v119
    v_mfma_f32_16x16x32_bf16 v[36:39], v[56:59], v[56:59], v[36:39]
    s_add_u32 m0, s69, 36864
    s_mov_b32 s38, 884736
    buffer_load_dwordx4 v4, s[12:15], s38 offen offset:2048 lds
    v_fract_f32 v127, v127
    ds_read_b128 v[80:83], v12 offset:4096
    v_sin_f32 v120, v124
    v_cos_f32 v124, v124
    v_mfma_f32_16x16x32_bf16 v[40:43], v[48:51], v[56:59], v[40:43]
    v_sin_f32 v121, v125
    v_cos_f32 v125, v125
    ds_read_b128 v[84:87], v13 offset:4096
    v_sin_f32 v122, v126
    s_waitcnt lgkmcnt(6)
    v_mfma_f32_16x16x32_bf16 v[24:27], v[60:63], v[204:207], v[24:27]
    v_cos_f32 v126, v126
    ds_read_b128 v[88:91], v14 offset:4096
    v_sin_f32 v123, v127
    s_waitcnt lgkmcnt(6)
    v_mfma_f32_16x16x32_bf16 v[28:31], v[64:67], v[204:207], v[28:31]
    v_cos_f32 v127, v127
    s_waitcnt lgkmcnt(5)
    v_mfma_f32_16x16x32_bf16 v[32:35], v[68:71], v[204:207], v[32:35]
    v_fma_mixlo_f16 v144, v116, v124, 0
    s_waitcnt lgkmcnt(4)
    v_mfma_f32_16x16x32_bf16 v[16:19], v[72:75], v[208:211], v[16:19]
    v_fma_mixlo_f16 v145, v117, v125, 0
    v_mfma_f32_16x16x32_bf16 v[44:47], v[72:75], v[72:75], v[44:47]
    v_fma_mixlo_f16 v146, v118, v126, 0
    s_waitcnt lgkmcnt(3)
    v_mfma_f32_16x16x32_bf16 v[20:23], v[76:79], v[208:211], v[20:23]
    v_fma_mixlo_f16 v147, v119, v127, 0
    v_mfma_f32_16x16x32_bf16 v[36:39], v[76:79], v[76:79], v[36:39]
    v_fma_mixhi_f16 v144, v116, v120, 0
    v_mfma_f32_16x16x32_bf16 v[40:43], v[48:51], v[76:79], v[40:43]
    v_fma_mixhi_f16 v145, v117, v121, 0
    s_waitcnt lgkmcnt(2)
    v_mfma_f32_16x16x32_bf16 v[24:27], v[80:83], v[208:211], v[24:27]
    v_fma_mixhi_f16 v146, v118, v122, 0
    s_waitcnt lgkmcnt(1)
    v_mfma_f32_16x16x32_bf16 v[28:31], v[84:87], v[208:211], v[28:31]
    v_fma_mixhi_f16 v147, v119, v123, 0
    s_waitcnt lgkmcnt(0)
    v_mfma_f32_16x16x32_bf16 v[32:35], v[88:91], v[208:211], v[32:35]
    v_mfma_f32_16x16x32_f16 v[96:99], v[144:147], v[136:139], v[96:99]
    s_waitcnt vmcnt(6)
    s_barrier
    ds_read_b64_tr_b16 v[212:213], v15 offset:2048
    ds_read_b64_tr_b16 v[214:215], v15 offset:5120
    ds_read_b64_tr_b16 v[216:217], v15 offset:14336
    ds_read_b64_tr_b16 v[218:219], v15 offset:17408
    ds_read_b128 v[52:55], v2 offset:6144
    s_add_u32 m0, s69, 49152
    s_mov_b32 s38, 983040
    buffer_load_dwordx4 v4, s[12:15], s38 offen offset:0 lds
    v_mul_f32_dpp v116, v104, v110 row_newbcast:4 row_mask:0xf bank_mask:0xf
    ds_read_b128 v[56:59], v3 offset:6144
    v_mul_f32_dpp v124, v105, v110 row_newbcast:4 row_mask:0xf bank_mask:0xf
    v_mul_f32_dpp v117, v104, v110 row_newbcast:5 row_mask:0xf bank_mask:0xf
    ds_read_b128 v[60:63], v7 offset:6144
    s_add_u32 m0, s69, 49152
    s_mov_b32 s38, 983040
    buffer_load_dwordx4 v4, s[12:15], s38 offen offset:1024 lds
    v_mul_f32_dpp v125, v105, v110 row_newbcast:5 row_mask:0xf bank_mask:0xf
    ds_read_b128 v[64:67], v8 offset:6144
    v_mul_f32_dpp v118, v104, v110 row_newbcast:6 row_mask:0xf bank_mask:0xf
    v_mul_f32_dpp v126, v105, v110 row_newbcast:6 row_mask:0xf bank_mask:0xf
    ds_read_b128 v[68:71], v9 offset:6144
    s_add_u32 m0, s69, 49152
    s_mov_b32 s38, 983040
    buffer_load_dwordx4 v4, s[12:15], s38 offen offset:2048 lds
    v_mul_f32_dpp v119, v104, v110 row_newbcast:7 row_mask:0xf bank_mask:0xf
    s_waitcnt lgkmcnt(4)
    v_mfma_f32_16x16x32_bf16 v[16:19], v[52:55], v[212:215], v[16:19]
    v_mul_f32_dpp v127, v105, v110 row_newbcast:7 row_mask:0xf bank_mask:0xf
    v_exp_f32 v116, v116
    v_mfma_f32_16x16x32_bf16 v[44:47], v[52:55], v[52:55], v[44:47]
    s_add_u32 m0, s69, 61440
    s_mov_b32 s38, 1081344
    buffer_load_dwordx4 v4, s[12:15], s38 offen offset:0 lds
    v_fract_f32 v124, v124
    ds_read_b128 v[72:75], v10 offset:6144
    v_exp_f32 v117, v117
    v_fract_f32 v125, v125
    s_waitcnt lgkmcnt(4)
    v_mfma_f32_16x16x32_bf16 v[20:23], v[56:59], v[212:215], v[20:23]
    s_add_u32 m0, s69, 61440
    s_mov_b32 s38, 1081344
    buffer_load_dwordx4 v4, s[12:15], s38 offen offset:1024 lds
    v_exp_f32 v118, v118
    ds_read_b128 v[76:79], v11 offset:6144
    v_fract_f32 v126, v126
    v_exp_f32 v119, v119
    v_mfma_f32_16x16x32_bf16 v[36:39], v[56:59], v[56:59], v[36:39]
    s_add_u32 m0, s69, 61440
    s_mov_b32 s38, 1081344
    buffer_load_dwordx4 v4, s[12:15], s38 offen offset:2048 lds
    v_fract_f32 v127, v127
    ds_read_b128 v[80:83], v12 offset:6144
    v_sin_f32 v120, v124
    v_cos_f32 v124, v124
    v_mfma_f32_16x16x32_bf16 v[40:43], v[48:51], v[56:59], v[40:43]
    v_sin_f32 v121, v125
    v_cos_f32 v125, v125
    ds_read_b128 v[84:87], v13 offset:6144
    v_sin_f32 v122, v126
    s_waitcnt lgkmcnt(6)
    v_mfma_f32_16x16x32_bf16 v[24:27], v[60:63], v[212:215], v[24:27]
    v_cos_f32 v126, v126
    ds_read_b128 v[88:91], v14 offset:6144
    v_sin_f32 v123, v127
    s_waitcnt lgkmcnt(6)
    v_mfma_f32_16x16x32_bf16 v[28:31], v[64:67], v[212:215], v[28:31]
    v_cos_f32 v127, v127
    s_waitcnt lgkmcnt(5)
    v_mfma_f32_16x16x32_bf16 v[32:35], v[68:71], v[212:215], v[32:35]
    v_fma_mixlo_f16 v140, v116, v124, 0
    s_waitcnt lgkmcnt(4)
    v_mfma_f32_16x16x32_bf16 v[16:19], v[72:75], v[216:219], v[16:19]
    v_fma_mixlo_f16 v141, v117, v125, 0
    v_mfma_f32_16x16x32_bf16 v[44:47], v[72:75], v[72:75], v[44:47]
    v_fma_mixlo_f16 v142, v118, v126, 0
    s_waitcnt lgkmcnt(3)
    v_mfma_f32_16x16x32_bf16 v[20:23], v[76:79], v[216:219], v[20:23]
    v_fma_mixlo_f16 v143, v119, v127, 0
    v_mfma_f32_16x16x32_bf16 v[36:39], v[76:79], v[76:79], v[36:39]
    v_fma_mixhi_f16 v140, v116, v120, 0
    v_mfma_f32_16x16x32_bf16 v[40:43], v[48:51], v[76:79], v[40:43]
    v_fma_mixhi_f16 v141, v117, v121, 0
    s_waitcnt lgkmcnt(2)
    v_mfma_f32_16x16x32_bf16 v[24:27], v[80:83], v[216:219], v[24:27]
    v_fma_mixhi_f16 v142, v118, v122, 0
    s_waitcnt lgkmcnt(1)
    v_mfma_f32_16x16x32_bf16 v[28:31], v[84:87], v[216:219], v[28:31]
    v_fma_mixhi_f16 v143, v119, v123, 0
    s_waitcnt lgkmcnt(0)
    v_mfma_f32_16x16x32_bf16 v[32:35], v[88:91], v[216:219], v[32:35]
    v_mfma_f32_16x16x32_f16 v[100:103], v[140:143], v[136:139], v[100:103]
    s_waitcnt vmcnt(6)
    s_barrier
    ds_read_b64_tr_b16 v[220:221], v15 offset:26624
    ds_read_b64_tr_b16 v[222:223], v15 offset:29696
    ds_read_b64_tr_b16 v[224:225], v15 offset:38912
    ds_read_b64_tr_b16 v[226:227], v15 offset:41984
    ds_read_b128 v[52:55], v2 offset:8192
    s_add_u32 m0, s69, 0
    s_mov_b32 s38, 1179648
    buffer_load_dwordx4 v4, s[12:15], s38 offen offset:0 lds
    v_lshrrev_b32 v128, 4, v1
    v_and_b32 v129, 15, v1
    ds_read_b128 v[56:59], v3 offset:8192
    v_lshrrev_b32 v130, 5, v1
    s_add_u32 m0, s69, 0
    s_mov_b32 s38, 1179648
    buffer_load_dwordx4 v4, s[12:15], s38 offen offset:1024 lds
    v_and_b32 v131, 1, v128
    ds_read_b128 v[60:63], v7 offset:8192
    v_lshl_add_u32 v130, v130, 5, v131
    v_lshlrev_b32 v130, 2, v130
    s_add_u32 m0, s69, 0
    s_mov_b32 s38, 1179648
    buffer_load_dwordx4 v4, s[12:15], s38 offen offset:2048 lds
    ds_read_b128 v[64:67], v8 offset:8192
    v_lshl_add_u32 v130, v129, 3, v130
    s_mul_i32 s46, s28, 2624
    ds_read_b128 v[68:71], v9 offset:8192
    s_add_u32 s46, s46, 131072
    s_add_u32 m0, s69, 12288
    s_mov_b32 s38, 1277952
    buffer_load_dwordx4 v4, s[12:15], s38 offen offset:0 lds
    s_waitcnt lgkmcnt(4)
    v_mfma_f32_16x16x32_bf16 v[16:19], v[52:55], v[220:223], v[16:19]
    v_cvt_f32_u32 v116, v130
    v_lshl_add_u32 v108, v130, 2, s46
    v_mfma_f32_16x16x32_bf16 v[44:47], v[52:55], v[52:55], v[44:47]
    v_lshlrev_b32 v130, 7, v128
    s_add_u32 m0, s69, 12288
    s_mov_b32 s38, 1277952
    buffer_load_dwordx4 v4, s[12:15], s38 offen offset:1024 lds
    ds_read_b128 v[72:75], v10 offset:8192
    v_add_u32 v130, 256, v130
    v_lshlrev_b32 v131, 8, v128
    s_waitcnt lgkmcnt(4)
    v_mfma_f32_16x16x32_bf16 v[20:23], v[56:59], v[220:223], v[20:23]
    v_max_u32 v130, v130, v131
    s_add_u32 m0, s69, 12288
    s_mov_b32 s38, 1277952
    buffer_load_dwordx4 v4, s[12:15], s38 offen offset:2048 lds
    ds_read_b128 v[76:79], v11 offset:8192
    v_cvt_f32_u32 v120, v130
    v_add_f32 v120, v120, v111
    v_mfma_f32_16x16x32_bf16 v[36:39], v[56:59], v[56:59], v[36:39]
    v_lshlrev_b32 v130, 9, v128
    v_add_u32 v130, 1024, v130
    ds_read_b128 v[80:83], v12 offset:8192
    v_cvt_f32_u32 v124, v130
    v_add_f32 v124, v124, v111
    v_mfma_f32_16x16x32_bf16 v[40:43], v[48:51], v[56:59], v[40:43]
    v_cmp_gt_u32 s[44:45], 32, v1
    s_mov_b32 s47, 0x43000000
    ds_read_b128 v[84:87], v13 offset:8192
    v_mov_b32 v132, 4.0
    v_mov_b32 v133, s47
    s_waitcnt lgkmcnt(6)
    v_mfma_f32_16x16x32_bf16 v[24:27], v[60:63], v[220:223], v[24:27]
    v_cndmask_b32 v133, v133, v132, s[44:45]
    v_cndmask_b32 v132, v132, 2.0, s[44:45]
    ds_read_b128 v[88:91], v14 offset:8192
    v_add_u32 v110, s46, v131
    v_lshlrev_b32 v130, 3, v129
    s_waitcnt lgkmcnt(6)
    v_mfma_f32_16x16x32_bf16 v[28:31], v[64:67], v[220:223], v[28:31]
    v_lshlrev_b32 v134, 4, v129
    v_cndmask_b32 v130, v130, v134, s[44:45]
    s_waitcnt lgkmcnt(5)
    v_mfma_f32_16x16x32_bf16 v[32:35], v[68:71], v[220:223], v[32:35]
    v_add_u32 v109, v110, v130
    v_mov_b32 v134, 128
    s_waitcnt lgkmcnt(4)
    v_mfma_f32_16x16x32_bf16 v[16:19], v[72:75], v[224:227], v[16:19]
    v_cndmask_b32 v134, v134, 8, s[44:45]
    v_add_u32 v105, v109, v134
    v_mfma_f32_16x16x32_bf16 v[44:47], v[72:75], v[72:75], v[44:47]
    v_lshl_add_u32 v110, v129, 2, v110
    v_mul_f32 v134, s47, v112
    s_waitcnt lgkmcnt(3)
    v_mfma_f32_16x16x32_bf16 v[20:23], v[76:79], v[224:227], v[20:23]
    v_fma_f32 v116, v116, v112, v113
    v_fma_f32 v120, v120, v112, v113
    v_mfma_f32_16x16x32_bf16 v[36:39], v[76:79], v[76:79], v[36:39]
    v_fma_f32 v124, v124, v112, v113
    v_add_f32 v117, v116, v112
    v_mfma_f32_16x16x32_bf16 v[40:43], v[48:51], v[76:79], v[40:43]
    v_fma_f32 v118, 2.0, v112, v116
    v_fma_f32 v121, v132, v112, v120
    s_waitcnt lgkmcnt(2)
    v_mfma_f32_16x16x32_bf16 v[24:27], v[80:83], v[224:227], v[24:27]
    v_fma_f32 v122, v133, v112, v120
    v_add_f32 v125, v124, v134
    s_waitcnt lgkmcnt(1)
    v_mfma_f32_16x16x32_bf16 v[28:31], v[84:87], v[224:227], v[28:31]
    v_fma_f32 v126, 2.0, v134, v124
    v_add_f32 v119, v118, v112
    s_waitcnt lgkmcnt(0)
    v_mfma_f32_16x16x32_bf16 v[32:35], v[88:91], v[224:227], v[32:35]
    v_fma_f32 v123, v132, v112, v122
    v_add_f32 v127, v126, v134
    s_waitcnt vmcnt(6)
    s_barrier
    ds_read_b64_tr_b16 v[228:229], v156 offset:2048
    ds_read_b64_tr_b16 v[230:231], v156 offset:5120
    ds_read_b64_tr_b16 v[232:233], v156 offset:14336
    ds_read_b64_tr_b16 v[234:235], v156 offset:17408
    ds_read_b128 v[52:55], v2 offset:10240
    s_add_u32 m0, s69, 24576
    s_mov_b32 s38, 1376256
    buffer_load_dwordx4 v4, s[12:15], s38 offen offset:0 lds
    v_exp_f32 v116, v116
    ds_read_b128 v[56:59], v3 offset:10240
    v_exp_f32 v117, v117
    v_exp_f32 v118, v118
    ds_read_b128 v[60:63], v7 offset:10240
    s_add_u32 m0, s69, 24576
    s_mov_b32 s38, 1376256
    buffer_load_dwordx4 v4, s[12:15], s38 offen offset:1024 lds
    v_exp_f32 v119, v119
    ds_read_b128 v[64:67], v8 offset:10240
    v_exp_f32 v120, v120
    v_exp_f32 v121, v121
    ds_read_b128 v[68:71], v9 offset:10240
    s_add_u32 m0, s69, 24576
    s_mov_b32 s38, 1376256
    buffer_load_dwordx4 v4, s[12:15], s38 offen offset:2048 lds
    s_waitcnt lgkmcnt(4)
    v_mfma_f32_16x16x32_bf16 v[16:19], v[52:55], v[228:231], v[16:19]
    v_exp_f32 v122, v122
    v_mfma_f32_16x16x32_bf16 v[44:47], v[52:55], v[52:55], v[44:47]
    v_exp_f32 v123, v123
    ds_read_b128 v[72:75], v10 offset:10240
    v_exp_f32 v124, v124
    s_waitcnt lgkmcnt(4)
    v_mfma_f32_16x16x32_bf16 v[20:23], v[56:59], v[228:231], v[20:23]
    s_add_u32 m0, s69, 36864
    s_mov_b32 s38, 1474560
    buffer_load_dwordx4 v4, s[12:15], s38 offen offset:0 lds
    ds_read_b128 v[76:79], v11 offset:10240
    v_exp_f32 v125, v125
    v_mfma_f32_16x16x32_bf16 v[36:39], v[56:59], v[56:59], v[36:39]
    v_exp_f32 v126, v126
    ds_read_b128 v[80:83], v12 offset:10240
    v_exp_f32 v127, v127
    v_mfma_f32_16x16x32_bf16 v[40:43], v[48:51], v[56:59], v[40:43]
    s_add_u32 m0, s69, 36864
    s_mov_b32 s38, 1474560
    buffer_load_dwordx4 v4, s[12:15], s38 offen offset:1024 lds
    ds_read_b128 v[84:87], v13 offset:10240
    v_mul_f32 v92, v92, v116
    s_waitcnt lgkmcnt(6)
    v_mfma_f32_16x16x32_bf16 v[24:27], v[60:63], v[228:231], v[24:27]
    v_mul_f32 v93, v93, v117
    ds_read_b128 v[88:91], v14 offset:10240
    v_mul_f32 v94, v94, v118
    s_waitcnt lgkmcnt(6)
    v_mfma_f32_16x16x32_bf16 v[28:31], v[64:67], v[228:231], v[28:31]
    s_add_u32 m0, s69, 36864
    s_mov_b32 s38, 1474560
    buffer_load_dwordx4 v4, s[12:15], s38 offen offset:2048 lds
    s_waitcnt lgkmcnt(5)
    v_mfma_f32_16x16x32_bf16 v[32:35], v[68:71], v[228:231], v[32:35]
    v_mul_f32 v95, v95, v119
    s_waitcnt lgkmcnt(4)
    v_mfma_f32_16x16x32_bf16 v[16:19], v[72:75], v[232:235], v[16:19]
    v_mul_f32 v96, v96, v120
    v_mfma_f32_16x16x32_bf16 v[44:47], v[72:75], v[72:75], v[44:47]
    v_mul_f32 v97, v97, v121
    s_waitcnt lgkmcnt(3)
    v_mfma_f32_16x16x32_bf16 v[20:23], v[76:79], v[232:235], v[20:23]
    v_mul_f32 v98, v98, v122
    v_mfma_f32_16x16x32_bf16 v[36:39], v[76:79], v[76:79], v[36:39]
    v_mul_f32 v99, v99, v123
    v_mfma_f32_16x16x32_bf16 v[40:43], v[48:51], v[76:79], v[40:43]
    v_mul_f32 v100, v100, v124
    s_waitcnt lgkmcnt(2)
    v_mfma_f32_16x16x32_bf16 v[24:27], v[80:83], v[232:235], v[24:27]
    v_mul_f32 v101, v101, v125
    s_waitcnt lgkmcnt(1)
    v_mfma_f32_16x16x32_bf16 v[28:31], v[84:87], v[232:235], v[28:31]
    v_mul_f32 v102, v102, v126
    s_waitcnt lgkmcnt(0)
    v_mfma_f32_16x16x32_bf16 v[32:35], v[88:91], v[232:235], v[32:35]
    v_mul_f32 v103, v103, v127
    s_waitcnt vmcnt(6)
    s_barrier
    ds_read_b64_tr_b16 v[236:237], v15 offset:2048
    ds_read_b64_tr_b16 v[238:239], v15 offset:5120
    ds_read_b64_tr_b16 v[240:241], v15 offset:14336
    ds_read_b64_tr_b16 v[242:243], v15 offset:17408
    ds_write_b128 v108, v[92:95]
    ds_write_b64 v109, v[96:97] offset:1024
    ds_write_b64 v105, v[98:99] offset:1024
    s_mov_b32 exec_hi, 1
    ds_write_b32 v110, v100 offset:2048
    s_mov_b32 exec_hi, 0
    ds_write_b32 v110, v101 offset:2112
    ds_write_b32 v110, v102 offset:2176
    ds_write_b32 v110, v103 offset:2240
    s_mov_b32 exec_hi, -1
    ds_read_b128 v[52:55], v2 offset:12288
    ds_read_b128 v[56:59], v3 offset:12288
    ds_read_b128 v[60:63], v7 offset:12288
    ds_read_b128 v[64:67], v8 offset:12288
    ds_read_b128 v[68:71], v9 offset:12288
    s_waitcnt lgkmcnt(4)
    v_mfma_f32_16x16x32_bf16 v[16:19], v[52:55], v[236:239], v[16:19]
    v_mfma_f32_16x16x32_bf16 v[44:47], v[52:55], v[52:55], v[44:47]
    ds_read_b128 v[72:75], v10 offset:12288
    s_waitcnt lgkmcnt(4)
    v_mfma_f32_16x16x32_bf16 v[20:23], v[56:59], v[236:239], v[20:23]
    ds_read_b128 v[76:79], v11 offset:12288
    v_mfma_f32_16x16x32_bf16 v[36:39], v[56:59], v[56:59], v[36:39]
    ds_read_b128 v[80:83], v12 offset:12288
    v_mfma_f32_16x16x32_bf16 v[40:43], v[48:51], v[56:59], v[40:43]
    ds_read_b128 v[84:87], v13 offset:12288
    s_waitcnt lgkmcnt(6)
    v_mfma_f32_16x16x32_bf16 v[24:27], v[60:63], v[236:239], v[24:27]
    ds_read_b128 v[88:91], v14 offset:12288
    s_waitcnt lgkmcnt(6)
    v_mfma_f32_16x16x32_bf16 v[28:31], v[64:67], v[236:239], v[28:31]
    s_waitcnt lgkmcnt(5)
    v_mfma_f32_16x16x32_bf16 v[32:35], v[68:71], v[236:239], v[32:35]
    s_waitcnt lgkmcnt(4)
    v_mfma_f32_16x16x32_bf16 v[16:19], v[72:75], v[240:243], v[16:19]
    v_mfma_f32_16x16x32_bf16 v[44:47], v[72:75], v[72:75], v[44:47]
    s_waitcnt lgkmcnt(3)
    v_mfma_f32_16x16x32_bf16 v[20:23], v[76:79], v[240:243], v[20:23]
    v_mfma_f32_16x16x32_bf16 v[36:39], v[76:79], v[76:79], v[36:39]
    v_mfma_f32_16x16x32_bf16 v[40:43], v[48:51], v[76:79], v[40:43]
    s_waitcnt lgkmcnt(2)
    v_mfma_f32_16x16x32_bf16 v[24:27], v[80:83], v[240:243], v[24:27]
    s_waitcnt lgkmcnt(1)
    v_mfma_f32_16x16x32_bf16 v[28:31], v[84:87], v[240:243], v[28:31]
    s_waitcnt lgkmcnt(0)
    v_mfma_f32_16x16x32_bf16 v[32:35], v[88:91], v[240:243], v[32:35]
    s_waitcnt vmcnt(0)
    s_barrier
    ds_read_b64_tr_b16 v[244:245], v15 offset:26624
    ds_read_b64_tr_b16 v[246:247], v15 offset:29696
    ds_read_b64_tr_b16 v[248:249], v15 offset:38912
    ds_read_b64_tr_b16 v[250:251], v15 offset:41984
    ds_read_b128 v[52:55], v2 offset:14336
    ds_read_b128 v[56:59], v3 offset:14336
    ds_read_b128 v[60:63], v7 offset:14336
    ds_read_b128 v[64:67], v8 offset:14336
    ds_read_b128 v[68:71], v9 offset:14336
    s_waitcnt lgkmcnt(4)
    v_mfma_f32_16x16x32_bf16 v[16:19], v[52:55], v[244:247], v[16:19]
    v_mfma_f32_16x16x32_bf16 v[44:47], v[52:55], v[52:55], v[44:47]
    ds_read_b128 v[72:75], v10 offset:14336
    s_waitcnt lgkmcnt(4)
    v_mfma_f32_16x16x32_bf16 v[20:23], v[56:59], v[244:247], v[20:23]
    ds_read_b128 v[76:79], v11 offset:14336
    v_mfma_f32_16x16x32_bf16 v[36:39], v[56:59], v[56:59], v[36:39]
    ds_read_b128 v[80:83], v12 offset:14336
    v_mfma_f32_16x16x32_bf16 v[40:43], v[48:51], v[56:59], v[40:43]
    ds_read_b128 v[84:87], v13 offset:14336
    s_waitcnt lgkmcnt(6)
    v_mfma_f32_16x16x32_bf16 v[24:27], v[60:63], v[244:247], v[24:27]
    ds_read_b128 v[88:91], v14 offset:14336
    s_waitcnt lgkmcnt(6)
    v_mfma_f32_16x16x32_bf16 v[28:31], v[64:67], v[244:247], v[28:31]
    s_waitcnt lgkmcnt(5)
    v_mfma_f32_16x16x32_bf16 v[32:35], v[68:71], v[244:247], v[32:35]
    s_waitcnt lgkmcnt(4)
    v_mfma_f32_16x16x32_bf16 v[16:19], v[72:75], v[248:251], v[16:19]
    v_mfma_f32_16x16x32_bf16 v[44:47], v[72:75], v[72:75], v[44:47]
    s_waitcnt lgkmcnt(3)
    v_mfma_f32_16x16x32_bf16 v[20:23], v[76:79], v[248:251], v[20:23]
    v_mfma_f32_16x16x32_bf16 v[36:39], v[76:79], v[76:79], v[36:39]
    v_mfma_f32_16x16x32_bf16 v[40:43], v[48:51], v[76:79], v[40:43]
    s_waitcnt lgkmcnt(2)
    v_mfma_f32_16x16x32_bf16 v[24:27], v[80:83], v[248:251], v[24:27]
    s_waitcnt lgkmcnt(1)
    v_mfma_f32_16x16x32_bf16 v[28:31], v[84:87], v[248:251], v[28:31]
    s_waitcnt lgkmcnt(0)
    v_mfma_f32_16x16x32_bf16 v[32:35], v[88:91], v[248:251], v[32:35]
    v_mov_b32 v252, v16
    v_mov_b32 v253, v16
    s_nop 1
    v_permlane16_swap_b32 v252, v253
    v_mov_b32 v253, v252
    s_nop 1
    v_permlane32_swap_b32 v252, v253
    s_nop 2
v_common:
    v_and_b32 v10, 15, v1
    v_lshrrev_b32 v11, 4, v1
    v_and_b32 v12, 1, v1
    v_cmp_eq_u32 s[40:41], 1, v12
    v_and_b32 v12, 2, v1
    v_cmp_eq_u32 s[42:43], 2, v12
    s_mov_b32 s44, 0x3b000000
    v_mov_b32 v13, 0x3727c5ac
    s_lshl_b32 s45, s52, 7
    s_add_u32 s45, s45, 155648
    v_lshl_add_u32 v14, v10, 3, s45
    s_lshl_b32 s45, s52, 6
    s_add_u32 s45, s45, 156288
    v_lshl_add_u32 v15, v10, 2, s45
    v_lshlrev_b32 v60, 3, v10
    v_lshlrev_b32 v61, 2, v10
    v_mov_b32 v54, v44
    v_mov_b32 v55, v44
    s_nop 1
    v_permlane16_swap_b32 v54, v55
    v_mov_b32 v55, v54
    s_nop 1
    v_permlane32_swap_b32 v54, v55
    v_cndmask_b32 v56, v36, v37, s[40:41]
    v_cndmask_b32 v57, v38, v39, s[40:41]
    v_cndmask_b32 v53, v56, v57, s[42:43]
    v_cndmask_b32 v56, v44, v45, s[40:41]
    v_cndmask_b32 v57, v46, v47, s[40:41]
    v_cndmask_b32 v55, v56, v57, s[42:43]
    v_mul_f32 v52, s44, v40
    v_mul_f32 v54, s44, v54
    v_fma_f32 v53, v53, s44, v13
    v_fma_f32 v55, v55, s44, v13
    v_fma_f32 v53, -v52, v52, v53
    v_fma_f32 v55, -v54, v54, v55
    v_max_f32 v53, v13, v53
    v_max_f32 v55, v13, v55
    v_sqrt_f32 v53, v53
    v_sqrt_f32 v55, v55
    v_cvt_pk_bf16_f32 v56, v52, v54
    v_cvt_pk_bf16_f32 v57, v53, v55
    v_lshlrev_b32 v52, 16, v56
    v_and_b32 v54, 0xffff0000, v56
    v_lshlrev_b32 v53, 16, v57
    v_and_b32 v55, 0xffff0000, v57
    v_rcp_f32 v53, v53
    v_rcp_f32 v55, v55
    s_mov_b32 exec_lo, 0x00f0000f
    s_mov_b32 exec_hi, 0xf0000f00
    ds_write_b64 v14, v[52:53]
    ds_write_b32 v15, v52
    ds_write_b32 v15, v53 offset:320
    v_add_u32 v60, 155648, v60
    v_add_u32 v61, 156288, v61
    ds_write_b64 v60, v[54:55]
    ds_write_b32 v61, v54
    ds_write_b32 v61, v55 offset:320
    s_mov_b64 exec, 1
    v_mov_b32 v12, 156928
    v_mov_b32 v13, 1
    ds_add_u32 v12, v13
    s_mov_b64 exec, -1
    v_mov_b32 v12, 156928
    s_and_b32 s45, s29, 1
    s_lshl_b32 s45, s45, 2
    v_lshrrev_b32 v15, 1, v11
    v_xor_b32 v15, v15, v10
    v_xor_b32 v15, s45, v15
    v_and_b32 v15, 7, v15
    v_and_b32 v14, 7, v10
    v_lshlrev_b32 v14, 8, v14
    v_lshl_add_u32 v14, v15, 4, v14
    v_lshrrev_b32 v15, 3, v10
    v_lshl_add_u32 v14, v15, 14, v14
    v_and_b32 v15, 1, v11
    v_lshl_add_u32 v14, v15, 3, v14
    s_lshr_b32 s45, s31, 2
    s_lshl_b32 s45, s45, 15
    s_and_b32 s46, s31, 3
    s_lshl_b32 s46, s46, 12
    s_add_u32 s45, s45, s46
    s_lshr_b32 s46, s29, 1
    s_lshl_b32 s46, s46, 11
    s_add_u32 s45, s45, s46
    s_add_u32 s45, s45, 16384
    v_add_u32 v14, s45, v14
    v_xor_b32 v15, 32, v14
    v_lshlrev_b32 v96, 4, v11
    v_add_u32 v96, 156288, v96
    s_mul_i32 s45, s29, 2560
    s_add_u32 s45, s45, 81920
    v_lshl_add_u32 v101, v1, 3, s45
    s_lshl_b32 s45, s52, 6
    v_add_u32 v97, s45, v96
    s_lshl_b32 s45, s52, 9
    v_add_u32 v102, s45, v101
    s_lshl_b32 s45, s53, 6
    v_add_u32 v98, s45, v96
    s_lshl_b32 s45, s53, 9
    v_add_u32 v103, s45, v101
    s_lshl_b32 s45, s54, 6
    v_add_u32 v99, s45, v96
    s_lshl_b32 s45, s54, 9
    v_add_u32 v104, s45, v101
    s_lshl_b32 s45, s55, 6
    v_add_u32 v100, s45, v96
    s_lshl_b32 s45, s55, 9
    v_add_u32 v105, s45, v101
    s_lshl_b32 s45, s34, 2
    s_add_u32 s45, s45, 4
    s_mov_b32 s38, 0
v_spin:
    ds_read_b32 v13, v12
    ds_read_b128 v[56:59], v96
    ds_read_b128 v[60:63], v96 offset:320
    ds_read_b128 v[64:67], v97
    ds_read_b128 v[68:71], v97 offset:320
    ds_read_b128 v[72:75], v98
    ds_read_b128 v[76:79], v98 offset:320
    ds_read_b128 v[80:83], v99
    ds_read_b128 v[84:87], v99 offset:320
    ds_read_b128 v[88:91], v100
    ds_read_b128 v[92:95], v100 offset:320
    s_add_u32 s38, s38, 1
    s_waitcnt lgkmcnt(10)
    v_cmp_gt_u32 vcc, s45, v13
    s_cmp_gt_u32 s38, 131072
    s_cbranch_scc1 v_spin_x
    s_cbranch_vccnz v_spin
v_spin_x:
    ds_read_b64 v[106:107], v14
    ds_read_b64 v[108:109], v14 offset:128
    ds_read_b64 v[110:111], v15
    ds_read_b64 v[112:113], v15 offset:128
    s_waitcnt lgkmcnt(4)
    v_pk_fma_f32 v[16:17], v[56:57], v[252:253], v[16:17] op_sel_hi:[1,0,1] neg_lo:[1,0,0] neg_hi:[1,0,0]
    v_pk_fma_f32 v[18:19], v[58:59], v[252:253], v[18:19] op_sel_hi:[1,0,1] neg_lo:[1,0,0] neg_hi:[1,0,0]
    v_pk_fma_f32 v[20:21], v[64:65], v[252:253], v[20:21] op_sel_hi:[1,0,1] neg_lo:[1,0,0] neg_hi:[1,0,0]
    v_pk_fma_f32 v[22:23], v[66:67], v[252:253], v[22:23] op_sel_hi:[1,0,1] neg_lo:[1,0,0] neg_hi:[1,0,0]
    v_pk_fma_f32 v[24:25], v[72:73], v[252:253], v[24:25] op_sel_hi:[1,0,1] neg_lo:[1,0,0] neg_hi:[1,0,0]
    v_pk_fma_f32 v[26:27], v[74:75], v[252:253], v[26:27] op_sel_hi:[1,0,1] neg_lo:[1,0,0] neg_hi:[1,0,0]
    v_pk_fma_f32 v[28:29], v[80:81], v[252:253], v[28:29] op_sel_hi:[1,0,1] neg_lo:[1,0,0] neg_hi:[1,0,0]
    v_pk_fma_f32 v[30:31], v[82:83], v[252:253], v[30:31] op_sel_hi:[1,0,1] neg_lo:[1,0,0] neg_hi:[1,0,0]
    v_pk_fma_f32 v[32:33], v[88:89], v[252:253], v[32:33] op_sel_hi:[1,0,1] neg_lo:[1,0,0] neg_hi:[1,0,0]
    v_pk_fma_f32 v[34:35], v[90:91], v[252:253], v[34:35] op_sel_hi:[1,0,1] neg_lo:[1,0,0] neg_hi:[1,0,0]
    v_pk_mul_f32 v[16:17], v[16:17], v[60:61]
    v_pk_mul_f32 v[18:19], v[18:19], v[62:63]
    v_pk_mul_f32 v[20:21], v[20:21], v[68:69]
    v_pk_mul_f32 v[22:23], v[22:23], v[70:71]
    v_pk_mul_f32 v[24:25], v[24:25], v[76:77]
    v_pk_mul_f32 v[26:27], v[26:27], v[78:79]
    v_pk_mul_f32 v[28:29], v[28:29], v[84:85]
    v_pk_mul_f32 v[30:31], v[30:31], v[86:87]
    v_pk_mul_f32 v[32:33], v[32:33], v[92:93]
    v_pk_mul_f32 v[34:35], v[34:35], v[94:95]
    v_cvt_pk_bf16_f32 v16, v16, v17
    v_cvt_pk_bf16_f32 v17, v18, v19
    ds_write_b64 v101, v[16:17]
    v_cvt_pk_bf16_f32 v20, v20, v21
    v_cvt_pk_bf16_f32 v21, v22, v23
    ds_write_b64 v102, v[20:21]
    v_cvt_pk_bf16_f32 v24, v24, v25
    v_cvt_pk_bf16_f32 v25, v26, v27
    ds_write_b64 v103, v[24:25]
    v_cvt_pk_bf16_f32 v28, v28, v29
    v_cvt_pk_bf16_f32 v29, v30, v31
    ds_write_b64 v104, v[28:29]
    v_cvt_pk_bf16_f32 v32, v32, v33
    v_cvt_pk_bf16_f32 v33, v34, v35
    ds_write_b64 v105, v[32:33]
    s_waitcnt lgkmcnt(0)
    v_mov_b32 v24, v106
    v_mov_b32 v25, v107
    v_mov_b32 v26, v108
    v_mov_b32 v27, v109
    v_mov_b32 v28, v110
    v_mov_b32 v29, v111
    v_mov_b32 v30, v112
    v_mov_b32 v31, v113
    s_setprio 0
    s_barrier
    v_lshrrev_b32 v10, 4, v1
    v_bfe_u32 v11, v1, 2, 2
    v_lshl_add_u32 v4, v10, 3, v11
    v_lshlrev_b32 v4, 10, v4
    v_lshrrev_b32 v11, 1, v1
    v_xor_b32 v11, v11, v10
    v_and_b32 v11, 1, v11
    v_lshl_add_u32 v4, v11, 5, v4
    v_and_b32 v11, 1, v1
    v_lshl_add_u32 v4, v11, 4, v4
    s_and_b32 s38, s31, 3
    s_lshl_b32 s38, s38, 8
    s_lshl_b32 s39, s29, 6
    s_add_u32 s38, s38, s39
    v_add_u32 v4, s38, v4
    s_cmp_eq_u32 s34, 0
    s_cbranch_scc0 v_nofirst
    s_mul_i32 s38, s29, 14336
    s_add_u32 m0, s38, 98304
    s_mov_b32 s38, 0
    buffer_load_dwordx4 v4, s[16:19], s38 offen lds
    s_add_u32 m0, m0, 1024
    s_mov_b32 s38, 4096
    buffer_load_dwordx4 v4, s[16:19], s38 offen lds
    s_add_u32 m0, m0, 1024
    s_mov_b32 s38, 32768
    buffer_load_dwordx4 v4, s[16:19], s38 offen lds
    s_add_u32 m0, m0, 1024
    s_mov_b32 s38, 36864
    buffer_load_dwordx4 v4, s[16:19], s38 offen lds
    s_add_u32 m0, m0, 1024
    s_mov_b32 s38, 65536
    buffer_load_dwordx4 v4, s[16:19], s38 offen lds
    s_add_u32 m0, m0, 1024
    s_mov_b32 s38, 69632
    buffer_load_dwordx4 v4, s[16:19], s38 offen lds
    s_add_u32 m0, m0, 1024
    s_mov_b32 s38, 98304
    buffer_load_dwordx4 v4, s[16:19], s38 offen lds
    s_add_u32 m0, m0, 1024
    s_mov_b32 s38, 102400
    buffer_load_dwordx4 v4, s[16:19], s38 offen lds
    s_add_u32 m0, m0, 1024
    s_mov_b32 s38, 131072
    buffer_load_dwordx4 v4, s[16:19], s38 offen lds
    s_add_u32 m0, m0, 1024
    s_mov_b32 s38, 135168
    buffer_load_dwordx4 v4, s[16:19], s38 offen lds
    s_add_u32 m0, m0, 1024
    s_mov_b32 s38, 163840
    buffer_load_dwordx4 v4, s[16:19], s38 offen lds
    s_add_u32 m0, m0, 1024
    s_mov_b32 s38, 167936
    buffer_load_dwordx4 v4, s[16:19], s38 offen lds
    s_add_u32 m0, m0, 1024
    s_mov_b32 s38, 196608
    buffer_load_dwordx4 v4, s[16:19], s38 offen lds
    s_add_u32 m0, m0, 1024
    s_mov_b32 s38, 200704
    buffer_load_dwordx4 v4, s[16:19], s38 offen lds
v_nofirst:
    s_mul_i32 s38, s29, 18432
    s_add_u32 m0, s38, 0
    s_mov_b32 s38, 229376
    buffer_load_dwordx4 v4, s[16:19], s38 offen lds
    s_add_u32 m0, m0, 1024
    s_mov_b32 s38, 233472
    buffer_load_dwordx4 v4, s[16:19], s38 offen lds
    s_add_u32 m0, m0, 1024
    s_mov_b32 s38, 262144
    buffer_load_dwordx4 v4, s[16:19], s38 offen lds
    s_add_u32 m0, m0, 1024
    s_mov_b32 s38, 266240
    buffer_load_dwordx4 v4, s[16:19], s38 offen lds
    s_add_u32 m0, m0, 1024
    s_mov_b32 s38, 294912
    buffer_load_dwordx4 v4, s[16:19], s38 offen lds
    s_add_u32 m0, m0, 1024
    s_mov_b32 s38, 299008
    buffer_load_dwordx4 v4, s[16:19], s38 offen lds
    s_add_u32 m0, m0, 1024
    s_mov_b32 s38, 327680
    buffer_load_dwordx4 v4, s[16:19], s38 offen lds
    s_add_u32 m0, m0, 1024
    s_mov_b32 s38, 331776
    buffer_load_dwordx4 v4, s[16:19], s38 offen lds
    s_add_u32 m0, m0, 1024
    s_mov_b32 s38, 360448
    buffer_load_dwordx4 v4, s[16:19], s38 offen lds
    s_add_u32 m0, m0, 1024
    s_mov_b32 s38, 364544
    buffer_load_dwordx4 v4, s[16:19], s38 offen lds
    s_add_u32 m0, m0, 1024
    s_mov_b32 s38, 393216
    buffer_load_dwordx4 v4, s[16:19], s38 offen lds
    s_add_u32 m0, m0, 1024
    s_mov_b32 s38, 397312
    buffer_load_dwordx4 v4, s[16:19], s38 offen lds
    s_add_u32 m0, m0, 1024
    s_mov_b32 s38, 425984
    buffer_load_dwordx4 v4, s[16:19], s38 offen lds
    s_add_u32 m0, m0, 1024
    s_mov_b32 s38, 430080
    buffer_load_dwordx4 v4, s[16:19], s38 offen lds
    s_add_u32 m0, m0, 1024
    s_mov_b32 s38, 458752
    buffer_load_dwordx4 v4, s[16:19], s38 offen lds
    s_add_u32 m0, m0, 1024
    s_mov_b32 s38, 462848
    buffer_load_dwordx4 v4, s[16:19], s38 offen lds
    s_add_u32 m0, m0, 1024
    s_mov_b32 s38, 491520
    buffer_load_dwordx4 v4, s[16:19], s38 offen lds
    s_add_u32 m0, m0, 1024
    s_mov_b32 s38, 495616
    buffer_load_dwordx4 v4, s[16:19], s38 offen lds
    v_lshrrev_b32 v10, 2, v1
    v_lshlrev_b32 v10, 6, v10
    v_bfe_u32 v11, v1, 4, 1
    v_lshl_add_u32 v10, v11, 5, v10
    v_and_b32 v11, 3, v1
    v_lshl_add_u32 v10, v11, 3, v10
    s_mul_i32 s38, s29, 14336
    s_add_u32 s38, s38, 98304
    v_add_u32 v12, s38, v10
    v_xor_b32 v13, 32, v12
    s_mul_i32 s38, s29, 18432
    v_add_u32 v14, s38, v10
    v_xor_b32 v15, 32, v14
    s_waitcnt vmcnt(30)
    ds_read_b64_tr_b16 v[48:49], v12 offset:0
    ds_read_b64_tr_b16 v[50:51], v12 offset:1024
    ds_read_b64_tr_b16 v[52:53], v13 offset:0
    ds_read_b64_tr_b16 v[54:55], v13 offset:1024
    s_waitcnt vmcnt(28)
    ds_read_b64_tr_b16 v[56:57], v12 offset:2048
    ds_read_b64_tr_b16 v[58:59], v12 offset:3072
    ds_read_b64_tr_b16 v[60:61], v13 offset:2048
    ds_read_b64_tr_b16 v[62:63], v13 offset:3072
    s_waitcnt vmcnt(26)
    ds_read_b64_tr_b16 v[64:65], v12 offset:4096
    ds_read_b64_tr_b16 v[66:67], v12 offset:5120
    ds_read_b64_tr_b16 v[68:69], v13 offset:4096
    ds_read_b64_tr_b16 v[70:71], v13 offset:5120
    s_waitcnt vmcnt(24)
    ds_read_b64_tr_b16 v[72:73], v12 offset:6144
    ds_read_b64_tr_b16 v[74:75], v12 offset:7168
    ds_read_b64_tr_b16 v[76:77], v13 offset:6144
    ds_read_b64_tr_b16 v[78:79], v13 offset:7168
    s_waitcnt vmcnt(22)
    ds_read_b64_tr_b16 v[80:81], v12 offset:8192
    ds_read_b64_tr_b16 v[82:83], v12 offset:9216
    ds_read_b64_tr_b16 v[84:85], v13 offset:8192
    ds_read_b64_tr_b16 v[86:87], v13 offset:9216
    s_waitcnt vmcnt(20)
    ds_read_b64_tr_b16 v[88:89], v12 offset:10240
    ds_read_b64_tr_b16 v[90:91], v12 offset:11264
    ds_read_b64_tr_b16 v[92:93], v13 offset:10240
    ds_read_b64_tr_b16 v[94:95], v13 offset:11264
    s_waitcnt vmcnt(18)
    ds_read_b64_tr_b16 v[96:97], v12 offset:12288
    ds_read_b64_tr_b16 v[98:99], v12 offset:13312
    ds_read_b64_tr_b16 v[100:101], v13 offset:12288
    ds_read_b64_tr_b16 v[102:103], v13 offset:13312
    s_waitcnt lgkmcnt(0)
    s_barrier
    s_waitcnt vmcnt(16)
    ds_read_b64_tr_b16 v[104:105], v14 offset:0
    ds_read_b64_tr_b16 v[106:107], v14 offset:1024
    ds_read_b64_tr_b16 v[108:109], v15 offset:0
    ds_read_b64_tr_b16 v[110:111], v15 offset:1024
    s_waitcnt vmcnt(14)
    ds_read_b64_tr_b16 v[112:113], v14 offset:2048
    ds_read_b64_tr_b16 v[114:115], v14 offset:3072
    ds_read_b64_tr_b16 v[116:117], v15 offset:2048
    ds_read_b64_tr_b16 v[118:119], v15 offset:3072
    s_waitcnt vmcnt(12)
    ds_read_b64_tr_b16 v[120:121], v14 offset:4096
    ds_read_b64_tr_b16 v[122:123], v14 offset:5120
    ds_read_b64_tr_b16 v[124:125], v15 offset:4096
    ds_read_b64_tr_b16 v[126:127], v15 offset:5120
    s_waitcnt vmcnt(10)
    ds_read_b64_tr_b16 v[128:129], v14 offset:6144
    ds_read_b64_tr_b16 v[130:131], v14 offset:7168
    ds_read_b64_tr_b16 v[132:133], v15 offset:6144
    ds_read_b64_tr_b16 v[134:135], v15 offset:7168
    s_waitcnt vmcnt(8)
    ds_read_b64_tr_b16 v[136:137], v14 offset:8192
    ds_read_b64_tr_b16 v[138:139], v14 offset:9216
    ds_read_b64_tr_b16 v[140:141], v15 offset:8192
    ds_read_b64_tr_b16 v[142:143], v15 offset:9216
    s_waitcnt vmcnt(6)
    ds_read_b64_tr_b16 v[144:145], v14 offset:10240
    ds_read_b64_tr_b16 v[146:147], v14 offset:11264
    ds_read_b64_tr_b16 v[148:149], v15 offset:10240
    ds_read_b64_tr_b16 v[150:151], v15 offset:11264
    s_waitcnt vmcnt(4)
    ds_read_b64_tr_b16 v[152:153], v14 offset:12288
    ds_read_b64_tr_b16 v[154:155], v14 offset:13312
    ds_read_b64_tr_b16 v[156:157], v15 offset:12288
    ds_read_b64_tr_b16 v[158:159], v15 offset:13312
    s_waitcnt vmcnt(2)
    ds_read_b64_tr_b16 v[160:161], v14 offset:14336
    ds_read_b64_tr_b16 v[162:163], v14 offset:15360
    ds_read_b64_tr_b16 v[164:165], v15 offset:14336
    ds_read_b64_tr_b16 v[166:167], v15 offset:15360
    s_waitcnt vmcnt(0)
    ds_read_b64_tr_b16 v[168:169], v14 offset:16384
    ds_read_b64_tr_b16 v[170:171], v14 offset:17408
    ds_read_b64_tr_b16 v[172:173], v15 offset:16384
    ds_read_b64_tr_b16 v[174:175], v15 offset:17408
    v_and_b32 v6, 15, v1
    v_lshrrev_b32 v7, 4, v1
    v_lshlrev_b32 v5, 4, v6
    v_lshl_add_u32 v184, v7, 9, v5
    v_add_u32 v184, 81920, v184
    v_lshl_add_u32 v185, v7, 14, v5
    v_add_u32 v186, 157184, v5
    s_lshl_b32 s38, s29, 8
    v_add_u32 v187, s38, v186
    s_and_b32 s44, s31, 3
    s_lshl_b32 s44, s44, 19
    s_lshl_b32 s41, s30, 9
    s_add_u32 s44, s44, s41
    s_lshr_b32 s41, s31, 2
    s_lshl_b32 s41, s41, 8
    s_add_u32 s44, s44, s41
    s_add_u32 s44, s44, s36
    s_lshl_b32 s38, s29, 17
    s_add_u32 s44, s44, s38
    s_add_u32 s45, s44, 65536
    s_and_b32 s46, s31, 3
    s_lshl_b32 s46, s46, 14
    s_lshl_b32 s41, s30, 9
    s_add_u32 s46, s46, s41
    s_lshr_b32 s41, s31, 2
    s_lshl_b32 s41, s41, 8
    s_add_u32 s46, s46, s41
    s_add_u32 s46, s46, s37
    s_mov_b32 s47, 0xffff0000
    s_waitcnt lgkmcnt(0)
    s_barrier
    ds_read_b128 v[8:11], v184 offset:0
    ds_read_b128 v[12:15], v184 offset:256
    ds_read_b128 v[16:19], v184 offset:2048
    ds_read_b128 v[20:23], v184 offset:2304
    s_waitcnt lgkmcnt(3)
    v_mfma_f32_16x16x32_bf16 v[32:35], v[48:51], v[8:11], 0
    ds_read_b128 v[176:179], v184 offset:4096
    ds_read_b128 v[180:183], v184 offset:4352
    v_mfma_f32_16x16x32_bf16 v[40:43], v[52:55], v[8:11], 0
    s_waitcnt lgkmcnt(4)
    v_mfma_f32_16x16x32_bf16 v[36:39], v[48:51], v[12:15], 0
    v_mfma_f32_16x16x32_bf16 v[44:47], v[52:55], v[12:15], 0
    s_waitcnt lgkmcnt(3)
    v_mfma_f32_16x16x32_bf16 v[32:35], v[56:59], v[16:19], v[32:35]
    ds_read_b128 v[8:11], v184 offset:6144
    ds_read_b128 v[12:15], v184 offset:6400
    v_mfma_f32_16x16x32_bf16 v[40:43], v[60:63], v[16:19], v[40:43]
    s_waitcnt lgkmcnt(4)
    v_mfma_f32_16x16x32_bf16 v[36:39], v[56:59], v[20:23], v[36:39]
    v_mfma_f32_16x16x32_bf16 v[44:47], v[60:63], v[20:23], v[44:47]
    s_waitcnt lgkmcnt(3)
    v_mfma_f32_16x16x32_bf16 v[32:35], v[64:67], v[176:179], v[32:35]
    ds_read_b128 v[16:19], v184 offset:8192
    ds_read_b128 v[20:23], v184 offset:8448
    v_mfma_f32_16x16x32_bf16 v[40:43], v[68:71], v[176:179], v[40:43]
    s_waitcnt lgkmcnt(4)
    v_mfma_f32_16x16x32_bf16 v[36:39], v[64:67], v[180:183], v[36:39]
    v_mfma_f32_16x16x32_bf16 v[44:47], v[68:71], v[180:183], v[44:47]
    s_waitcnt lgkmcnt(3)
    v_mfma_f32_16x16x32_bf16 v[32:35], v[72:75], v[8:11], v[32:35]
    ds_read_b128 v[176:179], v184 offset:10240
    ds_read_b128 v[180:183], v184 offset:10496
    v_mfma_f32_16x16x32_bf16 v[40:43], v[76:79], v[8:11], v[40:43]
    s_waitcnt lgkmcnt(4)
    v_mfma_f32_16x16x32_bf16 v[36:39], v[72:75], v[12:15], v[36:39]
    v_mfma_f32_16x16x32_bf16 v[44:47], v[76:79], v[12:15], v[44:47]
    s_waitcnt lgkmcnt(3)
    v_mfma_f32_16x16x32_bf16 v[32:35], v[80:83], v[16:19], v[32:35]
    ds_read_b128 v[8:11], v184 offset:12288
    ds_read_b128 v[12:15], v184 offset:12544
    v_mfma_f32_16x16x32_bf16 v[40:43], v[84:87], v[16:19], v[40:43]
    s_waitcnt lgkmcnt(4)
    v_mfma_f32_16x16x32_bf16 v[36:39], v[80:83], v[20:23], v[36:39]
    v_mfma_f32_16x16x32_bf16 v[44:47], v[84:87], v[20:23], v[44:47]
    s_waitcnt lgkmcnt(3)
    v_mfma_f32_16x16x32_bf16 v[32:35], v[88:91], v[176:179], v[32:35]
    ds_read_b128 v[16:19], v184 offset:14336
    ds_read_b128 v[20:23], v184 offset:14592
    v_mfma_f32_16x16x32_bf16 v[40:43], v[92:95], v[176:179], v[40:43]
    s_waitcnt lgkmcnt(4)
    v_mfma_f32_16x16x32_bf16 v[36:39], v[88:91], v[180:183], v[36:39]
    v_mfma_f32_16x16x32_bf16 v[44:47], v[92:95], v[180:183], v[44:47]
    s_waitcnt lgkmcnt(3)
    v_mfma_f32_16x16x32_bf16 v[32:35], v[96:99], v[8:11], v[32:35]
    ds_read_b128 v[176:179], v184 offset:16384
    ds_read_b128 v[180:183], v184 offset:16640
    v_mfma_f32_16x16x32_bf16 v[40:43], v[100:103], v[8:11], v[40:43]
    s_waitcnt lgkmcnt(4)
    v_mfma_f32_16x16x32_bf16 v[36:39], v[96:99], v[12:15], v[36:39]
    v_mfma_f32_16x16x32_bf16 v[44:47], v[100:103], v[12:15], v[44:47]
    s_waitcnt lgkmcnt(3)
    v_mfma_f32_16x16x32_bf16 v[32:35], v[104:107], v[16:19], v[32:35]
    ds_read_b128 v[8:11], v184 offset:18432
    ds_read_b128 v[12:15], v184 offset:18688
    v_mfma_f32_16x16x32_bf16 v[40:43], v[108:111], v[16:19], v[40:43]
    s_waitcnt lgkmcnt(4)
    v_mfma_f32_16x16x32_bf16 v[36:39], v[104:107], v[20:23], v[36:39]
    v_mfma_f32_16x16x32_bf16 v[44:47], v[108:111], v[20:23], v[44:47]
    s_waitcnt lgkmcnt(3)
    v_mfma_f32_16x16x32_bf16 v[32:35], v[112:115], v[176:179], v[32:35]
    ds_read_b128 v[16:19], v184 offset:20480
    ds_read_b128 v[20:23], v184 offset:20736
    v_mfma_f32_16x16x32_bf16 v[40:43], v[116:119], v[176:179], v[40:43]
    s_waitcnt lgkmcnt(4)
    v_mfma_f32_16x16x32_bf16 v[36:39], v[112:115], v[180:183], v[36:39]
    v_mfma_f32_16x16x32_bf16 v[44:47], v[116:119], v[180:183], v[44:47]
    s_waitcnt lgkmcnt(3)
    v_mfma_f32_16x16x32_bf16 v[32:35], v[120:123], v[8:11], v[32:35]
    ds_read_b128 v[176:179], v184 offset:22528
    ds_read_b128 v[180:183], v184 offset:22784
    v_mfma_f32_16x16x32_bf16 v[40:43], v[124:127], v[8:11], v[40:43]
    s_waitcnt lgkmcnt(4)
    v_mfma_f32_16x16x32_bf16 v[36:39], v[120:123], v[12:15], v[36:39]
    v_mfma_f32_16x16x32_bf16 v[44:47], v[124:127], v[12:15], v[44:47]
    s_waitcnt lgkmcnt(3)
    v_mfma_f32_16x16x32_bf16 v[32:35], v[128:131], v[16:19], v[32:35]
    ds_read_b128 v[8:11], v184 offset:24576
    ds_read_b128 v[12:15], v184 offset:24832
    v_mfma_f32_16x16x32_bf16 v[40:43], v[132:135], v[16:19], v[40:43]
    s_waitcnt lgkmcnt(4)
    v_mfma_f32_16x16x32_bf16 v[36:39], v[128:131], v[20:23], v[36:39]
    v_mfma_f32_16x16x32_bf16 v[44:47], v[132:135], v[20:23], v[44:47]
    s_waitcnt lgkmcnt(3)
    v_mfma_f32_16x16x32_bf16 v[32:35], v[136:139], v[176:179], v[32:35]
    ds_read_b128 v[16:19], v184 offset:26624
    ds_read_b128 v[20:23], v184 offset:26880
    v_mfma_f32_16x16x32_bf16 v[40:43], v[140:143], v[176:179], v[40:43]
    s_waitcnt lgkmcnt(4)
    v_mfma_f32_16x16x32_bf16 v[36:39], v[136:139], v[180:183], v[36:39]
    v_mfma_f32_16x16x32_bf16 v[44:47], v[140:143], v[180:183], v[44:47]
    s_waitcnt lgkmcnt(3)
    v_mfma_f32_16x16x32_bf16 v[32:35], v[144:147], v[8:11], v[32:35]
    ds_read_b128 v[176:179], v184 offset:28672
    ds_read_b128 v[180:183], v184 offset:28928
    v_mfma_f32_16x16x32_bf16 v[40:43], v[148:151], v[8:11], v[40:43]
    s_waitcnt lgkmcnt(4)
    v_mfma_f32_16x16x32_bf16 v[36:39], v[144:147], v[12:15], v[36:39]
    v_mfma_f32_16x16x32_bf16 v[44:47], v[148:151], v[12:15], v[44:47]
    s_waitcnt lgkmcnt(3)
    v_mfma_f32_16x16x32_bf16 v[32:35], v[152:155], v[16:19], v[32:35]
    ds_read_b128 v[8:11], v184 offset:30720
    ds_read_b128 v[12:15], v184 offset:30976
    v_mfma_f32_16x16x32_bf16 v[40:43], v[156:159], v[16:19], v[40:43]
    s_waitcnt lgkmcnt(4)
    v_mfma_f32_16x16x32_bf16 v[36:39], v[152:155], v[20:23], v[36:39]
    v_mfma_f32_16x16x32_bf16 v[44:47], v[156:159], v[20:23], v[44:47]
    s_waitcnt lgkmcnt(3)
    v_mfma_f32_16x16x32_bf16 v[32:35], v[160:163], v[176:179], v[32:35]
    v_mfma_f32_16x16x32_bf16 v[40:43], v[164:167], v[176:179], v[40:43]
    s_waitcnt lgkmcnt(2)
    v_mfma_f32_16x16x32_bf16 v[36:39], v[160:163], v[180:183], v[36:39]
    v_mfma_f32_16x16x32_bf16 v[44:47], v[164:167], v[180:183], v[44:47]
    s_waitcnt lgkmcnt(1)
    v_mfma_f32_16x16x32_bf16 v[32:35], v[168:171], v[8:11], v[32:35]
    v_mfma_f32_16x16x32_bf16 v[40:43], v[172:175], v[8:11], v[40:43]
    s_waitcnt lgkmcnt(0)
    v_mfma_f32_16x16x32_bf16 v[36:39], v[168:171], v[12:15], v[36:39]
    v_mfma_f32_16x16x32_bf16 v[44:47], v[172:175], v[12:15], v[44:47]
    s_nop 3
    v_cvt_pk_bf16_f32 v80, v32, v33
    v_cvt_pk_bf16_f32 v81, v34, v35
    s_nop 0
    v_cvt_pk_bf16_f32 v82, v36, v37
    v_cvt_pk_bf16_f32 v83, v38, v39
    v_cvt_pk_bf16_f32 v84, v40, v41
    v_cvt_pk_bf16_f32 v85, v42, v43
    v_cvt_pk_bf16_f32 v86, v44, v45
    v_cvt_pk_bf16_f32 v87, v46, v47
    v_lshlrev_b32 v64, 16, v24
    v_and_b32 v65, s47, v24
    v_lshlrev_b32 v66, 16, v25
    v_and_b32 v67, s47, v25
    v_lshlrev_b32 v68, 16, v26
    v_and_b32 v69, s47, v26
    v_lshlrev_b32 v70, 16, v27
    v_and_b32 v71, s47, v27
    v_lshlrev_b32 v72, 16, v28
    v_and_b32 v73, s47, v28
    v_lshlrev_b32 v74, 16, v29
    v_and_b32 v75, s47, v29
    v_lshlrev_b32 v76, 16, v30
    v_and_b32 v77, s47, v30
    v_lshlrev_b32 v78, 16, v31
    v_and_b32 v79, s47, v31
    v_lshlrev_b32 v48, 16, v80
    v_and_b32 v49, s47, v80
    v_lshlrev_b32 v50, 16, v81
    v_and_b32 v51, s47, v81
    v_lshlrev_b32 v52, 16, v82
    v_and_b32 v53, s47, v82
    v_lshlrev_b32 v54, 16, v83
    v_and_b32 v55, s47, v83
    v_lshlrev_b32 v56, 16, v84
    v_and_b32 v57, s47, v84
    v_lshlrev_b32 v58, 16, v85
    v_and_b32 v59, s47, v85
    v_lshlrev_b32 v60, 16, v86
    v_and_b32 v61, s47, v86
    v_lshlrev_b32 v62, 16, v87
    v_and_b32 v63, s47, v87
    v_add_f32 v48, v48, v64
    v_add_f32 v49, v49, v65
    v_add_f32 v50, v50, v66
    v_add_f32 v51, v51, v67
    v_add_f32 v52, v52, v68
    v_add_f32 v53, v53, v69
    v_add_f32 v54, v54, v70
    v_add_f32 v55, v55, v71
    v_add_f32 v56, v56, v72
    v_add_f32 v57, v57, v73
    v_add_f32 v58, v58, v74
    v_add_f32 v59, v59, v75
    v_add_f32 v60, v60, v76
    v_add_f32 v61, v61, v77
    v_add_f32 v62, v62, v78
    v_add_f32 v63, v63, v79
    v_cvt_pk_bf16_f32 v80, v48, v49
    v_cvt_pk_bf16_f32 v81, v50, v51
    v_cvt_pk_bf16_f32 v82, v52, v53
    v_cvt_pk_bf16_f32 v83, v54, v55
    v_cvt_pk_bf16_f32 v84, v56, v57
    v_cvt_pk_bf16_f32 v85, v58, v59
    v_cvt_pk_bf16_f32 v86, v60, v61
    v_cvt_pk_bf16_f32 v87, v62, v63
    v_min_u32 v83, -2, v83
    buffer_store_dwordx4 v[80:83], v185, s[4:7], s44 offen sc1
    v_min_u32 v87, -2, v87
    buffer_store_dwordx4 v[84:87], v185, s[4:7], s45 offen sc1
    v_mov_b32 v92, 0x3f803f80
    v_mov_b32 v88, 0
    v_mov_b32 v89, 0
    v_mov_b32 v90, 0
    v_mov_b32 v91, 0
    v_dot2c_f32_bf16 v88, v80, v92
    v_dot2c_f32_bf16 v89, v80, v80
    v_dot2c_f32_bf16 v90, v82, v92
    v_dot2c_f32_bf16 v91, v82, v82
    v_dot2c_f32_bf16 v88, v81, v92
    v_dot2c_f32_bf16 v89, v81, v81
    v_dot2c_f32_bf16 v90, v83, v92
    v_dot2c_f32_bf16 v91, v83, v83
    v_dot2c_f32_bf16 v88, v84, v92
    v_dot2c_f32_bf16 v89, v84, v84
    v_dot2c_f32_bf16 v90, v86, v92
    v_dot2c_f32_bf16 v91, v86, v86
    v_dot2c_f32_bf16 v88, v85, v92
    v_dot2c_f32_bf16 v89, v85, v85
    v_dot2c_f32_bf16 v90, v87, v92
    v_dot2c_f32_bf16 v91, v87, v87
    v_mov_b32 v92, v88
    v_mov_b32 v93, v89
    v_mov_b32 v94, v90
    v_mov_b32 v95, v91
    v_permlane16_swap_b32 v88, v92
    v_permlane16_swap_b32 v89, v93
    v_permlane16_swap_b32 v90, v94
    v_permlane16_swap_b32 v91, v95
    v_add_f32 v88, v88, v92
    v_add_f32 v89, v89, v93
    v_add_f32 v90, v90, v94
    v_add_f32 v91, v91, v95
    v_mov_b32 v92, v88
    v_mov_b32 v93, v89
    v_mov_b32 v94, v90
    v_mov_b32 v95, v91
    v_permlane32_swap_b32 v88, v92
    v_permlane32_swap_b32 v89, v93
    v_permlane32_swap_b32 v90, v94
    v_permlane32_swap_b32 v91, v95
    v_add_f32 v88, v88, v92
    v_add_f32 v89, v89, v93
    v_add_f32 v90, v90, v94
    v_add_f32 v91, v91, v95
    v_mov_b32 v92, 156932
    v_mov_b32 v93, 1
    s_mov_b64 exec, 0xffff
    ds_write_b128 v187, v[88:91]
    s_mov_b64 exec, 1
    ds_add_rtn_u32 v94, v92, v93
    s_mov_b64 exec, 0xffff
    ds_read_b128 v[48:51], v186 offset:0
    ds_read_b128 v[52:55], v186 offset:256
    ds_read_b128 v[56:59], v186 offset:512
    ds_read_b128 v[60:63], v186 offset:768
    s_waitcnt lgkmcnt(4)
    v_readfirstlane_b32 s38, v94
    s_and_b32 s38, s38, 3
    s_cmp_eq_u32 s38, 3
    s_cbranch_scc0 v_nolast
    s_waitcnt lgkmcnt(0)
    v_add_f32 v48, v48, v52
    v_add_f32 v56, v56, v60
    v_add_f32 v49, v49, v53
    v_add_f32 v57, v57, v61
    v_add_f32 v50, v50, v54
    v_add_f32 v58, v58, v62
    v_add_f32 v51, v51, v55
    v_add_f32 v59, v59, v63
    v_add_f32 v48, v48, v56
    v_add_f32 v49, v49, v57
    v_add_f32 v50, v50, v58
    v_add_f32 v51, v51, v59
    v_min_u32 v51, -2, v51
    buffer_store_dwordx4 v[48:51], v5, s[4:7], s46 offen sc1
v_nolast:
    s_mov_b64 exec, -1
    v_and_b32 v10, 15, v1
    v_lshrrev_b32 v11, 4, v1
    v_and_b32 v12, 3, v1
    v_mul_u32_u24 v2, 4160, v12
    v_bfe_u32 v12, v1, 2, 2
    v_lshlrev_b32 v12, 3, v12
    v_sub_u32 v2, v2, v12
    v_lshl_add_u32 v2, v11, 4, v2
    s_mul_i32 s38, s29, 16640
    s_add_u32 s38, s38, 24
    v_add_u32 v2, s38, v2
    v_lshlrev_b32 v3, 5, v10
    v_lshl_add_u32 v7, v11, 3, v3
    v_lshl_add_u32 v3, v11, 4, v3
    s_mul_i32 s38, s29, 4608
    s_add_u32 s38, s38, 66592
    v_add_u32 v3, s38, v3
    s_lshl_b32 s38, s29, 9
    s_add_u32 s38, s38, 84992
    v_add_u32 v7, s38, v7
    s_waitcnt lgkmcnt(0)
    s_barrier
    s_cmp_eq_u32 s34, 0
    s_cbranch_scc0 v_nopre
    s_mul_i32 s38, s29, 14336
    s_add_u32 m0, s38, 98304
    s_mov_b32 s38, 0
    buffer_load_dwordx4 v4, s[16:19], s38 offen lds
    s_add_u32 m0, m0, 1024
    s_mov_b32 s38, 4096
    buffer_load_dwordx4 v4, s[16:19], s38 offen lds
    s_add_u32 m0, m0, 1024
    s_mov_b32 s38, 32768
    buffer_load_dwordx4 v4, s[16:19], s38 offen lds
    s_add_u32 m0, m0, 1024
    s_mov_b32 s38, 36864
    buffer_load_dwordx4 v4, s[16:19], s38 offen lds
    s_add_u32 m0, m0, 1024
    s_mov_b32 s38, 65536
    buffer_load_dwordx4 v4, s[16:19], s38 offen lds
    s_add_u32 m0, m0, 1024
    s_mov_b32 s38, 69632
    buffer_load_dwordx4 v4, s[16:19], s38 offen lds
    s_add_u32 m0, m0, 1024
    s_mov_b32 s38, 98304
    buffer_load_dwordx4 v4, s[16:19], s38 offen lds
    s_add_u32 m0, m0, 1024
    s_mov_b32 s38, 102400
    buffer_load_dwordx4 v4, s[16:19], s38 offen lds
    s_add_u32 m0, m0, 1024
    s_mov_b32 s38, 131072
    buffer_load_dwordx4 v4, s[16:19], s38 offen lds
    s_add_u32 m0, m0, 1024
    s_mov_b32 s38, 135168
    buffer_load_dwordx4 v4, s[16:19], s38 offen lds
    s_add_u32 m0, m0, 1024
    s_mov_b32 s38, 163840
    buffer_load_dwordx4 v4, s[16:19], s38 offen lds
    s_add_u32 m0, m0, 1024
    s_mov_b32 s38, 167936
    buffer_load_dwordx4 v4, s[16:19], s38 offen lds
    s_add_u32 m0, m0, 1024
    s_mov_b32 s38, 196608
    buffer_load_dwordx4 v4, s[16:19], s38 offen lds
    s_add_u32 m0, m0, 1024
    s_mov_b32 s38, 200704
    buffer_load_dwordx4 v4, s[16:19], s38 offen lds
v_nopre:
    ds_read_b64 v[64:65], v2 offset:4032
    ds_read_b64 v[66:67], v2 offset:4040
    ds_read_b64 v[68:69], v2 offset:3968
    ds_read_b64 v[70:71], v2 offset:3976
    ds_read_b64 v[72:73], v2 offset:3904
    ds_read_b64 v[74:75], v2 offset:3912
    ds_read_b64 v[76:77], v2 offset:3840
    ds_read_b64 v[78:79], v2 offset:3848
    ds_read_b64 v[80:81], v2 offset:3776
    ds_read_b64 v[82:83], v2 offset:3784
    ds_read_b64 v[84:85], v2 offset:3712
    ds_read_b64 v[86:87], v2 offset:3720
    ds_read_b64 v[88:89], v2 offset:3648
    ds_read_b64 v[90:91], v2 offset:3656
    ds_read_b64 v[92:93], v2 offset:3584
    ds_read_b64 v[94:95], v2 offset:3592
    ds_read_b64 v[96:97], v2 offset:3520
    ds_read_b64 v[98:99], v2 offset:3528
    ds_read_b64 v[100:101], v2 offset:3456
    ds_read_b64 v[102:103], v2 offset:3464
    ds_read_b64 v[104:105], v2 offset:3392
    ds_read_b64 v[106:107], v2 offset:3400
    ds_read_b64 v[108:109], v2 offset:3328
    ds_read_b64 v[110:111], v2 offset:3336
    ds_read_b64 v[112:113], v2 offset:3264
    ds_read_b64 v[114:115], v2 offset:3272
    ds_read_b64 v[116:117], v2 offset:3200
    ds_read_b64 v[118:119], v2 offset:3208
    ds_read_b64 v[120:121], v2 offset:3136
    ds_read_b64 v[122:123], v2 offset:3144
    ds_read_b64 v[124:125], v2 offset:3072
    ds_read_b64 v[126:127], v2 offset:3080
    ds_read_b64 v[128:129], v2 offset:3008
    ds_read_b64 v[130:131], v2 offset:3016
    ds_read_b64 v[132:133], v2 offset:2944
    ds_read_b64 v[134:135], v2 offset:2952
    ds_read_b64 v[136:137], v2 offset:2880
    ds_read_b64 v[138:139], v2 offset:2888
    ds_read_b64 v[140:141], v2 offset:2816
    ds_read_b64 v[142:143], v2 offset:2824
    ds_read_b64 v[144:145], v2 offset:2752
    ds_read_b64 v[146:147], v2 offset:2760
    ds_read_b64 v[148:149], v2 offset:2688
    ds_read_b64 v[150:151], v2 offset:2696
    ds_read_b64 v[152:153], v2 offset:2624
    ds_read_b64 v[154:155], v2 offset:2632
    ds_read_b64 v[156:157], v2 offset:2560
    ds_read_b64 v[158:159], v2 offset:2568
    ds_read_b64 v[160:161], v2 offset:2496
    ds_read_b64 v[162:163], v2 offset:2504
    ds_read_b64 v[164:165], v2 offset:2432
    ds_read_b64 v[166:167], v2 offset:2440
    ds_read_b64 v[168:169], v2 offset:2368
    ds_read_b64 v[170:171], v2 offset:2376
    ds_read_b64 v[172:173], v2 offset:2304
    ds_read_b64 v[174:175], v2 offset:2312
    ds_read_b64 v[176:177], v2 offset:2240
    ds_read_b64 v[178:179], v2 offset:2248
    ds_read_b64 v[180:181], v2 offset:2176
    ds_read_b64 v[182:183], v2 offset:2184
    ds_read_b64 v[184:185], v2 offset:2112
    ds_read_b64 v[186:187], v2 offset:2120
    s_waitcnt lgkmcnt(0)
    s_barrier
    s_cmp_eq_u32 s33, 0
    s_cbranch_scc0 v_conv1
v_conv0:
    ds_read_b128 v[32:35], v3 offset:0
    ds_read_b128 v[36:39], v3 offset:64
    ds_read_b128 v[40:43], v3 offset:128
    ds_read_b128 v[44:47], v3 offset:192
    ds_read_b64 v[48:49], v2 offset:2048
    ds_read_b64 v[50:51], v2 offset:2056
    ds_read_b64 v[52:53], v2 offset:1536
    ds_read_b64 v[54:55], v2 offset:1544
    ds_read_b64 v[56:57], v2 offset:0
    ds_read_b64 v[58:59], v2 offset:8
    ds_read_b64 v[60:61], v2 offset:1600
    ds_read_b64 v[62:63], v2 offset:1608
    s_waitcnt lgkmcnt(11)
    v_mfma_f32_16x16x32_bf16 v[16:19], v[92:95], v[32:35], 0
    s_waitcnt lgkmcnt(6)
    v_mfma_f32_16x16x32_bf16 v[20:23], v[48:51], v[32:35], 0
    ds_read_b64 v[48:49], v2 offset:64
    ds_read_b64 v[50:51], v2 offset:72
    s_waitcnt lgkmcnt(6)
    v_mfma_f32_16x16x32_bf16 v[24:27], v[52:55], v[32:35], 0
    ds_read_b64 v[52:53], v2 offset:1664
    ds_read_b64 v[54:55], v2 offset:1672
    s_waitcnt lgkmcnt(6)
    v_mfma_f32_16x16x32_bf16 v[28:31], v[56:59], v[32:35], 0
    ds_read_b128 v[32:35], v3 offset:256
    ds_read_b64 v[56:57], v2 offset:128
    ds_read_b64 v[58:59], v2 offset:136
    v_mfma_f32_16x16x32_bf16 v[16:19], v[88:91], v[36:39], v[16:19]
    v_mfma_f32_16x16x32_bf16 v[20:23], v[184:187], v[36:39], v[20:23]
    s_waitcnt lgkmcnt(7)
    v_mfma_f32_16x16x32_bf16 v[24:27], v[60:63], v[36:39], v[24:27]
    ds_read_b64 v[60:61], v2 offset:1728
    ds_read_b64 v[62:63], v2 offset:1736
    s_waitcnt lgkmcnt(7)
    v_mfma_f32_16x16x32_bf16 v[28:31], v[48:51], v[36:39], v[28:31]
    ds_read_b128 v[36:39], v3 offset:320
    ds_read_b64 v[48:49], v2 offset:192
    ds_read_b64 v[50:51], v2 offset:200
    v_mfma_f32_16x16x32_bf16 v[16:19], v[84:87], v[40:43], v[16:19]
    v_mfma_f32_16x16x32_bf16 v[20:23], v[180:183], v[40:43], v[20:23]
    s_waitcnt lgkmcnt(8)
    v_mfma_f32_16x16x32_bf16 v[24:27], v[52:55], v[40:43], v[24:27]
    ds_read_b64 v[52:53], v2 offset:1792
    ds_read_b64 v[54:55], v2 offset:1800
    s_waitcnt lgkmcnt(7)
    v_mfma_f32_16x16x32_bf16 v[28:31], v[56:59], v[40:43], v[28:31]
    ds_read_b128 v[40:43], v3 offset:384
    ds_read_b64 v[56:57], v2 offset:256
    ds_read_b64 v[58:59], v2 offset:264
    v_mfma_f32_16x16x32_bf16 v[16:19], v[80:83], v[44:47], v[16:19]
    v_mfma_f32_16x16x32_bf16 v[20:23], v[176:179], v[44:47], v[20:23]
    s_waitcnt lgkmcnt(8)
    v_mfma_f32_16x16x32_bf16 v[24:27], v[60:63], v[44:47], v[24:27]
    ds_read_b64 v[60:61], v2 offset:1856
    ds_read_b64 v[62:63], v2 offset:1864
    s_waitcnt lgkmcnt(7)
    v_mfma_f32_16x16x32_bf16 v[28:31], v[48:51], v[44:47], v[28:31]
    ds_read_b128 v[44:47], v3 offset:448
    ds_read_b64 v[48:49], v2 offset:320
    ds_read_b64 v[50:51], v2 offset:328
    v_mfma_f32_16x16x32_bf16 v[16:19], v[76:79], v[32:35], v[16:19]
    v_mfma_f32_16x16x32_bf16 v[20:23], v[172:175], v[32:35], v[20:23]
    s_waitcnt lgkmcnt(8)
    v_mfma_f32_16x16x32_bf16 v[24:27], v[52:55], v[32:35], v[24:27]
    ds_read_b64 v[52:53], v2 offset:1920
    ds_read_b64 v[54:55], v2 offset:1928
    s_waitcnt lgkmcnt(7)
    v_mfma_f32_16x16x32_bf16 v[28:31], v[56:59], v[32:35], v[28:31]
    ds_read_b128 v[32:35], v3 offset:512
    ds_read_b64 v[56:57], v2 offset:384
    ds_read_b64 v[58:59], v2 offset:392
    v_mfma_f32_16x16x32_bf16 v[16:19], v[72:75], v[36:39], v[16:19]
    v_mfma_f32_16x16x32_bf16 v[20:23], v[168:171], v[36:39], v[20:23]
    s_waitcnt lgkmcnt(8)
    v_mfma_f32_16x16x32_bf16 v[24:27], v[60:63], v[36:39], v[24:27]
    ds_read_b64 v[60:61], v2 offset:1984
    ds_read_b64 v[62:63], v2 offset:1992
    s_waitcnt lgkmcnt(7)
    v_mfma_f32_16x16x32_bf16 v[28:31], v[48:51], v[36:39], v[28:31]
    ds_read_b128 v[36:39], v3 offset:576
    ds_read_b64 v[48:49], v2 offset:448
    ds_read_b64 v[50:51], v2 offset:456
    v_mfma_f32_16x16x32_bf16 v[16:19], v[68:71], v[40:43], v[16:19]
    v_mfma_f32_16x16x32_bf16 v[20:23], v[164:167], v[40:43], v[20:23]
    s_waitcnt lgkmcnt(8)
    v_mfma_f32_16x16x32_bf16 v[24:27], v[52:55], v[40:43], v[24:27]
    ds_read_b64 v[52:53], v2 offset:2048
    ds_read_b64 v[54:55], v2 offset:2056
    s_waitcnt lgkmcnt(7)
    v_mfma_f32_16x16x32_bf16 v[28:31], v[56:59], v[40:43], v[28:31]
    ds_read_b128 v[40:43], v3 offset:640
    ds_read_b64 v[56:57], v2 offset:512
    ds_read_b64 v[58:59], v2 offset:520
    v_mfma_f32_16x16x32_bf16 v[16:19], v[64:67], v[44:47], v[16:19]
    v_mfma_f32_16x16x32_bf16 v[20:23], v[160:163], v[44:47], v[20:23]
    s_waitcnt lgkmcnt(8)
    v_mfma_f32_16x16x32_bf16 v[24:27], v[60:63], v[44:47], v[24:27]
    s_nop 4
    v_cvt_pk_bf16_f32 v8, v16, v17
    v_cvt_pk_bf16_f32 v9, v18, v19
    ds_write_b64 v7, v[8:9] offset:0
    ds_read_b64 v[60:61], v2 offset:576
    ds_read_b64 v[62:63], v2 offset:584
    s_waitcnt lgkmcnt(8)
    v_mfma_f32_16x16x32_bf16 v[28:31], v[48:51], v[44:47], v[28:31]
    ds_read_b128 v[44:47], v3 offset:704
    ds_read_b64 v[48:49], v2 offset:640
    ds_read_b64 v[50:51], v2 offset:648
    v_mfma_f32_16x16x32_bf16 v[20:23], v[156:159], v[32:35], v[20:23]
    s_waitcnt lgkmcnt(9)
    v_mfma_f32_16x16x32_bf16 v[24:27], v[52:55], v[32:35], v[24:27]
    ds_read_b64 v[52:53], v2 offset:704
    ds_read_b64 v[54:55], v2 offset:712
    s_waitcnt lgkmcnt(8)
    v_mfma_f32_16x16x32_bf16 v[28:31], v[56:59], v[32:35], v[28:31]
    ds_read_b128 v[32:35], v3 offset:768
    ds_read_b64 v[56:57], v2 offset:768
    ds_read_b64 v[58:59], v2 offset:776
    v_mfma_f32_16x16x32_bf16 v[20:23], v[152:155], v[36:39], v[20:23]
    v_mfma_f32_16x16x32_bf16 v[24:27], v[184:187], v[36:39], v[24:27]
    s_waitcnt lgkmcnt(8)
    v_mfma_f32_16x16x32_bf16 v[28:31], v[60:63], v[36:39], v[28:31]
    ds_read_b128 v[36:39], v3 offset:832
    ds_read_b64 v[60:61], v2 offset:832
    ds_read_b64 v[62:63], v2 offset:840
    v_mfma_f32_16x16x32_bf16 v[20:23], v[148:151], v[40:43], v[20:23]
    v_mfma_f32_16x16x32_bf16 v[24:27], v[180:183], v[40:43], v[24:27]
    s_waitcnt lgkmcnt(8)
    v_mfma_f32_16x16x32_bf16 v[28:31], v[48:51], v[40:43], v[28:31]
    ds_read_b128 v[40:43], v3 offset:896
    ds_read_b64 v[48:49], v2 offset:896
    ds_read_b64 v[50:51], v2 offset:904
    v_mfma_f32_16x16x32_bf16 v[20:23], v[144:147], v[44:47], v[20:23]
    v_mfma_f32_16x16x32_bf16 v[24:27], v[176:179], v[44:47], v[24:27]
    s_waitcnt lgkmcnt(9)
    v_mfma_f32_16x16x32_bf16 v[28:31], v[52:55], v[44:47], v[28:31]
    ds_read_b128 v[44:47], v3 offset:960
    ds_read_b64 v[52:53], v2 offset:960
    ds_read_b64 v[54:55], v2 offset:968
    s_waitcnt lgkmcnt(11)
    v_mfma_f32_16x16x32_bf16 v[20:23], v[140:143], v[32:35], v[20:23]
    v_mfma_f32_16x16x32_bf16 v[24:27], v[172:175], v[32:35], v[24:27]
    s_waitcnt lgkmcnt(9)
    v_mfma_f32_16x16x32_bf16 v[28:31], v[56:59], v[32:35], v[28:31]
    ds_read_b64 v[56:57], v2 offset:1024
    ds_read_b64 v[58:59], v2 offset:1032
    s_waitcnt lgkmcnt(10)
    v_mfma_f32_16x16x32_bf16 v[20:23], v[136:139], v[36:39], v[20:23]
    v_mfma_f32_16x16x32_bf16 v[24:27], v[168:171], v[36:39], v[24:27]
    s_waitcnt lgkmcnt(8)
    v_mfma_f32_16x16x32_bf16 v[28:31], v[60:63], v[36:39], v[28:31]
    ds_read_b64 v[60:61], v2 offset:1088
    ds_read_b64 v[62:63], v2 offset:1096
    s_waitcnt lgkmcnt(9)
    v_mfma_f32_16x16x32_bf16 v[20:23], v[132:135], v[40:43], v[20:23]
    v_mfma_f32_16x16x32_bf16 v[24:27], v[164:167], v[40:43], v[24:27]
    s_waitcnt lgkmcnt(7)
    v_mfma_f32_16x16x32_bf16 v[28:31], v[48:51], v[40:43], v[28:31]
    ds_read_b64 v[48:49], v2 offset:1152
    ds_read_b64 v[50:51], v2 offset:1160
    s_waitcnt lgkmcnt(8)
    v_mfma_f32_16x16x32_bf16 v[20:23], v[128:131], v[44:47], v[20:23]
    v_mfma_f32_16x16x32_bf16 v[24:27], v[160:163], v[44:47], v[24:27]
    s_waitcnt lgkmcnt(6)
    v_mfma_f32_16x16x32_bf16 v[28:31], v[52:55], v[44:47], v[28:31]
    s_waitcnt lgkmcnt(0)
    s_barrier
    ds_read_b128 v[32:35], v3 offset:1024
    ds_read_b128 v[36:39], v3 offset:1088
    ds_read_b128 v[40:43], v3 offset:1152
    ds_read_b128 v[44:47], v3 offset:1216
    ds_read_b64 v[52:53], v2 offset:1216
    ds_read_b64 v[54:55], v2 offset:1224
    s_waitcnt lgkmcnt(5)
    v_mfma_f32_16x16x32_bf16 v[20:23], v[124:127], v[32:35], v[20:23]
    v_mfma_f32_16x16x32_bf16 v[24:27], v[156:159], v[32:35], v[24:27]
    v_mfma_f32_16x16x32_bf16 v[28:31], v[56:59], v[32:35], v[28:31]
    ds_read_b128 v[32:35], v3 offset:1280
    ds_read_b64 v[56:57], v2 offset:1280
    ds_read_b64 v[58:59], v2 offset:1288
    s_waitcnt lgkmcnt(7)
    v_mfma_f32_16x16x32_bf16 v[20:23], v[120:123], v[36:39], v[20:23]
    v_mfma_f32_16x16x32_bf16 v[24:27], v[152:155], v[36:39], v[24:27]
    v_mfma_f32_16x16x32_bf16 v[28:31], v[60:63], v[36:39], v[28:31]
    ds_read_b128 v[36:39], v3 offset:1344
    ds_read_b64 v[60:61], v2 offset:1344
    ds_read_b64 v[62:63], v2 offset:1352
    s_waitcnt lgkmcnt(9)
    v_mfma_f32_16x16x32_bf16 v[20:23], v[116:119], v[40:43], v[20:23]
    v_mfma_f32_16x16x32_bf16 v[24:27], v[148:151], v[40:43], v[24:27]
    v_mfma_f32_16x16x32_bf16 v[28:31], v[48:51], v[40:43], v[28:31]
    ds_read_b128 v[40:43], v3 offset:1408
    ds_read_b64 v[48:49], v2 offset:1408
    ds_read_b64 v[50:51], v2 offset:1416
    s_waitcnt lgkmcnt(11)
    v_mfma_f32_16x16x32_bf16 v[20:23], v[112:115], v[44:47], v[20:23]
    v_mfma_f32_16x16x32_bf16 v[24:27], v[144:147], v[44:47], v[24:27]
    s_waitcnt lgkmcnt(9)
    v_mfma_f32_16x16x32_bf16 v[28:31], v[52:55], v[44:47], v[28:31]
    ds_read_b128 v[44:47], v3 offset:1472
    ds_read_b64 v[52:53], v2 offset:1472
    ds_read_b64 v[54:55], v2 offset:1480
    s_waitcnt lgkmcnt(11)
    v_mfma_f32_16x16x32_bf16 v[20:23], v[108:111], v[32:35], v[20:23]
    v_mfma_f32_16x16x32_bf16 v[24:27], v[140:143], v[32:35], v[24:27]
    s_waitcnt lgkmcnt(9)
    v_mfma_f32_16x16x32_bf16 v[28:31], v[56:59], v[32:35], v[28:31]
    ds_read_b128 v[32:35], v3 offset:1536
    ds_read_b64 v[56:57], v2 offset:1536
    ds_read_b64 v[58:59], v2 offset:1544
    s_waitcnt lgkmcnt(11)
    v_mfma_f32_16x16x32_bf16 v[20:23], v[104:107], v[36:39], v[20:23]
    v_mfma_f32_16x16x32_bf16 v[24:27], v[136:139], v[36:39], v[24:27]
    s_waitcnt lgkmcnt(9)
    v_mfma_f32_16x16x32_bf16 v[28:31], v[60:63], v[36:39], v[28:31]
    ds_read_b128 v[36:39], v3 offset:1600
    ds_read_b64 v[60:61], v2 offset:1600
    ds_read_b64 v[62:63], v2 offset:1608
    s_waitcnt lgkmcnt(11)
    v_mfma_f32_16x16x32_bf16 v[20:23], v[100:103], v[40:43], v[20:23]
    v_mfma_f32_16x16x32_bf16 v[24:27], v[132:135], v[40:43], v[24:27]
    s_waitcnt lgkmcnt(9)
    v_mfma_f32_16x16x32_bf16 v[28:31], v[48:51], v[40:43], v[28:31]
    ds_read_b128 v[40:43], v3 offset:1664
    ds_read_b64 v[48:49], v2 offset:1664
    ds_read_b64 v[50:51], v2 offset:1672
    s_waitcnt lgkmcnt(11)
    v_mfma_f32_16x16x32_bf16 v[20:23], v[96:99], v[44:47], v[20:23]
    v_mfma_f32_16x16x32_bf16 v[24:27], v[128:131], v[44:47], v[24:27]
    s_waitcnt lgkmcnt(9)
    v_mfma_f32_16x16x32_bf16 v[28:31], v[52:55], v[44:47], v[28:31]
    ds_read_b128 v[44:47], v3 offset:1728
    ds_read_b64 v[52:53], v2 offset:1728
    ds_read_b64 v[54:55], v2 offset:1736
    s_waitcnt lgkmcnt(11)
    v_mfma_f32_16x16x32_bf16 v[20:23], v[92:95], v[32:35], v[20:23]
    v_mfma_f32_16x16x32_bf16 v[24:27], v[124:127], v[32:35], v[24:27]
    s_waitcnt lgkmcnt(9)
    v_mfma_f32_16x16x32_bf16 v[28:31], v[56:59], v[32:35], v[28:31]
    ds_read_b128 v[32:35], v3 offset:1792
    ds_read_b64 v[56:57], v2 offset:1792
    ds_read_b64 v[58:59], v2 offset:1800
    s_waitcnt lgkmcnt(11)
    v_mfma_f32_16x16x32_bf16 v[20:23], v[88:91], v[36:39], v[20:23]
    v_mfma_f32_16x16x32_bf16 v[24:27], v[120:123], v[36:39], v[24:27]
    s_waitcnt lgkmcnt(9)
    v_mfma_f32_16x16x32_bf16 v[28:31], v[60:63], v[36:39], v[28:31]
    ds_read_b128 v[36:39], v3 offset:1856
    ds_read_b64 v[60:61], v2 offset:1856
    ds_read_b64 v[62:63], v2 offset:1864
    s_waitcnt lgkmcnt(11)
    v_mfma_f32_16x16x32_bf16 v[20:23], v[84:87], v[40:43], v[20:23]
    v_mfma_f32_16x16x32_bf16 v[24:27], v[116:119], v[40:43], v[24:27]
    s_waitcnt lgkmcnt(9)
    v_mfma_f32_16x16x32_bf16 v[28:31], v[48:51], v[40:43], v[28:31]
    ds_read_b128 v[40:43], v3 offset:1920
    ds_read_b64 v[48:49], v2 offset:1920
    ds_read_b64 v[50:51], v2 offset:1928
    s_waitcnt lgkmcnt(11)
    v_mfma_f32_16x16x32_bf16 v[20:23], v[80:83], v[44:47], v[20:23]
    v_mfma_f32_16x16x32_bf16 v[24:27], v[112:115], v[44:47], v[24:27]
    s_waitcnt lgkmcnt(9)
    v_mfma_f32_16x16x32_bf16 v[28:31], v[52:55], v[44:47], v[28:31]
    ds_read_b128 v[44:47], v3 offset:1984
    ds_read_b64 v[52:53], v2 offset:1984
    ds_read_b64 v[54:55], v2 offset:1992
    s_waitcnt lgkmcnt(11)
    v_mfma_f32_16x16x32_bf16 v[20:23], v[76:79], v[32:35], v[20:23]
    v_mfma_f32_16x16x32_bf16 v[24:27], v[108:111], v[32:35], v[24:27]
    s_waitcnt lgkmcnt(9)
    v_mfma_f32_16x16x32_bf16 v[28:31], v[56:59], v[32:35], v[28:31]
    ds_read_b64 v[56:57], v2 offset:2048
    ds_read_b64 v[58:59], v2 offset:2056
    s_waitcnt lgkmcnt(10)
    v_mfma_f32_16x16x32_bf16 v[20:23], v[72:75], v[36:39], v[20:23]
    v_mfma_f32_16x16x32_bf16 v[24:27], v[104:107], v[36:39], v[24:27]
    s_waitcnt lgkmcnt(8)
    v_mfma_f32_16x16x32_bf16 v[28:31], v[60:63], v[36:39], v[28:31]
    s_waitcnt lgkmcnt(7)
    v_mfma_f32_16x16x32_bf16 v[20:23], v[68:71], v[40:43], v[20:23]
    v_mfma_f32_16x16x32_bf16 v[24:27], v[100:103], v[40:43], v[24:27]
    s_waitcnt lgkmcnt(5)
    v_mfma_f32_16x16x32_bf16 v[28:31], v[48:51], v[40:43], v[28:31]
    s_waitcnt lgkmcnt(4)
    v_mfma_f32_16x16x32_bf16 v[20:23], v[64:67], v[44:47], v[20:23]
    v_mfma_f32_16x16x32_bf16 v[24:27], v[96:99], v[44:47], v[24:27]
    s_waitcnt lgkmcnt(2)
    v_mfma_f32_16x16x32_bf16 v[28:31], v[52:55], v[44:47], v[28:31]
    s_nop 4
    v_cvt_pk_bf16_f32 v8, v20, v21
    v_cvt_pk_bf16_f32 v9, v22, v23
    ds_write_b64 v7, v[8:9] offset:2048
    s_waitcnt lgkmcnt(0)
    s_barrier
    ds_read_b128 v[32:35], v3 offset:2048
    ds_read_b128 v[36:39], v3 offset:2112
    ds_read_b128 v[40:43], v3 offset:2176
    ds_read_b128 v[44:47], v3 offset:2240
    s_waitcnt lgkmcnt(3)
    v_mfma_f32_16x16x32_bf16 v[24:27], v[92:95], v[32:35], v[24:27]
    v_mfma_f32_16x16x32_bf16 v[28:31], v[56:59], v[32:35], v[28:31]
    ds_read_b128 v[32:35], v3 offset:2304
    s_waitcnt lgkmcnt(3)
    v_mfma_f32_16x16x32_bf16 v[24:27], v[88:91], v[36:39], v[24:27]
    v_mfma_f32_16x16x32_bf16 v[28:31], v[184:187], v[36:39], v[28:31]
    ds_read_b128 v[36:39], v3 offset:2368
    s_waitcnt lgkmcnt(3)
    v_mfma_f32_16x16x32_bf16 v[24:27], v[84:87], v[40:43], v[24:27]
    v_mfma_f32_16x16x32_bf16 v[28:31], v[180:183], v[40:43], v[28:31]
    ds_read_b128 v[40:43], v3 offset:2432
    s_waitcnt lgkmcnt(3)
    v_mfma_f32_16x16x32_bf16 v[24:27], v[80:83], v[44:47], v[24:27]
    v_mfma_f32_16x16x32_bf16 v[28:31], v[176:179], v[44:47], v[28:31]
    ds_read_b128 v[44:47], v3 offset:2496
    s_waitcnt lgkmcnt(3)
    v_mfma_f32_16x16x32_bf16 v[24:27], v[76:79], v[32:35], v[24:27]
    v_mfma_f32_16x16x32_bf16 v[28:31], v[172:175], v[32:35], v[28:31]
    ds_read_b128 v[32:35], v3 offset:2560
    s_waitcnt lgkmcnt(3)
    v_mfma_f32_16x16x32_bf16 v[24:27], v[72:75], v[36:39], v[24:27]
    v_mfma_f32_16x16x32_bf16 v[28:31], v[168:171], v[36:39], v[28:31]
    ds_read_b128 v[36:39], v3 offset:2624
    s_waitcnt lgkmcnt(3)
    v_mfma_f32_16x16x32_bf16 v[24:27], v[68:71], v[40:43], v[24:27]
    v_mfma_f32_16x16x32_bf16 v[28:31], v[164:167], v[40:43], v[28:31]
    ds_read_b128 v[40:43], v3 offset:2688
    s_waitcnt lgkmcnt(3)
    v_mfma_f32_16x16x32_bf16 v[24:27], v[64:67], v[44:47], v[24:27]
    v_mfma_f32_16x16x32_bf16 v[28:31], v[160:163], v[44:47], v[28:31]
    ds_read_b128 v[44:47], v3 offset:2752
    s_waitcnt lgkmcnt(3)
    v_mfma_f32_16x16x32_bf16 v[28:31], v[156:159], v[32:35], v[28:31]
    s_nop 3
    v_cvt_pk_bf16_f32 v8, v24, v25
    v_cvt_pk_bf16_f32 v9, v26, v27
    ds_write_b64 v7, v[8:9] offset:4096
    ds_read_b128 v[32:35], v3 offset:2816
    s_waitcnt lgkmcnt(4)
    v_mfma_f32_16x16x32_bf16 v[28:31], v[152:155], v[36:39], v[28:31]
    ds_read_b128 v[36:39], v3 offset:2880
    s_waitcnt lgkmcnt(4)
    v_mfma_f32_16x16x32_bf16 v[28:31], v[148:151], v[40:43], v[28:31]
    ds_read_b128 v[40:43], v3 offset:2944
    s_waitcnt lgkmcnt(4)
    v_mfma_f32_16x16x32_bf16 v[28:31], v[144:147], v[44:47], v[28:31]
    ds_read_b128 v[44:47], v3 offset:3008
    s_waitcnt lgkmcnt(3)
    v_mfma_f32_16x16x32_bf16 v[28:31], v[140:143], v[32:35], v[28:31]
    s_waitcnt lgkmcnt(2)
    v_mfma_f32_16x16x32_bf16 v[28:31], v[136:139], v[36:39], v[28:31]
    s_waitcnt lgkmcnt(1)
    v_mfma_f32_16x16x32_bf16 v[28:31], v[132:135], v[40:43], v[28:31]
    s_waitcnt lgkmcnt(0)
    v_mfma_f32_16x16x32_bf16 v[28:31], v[128:131], v[44:47], v[28:31]
    s_barrier
    ds_read_b128 v[32:35], v3 offset:3072
    ds_read_b128 v[36:39], v3 offset:3136
    ds_read_b128 v[40:43], v3 offset:3200
    ds_read_b128 v[44:47], v3 offset:3264
    s_waitcnt lgkmcnt(3)
    v_mfma_f32_16x16x32_bf16 v[28:31], v[124:127], v[32:35], v[28:31]
    ds_read_b128 v[32:35], v3 offset:3328
    s_waitcnt lgkmcnt(3)
    v_mfma_f32_16x16x32_bf16 v[28:31], v[120:123], v[36:39], v[28:31]
    ds_read_b128 v[36:39], v3 offset:3392
    s_waitcnt lgkmcnt(3)
    v_mfma_f32_16x16x32_bf16 v[28:31], v[116:119], v[40:43], v[28:31]
    ds_read_b128 v[40:43], v3 offset:3456
    s_waitcnt lgkmcnt(3)
    v_mfma_f32_16x16x32_bf16 v[28:31], v[112:115], v[44:47], v[28:31]
    ds_read_b128 v[44:47], v3 offset:3520
    s_waitcnt lgkmcnt(3)
    v_mfma_f32_16x16x32_bf16 v[28:31], v[108:111], v[32:35], v[28:31]
    ds_read_b128 v[32:35], v3 offset:3584
    s_waitcnt lgkmcnt(3)
    v_mfma_f32_16x16x32_bf16 v[28:31], v[104:107], v[36:39], v[28:31]
    ds_read_b128 v[36:39], v3 offset:3648
    s_waitcnt lgkmcnt(3)
    v_mfma_f32_16x16x32_bf16 v[28:31], v[100:103], v[40:43], v[28:31]
    ds_read_b128 v[40:43], v3 offset:3712
    s_waitcnt lgkmcnt(3)
    v_mfma_f32_16x16x32_bf16 v[28:31], v[96:99], v[44:47], v[28:31]
    ds_read_b128 v[44:47], v3 offset:3776
    s_waitcnt lgkmcnt(3)
    v_mfma_f32_16x16x32_bf16 v[28:31], v[92:95], v[32:35], v[28:31]
    ds_read_b128 v[32:35], v3 offset:3840
    s_waitcnt lgkmcnt(3)
    v_mfma_f32_16x16x32_bf16 v[28:31], v[88:91], v[36:39], v[28:31]
    ds_read_b128 v[36:39], v3 offset:3904
    s_waitcnt lgkmcnt(3)
    v_mfma_f32_16x16x32_bf16 v[28:31], v[84:87], v[40:43], v[28:31]
    ds_read_b128 v[40:43], v3 offset:3968
    s_waitcnt lgkmcnt(3)
    v_mfma_f32_16x16x32_bf16 v[28:31], v[80:83], v[44:47], v[28:31]
    ds_read_b128 v[44:47], v3 offset:4032
    s_waitcnt lgkmcnt(3)
    v_mfma_f32_16x16x32_bf16 v[28:31], v[76:79], v[32:35], v[28:31]
    s_waitcnt lgkmcnt(2)
    v_mfma_f32_16x16x32_bf16 v[28:31], v[72:75], v[36:39], v[28:31]
    s_waitcnt lgkmcnt(1)
    v_mfma_f32_16x16x32_bf16 v[28:31], v[68:71], v[40:43], v[28:31]
    s_waitcnt lgkmcnt(0)
    v_mfma_f32_16x16x32_bf16 v[28:31], v[64:67], v[44:47], v[28:31]
    s_nop 7
    v_cvt_pk_bf16_f32 v8, v28, v29
    v_cvt_pk_bf16_f32 v9, v30, v31
    ds_write_b64 v7, v[8:9] offset:6144
    s_waitcnt lgkmcnt(0)
    s_barrier
    s_branch v_conv_done
v_conv1:
    ds_read_b128 v[32:35], v3 offset:0
    ds_read_b128 v[36:39], v3 offset:64
    ds_read_b128 v[40:43], v3 offset:128
    ds_read_b128 v[44:47], v3 offset:192
    ds_read_b64 v[48:49], v2 offset:1024
    ds_read_b64 v[50:51], v2 offset:1032
    ds_read_b64 v[52:53], v2 offset:512
    ds_read_b64 v[54:55], v2 offset:520
    ds_read_b64 v[56:57], v2 offset:1088
    ds_read_b64 v[58:59], v2 offset:1096
    ds_read_b64 v[60:61], v2 offset:576
    ds_read_b64 v[62:63], v2 offset:584
    s_waitcnt lgkmcnt(11)
    v_mfma_f32_16x16x32_bf16 v[16:19], v[124:127], v[32:35], 0
    v_mfma_f32_16x16x32_bf16 v[20:23], v[156:159], v[32:35], 0
    s_waitcnt lgkmcnt(6)
    v_mfma_f32_16x16x32_bf16 v[24:27], v[48:51], v[32:35], 0
    ds_read_b64 v[48:49], v2 offset:1152
    ds_read_b64 v[50:51], v2 offset:1160
    s_waitcnt lgkmcnt(6)
    v_mfma_f32_16x16x32_bf16 v[28:31], v[52:55], v[32:35], 0
    ds_read_b128 v[32:35], v3 offset:256
    ds_read_b64 v[52:53], v2 offset:640
    ds_read_b64 v[54:55], v2 offset:648
    v_mfma_f32_16x16x32_bf16 v[16:19], v[120:123], v[36:39], v[16:19]
    v_mfma_f32_16x16x32_bf16 v[20:23], v[152:155], v[36:39], v[20:23]
    s_waitcnt lgkmcnt(7)
    v_mfma_f32_16x16x32_bf16 v[24:27], v[56:59], v[36:39], v[24:27]
    ds_read_b64 v[56:57], v2 offset:1216
    ds_read_b64 v[58:59], v2 offset:1224
    s_waitcnt lgkmcnt(7)
    v_mfma_f32_16x16x32_bf16 v[28:31], v[60:63], v[36:39], v[28:31]
    ds_read_b128 v[36:39], v3 offset:320
    ds_read_b64 v[60:61], v2 offset:704
    ds_read_b64 v[62:63], v2 offset:712
    v_mfma_f32_16x16x32_bf16 v[16:19], v[116:119], v[40:43], v[16:19]
    v_mfma_f32_16x16x32_bf16 v[20:23], v[148:151], v[40:43], v[20:23]
    s_waitcnt lgkmcnt(8)
    v_mfma_f32_16x16x32_bf16 v[24:27], v[48:51], v[40:43], v[24:27]
    ds_read_b64 v[48:49], v2 offset:1280
    ds_read_b64 v[50:51], v2 offset:1288
    s_waitcnt lgkmcnt(7)
    v_mfma_f32_16x16x32_bf16 v[28:31], v[52:55], v[40:43], v[28:31]
    ds_read_b128 v[40:43], v3 offset:384
    ds_read_b64 v[52:53], v2 offset:768
    ds_read_b64 v[54:55], v2 offset:776
    v_mfma_f32_16x16x32_bf16 v[16:19], v[112:115], v[44:47], v[16:19]
    v_mfma_f32_16x16x32_bf16 v[20:23], v[144:147], v[44:47], v[20:23]
    s_waitcnt lgkmcnt(8)
    v_mfma_f32_16x16x32_bf16 v[24:27], v[56:59], v[44:47], v[24:27]
    ds_read_b64 v[56:57], v2 offset:1344
    ds_read_b64 v[58:59], v2 offset:1352
    s_waitcnt lgkmcnt(7)
    v_mfma_f32_16x16x32_bf16 v[28:31], v[60:63], v[44:47], v[28:31]
    ds_read_b128 v[44:47], v3 offset:448
    ds_read_b64 v[60:61], v2 offset:832
    ds_read_b64 v[62:63], v2 offset:840
    v_mfma_f32_16x16x32_bf16 v[16:19], v[108:111], v[32:35], v[16:19]
    v_mfma_f32_16x16x32_bf16 v[20:23], v[140:143], v[32:35], v[20:23]
    s_waitcnt lgkmcnt(8)
    v_mfma_f32_16x16x32_bf16 v[24:27], v[48:51], v[32:35], v[24:27]
    ds_read_b64 v[48:49], v2 offset:1408
    ds_read_b64 v[50:51], v2 offset:1416
    s_waitcnt lgkmcnt(7)
    v_mfma_f32_16x16x32_bf16 v[28:31], v[52:55], v[32:35], v[28:31]
    ds_read_b128 v[32:35], v3 offset:512
    ds_read_b64 v[52:53], v2 offset:896
    ds_read_b64 v[54:55], v2 offset:904
    v_mfma_f32_16x16x32_bf16 v[16:19], v[104:107], v[36:39], v[16:19]
    v_mfma_f32_16x16x32_bf16 v[20:23], v[136:139], v[36:39], v[20:23]
    s_waitcnt lgkmcnt(8)
    v_mfma_f32_16x16x32_bf16 v[24:27], v[56:59], v[36:39], v[24:27]
    ds_read_b64 v[56:57], v2 offset:1472
    ds_read_b64 v[58:59], v2 offset:1480
    s_waitcnt lgkmcnt(7)
    v_mfma_f32_16x16x32_bf16 v[28:31], v[60:63], v[36:39], v[28:31]
    ds_read_b128 v[36:39], v3 offset:576
    ds_read_b64 v[60:61], v2 offset:960
    ds_read_b64 v[62:63], v2 offset:968
    v_mfma_f32_16x16x32_bf16 v[16:19], v[100:103], v[40:43], v[16:19]
    v_mfma_f32_16x16x32_bf16 v[20:23], v[132:135], v[40:43], v[20:23]
    s_waitcnt lgkmcnt(8)
    v_mfma_f32_16x16x32_bf16 v[24:27], v[48:51], v[40:43], v[24:27]
    ds_read_b64 v[48:49], v2 offset:1536
    ds_read_b64 v[50:51], v2 offset:1544
    s_waitcnt lgkmcnt(7)
    v_mfma_f32_16x16x32_bf16 v[28:31], v[52:55], v[40:43], v[28:31]
    ds_read_b128 v[40:43], v3 offset:640
    ds_read_b64 v[52:53], v2 offset:1024
    ds_read_b64 v[54:55], v2 offset:1032
    v_mfma_f32_16x16x32_bf16 v[16:19], v[96:99], v[44:47], v[16:19]
    v_mfma_f32_16x16x32_bf16 v[20:23], v[128:131], v[44:47], v[20:23]
    s_waitcnt lgkmcnt(8)
    v_mfma_f32_16x16x32_bf16 v[24:27], v[56:59], v[44:47], v[24:27]
    ds_read_b64 v[56:57], v2 offset:1600
    ds_read_b64 v[58:59], v2 offset:1608
    s_waitcnt lgkmcnt(7)
    v_mfma_f32_16x16x32_bf16 v[28:31], v[60:63], v[44:47], v[28:31]
    ds_read_b128 v[44:47], v3 offset:704
    ds_read_b64 v[60:61], v2 offset:1088
    ds_read_b64 v[62:63], v2 offset:1096
    v_mfma_f32_16x16x32_bf16 v[16:19], v[92:95], v[32:35], v[16:19]
    v_mfma_f32_16x16x32_bf16 v[20:23], v[124:127], v[32:35], v[20:23]
    s_waitcnt lgkmcnt(8)
    v_mfma_f32_16x16x32_bf16 v[24:27], v[48:51], v[32:35], v[24:27]
    ds_read_b64 v[48:49], v2 offset:1664
    ds_read_b64 v[50:51], v2 offset:1672
    s_waitcnt lgkmcnt(7)
    v_mfma_f32_16x16x32_bf16 v[28:31], v[52:55], v[32:35], v[28:31]
    ds_read_b128 v[32:35], v3 offset:768
    ds_read_b64 v[52:53], v2 offset:1152
    ds_read_b64 v[54:55], v2 offset:1160
    v_mfma_f32_16x16x32_bf16 v[16:19], v[88:91], v[36:39], v[16:19]
    v_mfma_f32_16x16x32_bf16 v[20:23], v[120:123], v[36:39], v[20:23]
    s_waitcnt lgkmcnt(8)
    v_mfma_f32_16x16x32_bf16 v[24:27], v[56:59], v[36:39], v[24:27]
    ds_read_b64 v[56:57], v2 offset:1728
    ds_read_b64 v[58:59], v2 offset:1736
    s_waitcnt lgkmcnt(7)
    v_mfma_f32_16x16x32_bf16 v[28:31], v[60:63], v[36:39], v[28:31]
    ds_read_b128 v[36:39], v3 offset:832
    ds_read_b64 v[60:61], v2 offset:1216
    ds_read_b64 v[62:63], v2 offset:1224
    v_mfma_f32_16x16x32_bf16 v[16:19], v[84:87], v[40:43], v[16:19]
    v_mfma_f32_16x16x32_bf16 v[20:23], v[116:119], v[40:43], v[20:23]
    s_waitcnt lgkmcnt(8)
    v_mfma_f32_16x16x32_bf16 v[24:27], v[48:51], v[40:43], v[24:27]
    ds_read_b64 v[48:49], v2 offset:1792
    ds_read_b64 v[50:51], v2 offset:1800
    s_waitcnt lgkmcnt(7)
    v_mfma_f32_16x16x32_bf16 v[28:31], v[52:55], v[40:43], v[28:31]
    ds_read_b128 v[40:43], v3 offset:896
    ds_read_b64 v[52:53], v2 offset:1280
    ds_read_b64 v[54:55], v2 offset:1288
    v_mfma_f32_16x16x32_bf16 v[16:19], v[80:83], v[44:47], v[16:19]
    v_mfma_f32_16x16x32_bf16 v[20:23], v[112:115], v[44:47], v[20:23]
    s_waitcnt lgkmcnt(8)
    v_mfma_f32_16x16x32_bf16 v[24:27], v[56:59], v[44:47], v[24:27]
    ds_read_b64 v[56:57], v2 offset:1856
    ds_read_b64 v[58:59], v2 offset:1864
    s_waitcnt lgkmcnt(7)
    v_mfma_f32_16x16x32_bf16 v[28:31], v[60:63], v[44:47], v[28:31]
    ds_read_b128 v[44:47], v3 offset:960
    ds_read_b64 v[60:61], v2 offset:1344
    ds_read_b64 v[62:63], v2 offset:1352
    v_mfma_f32_16x16x32_bf16 v[16:19], v[76:79], v[32:35], v[16:19]
    v_mfma_f32_16x16x32_bf16 v[20:23], v[108:111], v[32:35], v[20:23]
    s_waitcnt lgkmcnt(8)
    v_mfma_f32_16x16x32_bf16 v[24:27], v[48:51], v[32:35], v[24:27]
    ds_read_b64 v[48:49], v2 offset:1920
    ds_read_b64 v[50:51], v2 offset:1928
    s_waitcnt lgkmcnt(7)
    v_mfma_f32_16x16x32_bf16 v[28:31], v[52:55], v[32:35], v[28:31]
    ds_read_b64 v[52:53], v2 offset:1408
    ds_read_b64 v[54:55], v2 offset:1416
    v_mfma_f32_16x16x32_bf16 v[16:19], v[72:75], v[36:39], v[16:19]
    v_mfma_f32_16x16x32_bf16 v[20:23], v[104:107], v[36:39], v[20:23]
    s_waitcnt lgkmcnt(7)
    v_mfma_f32_16x16x32_bf16 v[24:27], v[56:59], v[36:39], v[24:27]
    ds_read_b64 v[56:57], v2 offset:1984
    ds_read_b64 v[58:59], v2 offset:1992
    s_waitcnt lgkmcnt(6)
    v_mfma_f32_16x16x32_bf16 v[28:31], v[60:63], v[36:39], v[28:31]
    ds_read_b64 v[60:61], v2 offset:1472
    ds_read_b64 v[62:63], v2 offset:1480
    v_mfma_f32_16x16x32_bf16 v[16:19], v[68:71], v[40:43], v[16:19]
    v_mfma_f32_16x16x32_bf16 v[20:23], v[100:103], v[40:43], v[20:23]
    s_waitcnt lgkmcnt(6)
    v_mfma_f32_16x16x32_bf16 v[24:27], v[48:51], v[40:43], v[24:27]
    ds_read_b64 v[48:49], v2 offset:2048
    ds_read_b64 v[50:51], v2 offset:2056
    s_waitcnt lgkmcnt(6)
    v_mfma_f32_16x16x32_bf16 v[28:31], v[52:55], v[40:43], v[28:31]
    ds_read_b64 v[52:53], v2 offset:1536
    ds_read_b64 v[54:55], v2 offset:1544
    v_mfma_f32_16x16x32_bf16 v[16:19], v[64:67], v[44:47], v[16:19]
    v_mfma_f32_16x16x32_bf16 v[20:23], v[96:99], v[44:47], v[20:23]
    s_waitcnt lgkmcnt(6)
    v_mfma_f32_16x16x32_bf16 v[24:27], v[56:59], v[44:47], v[24:27]
    s_nop 4
    v_cvt_pk_bf16_f32 v8, v16, v17
    v_cvt_pk_bf16_f32 v9, v18, v19
    ds_write_b64 v7, v[8:9] offset:0
    ds_read_b64 v[56:57], v2 offset:1600
    ds_read_b64 v[58:59], v2 offset:1608
    s_waitcnt lgkmcnt(7)
    v_mfma_f32_16x16x32_bf16 v[28:31], v[60:63], v[44:47], v[28:31]
    s_waitcnt lgkmcnt(0)
    s_barrier
    ds_read_b128 v[32:35], v3 offset:1024
    ds_read_b128 v[36:39], v3 offset:1088
    ds_read_b128 v[40:43], v3 offset:1152
    ds_read_b128 v[44:47], v3 offset:1216
    ds_read_b64 v[60:61], v2 offset:1664
    ds_read_b64 v[62:63], v2 offset:1672
    s_waitcnt lgkmcnt(5)
    v_mfma_f32_16x16x32_bf16 v[20:23], v[92:95], v[32:35], v[20:23]
    v_mfma_f32_16x16x32_bf16 v[24:27], v[48:51], v[32:35], v[24:27]
    ds_read_b64 v[48:49], v2 offset:1728
    ds_read_b64 v[50:51], v2 offset:1736
    v_mfma_f32_16x16x32_bf16 v[28:31], v[52:55], v[32:35], v[28:31]
    ds_read_b128 v[32:35], v3 offset:1280
    ds_read_b64 v[52:53], v2 offset:1792
    ds_read_b64 v[54:55], v2 offset:1800
    s_waitcnt lgkmcnt(9)
    v_mfma_f32_16x16x32_bf16 v[20:23], v[88:91], v[36:39], v[20:23]
    v_mfma_f32_16x16x32_bf16 v[24:27], v[184:187], v[36:39], v[24:27]
    v_mfma_f32_16x16x32_bf16 v[28:31], v[56:59], v[36:39], v[28:31]
    ds_read_b128 v[36:39], v3 offset:1344
    ds_read_b64 v[56:57], v2 offset:1856
    ds_read_b64 v[58:59], v2 offset:1864
    s_waitcnt lgkmcnt(11)
    v_mfma_f32_16x16x32_bf16 v[20:23], v[84:87], v[40:43], v[20:23]
    v_mfma_f32_16x16x32_bf16 v[24:27], v[180:183], v[40:43], v[24:27]
    s_waitcnt lgkmcnt(8)
    v_mfma_f32_16x16x32_bf16 v[28:31], v[60:63], v[40:43], v[28:31]
    ds_read_b128 v[40:43], v3 offset:1408
    ds_read_b64 v[60:61], v2 offset:1920
    ds_read_b64 v[62:63], v2 offset:1928
    v_mfma_f32_16x16x32_bf16 v[20:23], v[80:83], v[44:47], v[20:23]
    v_mfma_f32_16x16x32_bf16 v[24:27], v[176:179], v[44:47], v[24:27]
    s_waitcnt lgkmcnt(9)
    v_mfma_f32_16x16x32_bf16 v[28:31], v[48:51], v[44:47], v[28:31]
    ds_read_b128 v[44:47], v3 offset:1472
    ds_read_b64 v[48:49], v2 offset:1984
    ds_read_b64 v[50:51], v2 offset:1992
    s_waitcnt lgkmcnt(11)
    v_mfma_f32_16x16x32_bf16 v[20:23], v[76:79], v[32:35], v[20:23]
    v_mfma_f32_16x16x32_bf16 v[24:27], v[172:175], v[32:35], v[24:27]
    s_waitcnt lgkmcnt(9)
    v_mfma_f32_16x16x32_bf16 v[28:31], v[52:55], v[32:35], v[28:31]
    ds_read_b128 v[32:35], v3 offset:1536
    ds_read_b64 v[52:53], v2 offset:2048
    ds_read_b64 v[54:55], v2 offset:2056
    s_waitcnt lgkmcnt(11)
    v_mfma_f32_16x16x32_bf16 v[20:23], v[72:75], v[36:39], v[20:23]
    v_mfma_f32_16x16x32_bf16 v[24:27], v[168:171], v[36:39], v[24:27]
    s_waitcnt lgkmcnt(9)
    v_mfma_f32_16x16x32_bf16 v[28:31], v[56:59], v[36:39], v[28:31]
    ds_read_b128 v[36:39], v3 offset:1600
    s_waitcnt lgkmcnt(9)
    v_mfma_f32_16x16x32_bf16 v[20:23], v[68:71], v[40:43], v[20:23]
    v_mfma_f32_16x16x32_bf16 v[24:27], v[164:167], v[40:43], v[24:27]
    s_waitcnt lgkmcnt(7)
    v_mfma_f32_16x16x32_bf16 v[28:31], v[60:63], v[40:43], v[28:31]
    ds_read_b128 v[40:43], v3 offset:1664
    s_waitcnt lgkmcnt(7)
    v_mfma_f32_16x16x32_bf16 v[20:23], v[64:67], v[44:47], v[20:23]
    v_mfma_f32_16x16x32_bf16 v[24:27], v[160:163], v[44:47], v[24:27]
    s_waitcnt lgkmcnt(5)
    v_mfma_f32_16x16x32_bf16 v[28:31], v[48:51], v[44:47], v[28:31]
    s_nop 4
    v_cvt_pk_bf16_f32 v8, v20, v21
    v_cvt_pk_bf16_f32 v9, v22, v23
    ds_write_b64 v7, v[8:9] offset:2048
    ds_read_b128 v[44:47], v3 offset:1728
    s_waitcnt lgkmcnt(6)
    v_mfma_f32_16x16x32_bf16 v[24:27], v[156:159], v[32:35], v[24:27]
    s_waitcnt lgkmcnt(4)
    v_mfma_f32_16x16x32_bf16 v[28:31], v[52:55], v[32:35], v[28:31]
    ds_read_b128 v[32:35], v3 offset:1792
    s_waitcnt lgkmcnt(4)
    v_mfma_f32_16x16x32_bf16 v[24:27], v[152:155], v[36:39], v[24:27]
    v_mfma_f32_16x16x32_bf16 v[28:31], v[184:187], v[36:39], v[28:31]
    ds_read_b128 v[36:39], v3 offset:1856
    s_waitcnt lgkmcnt(4)
    v_mfma_f32_16x16x32_bf16 v[24:27], v[148:151], v[40:43], v[24:27]
    v_mfma_f32_16x16x32_bf16 v[28:31], v[180:183], v[40:43], v[28:31]
    ds_read_b128 v[40:43], v3 offset:1920
    s_waitcnt lgkmcnt(3)
    v_mfma_f32_16x16x32_bf16 v[24:27], v[144:147], v[44:47], v[24:27]
    v_mfma_f32_16x16x32_bf16 v[28:31], v[176:179], v[44:47], v[28:31]
    ds_read_b128 v[44:47], v3 offset:1984
    s_waitcnt lgkmcnt(3)
    v_mfma_f32_16x16x32_bf16 v[24:27], v[140:143], v[32:35], v[24:27]
    v_mfma_f32_16x16x32_bf16 v[28:31], v[172:175], v[32:35], v[28:31]
    s_waitcnt lgkmcnt(2)
    v_mfma_f32_16x16x32_bf16 v[24:27], v[136:139], v[36:39], v[24:27]
    v_mfma_f32_16x16x32_bf16 v[28:31], v[168:171], v[36:39], v[28:31]
    s_waitcnt lgkmcnt(1)
    v_mfma_f32_16x16x32_bf16 v[24:27], v[132:135], v[40:43], v[24:27]
    v_mfma_f32_16x16x32_bf16 v[28:31], v[164:167], v[40:43], v[28:31]
    s_waitcnt lgkmcnt(0)
    v_mfma_f32_16x16x32_bf16 v[24:27], v[128:131], v[44:47], v[24:27]
    v_mfma_f32_16x16x32_bf16 v[28:31], v[160:163], v[44:47], v[28:31]
    s_barrier
    ds_read_b128 v[32:35], v3 offset:2048
    ds_read_b128 v[36:39], v3 offset:2112
    ds_read_b128 v[40:43], v3 offset:2176
    ds_read_b128 v[44:47], v3 offset:2240
    s_waitcnt lgkmcnt(3)
    v_mfma_f32_16x16x32_bf16 v[24:27], v[124:127], v[32:35], v[24:27]
    v_mfma_f32_16x16x32_bf16 v[28:31], v[156:159], v[32:35], v[28:31]
    ds_read_b128 v[32:35], v3 offset:2304
    s_waitcnt lgkmcnt(3)
    v_mfma_f32_16x16x32_bf16 v[24:27], v[120:123], v[36:39], v[24:27]
    v_mfma_f32_16x16x32_bf16 v[28:31], v[152:155], v[36:39], v[28:31]
    ds_read_b128 v[36:39], v3 offset:2368
    s_waitcnt lgkmcnt(3)
    v_mfma_f32_16x16x32_bf16 v[24:27], v[116:119], v[40:43], v[24:27]
    v_mfma_f32_16x16x32_bf16 v[28:31], v[148:151], v[40:43], v[28:31]
    ds_read_b128 v[40:43], v3 offset:2432
    s_waitcnt lgkmcnt(3)
    v_mfma_f32_16x16x32_bf16 v[24:27], v[112:115], v[44:47], v[24:27]
    v_mfma_f32_16x16x32_bf16 v[28:31], v[144:147], v[44:47], v[28:31]
    ds_read_b128 v[44:47], v3 offset:2496
    s_waitcnt lgkmcnt(3)
    v_mfma_f32_16x16x32_bf16 v[24:27], v[108:111], v[32:35], v[24:27]
    v_mfma_f32_16x16x32_bf16 v[28:31], v[140:143], v[32:35], v[28:31]
    ds_read_b128 v[32:35], v3 offset:2560
    s_waitcnt lgkmcnt(3)
    v_mfma_f32_16x16x32_bf16 v[24:27], v[104:107], v[36:39], v[24:27]
    v_mfma_f32_16x16x32_bf16 v[28:31], v[136:139], v[36:39], v[28:31]
    ds_read_b128 v[36:39], v3 offset:2624
    s_waitcnt lgkmcnt(3)
    v_mfma_f32_16x16x32_bf16 v[24:27], v[100:103], v[40:43], v[24:27]
    v_mfma_f32_16x16x32_bf16 v[28:31], v[132:135], v[40:43], v[28:31]
    ds_read_b128 v[40:43], v3 offset:2688
    s_waitcnt lgkmcnt(3)
    v_mfma_f32_16x16x32_bf16 v[24:27], v[96:99], v[44:47], v[24:27]
    v_mfma_f32_16x16x32_bf16 v[28:31], v[128:131], v[44:47], v[28:31]
    ds_read_b128 v[44:47], v3 offset:2752
    s_waitcnt lgkmcnt(3)
    v_mfma_f32_16x16x32_bf16 v[24:27], v[92:95], v[32:35], v[24:27]
    v_mfma_f32_16x16x32_bf16 v[28:31], v[124:127], v[32:35], v[28:31]
    ds_read_b128 v[32:35], v3 offset:2816
    s_waitcnt lgkmcnt(3)
    v_mfma_f32_16x16x32_bf16 v[24:27], v[88:91], v[36:39], v[24:27]
    v_mfma_f32_16x16x32_bf16 v[28:31], v[120:123], v[36:39], v[28:31]
    ds_read_b128 v[36:39], v3 offset:2880
    s_waitcnt lgkmcnt(3)
    v_mfma_f32_16x16x32_bf16 v[24:27], v[84:87], v[40:43], v[24:27]
    v_mfma_f32_16x16x32_bf16 v[28:31], v[116:119], v[40:43], v[28:31]
    ds_read_b128 v[40:43], v3 offset:2944
    s_waitcnt lgkmcnt(3)
    v_mfma_f32_16x16x32_bf16 v[24:27], v[80:83], v[44:47], v[24:27]
    v_mfma_f32_16x16x32_bf16 v[28:31], v[112:115], v[44:47], v[28:31]
    ds_read_b128 v[44:47], v3 offset:3008
    s_waitcnt lgkmcnt(3)
    v_mfma_f32_16x16x32_bf16 v[24:27], v[76:79], v[32:35], v[24:27]
    v_mfma_f32_16x16x32_bf16 v[28:31], v[108:111], v[32:35], v[28:31]
    s_waitcnt lgkmcnt(2)
    v_mfma_f32_16x16x32_bf16 v[24:27], v[72:75], v[36:39], v[24:27]
    v_mfma_f32_16x16x32_bf16 v[28:31], v[104:107], v[36:39], v[28:31]
    s_waitcnt lgkmcnt(1)
    v_mfma_f32_16x16x32_bf16 v[24:27], v[68:71], v[40:43], v[24:27]
    v_mfma_f32_16x16x32_bf16 v[28:31], v[100:103], v[40:43], v[28:31]
    s_waitcnt lgkmcnt(0)
    v_mfma_f32_16x16x32_bf16 v[24:27], v[64:67], v[44:47], v[24:27]
    v_mfma_f32_16x16x32_bf16 v[28:31], v[96:99], v[44:47], v[28:31]
    s_nop 6
    v_cvt_pk_bf16_f32 v8, v24, v25
    v_cvt_pk_bf16_f32 v9, v26, v27
    ds_write_b64 v7, v[8:9] offset:4096
    s_waitcnt lgkmcnt(0)
    s_barrier
    ds_read_b128 v[32:35], v3 offset:3072
    ds_read_b128 v[36:39], v3 offset:3136
    ds_read_b128 v[40:43], v3 offset:3200
    ds_read_b128 v[44:47], v3 offset:3264
    s_waitcnt lgkmcnt(3)
    v_mfma_f32_16x16x32_bf16 v[28:31], v[92:95], v[32:35], v[28:31]
    ds_read_b128 v[32:35], v3 offset:3328
    s_waitcnt lgkmcnt(3)
    v_mfma_f32_16x16x32_bf16 v[28:31], v[88:91], v[36:39], v[28:31]
    ds_read_b128 v[36:39], v3 offset:3392
    s_waitcnt lgkmcnt(3)
    v_mfma_f32_16x16x32_bf16 v[28:31], v[84:87], v[40:43], v[28:31]
    ds_read_b128 v[40:43], v3 offset:3456
    s_waitcnt lgkmcnt(3)
    v_mfma_f32_16x16x32_bf16 v[28:31], v[80:83], v[44:47], v[28:31]
    ds_read_b128 v[44:47], v3 offset:3520
    s_waitcnt lgkmcnt(3)
    v_mfma_f32_16x16x32_bf16 v[28:31], v[76:79], v[32:35], v[28:31]
    s_waitcnt lgkmcnt(2)
    v_mfma_f32_16x16x32_bf16 v[28:31], v[72:75], v[36:39], v[28:31]
    s_waitcnt lgkmcnt(1)
    v_mfma_f32_16x16x32_bf16 v[28:31], v[68:71], v[40:43], v[28:31]
    s_waitcnt lgkmcnt(0)
    v_mfma_f32_16x16x32_bf16 v[28:31], v[64:67], v[44:47], v[28:31]
    s_nop 7
    v_cvt_pk_bf16_f32 v8, v28, v29
    v_cvt_pk_bf16_f32 v9, v30, v31
    ds_write_b64 v7, v[8:9] offset:6144
    s_waitcnt lgkmcnt(0)
    s_barrier
v_conv_done:
    s_cmp_eq_u32 s34, 1
    s_cbranch_scc1 k_done
    s_mov_b32 s34, 1
    s_mov_b32 s35, 2097152
    s_mov_b32 s36, 6291456
    s_mov_b32 s37, 10551296
    v_bfe_u32 v8, v1, 1, 3
    v_lshrrev_b32 v9, 4, v1
    v_xor_b32 v8, v8, v9
    v_and_b32 v9, 15, v1
    v_lshlrev_b32 v9, 7, v9
    v_lshl_add_u32 v2, v8, 4, v9
    s_add_u32 s38, s29, 0
    s_and_b32 s38, s38, 3
    s_add_u32 s38, s38, 1
    s_mov_b32 s52, s38
    s_lshl_b32 s38, s38, 14
    v_add_u32 v3, s38, v2
    s_add_u32 s38, s29, 1
    s_and_b32 s38, s38, 3
    s_add_u32 s38, s38, 1
    s_mov_b32 s53, s38
    s_lshl_b32 s38, s38, 14
    v_add_u32 v7, s38, v2
    s_add_u32 s38, s29, 2
    s_and_b32 s38, s38, 3
    s_add_u32 s38, s38, 1
    s_mov_b32 s54, s38
    s_lshl_b32 s38, s38, 14
    v_add_u32 v8, s38, v2
    s_add_u32 s38, s29, 3
    s_and_b32 s38, s38, 3
    s_add_u32 s38, s38, 1
    s_mov_b32 s55, s38
    s_lshl_b32 s38, s38, 14
    v_add_u32 v9, s38, v2
    v_xor_b32 v10, 64, v2
    v_xor_b32 v11, 64, v3
    v_xor_b32 v12, 64, v7
    v_xor_b32 v13, 64, v8
    v_xor_b32 v14, 64, v9
    v_mov_b32 v48, 0x3f803f80
    v_mov_b32 v49, 0x3f803f80
    v_mov_b32 v50, 0x3f803f80
    v_mov_b32 v51, 0x3f803f80
    s_lshl_b32 s40, s30, 16
    s_lshl_b32 s41, s28, 10
    s_add_u32 s40, s40, s41
    s_add_u32 s40, s40, 8372224
    s_cmp_eq_u32 s30, 0
    s_cselect_b32 s42, 0x7f000000, 0
    v_add_u32 v92, s42, v0
    v_and_b32 v95, 7, v1
    s_and_b32 s43, s28, 1
    s_lshl_b32 s43, s43, 2
    v_lshrrev_b32 v94, 4, v1
    v_xor_b32 v94, v94, v95
    v_xor_b32 v94, s43, v94
    v_lshlrev_b32 v93, 8, v95
    v_lshl_add_u32 v93, v94, 4, v93
    v_bfe_u32 v94, v1, 3, 1
    v_lshl_add_u32 v93, v94, 3, v93
    s_lshr_b32 s43, s28, 1
    s_lshl_b32 s43, s43, 11
    v_add_u32 v93, s43, v93
    v_add_u32 v94, 0x10000, v93
    v_cmp_eq_u32 s[44:45], 0, v95
    s_waitcnt vmcnt(0)
    s_mov_b32 s38, 0
v_x2poll:
    s_add_u32 s43, s40, 0
    buffer_load_dwordx4 v[52:55], v92, s[4:7], s43 offen sc1
    s_add_u32 s43, s40, 16384
    buffer_load_dwordx4 v[56:59], v0, s[4:7], s43 offen sc1
    s_add_u32 s43, s40, 32768
    buffer_load_dwordx4 v[60:63], v0, s[4:7], s43 offen sc1
    s_add_u32 s43, s40, 49152
    buffer_load_dwordx4 v[64:67], v0, s[4:7], s43 offen sc1
    s_add_u32 s43, s40, 65536
    buffer_load_dwordx4 v[68:71], v0, s[4:7], s43 offen sc1
    s_add_u32 s43, s40, 8192
    buffer_load_dwordx4 v[72:75], v92, s[4:7], s43 offen sc1
    s_add_u32 s43, s40, 24576
    buffer_load_dwordx4 v[76:79], v0, s[4:7], s43 offen sc1
    s_add_u32 s43, s40, 40960
    buffer_load_dwordx4 v[80:83], v0, s[4:7], s43 offen sc1
    s_add_u32 s43, s40, 57344
    buffer_load_dwordx4 v[84:87], v0, s[4:7], s43 offen sc1
    s_add_u32 s43, s40, 73728
    buffer_load_dwordx4 v[88:91], v0, s[4:7], s43 offen sc1
    s_add_u32 s38, s38, 1
    s_waitcnt vmcnt(0)
    v_max3_u32 v95, v55, v59, v63
    v_max3_u32 v95, v95, v67, v71
    v_max3_u32 v95, v95, v75, v79
    v_max3_u32 v95, v95, v83, v87
    v_max_u32 v95, v95, v91
    v_cmp_eq_u32 vcc, -1, v95
    s_cmp_gt_u32 s38, 131072
    s_cbranch_scc1 v_x2poll_x
    s_cbranch_vccnz v_x2poll
v_x2poll_x:
    v_mov_b32 v95, 0x3f803f80
    v_cndmask_b32 v52, v52, v95, s[44:45]
    v_cndmask_b32 v53, v53, v95, s[44:45]
    v_cndmask_b32 v72, v72, v95, s[44:45]
    v_cndmask_b32 v73, v73, v95, s[44:45]
    ds_write_b64 v93, v[52:53] offset:0
    ds_write_b64 v93, v[54:55] offset:128
    ds_write_b64 v93, v[56:57] offset:16384
    ds_write_b64 v93, v[58:59] offset:16512
    ds_write_b64 v93, v[60:61] offset:32768
    ds_write_b64 v93, v[62:63] offset:32896
    ds_write_b64 v93, v[64:65] offset:49152
    ds_write_b64 v93, v[66:67] offset:49280
    ds_write_b64 v94, v[68:69] offset:0
    ds_write_b64 v94, v[70:71] offset:128
    ds_write_b64 v93, v[72:73] offset:8192
    ds_write_b64 v93, v[74:75] offset:8320
    ds_write_b64 v93, v[76:77] offset:24576
    ds_write_b64 v93, v[78:79] offset:24704
    ds_write_b64 v93, v[80:81] offset:40960
    ds_write_b64 v93, v[82:83] offset:41088
    ds_write_b64 v93, v[84:85] offset:57344
    ds_write_b64 v93, v[86:87] offset:57472
    ds_write_b64 v94, v[88:89] offset:8192
    ds_write_b64 v94, v[90:91] offset:8320
    s_waitcnt lgkmcnt(0)
    s_barrier
    s_setprio 1
    ds_read_b128 v[52:55], v2 offset:0
    ds_read_b128 v[56:59], v3 offset:0
    ds_read_b128 v[60:63], v7 offset:0
    ds_read_b128 v[64:67], v8 offset:0
    ds_read_b128 v[68:71], v9 offset:0
    s_waitcnt lgkmcnt(4)
    v_mfma_f32_16x16x32_bf16 v[16:19], v[52:55], v[188:191], 0
    v_mfma_f32_16x16x32_bf16 v[44:47], v[52:55], v[52:55], 0
    ds_read_b128 v[72:75], v10 offset:0
    s_waitcnt lgkmcnt(4)
    v_mfma_f32_16x16x32_bf16 v[20:23], v[56:59], v[188:191], 0
    ds_read_b128 v[76:79], v11 offset:0
    v_mfma_f32_16x16x32_bf16 v[36:39], v[56:59], v[56:59], 0
    ds_read_b128 v[80:83], v12 offset:0
    v_mfma_f32_16x16x32_bf16 v[40:43], v[48:51], v[56:59], 0
    ds_read_b128 v[84:87], v13 offset:0
    s_waitcnt lgkmcnt(6)
    v_mfma_f32_16x16x32_bf16 v[24:27], v[60:63], v[188:191], 0
    ds_read_b128 v[88:91], v14 offset:0
    s_waitcnt lgkmcnt(6)
    v_mfma_f32_16x16x32_bf16 v[28:31], v[64:67], v[188:191], 0
    s_waitcnt lgkmcnt(5)
    v_mfma_f32_16x16x32_bf16 v[32:35], v[68:71], v[188:191], 0
    s_waitcnt lgkmcnt(4)
    v_mfma_f32_16x16x32_bf16 v[16:19], v[72:75], v[192:195], v[16:19]
    v_mfma_f32_16x16x32_bf16 v[44:47], v[72:75], v[72:75], v[44:47]
    ds_read_b128 v[52:55], v2 offset:2048
    s_waitcnt lgkmcnt(4)
    v_mfma_f32_16x16x32_bf16 v[20:23], v[76:79], v[192:195], v[20:23]
    ds_read_b128 v[56:59], v3 offset:2048
    v_mfma_f32_16x16x32_bf16 v[36:39], v[76:79], v[76:79], v[36:39]
    ds_read_b128 v[60:63], v7 offset:2048
    v_mfma_f32_16x16x32_bf16 v[40:43], v[48:51], v[76:79], v[40:43]
    ds_read_b128 v[64:67], v8 offset:2048
    s_waitcnt lgkmcnt(6)
    v_mfma_f32_16x16x32_bf16 v[24:27], v[80:83], v[192:195], v[24:27]
    ds_read_b128 v[68:71], v9 offset:2048
    s_waitcnt lgkmcnt(6)
    v_mfma_f32_16x16x32_bf16 v[28:31], v[84:87], v[192:195], v[28:31]
    s_waitcnt lgkmcnt(5)
    v_mfma_f32_16x16x32_bf16 v[32:35], v[88:91], v[192:195], v[32:35]
    s_waitcnt lgkmcnt(4)
    v_mfma_f32_16x16x32_bf16 v[16:19], v[52:55], v[196:199], v[16:19]
    v_mfma_f32_16x16x32_bf16 v[44:47], v[52:55], v[52:55], v[44:47]
    ds_read_b128 v[72:75], v10 offset:2048
    s_waitcnt lgkmcnt(4)
    v_mfma_f32_16x16x32_bf16 v[20:23], v[56:59], v[196:199], v[20:23]
    ds_read_b128 v[76:79], v11 offset:2048
    v_mfma_f32_16x16x32_bf16 v[36:39], v[56:59], v[56:59], v[36:39]
    ds_read_b128 v[80:83], v12 offset:2048
    v_mfma_f32_16x16x32_bf16 v[40:43], v[48:51], v[56:59], v[40:43]
    ds_read_b128 v[84:87], v13 offset:2048
    s_waitcnt lgkmcnt(6)
    v_mfma_f32_16x16x32_bf16 v[24:27], v[60:63], v[196:199], v[24:27]
    ds_read_b128 v[88:91], v14 offset:2048
    s_waitcnt lgkmcnt(6)
    v_mfma_f32_16x16x32_bf16 v[28:31], v[64:67], v[196:199], v[28:31]
    s_waitcnt lgkmcnt(5)
    v_mfma_f32_16x16x32_bf16 v[32:35], v[68:71], v[196:199], v[32:35]
    s_waitcnt lgkmcnt(4)
    v_mfma_f32_16x16x32_bf16 v[16:19], v[72:75], v[200:203], v[16:19]
    v_mfma_f32_16x16x32_bf16 v[44:47], v[72:75], v[72:75], v[44:47]
    ds_read_b128 v[52:55], v2 offset:4096
    s_waitcnt lgkmcnt(4)
    v_mfma_f32_16x16x32_bf16 v[20:23], v[76:79], v[200:203], v[20:23]
    ds_read_b128 v[56:59], v3 offset:4096
    v_mfma_f32_16x16x32_bf16 v[36:39], v[76:79], v[76:79], v[36:39]
    ds_read_b128 v[60:63], v7 offset:4096
    v_mfma_f32_16x16x32_bf16 v[40:43], v[48:51], v[76:79], v[40:43]
    ds_read_b128 v[64:67], v8 offset:4096
    s_waitcnt lgkmcnt(6)
    v_mfma_f32_16x16x32_bf16 v[24:27], v[80:83], v[200:203], v[24:27]
    ds_read_b128 v[68:71], v9 offset:4096
    s_waitcnt lgkmcnt(6)
    v_mfma_f32_16x16x32_bf16 v[28:31], v[84:87], v[200:203], v[28:31]
    s_waitcnt lgkmcnt(5)
    v_mfma_f32_16x16x32_bf16 v[32:35], v[88:91], v[200:203], v[32:35]
    s_waitcnt lgkmcnt(4)
    v_mfma_f32_16x16x32_bf16 v[16:19], v[52:55], v[204:207], v[16:19]
    v_mfma_f32_16x16x32_bf16 v[44:47], v[52:55], v[52:55], v[44:47]
    ds_read_b128 v[72:75], v10 offset:4096
    s_waitcnt lgkmcnt(4)
    v_mfma_f32_16x16x32_bf16 v[20:23], v[56:59], v[204:207], v[20:23]
    ds_read_b128 v[76:79], v11 offset:4096
    v_mfma_f32_16x16x32_bf16 v[36:39], v[56:59], v[56:59], v[36:39]
    ds_read_b128 v[80:83], v12 offset:4096
    v_mfma_f32_16x16x32_bf16 v[40:43], v[48:51], v[56:59], v[40:43]
    ds_read_b128 v[84:87], v13 offset:4096
    s_waitcnt lgkmcnt(6)
    v_mfma_f32_16x16x32_bf16 v[24:27], v[60:63], v[204:207], v[24:27]
    ds_read_b128 v[88:91], v14 offset:4096
    s_waitcnt lgkmcnt(6)
    v_mfma_f32_16x16x32_bf16 v[28:31], v[64:67], v[204:207], v[28:31]
    s_waitcnt lgkmcnt(5)
    v_mfma_f32_16x16x32_bf16 v[32:35], v[68:71], v[204:207], v[32:35]
    s_waitcnt lgkmcnt(4)
    v_mfma_f32_16x16x32_bf16 v[16:19], v[72:75], v[208:211], v[16:19]
    v_mfma_f32_16x16x32_bf16 v[44:47], v[72:75], v[72:75], v[44:47]
    ds_read_b128 v[52:55], v2 offset:6144
    s_waitcnt lgkmcnt(4)
    v_mfma_f32_16x16x32_bf16 v[20:23], v[76:79], v[208:211], v[20:23]
    ds_read_b128 v[56:59], v3 offset:6144
    v_mfma_f32_16x16x32_bf16 v[36:39], v[76:79], v[76:79], v[36:39]
    ds_read_b128 v[60:63], v7 offset:6144
    v_mfma_f32_16x16x32_bf16 v[40:43], v[48:51], v[76:79], v[40:43]
    ds_read_b128 v[64:67], v8 offset:6144
    s_waitcnt lgkmcnt(6)
    v_mfma_f32_16x16x32_bf16 v[24:27], v[80:83], v[208:211], v[24:27]
    ds_read_b128 v[68:71], v9 offset:6144
    s_waitcnt lgkmcnt(6)
    v_mfma_f32_16x16x32_bf16 v[28:31], v[84:87], v[208:211], v[28:31]
    s_waitcnt lgkmcnt(5)
    v_mfma_f32_16x16x32_bf16 v[32:35], v[88:91], v[208:211], v[32:35]
    s_waitcnt lgkmcnt(4)
    v_mfma_f32_16x16x32_bf16 v[16:19], v[52:55], v[212:215], v[16:19]
    v_mfma_f32_16x16x32_bf16 v[44:47], v[52:55], v[52:55], v[44:47]
    ds_read_b128 v[72:75], v10 offset:6144
    s_waitcnt lgkmcnt(4)
    v_mfma_f32_16x16x32_bf16 v[20:23], v[56:59], v[212:215], v[20:23]
    ds_read_b128 v[76:79], v11 offset:6144
    v_mfma_f32_16x16x32_bf16 v[36:39], v[56:59], v[56:59], v[36:39]
    ds_read_b128 v[80:83], v12 offset:6144
    v_mfma_f32_16x16x32_bf16 v[40:43], v[48:51], v[56:59], v[40:43]
    ds_read_b128 v[84:87], v13 offset:6144
    s_waitcnt lgkmcnt(6)
    v_mfma_f32_16x16x32_bf16 v[24:27], v[60:63], v[212:215], v[24:27]
    ds_read_b128 v[88:91], v14 offset:6144
    s_waitcnt lgkmcnt(6)
    v_mfma_f32_16x16x32_bf16 v[28:31], v[64:67], v[212:215], v[28:31]
    s_waitcnt lgkmcnt(5)
    v_mfma_f32_16x16x32_bf16 v[32:35], v[68:71], v[212:215], v[32:35]
    s_waitcnt lgkmcnt(4)
    v_mfma_f32_16x16x32_bf16 v[16:19], v[72:75], v[216:219], v[16:19]
    v_mfma_f32_16x16x32_bf16 v[44:47], v[72:75], v[72:75], v[44:47]
    ds_read_b128 v[52:55], v2 offset:8192
    s_waitcnt lgkmcnt(4)
    v_mfma_f32_16x16x32_bf16 v[20:23], v[76:79], v[216:219], v[20:23]
    ds_read_b128 v[56:59], v3 offset:8192
    v_mfma_f32_16x16x32_bf16 v[36:39], v[76:79], v[76:79], v[36:39]
    ds_read_b128 v[60:63], v7 offset:8192
    v_mfma_f32_16x16x32_bf16 v[40:43], v[48:51], v[76:79], v[40:43]
    ds_read_b128 v[64:67], v8 offset:8192
    s_waitcnt lgkmcnt(6)
    v_mfma_f32_16x16x32_bf16 v[24:27], v[80:83], v[216:219], v[24:27]
    ds_read_b128 v[68:71], v9 offset:8192
    s_waitcnt lgkmcnt(6)
    v_mfma_f32_16x16x32_bf16 v[28:31], v[84:87], v[216:219], v[28:31]
    s_waitcnt lgkmcnt(5)
    v_mfma_f32_16x16x32_bf16 v[32:35], v[88:91], v[216:219], v[32:35]
    s_waitcnt lgkmcnt(4)
    v_mfma_f32_16x16x32_bf16 v[16:19], v[52:55], v[220:223], v[16:19]
    v_mfma_f32_16x16x32_bf16 v[44:47], v[52:55], v[52:55], v[44:47]
    ds_read_b128 v[72:75], v10 offset:8192
    s_waitcnt lgkmcnt(4)
    v_mfma_f32_16x16x32_bf16 v[20:23], v[56:59], v[220:223], v[20:23]
    ds_read_b128 v[76:79], v11 offset:8192
    v_mfma_f32_16x16x32_bf16 v[36:39], v[56:59], v[56:59], v[36:39]
    ds_read_b128 v[80:83], v12 offset:8192
    v_mfma_f32_16x16x32_bf16 v[40:43], v[48:51], v[56:59], v[40:43]
    ds_read_b128 v[84:87], v13 offset:8192
    s_waitcnt lgkmcnt(6)
    v_mfma_f32_16x16x32_bf16 v[24:27], v[60:63], v[220:223], v[24:27]
    ds_read_b128 v[88:91], v14 offset:8192
    s_waitcnt lgkmcnt(6)
    v_mfma_f32_16x16x32_bf16 v[28:31], v[64:67], v[220:223], v[28:31]
    s_waitcnt lgkmcnt(5)
    v_mfma_f32_16x16x32_bf16 v[32:35], v[68:71], v[220:223], v[32:35]
    s_waitcnt lgkmcnt(4)
    v_mfma_f32_16x16x32_bf16 v[16:19], v[72:75], v[224:227], v[16:19]
    v_mfma_f32_16x16x32_bf16 v[44:47], v[72:75], v[72:75], v[44:47]
    ds_read_b128 v[52:55], v2 offset:10240
    s_waitcnt lgkmcnt(4)
    v_mfma_f32_16x16x32_bf16 v[20:23], v[76:79], v[224:227], v[20:23]
    ds_read_b128 v[56:59], v3 offset:10240
    v_mfma_f32_16x16x32_bf16 v[36:39], v[76:79], v[76:79], v[36:39]
    ds_read_b128 v[60:63], v7 offset:10240
    v_mfma_f32_16x16x32_bf16 v[40:43], v[48:51], v[76:79], v[40:43]
    ds_read_b128 v[64:67], v8 offset:10240
    s_waitcnt lgkmcnt(6)
    v_mfma_f32_16x16x32_bf16 v[24:27], v[80:83], v[224:227], v[24:27]
    ds_read_b128 v[68:71], v9 offset:10240
    s_waitcnt lgkmcnt(6)
    v_mfma_f32_16x16x32_bf16 v[28:31], v[84:87], v[224:227], v[28:31]
    s_waitcnt lgkmcnt(5)
    v_mfma_f32_16x16x32_bf16 v[32:35], v[88:91], v[224:227], v[32:35]
    s_waitcnt lgkmcnt(4)
    v_mfma_f32_16x16x32_bf16 v[16:19], v[52:55], v[228:231], v[16:19]
    v_mfma_f32_16x16x32_bf16 v[44:47], v[52:55], v[52:55], v[44:47]
    ds_read_b128 v[72:75], v10 offset:10240
    s_waitcnt lgkmcnt(4)
    v_mfma_f32_16x16x32_bf16 v[20:23], v[56:59], v[228:231], v[20:23]
    ds_read_b128 v[76:79], v11 offset:10240
    v_mfma_f32_16x16x32_bf16 v[36:39], v[56:59], v[56:59], v[36:39]
    ds_read_b128 v[80:83], v12 offset:10240
    v_mfma_f32_16x16x32_bf16 v[40:43], v[48:51], v[56:59], v[40:43]
    ds_read_b128 v[84:87], v13 offset:10240
    s_waitcnt lgkmcnt(6)
    v_mfma_f32_16x16x32_bf16 v[24:27], v[60:63], v[228:231], v[24:27]
    ds_read_b128 v[88:91], v14 offset:10240
    s_waitcnt lgkmcnt(6)
    v_mfma_f32_16x16x32_bf16 v[28:31], v[64:67], v[228:231], v[28:31]
    s_waitcnt lgkmcnt(5)
    v_mfma_f32_16x16x32_bf16 v[32:35], v[68:71], v[228:231], v[32:35]
    s_waitcnt lgkmcnt(4)
    v_mfma_f32_16x16x32_bf16 v[16:19], v[72:75], v[232:235], v[16:19]
    v_mfma_f32_16x16x32_bf16 v[44:47], v[72:75], v[72:75], v[44:47]
    ds_read_b128 v[52:55], v2 offset:12288
    s_waitcnt lgkmcnt(4)
    v_mfma_f32_16x16x32_bf16 v[20:23], v[76:79], v[232:235], v[20:23]
    ds_read_b128 v[56:59], v3 offset:12288
    v_mfma_f32_16x16x32_bf16 v[36:39], v[76:79], v[76:79], v[36:39]
    ds_read_b128 v[60:63], v7 offset:12288
    v_mfma_f32_16x16x32_bf16 v[40:43], v[48:51], v[76:79], v[40:43]
    ds_read_b128 v[64:67], v8 offset:12288
    s_waitcnt lgkmcnt(6)
    v_mfma_f32_16x16x32_bf16 v[24:27], v[80:83], v[232:235], v[24:27]
    ds_read_b128 v[68:71], v9 offset:12288
    s_waitcnt lgkmcnt(6)
    v_mfma_f32_16x16x32_bf16 v[28:31], v[84:87], v[232:235], v[28:31]
    s_waitcnt lgkmcnt(5)
    v_mfma_f32_16x16x32_bf16 v[32:35], v[88:91], v[232:235], v[32:35]
    s_waitcnt lgkmcnt(4)
    v_mfma_f32_16x16x32_bf16 v[16:19], v[52:55], v[236:239], v[16:19]
    v_mfma_f32_16x16x32_bf16 v[44:47], v[52:55], v[52:55], v[44:47]
    ds_read_b128 v[72:75], v10 offset:12288
    s_waitcnt lgkmcnt(4)
    v_mfma_f32_16x16x32_bf16 v[20:23], v[56:59], v[236:239], v[20:23]
    ds_read_b128 v[76:79], v11 offset:12288
    v_mfma_f32_16x16x32_bf16 v[36:39], v[56:59], v[56:59], v[36:39]
    ds_read_b128 v[80:83], v12 offset:12288
    v_mfma_f32_16x16x32_bf16 v[40:43], v[48:51], v[56:59], v[40:43]
    ds_read_b128 v[84:87], v13 offset:12288
    s_waitcnt lgkmcnt(6)
    v_mfma_f32_16x16x32_bf16 v[24:27], v[60:63], v[236:239], v[24:27]
    ds_read_b128 v[88:91], v14 offset:12288
    s_waitcnt lgkmcnt(6)
    v_mfma_f32_16x16x32_bf16 v[28:31], v[64:67], v[236:239], v[28:31]
    s_waitcnt lgkmcnt(5)
    v_mfma_f32_16x16x32_bf16 v[32:35], v[68:71], v[236:239], v[32:35]
    s_waitcnt lgkmcnt(4)
    v_mfma_f32_16x16x32_bf16 v[16:19], v[72:75], v[240:243], v[16:19]
    v_mfma_f32_16x16x32_bf16 v[44:47], v[72:75], v[72:75], v[44:47]
    ds_read_b128 v[52:55], v2 offset:14336
    s_waitcnt lgkmcnt(4)
    v_mfma_f32_16x16x32_bf16 v[20:23], v[76:79], v[240:243], v[20:23]
    ds_read_b128 v[56:59], v3 offset:14336
    v_mfma_f32_16x16x32_bf16 v[36:39], v[76:79], v[76:79], v[36:39]
    ds_read_b128 v[60:63], v7 offset:14336
    v_mfma_f32_16x16x32_bf16 v[40:43], v[48:51], v[76:79], v[40:43]
    ds_read_b128 v[64:67], v8 offset:14336
    s_waitcnt lgkmcnt(6)
    v_mfma_f32_16x16x32_bf16 v[24:27], v[80:83], v[240:243], v[24:27]
    ds_read_b128 v[68:71], v9 offset:14336
    s_waitcnt lgkmcnt(6)
    v_mfma_f32_16x16x32_bf16 v[28:31], v[84:87], v[240:243], v[28:31]
    s_waitcnt lgkmcnt(5)
    v_mfma_f32_16x16x32_bf16 v[32:35], v[88:91], v[240:243], v[32:35]
    s_waitcnt lgkmcnt(4)
    v_mfma_f32_16x16x32_bf16 v[16:19], v[52:55], v[244:247], v[16:19]
    v_mfma_f32_16x16x32_bf16 v[44:47], v[52:55], v[52:55], v[44:47]
    ds_read_b128 v[72:75], v10 offset:14336
    s_waitcnt lgkmcnt(4)
    v_mfma_f32_16x16x32_bf16 v[20:23], v[56:59], v[244:247], v[20:23]
    ds_read_b128 v[76:79], v11 offset:14336
    v_mfma_f32_16x16x32_bf16 v[36:39], v[56:59], v[56:59], v[36:39]
    ds_read_b128 v[80:83], v12 offset:14336
    v_mfma_f32_16x16x32_bf16 v[40:43], v[48:51], v[56:59], v[40:43]
    ds_read_b128 v[84:87], v13 offset:14336
    s_waitcnt lgkmcnt(6)
    v_mfma_f32_16x16x32_bf16 v[24:27], v[60:63], v[244:247], v[24:27]
    ds_read_b128 v[88:91], v14 offset:14336
    s_waitcnt lgkmcnt(6)
    v_mfma_f32_16x16x32_bf16 v[28:31], v[64:67], v[244:247], v[28:31]
    s_waitcnt lgkmcnt(5)
    v_mfma_f32_16x16x32_bf16 v[32:35], v[68:71], v[244:247], v[32:35]
    s_waitcnt lgkmcnt(4)
    v_mfma_f32_16x16x32_bf16 v[16:19], v[72:75], v[248:251], v[16:19]
    v_mfma_f32_16x16x32_bf16 v[44:47], v[72:75], v[72:75], v[44:47]
    s_waitcnt lgkmcnt(3)
    v_mfma_f32_16x16x32_bf16 v[20:23], v[76:79], v[248:251], v[20:23]
    v_mfma_f32_16x16x32_bf16 v[36:39], v[76:79], v[76:79], v[36:39]
    v_mfma_f32_16x16x32_bf16 v[40:43], v[48:51], v[76:79], v[40:43]
    s_waitcnt lgkmcnt(2)
    v_mfma_f32_16x16x32_bf16 v[24:27], v[80:83], v[248:251], v[24:27]
    s_waitcnt lgkmcnt(1)
    v_mfma_f32_16x16x32_bf16 v[28:31], v[84:87], v[248:251], v[28:31]
    s_waitcnt lgkmcnt(0)
    v_mfma_f32_16x16x32_bf16 v[32:35], v[88:91], v[248:251], v[32:35]
    s_nop 7
    s_branch v_common
k_done:
k_exit:
    s_endpgm
.section .rodata,"a"
.p2align 6
.amdhsa_kernel interleave_layers__sliding_local_dilated__ssm_conv_s4__prompt_kernel
  .amdhsa_next_free_vgpr 256
  .amdhsa_next_free_sgpr 102
  .amdhsa_accum_offset 256
  .amdhsa_group_segment_fixed_size 0
  .amdhsa_kernarg_size 120
  .amdhsa_user_sgpr_count 2
  .amdhsa_user_sgpr_kernarg_segment_ptr 1
  .amdhsa_system_sgpr_workgroup_id_x 1
.end_amdhsa_kernel
```

```asm
; @launch grid=(256,1,1) block=(512,1,1) lds=163840
.amdgcn_target "amdgcn-amd-amdhsa--gfx950"
.text
.globl interleave_layers__sliding_local_dilated__ssm_conv_s4__prompt_kernel
.p2align 8
.type interleave_layers__sliding_local_dilated__ssm_conv_s4__prompt_kernel,@function
interleave_layers__sliding_local_dilated__ssm_conv_s4__prompt_kernel:
    s_cmp_ge_u32 s2, 256
    s_cbranch_scc1 k_exit
    s_load_dwordx4 s[60:63], s[0:1], 0
    s_setprio 1
    s_load_dwordx16 s[40:55], s[0:1], 32
    s_load_dwordx2 s[64:65], s[0:1], 16
    s_load_dwordx4 s[56:59], s[0:1], 96
    s_load_dwordx2 s[66:67], s[0:1], 112
    v_lshrrev_b32 v2, 6, v0
    v_and_b32 v1, 63, v0
    v_lshlrev_b32 v3, 4, v0
    v_readfirstlane_b32 s28, v2
    s_and_b32 s38, s2, 7
    s_lshr_b32 s39, s2, 3
    s_lshl_b32 s30, s38, 2
    s_lshr_b32 s31, s39, 3
    s_add_u32 s30, s30, s31
    s_and_b32 s31, s39, 7
    s_lshl_b32 s32, s38, 4
    s_lshr_b32 s33, s39, 1
    s_add_u32 s32, s32, s33
    s_and_b32 s33, s39, 1
    s_and_b32 s29, s28, 3
    s_lshl_b32 s38, s32, 1
    s_add_u32 s38, s38, s33
    s_lshl_b32 s69, s38, 2
    s_lshl_b32 s38, s38, 3
    s_add_u32 s38, s38, s28
    s_lshl_b32 s38, s38, 6
    v_and_b32 v8, 7, v1
    v_lshrrev_b32 v2, 4, v1
    v_lshl_add_u32 v7, v8, 1, s38
    v_lshl_add_u32 v7, v2, 4, v7
    v_mov_b32 v216, 0
    v_mov_b32 v217, 0
    v_mov_b32 v218, 0
    v_mov_b32 v219, 0
    v_mov_b32 v220, 0
    v_mov_b32 v221, 0
    v_lshrrev_b32 v9, 5, v1
    v_bfe_u32 v10, v1, 3, 2
    v_lshl_add_u32 v4, v9, 3, v10
    s_lshr_b32 s39, s28, 1
    s_lshl_b32 s38, s39, 4
    s_lshl_b32 s3, s39, 7
    s_and_b32 s39, s28, 1
    s_lshl_b32 s68, s39, 2
    s_add_u32 s38, s38, s68
    v_add_u32 v4, s38, v4
    v_mul_u32_u24 v4, 3072, v4
    v_bfe_u32 v10, v1, 1, 2
    v_xor_b32 v10, v10, v2
    v_lshl_add_u32 v4, v10, 5, v4
    v_and_b32 v10, 1, v1
    v_lshl_add_u32 v4, v10, 4, v4
    s_lshl_b32 s38, s31, 7
    v_add_u32 v4, s38, v4
    v_xor_b32 v5, v8, v2
    v_xor_b32 v5, s68, v5
    v_lshlrev_b32 v5, 4, v5
    s_lshl_b32 s38, s30, 3
    s_add_u32 s38, s38, s39
    s_lshl_b32 s38, s38, 3
    v_lshrrev_b32 v9, 3, v1
    v_add_u32 v6, s38, v9
    v_lshl_add_u32 v5, v6, 10, v5
    v_subrev_u32 v6, 16384, v5
    s_mov_b32 s14, 1572864
    s_mov_b32 s15, 0x00020000
    s_mov_b32 s10, 2097152
    s_mov_b32 s11, 0x00020000
    s_waitcnt lgkmcnt(0)
    s_or_b32 s38, s2, s28
    s_cbranch_scc1 k_nolead
    s_mov_b32 s4, s66
    s_mov_b32 s5, s67
    s_mov_b32 s6, 0x02000000
    s_mov_b32 s7, 0x00020000
    v_lshrrev_b32 v16, 1, v1
    v_lshlrev_b32 v16, 7, v16
    v_and_b32 v17, 1, v1
    v_lshl_add_u32 v16, v17, 4, v16
    v_add_u32 v16, 0x00d00000, v16
    v_mov_b32 v12, 0
    v_mov_b32 v13, 0
    v_mov_b32 v14, 0
    v_mov_b32 v15, 0
    buffer_store_dwordx4 v[12:15], v16, s[4:7], 0 offen sc1
k_nolead:
    global_load_short_d16_hi v216, v7, s[40:41]
    global_load_short_d16_hi v217, v7, s[42:43]
    global_load_short_d16_hi v218, v7, s[44:45]
    global_load_short_d16_hi v219, v7, s[46:47]
    global_load_short_d16_hi v220, v7, s[48:49]
    global_load_short_d16_hi v221, v7, s[50:51]
    s_load_dword s68, s[52:53], s69
    s_mov_b64 s[12:13], s[62:63]
    s_mov_b64 s[8:9], s[60:61]
    s_mul_i32 s69, s28, 3072
    s_add_u32 s69, s69, 81920
    s_add_u32 m0, s69, 0
    s_mov_b32 s38, 0
    buffer_load_dwordx4 v4, s[12:15], s38 offen offset:0 lds
    s_add_u32 m0, s69, 0
    s_mov_b32 s38, 0
    buffer_load_dwordx4 v4, s[12:15], s38 offen offset:1024 lds
    s_add_u32 m0, s69, 0
    s_mov_b32 s38, 0
    buffer_load_dwordx4 v4, s[12:15], s38 offen offset:2048 lds
    s_lshl_b32 m0, s28, 10
    s_add_u32 m0, m0, 0
    s_add_u32 s38, s3, 0
    s_bitcmp1_b32 s28, 0
    s_cselect_b32 exec_lo, -1, 0xffffff00
    buffer_load_dwordx4 v6, s[8:11], s38 offen lds
    s_mov_b32 exec_lo, -1
    s_lshl_b32 m0, s28, 10
    s_add_u32 m0, m0, 16384
    s_add_u32 s38, s3, 0
    buffer_load_dwordx4 v5, s[8:11], s38 offen lds
    s_lshl_b32 m0, s28, 10
    s_add_u32 m0, m0, 32768
    s_add_u32 s38, s3, 16384
    buffer_load_dwordx4 v5, s[8:11], s38 offen lds
    s_lshl_b32 m0, s28, 10
    s_add_u32 m0, m0, 49152
    s_add_u32 s38, s3, 32768
    buffer_load_dwordx4 v5, s[8:11], s38 offen lds
    s_lshl_b32 m0, s28, 10
    s_add_u32 m0, m0, 65536
    s_add_u32 s38, s3, 49152
    buffer_load_dwordx4 v5, s[8:11], s38 offen lds
    s_setprio 0
    s_mov_b32 s4, s66
    s_mov_b32 s5, s67
    s_mov_b32 s6, 0x02000000
    s_mov_b32 s7, 0x00020000
    s_mov_b32 s16, s64
    s_mov_b32 s17, s65
    s_mov_b32 s18, 0x00080000
    s_mov_b32 s19, 0x00020000
    s_mov_b32 s20, s56
    s_mov_b32 s21, s57
    s_mov_b32 s22, 0x00200000
    s_mov_b32 s23, 0x00020000
    s_mov_b32 s24, s58
    s_mov_b32 s25, s59
    s_mov_b32 s26, 0x00000100
    s_mov_b32 s27, 0x00020000
    s_lshl_b32 s38, s32, 3
    s_load_dwordx2 s[66:67], s[54:55], s38
    v_lshlrev_b32 v0, 4, v1
    s_mov_b32 s34, 0
    s_mov_b32 s35, 0
    s_mov_b32 s36, 4194304
    s_mov_b32 s37, 10485760
    v_mov_b32 v12, 0
    v_mov_b32 v13, 0
    v_mov_b32 v14, 0
    v_mov_b32 v15, 0
    v_add_u32 v3, 155648, v3
    ds_write_b128 v3, v[12:15]
    v_mov_b32 v16, 0x3f803f80
    v_mov_b32 v17, 0x3f803f80
    v_mov_b32 v18, 0x3f803f80
    v_mov_b32 v19, 0x3f803f80
    v_lshlrev_b32 v9, 11, v9
    v_lshl_add_u32 v9, v8, 4, v9
    ds_write_b128 v9, v[16:19]
    v_and_b32 v224, 15, v1
    v_lshlrev_b32 v225, 3, v224
    v_cvt_f32_u32 v111, v225
    v_lshlrev_b32 v225, 7, v224
    v_add_u32 v225, 1024, v225
    v_cvt_f32_u32 v110, v225
    v_lshrrev_b32 v225, 3, v224
    v_and_b32 v226, 7, v224
    v_lshl_add_u32 v225, v225, 7, v226
    v_cvt_f32_u32 v108, v225
    v_lshrrev_b32 v225, 2, v224
    v_and_b32 v226, 3, v224
    v_lshl_add_u32 v225, v225, 6, v226
    v_add_u32 v225, 128, v225
    v_bfe_u32 v226, v224, 1, 2
    v_and_b32 v227, 1, v224
    v_lshl_add_u32 v226, v226, 5, v227
    v_add_u32 v226, 128, v226
    v_lshlrev_b32 v226, 1, v226
    v_cmp_gt_u32 s[44:45], 8, v224
    s_nop 1
    v_cndmask_b32 v225, v226, v225, s[44:45]
    v_cvt_f32_u32 v109, v225
    v_add_f32 v109, v109, v109
    s_waitcnt lgkmcnt(0)
    s_add_u32 m0, s69, 24576
    s_mov_b32 s38, 196608
    buffer_load_dwordx4 v4, s[12:15], s38 offen offset:0 lds
    s_lshr_b32 s44, s28, 2
    s_add_u32 m0, s69, 24576
    s_mov_b32 s38, 196608
    buffer_load_dwordx4 v4, s[12:15], s38 offen offset:1024 lds
    s_lshl_b32 s44, s44, 4
    s_add_u32 m0, s69, 24576
    s_mov_b32 s38, 196608
    buffer_load_dwordx4 v4, s[12:15], s38 offen offset:2048 lds
    s_lshr_b32 s44, s68, s44
    s_add_u32 m0, s69, 49152
    s_mov_b32 s38, 393216
    buffer_load_dwordx4 v4, s[12:15], s38 offen offset:0 lds
    s_lshl_b32 s44, s44, 16
    s_add_u32 m0, s69, 49152
    s_mov_b32 s38, 393216
    buffer_load_dwordx4 v4, s[12:15], s38 offen offset:1024 lds
    v_mov_b32 v225, s44
    s_add_u32 m0, s69, 49152
    s_mov_b32 s38, 393216
    buffer_load_dwordx4 v4, s[12:15], s38 offen offset:2048 lds
    v_mul_f32 v224, 0x3fb8aa3b, v225
    s_lshr_b32 s39, s2, 3
    v_lshlrev_b32 v214, 7, v1
    s_getpc_b64 s[40:41]
k_pc:
    s_sub_u32 s40, s40, k_pc-interleave_layers__sliding_local_dilated__ssm_conv_s4__prompt_kernel
    s_subb_u32 s41, s41, 0
    s_and_b32 s39, s39, 1
    s_lshl_b32 s39, s39, 3
    s_add_u32 s39, s39, s28
    s_lshl_b32 s39, s39, 12
    v_add_u32 v214, s39, v214
    v_min_u32 v214, k_exit-interleave_layers__sliding_local_dilated__ssm_conv_s4__prompt_kernel, v214
    s_mov_b32 exec_hi, 0
    global_load_dword v215, v214, s[40:41]
    s_mov_b32 exec_hi, -1
    v_mov_b32 v227, 0x3fb8aa3b
    v_fma_f32 v226, v225, v227, -v224
    v_mov_b32 v227, 0x32a57060
    v_fma_f32 v226, v225, v227, v226
    v_exp_f32 v224, v224
    v_mul_f32 v226, 0x3f317218, v226
    v_fma_f32 v224, v224, v226, v224
    v_cvt_pk_bf16_f32 v224, v224, v224
    v_lshlrev_b32 v224, 16, v224
    s_waitcnt vmcnt(15)
    s_or_b32 s38, s2, s28
    s_cbranch_scc1 k_nogo
    v_mov_b32 v12, 1
    buffer_store_dword v12, off, s[24:27], 0 sc1
k_nogo:
    v_mul_f32 v216, v224, v216
    v_mul_f32 v217, v224, v217
    v_mul_f32 v218, v224, v218
    v_mul_f32 v219, v224, v219
    v_mul_f32 v104, 0x3fb8aa3b, v216
    v_mul_f32 v105, 0x3e22f983, v217
    v_mul_f32 v106, v220, v218
    v_mul_f32 v107, v220, v219
    v_fma_f32 v106, -v221, v219, v106
    v_fma_f32 v107, v221, v218, v107
    v_mov_b32 v113, 0x02081cea
    v_mov_b32 v112, v104
    v_max3_f32 v113, abs(v106), abs(v107), v113
    s_nop 0
    v_max_f32_dpp v112, v112, v112 row_ror:1 row_mask:0xf bank_mask:0xf
    v_max_f32_dpp v113, v113, v113 row_ror:1 row_mask:0xf bank_mask:0xf
    s_nop 0
    v_max_f32_dpp v112, v112, v112 row_ror:2 row_mask:0xf bank_mask:0xf
    v_max_f32_dpp v113, v113, v113 row_ror:2 row_mask:0xf bank_mask:0xf
    s_nop 0
    v_max_f32_dpp v112, v112, v112 row_ror:4 row_mask:0xf bank_mask:0xf
    v_max_f32_dpp v113, v113, v113 row_ror:4 row_mask:0xf bank_mask:0xf
    v_mov_b32 v225, v112
    v_mov_b32 v226, v113
    s_nop 0
    v_permlane16_swap_b32 v112, v225
    v_permlane16_swap_b32 v113, v226
    v_max_f32 v112, v112, v225
    v_max_f32 v113, v113, v226
    v_mov_b32 v225, v112
    v_mov_b32 v226, v113
    s_nop 0
    v_permlane32_swap_b32 v112, v225
    v_permlane32_swap_b32 v113, v226
    v_max_f32 v112, v112, v225
    v_max_f32 v113, v113, v226
    v_frexp_exp_i32_f32 v225, v113
    v_sub_f32 v104, v104, v112
    v_sub_u32 v226, 0, v225
    v_cvt_f32_i32 v113, v225
    v_ldexp_f32 v106, v106, v226
    v_ldexp_f32 v107, v107, v226
    v_mul_f32_dpp v216, v104, v111 row_newbcast:0 row_mask:0xf bank_mask:0xf
    v_mul_f32_dpp v224, v105, v111 row_newbcast:0 row_mask:0xf bank_mask:0xf
    v_mul_f32_dpp v217, v104, v111 row_newbcast:1 row_mask:0xf bank_mask:0xf
    v_mul_f32_dpp v225, v105, v111 row_newbcast:1 row_mask:0xf bank_mask:0xf
    v_mul_f32_dpp v218, v104, v111 row_newbcast:2 row_mask:0xf bank_mask:0xf
    v_mul_f32_dpp v226, v105, v111 row_newbcast:2 row_mask:0xf bank_mask:0xf
    v_mul_f32_dpp v219, v104, v111 row_newbcast:3 row_mask:0xf bank_mask:0xf
    v_mul_f32_dpp v227, v105, v111 row_newbcast:3 row_mask:0xf bank_mask:0xf
    v_exp_f32 v216, v216
    v_fract_f32 v224, v224
    v_exp_f32 v217, v217
    v_fract_f32 v225, v225
    v_exp_f32 v218, v218
    v_fract_f32 v226, v226
    v_exp_f32 v219, v219
    v_fract_f32 v227, v227
    v_sin_f32 v220, v224
    v_cos_f32 v224, v224
    v_sin_f32 v221, v225
    v_cos_f32 v225, v225
    v_sin_f32 v222, v226
    v_cos_f32 v226, v226
    v_sin_f32 v223, v227
    v_cos_f32 v227, v227
    v_mul_f32_dpp v228, v106, v216 row_newbcast:0 row_mask:0xf bank_mask:0xf
    v_mul_f32_dpp v232, v107, v216 row_newbcast:0 row_mask:0xf bank_mask:0xf
    v_mul_f32_dpp v229, v106, v217 row_newbcast:1 row_mask:0xf bank_mask:0xf
    v_mul_f32_dpp v233, v107, v217 row_newbcast:1 row_mask:0xf bank_mask:0xf
    v_mul_f32_dpp v230, v106, v218 row_newbcast:2 row_mask:0xf bank_mask:0xf
    v_mul_f32_dpp v234, v107, v218 row_newbcast:2 row_mask:0xf bank_mask:0xf
    v_mul_f32_dpp v231, v106, v219 row_newbcast:3 row_mask:0xf bank_mask:0xf
    v_mul_f32_dpp v235, v107, v219 row_newbcast:3 row_mask:0xf bank_mask:0xf
    v_mul_f32 v216, v232, v220
    v_mul_f32 v232, v232, v224
    v_mul_f32 v217, v233, v221
    v_mul_f32 v233, v233, v225
    v_mul_f32 v218, v234, v222
    v_mul_f32 v234, v234, v226
    v_mul_f32 v219, v235, v223
    v_mul_f32 v235, v235, v227
    v_fma_f32 v216, v228, v224, -v216
    v_fma_f32 v232, -v228, v220, -v232
    v_fma_f32 v217, v229, v225, -v217
    v_fma_f32 v233, -v229, v221, -v233
    v_fma_f32 v218, v230, v226, -v218
    v_fma_f32 v234, -v230, v222, -v234
    v_fma_f32 v219, v231, v227, -v219
    v_fma_f32 v235, -v231, v223, -v235
    v_cvt_pk_f16_f32 v236, v216, v232
    v_cvt_pk_f16_f32 v237, v217, v233
    v_cvt_pk_f16_f32 v238, v218, v234
    v_cvt_pk_f16_f32 v239, v219, v235
    v_mul_f32_dpp v216, v104, v108 row_newbcast:0 row_mask:0xf bank_mask:0xf
    v_mul_f32_dpp v224, v105, v108 row_newbcast:0 row_mask:0xf bank_mask:0xf
    v_mul_f32_dpp v217, v104, v108 row_newbcast:1 row_mask:0xf bank_mask:0xf
    v_mul_f32_dpp v225, v105, v108 row_newbcast:1 row_mask:0xf bank_mask:0xf
    v_mul_f32_dpp v218, v104, v108 row_newbcast:2 row_mask:0xf bank_mask:0xf
    v_mul_f32_dpp v226, v105, v108 row_newbcast:2 row_mask:0xf bank_mask:0xf
    v_mul_f32_dpp v219, v104, v108 row_newbcast:3 row_mask:0xf bank_mask:0xf
    v_mul_f32_dpp v227, v105, v108 row_newbcast:3 row_mask:0xf bank_mask:0xf
    v_exp_f32 v216, v216
    v_fract_f32 v224, v224
    v_exp_f32 v217, v217
    v_fract_f32 v225, v225
    v_exp_f32 v218, v218
    v_fract_f32 v226, v226
    v_exp_f32 v219, v219
    v_fract_f32 v227, v227
    v_sin_f32 v220, v224
    v_cos_f32 v224, v224
    v_sin_f32 v221, v225
    v_cos_f32 v225, v225
    v_sin_f32 v222, v226
    v_cos_f32 v226, v226
    v_sin_f32 v223, v227
    v_cos_f32 v227, v227
    v_mul_f32 v224, v216, v224
    v_mul_f32 v220, v216, v220
    v_mul_f32 v225, v217, v225
    v_mul_f32 v221, v217, v221
    v_mul_f32 v226, v218, v226
    v_mul_f32 v222, v218, v222
    v_mul_f32 v227, v219, v227
    v_mul_f32 v223, v219, v223
    v_cvt_pk_f16_f32 v240, v224, v220
    v_cvt_pk_f16_f32 v241, v225, v221
    v_cvt_pk_f16_f32 v242, v226, v222
    v_cvt_pk_f16_f32 v243, v227, v223
    s_nop 1
    v_mfma_f32_16x16x32_f16 v[92:95], v[240:243], v[236:239], 0
    v_mul_f32_dpp v216, v104, v109 row_newbcast:0 row_mask:0xf bank_mask:0xf
    v_mul_f32_dpp v224, v105, v109 row_newbcast:0 row_mask:0xf bank_mask:0xf
    v_mul_f32_dpp v217, v104, v109 row_newbcast:1 row_mask:0xf bank_mask:0xf
    v_mul_f32_dpp v225, v105, v109 row_newbcast:1 row_mask:0xf bank_mask:0xf
    v_mul_f32_dpp v218, v104, v109 row_newbcast:2 row_mask:0xf bank_mask:0xf
    v_mul_f32_dpp v226, v105, v109 row_newbcast:2 row_mask:0xf bank_mask:0xf
    v_mul_f32_dpp v219, v104, v109 row_newbcast:3 row_mask:0xf bank_mask:0xf
    v_mul_f32_dpp v227, v105, v109 row_newbcast:3 row_mask:0xf bank_mask:0xf
    v_exp_f32 v216, v216
    v_fract_f32 v224, v224
    v_exp_f32 v217, v217
    v_fract_f32 v225, v225
    v_exp_f32 v218, v218
    v_fract_f32 v226, v226
    v_exp_f32 v219, v219
    v_fract_f32 v227, v227
    v_sin_f32 v220, v224
    v_cos_f32 v224, v224
    v_sin_f32 v221, v225
    v_cos_f32 v225, v225
    v_sin_f32 v222, v226
    v_cos_f32 v226, v226
    v_sin_f32 v223, v227
    v_cos_f32 v227, v227
    v_mul_f32 v224, v216, v224
    v_mul_f32 v220, v216, v220
    v_mul_f32 v225, v217, v225
    v_mul_f32 v221, v217, v221
    v_mul_f32 v226, v218, v226
    v_mul_f32 v222, v218, v222
    v_mul_f32 v227, v219, v227
    v_mul_f32 v223, v219, v223
    v_cvt_pk_f16_f32 v244, v224, v220
    v_cvt_pk_f16_f32 v245, v225, v221
    v_cvt_pk_f16_f32 v246, v226, v222
    v_cvt_pk_f16_f32 v247, v227, v223
    s_nop 1
    v_mfma_f32_16x16x32_f16 v[96:99], v[244:247], v[236:239], 0
    v_mul_f32_dpp v216, v104, v110 row_newbcast:0 row_mask:0xf bank_mask:0xf
    v_mul_f32_dpp v224, v105, v110 row_newbcast:0 row_mask:0xf bank_mask:0xf
    v_mul_f32_dpp v217, v104, v110 row_newbcast:1 row_mask:0xf bank_mask:0xf
    v_mul_f32_dpp v225, v105, v110 row_newbcast:1 row_mask:0xf bank_mask:0xf
    v_mul_f32_dpp v218, v104, v110 row_newbcast:2 row_mask:0xf bank_mask:0xf
    v_mul_f32_dpp v226, v105, v110 row_newbcast:2 row_mask:0xf bank_mask:0xf
    v_mul_f32_dpp v219, v104, v110 row_newbcast:3 row_mask:0xf bank_mask:0xf
    v_mul_f32_dpp v227, v105, v110 row_newbcast:3 row_mask:0xf bank_mask:0xf
    v_exp_f32 v216, v216
    v_fract_f32 v224, v224
    v_exp_f32 v217, v217
    v_fract_f32 v225, v225
    v_exp_f32 v218, v218
    v_fract_f32 v226, v226
    v_exp_f32 v219, v219
    v_fract_f32 v227, v227
    v_sin_f32 v220, v224
    v_cos_f32 v224, v224
    v_sin_f32 v221, v225
    v_cos_f32 v225, v225
    v_sin_f32 v222, v226
    v_cos_f32 v226, v226
    v_sin_f32 v223, v227
    v_cos_f32 v227, v227
    v_mul_f32 v224, v216, v224
    v_mul_f32 v220, v216, v220
    v_mul_f32 v225, v217, v225
    v_mul_f32 v221, v217, v221
    v_mul_f32 v226, v218, v226
    v_mul_f32 v222, v218, v222
    v_mul_f32 v227, v219, v227
    v_mul_f32 v223, v219, v223
    v_cvt_pk_f16_f32 v240, v224, v220
    v_cvt_pk_f16_f32 v241, v225, v221
    v_cvt_pk_f16_f32 v242, v226, v222
    v_cvt_pk_f16_f32 v243, v227, v223
    s_nop 1
    v_mfma_f32_16x16x32_f16 v[100:103], v[240:243], v[236:239], 0
    s_cmp_lt_u32 s28, 4
    s_nop 6
    s_cbranch_scc0 v_role
    v_bfe_u32 v8, v1, 1, 3
    v_lshrrev_b32 v9, 4, v1
    v_xor_b32 v8, v8, v9
    v_and_b32 v9, 15, v1
    v_lshlrev_b32 v9, 7, v9
    v_lshl_add_u32 v2, v8, 4, v9
    v_add_u32 v3, 0x10000, v2
    v_xor_b32 v10, 64, v2
    v_xor_b32 v11, 64, v3
    v_lshrrev_b32 v14, 5, v1
    v_mul_u32_u24 v14, 6144, v14
    v_bfe_u32 v8, v1, 2, 3
    v_lshl_add_u32 v14, v8, 7, v14
    v_bfe_u32 v8, v1, 3, 2
    v_xor_b32 v8, s28, v8
    v_lshl_add_u32 v14, v8, 5, v14
    v_and_b32 v8, 3, v1
    v_lshl_add_u32 v14, v8, 3, v14
    v_add_u32 v14, 81920, v14
    v_add_u32 v15, 49152, v14
    s_lshl_b32 s56, s66, 16
    s_and_b32 s57, s66, 0xffff0000
    s_lshl_b32 s58, s67, 16
    s_and_b32 s59, s67, 0xffff0000
    s_lshl_b32 s48, s28, 1
    v_mov_b32 v116, -1
    v_mov_b32 v117, -1
    v_mov_b32 v118, -1
    v_mov_b32 v119, -1
    v_lshrrev_b32 v114, 4, v1
    v_lshlrev_b32 v114, 14, v114
    v_and_b32 v115, 15, v1
    v_lshl_add_u32 v114, v115, 4, v114
    s_add_u32 s40, s48, 0
    s_lshr_b32 s42, s40, 2
    s_and_b32 s43, s40, 3
    s_lshl_b32 s39, s31, 2
    s_add_u32 s39, s39, s43
    s_lshl_b32 s39, s39, 10
    s_lshl_b32 s41, s30, 16
    s_add_u32 s39, s39, s41
    s_lshl_b32 s41, s42, 15
    s_add_u32 s39, s39, s41
    s_add_u32 s39, s39, 0
    buffer_store_dwordx4 v[116:119], v0, s[4:7], s39 offen sc1
    s_and_b32 s39, s31, 3
    s_lshl_b32 s39, s39, 19
    s_lshl_b32 s41, s30, 9
    s_add_u32 s39, s39, s41
    s_lshr_b32 s41, s31, 2
    s_lshl_b32 s41, s41, 8
    s_add_u32 s39, s39, s41
    s_add_u32 s39, s39, 4194304
    s_add_u32 s40, s48, 0
    s_lshl_b32 s42, s40, 16
    s_add_u32 s39, s39, s42
    buffer_store_dwordx4 v[116:119], v114, s[4:7], s39 offen sc1
    s_add_u32 s40, s48, 1
    s_lshr_b32 s42, s40, 2
    s_and_b32 s43, s40, 3
    s_lshl_b32 s39, s31, 2
    s_add_u32 s39, s39, s43
    s_lshl_b32 s39, s39, 10
    s_lshl_b32 s41, s30, 16
    s_add_u32 s39, s39, s41
    s_lshl_b32 s41, s42, 15
    s_add_u32 s39, s39, s41
    s_add_u32 s39, s39, 0
    buffer_store_dwordx4 v[116:119], v0, s[4:7], s39 offen sc1
    s_and_b32 s39, s31, 3
    s_lshl_b32 s39, s39, 19
    s_lshl_b32 s41, s30, 9
    s_add_u32 s39, s39, s41
    s_lshr_b32 s41, s31, 2
    s_lshl_b32 s41, s41, 8
    s_add_u32 s39, s39, s41
    s_add_u32 s39, s39, 4194304
    s_add_u32 s40, s48, 1
    s_lshl_b32 s42, s40, 16
    s_add_u32 s39, s39, s42
    buffer_store_dwordx4 v[116:119], v114, s[4:7], s39 offen sc1
    s_and_b32 s39, s31, 3
    s_lshl_b32 s39, s39, 14
    s_lshl_b32 s41, s30, 9
    s_add_u32 s39, s39, s41
    s_lshr_b32 s41, s31, 2
    s_lshl_b32 s41, s41, 8
    s_add_u32 s39, s39, s41
    s_add_u32 s39, s39, 10485760
    s_lshl_b32 s42, s48, 5
    s_add_u32 s39, s39, s42
    s_mov_b64 exec, 15
    buffer_store_dwordx4 v[116:119], v0, s[4:7], s39 offen sc1
    s_mov_b64 exec, -1
    s_waitcnt vmcnt(12)
    s_barrier
    ds_read_b64_tr_b16 v[120:121], v14 offset:0
    ds_read_b64_tr_b16 v[122:123], v14 offset:3072
    ds_read_b64_tr_b16 v[124:125], v14 offset:1024
    ds_read_b64_tr_b16 v[126:127], v14 offset:4096
    ds_read_b64_tr_b16 v[128:129], v14 offset:12288
    ds_read_b64_tr_b16 v[130:131], v14 offset:15360
    ds_read_b64_tr_b16 v[132:133], v14 offset:13312
    ds_read_b64_tr_b16 v[134:135], v14 offset:16384
    ds_read_b128 v[52:55], v2 offset:0
    ds_read_b128 v[56:59], v2 offset:16384
    ds_read_b128 v[60:63], v2 offset:32768
    ds_read_b128 v[64:67], v2 offset:49152
    ds_read_b128 v[68:71], v3 offset:0
    s_waitcnt lgkmcnt(5)
    s_waitcnt vmcnt(9)
    s_barrier
    ds_read_b64_tr_b16 v[136:137], v14 offset:24576
    ds_read_b64_tr_b16 v[138:139], v14 offset:27648
    ds_read_b64_tr_b16 v[140:141], v14 offset:25600
    ds_read_b64_tr_b16 v[142:143], v14 offset:28672
    ds_read_b64_tr_b16 v[144:145], v14 offset:36864
    ds_read_b64_tr_b16 v[146:147], v14 offset:39936
    ds_read_b64_tr_b16 v[148:149], v14 offset:37888
    ds_read_b64_tr_b16 v[150:151], v14 offset:40960
    s_add_u32 m0, s69, 0
    s_mov_b32 s38, 589824
    buffer_load_dwordx4 v4, s[12:15], s38 offen offset:0 lds
    s_add_u32 m0, s69, 0
    s_mov_b32 s38, 589824
    buffer_load_dwordx4 v4, s[12:15], s38 offen offset:1024 lds
    s_add_u32 m0, s69, 0
    s_mov_b32 s38, 589824
    buffer_load_dwordx4 v4, s[12:15], s38 offen offset:2048 lds
    s_waitcnt lgkmcnt(12)
    v_mfma_f32_16x16x32_bf16 v[16:19], v[124:127], v[52:55], 0
    v_mul_f32_dpp v216, v104, v111 row_newbcast:4 row_mask:0xf bank_mask:0xf
    v_mul_f32_dpp v224, v105, v111 row_newbcast:4 row_mask:0xf bank_mask:0xf
    v_mul_f32_dpp v217, v104, v111 row_newbcast:5 row_mask:0xf bank_mask:0xf
    v_mul_f32_dpp v225, v105, v111 row_newbcast:5 row_mask:0xf bank_mask:0xf
    v_mul_f32_dpp v218, v104, v111 row_newbcast:6 row_mask:0xf bank_mask:0xf
    v_mul_f32_dpp v226, v105, v111 row_newbcast:6 row_mask:0xf bank_mask:0xf
    v_mfma_f32_16x16x32_bf16 v[248:251], v[120:123], v[52:55], 0
    v_mul_f32_dpp v219, v104, v111 row_newbcast:7 row_mask:0xf bank_mask:0xf
    v_mul_f32_dpp v227, v105, v111 row_newbcast:7 row_mask:0xf bank_mask:0xf
    v_exp_f32 v216, v216
    v_fract_f32 v224, v224
    v_exp_f32 v217, v217
    v_fract_f32 v225, v225
    ds_read_b128 v[72:75], v10 offset:0
    v_exp_f32 v218, v218
    v_fract_f32 v226, v226
    v_exp_f32 v219, v219
    v_fract_f32 v227, v227
    v_sin_f32 v220, v224
    v_cos_f32 v224, v224
    s_waitcnt lgkmcnt(12)
    v_mfma_f32_16x16x32_bf16 v[20:23], v[124:127], v[56:59], 0
    v_sin_f32 v221, v225
    v_cos_f32 v225, v225
    v_sin_f32 v222, v226
    v_cos_f32 v226, v226
    v_sin_f32 v223, v227
    v_cos_f32 v227, v227
    ds_read_b128 v[76:79], v10 offset:16384
    v_mul_f32_dpp v228, v106, v216 row_newbcast:4 row_mask:0xf bank_mask:0xf
    v_mul_f32_dpp v232, v107, v216 row_newbcast:4 row_mask:0xf bank_mask:0xf
    v_mul_f32_dpp v229, v106, v217 row_newbcast:5 row_mask:0xf bank_mask:0xf
    v_mul_f32_dpp v233, v107, v217 row_newbcast:5 row_mask:0xf bank_mask:0xf
    s_lshl_b32 m0, s28, 10
    s_add_u32 m0, m0, 8192
    s_add_u32 s38, s3, 512
    s_bitcmp1_b32 s28, 0
    s_cselect_b32 exec_lo, -1, 0xffffff00
    buffer_load_dwordx4 v6, s[8:11], s38 offen lds
    s_mov_b32 exec_lo, -1
    v_mul_f32_dpp v230, v106, v218 row_newbcast:6 row_mask:0xf bank_mask:0xf
    v_mfma_f32_16x16x32_bf16 v[36:39], v[120:123], v[56:59], 0
    v_mul_f32_dpp v234, v107, v218 row_newbcast:6 row_mask:0xf bank_mask:0xf
    v_mul_f32_dpp v231, v106, v219 row_newbcast:7 row_mask:0xf bank_mask:0xf
    v_mul_f32_dpp v235, v107, v219 row_newbcast:7 row_mask:0xf bank_mask:0xf
    v_mul_f32 v216, v232, v220
    v_mul_f32 v232, v232, v224
    v_mul_f32 v217, v233, v221
    ds_read_b128 v[80:83], v10 offset:32768
    v_mul_f32 v233, v233, v225
    v_mul_f32 v218, v234, v222
    v_mul_f32 v234, v234, v226
    v_mul_f32 v219, v235, v223
    v_mul_f32 v235, v235, v227
    v_fma_f32 v216, v228, v224, -v216
    s_waitcnt lgkmcnt(13)
    v_mfma_f32_16x16x32_bf16 v[24:27], v[124:127], v[60:63], 0
    v_fma_f32 v232, -v228, v220, -v232
    v_fma_f32 v217, v229, v225, -v217
    v_fma_f32 v233, -v229, v221, -v233
    v_fma_f32 v218, v230, v226, -v218
    v_fma_f32 v234, -v230, v222, -v234
    v_fma_f32 v219, v231, v227, -v219
    ds_read_b128 v[84:87], v10 offset:49152
    v_fma_f32 v235, -v231, v223, -v235
    v_cvt_pk_f16_f32 v236, v216, v232
    v_cvt_pk_f16_f32 v237, v217, v233
    v_cvt_pk_f16_f32 v238, v218, v234
    v_cvt_pk_f16_f32 v239, v219, v235
    v_mul_f32_dpp v216, v104, v108 row_newbcast:4 row_mask:0xf bank_mask:0xf
    v_mfma_f32_16x16x32_bf16 v[40:43], v[120:123], v[60:63], 0
    v_mul_f32_dpp v224, v105, v108 row_newbcast:4 row_mask:0xf bank_mask:0xf
    v_mul_f32_dpp v217, v104, v108 row_newbcast:5 row_mask:0xf bank_mask:0xf
    v_mul_f32_dpp v225, v105, v108 row_newbcast:5 row_mask:0xf bank_mask:0xf
    s_lshl_b32 m0, s28, 10
    s_add_u32 m0, m0, 24576
    s_add_u32 s38, s3, 512
    buffer_load_dwordx4 v5, s[8:11], s38 offen lds
    v_mul_f32_dpp v218, v104, v108 row_newbcast:6 row_mask:0xf bank_mask:0xf
    v_mul_f32_dpp v226, v105, v108 row_newbcast:6 row_mask:0xf bank_mask:0xf
    ds_read_b128 v[88:91], v11 offset:0
    v_mul_f32_dpp v219, v104, v108 row_newbcast:7 row_mask:0xf bank_mask:0xf
    v_mul_f32_dpp v227, v105, v108 row_newbcast:7 row_mask:0xf bank_mask:0xf
    v_exp_f32 v216, v216
    v_fract_f32 v224, v224
    v_exp_f32 v217, v217
    v_fract_f32 v225, v225
    s_waitcnt lgkmcnt(14)
    v_mfma_f32_16x16x32_bf16 v[28:31], v[124:127], v[64:67], 0
    v_exp_f32 v218, v218
    v_fract_f32 v226, v226
    v_exp_f32 v219, v219
    v_fract_f32 v227, v227
    v_sin_f32 v220, v224
    v_cos_f32 v224, v224
    v_mfma_f32_16x16x32_bf16 v[44:47], v[120:123], v[64:67], 0
    v_sin_f32 v221, v225
    v_cos_f32 v225, v225
    v_sin_f32 v222, v226
    v_cos_f32 v226, v226
    v_sin_f32 v223, v227
    v_cos_f32 v227, v227
    s_waitcnt lgkmcnt(13)
    v_mfma_f32_16x16x32_bf16 v[32:35], v[124:127], v[68:71], 0
    v_mul_f32 v224, v216, v224
    v_mul_f32 v220, v216, v220
    v_mul_f32 v225, v217, v225
    v_mul_f32 v221, v217, v221
    v_mul_f32 v226, v218, v226
    v_mul_f32 v222, v218, v222
    v_mfma_f32_16x16x32_bf16 v[48:51], v[120:123], v[68:71], 0
    v_mul_f32 v227, v219, v227
    v_mul_f32 v223, v219, v223
    s_lshl_b32 m0, s28, 10
    s_add_u32 m0, m0, 40960
    s_add_u32 s38, s3, 16896
    buffer_load_dwordx4 v5, s[8:11], s38 offen lds
    v_cvt_pk_f16_f32 v240, v224, v220
    v_cvt_pk_f16_f32 v241, v225, v221
    v_cvt_pk_f16_f32 v242, v226, v222
    s_waitcnt lgkmcnt(4)
    v_mfma_f32_16x16x32_bf16 v[16:19], v[132:135], v[72:75], v[16:19]
    v_cvt_pk_f16_f32 v243, v227, v223
    s_nop 1
    v_mfma_f32_16x16x32_f16 v[92:95], v[240:243], v[236:239], v[92:95]
    v_mul_f32_dpp v216, v104, v109 row_newbcast:4 row_mask:0xf bank_mask:0xf
    v_mul_f32_dpp v224, v105, v109 row_newbcast:4 row_mask:0xf bank_mask:0xf
    v_mul_f32_dpp v217, v104, v109 row_newbcast:5 row_mask:0xf bank_mask:0xf
    v_mul_f32_dpp v225, v105, v109 row_newbcast:5 row_mask:0xf bank_mask:0xf
    v_mfma_f32_16x16x32_bf16 v[248:251], v[128:131], v[72:75], v[248:251]
    v_mul_f32_dpp v218, v104, v109 row_newbcast:6 row_mask:0xf bank_mask:0xf
    v_mul_f32_dpp v226, v105, v109 row_newbcast:6 row_mask:0xf bank_mask:0xf
    v_mul_f32_dpp v219, v104, v109 row_newbcast:7 row_mask:0xf bank_mask:0xf
    v_mul_f32_dpp v227, v105, v109 row_newbcast:7 row_mask:0xf bank_mask:0xf
    v_exp_f32 v216, v216
    v_fract_f32 v224, v224
    ds_read_b128 v[52:55], v2 offset:2048
    v_exp_f32 v217, v217
    v_fract_f32 v225, v225
    v_exp_f32 v218, v218
    v_fract_f32 v226, v226
    v_exp_f32 v219, v219
    v_fract_f32 v227, v227
    s_waitcnt lgkmcnt(4)
    v_mfma_f32_16x16x32_bf16 v[20:23], v[132:135], v[76:79], v[20:23]
    v_sin_f32 v220, v224
    v_cos_f32 v224, v224
    v_sin_f32 v221, v225
    v_cos_f32 v225, v225
    v_sin_f32 v222, v226
    ds_read_b128 v[56:59], v2 offset:18432
    v_cos_f32 v226, v226
    v_sin_f32 v223, v227
    s_lshl_b32 m0, s28, 10
    s_add_u32 m0, m0, 57344
    s_add_u32 s38, s3, 33280
    buffer_load_dwordx4 v5, s[8:11], s38 offen lds
    v_cos_f32 v227, v227
    v_mul_f32 v224, v216, v224
    v_mfma_f32_16x16x32_bf16 v[36:39], v[128:131], v[76:79], v[36:39]
    v_mul_f32 v220, v216, v220
    v_mul_f32 v225, v217, v225
    v_mul_f32 v221, v217, v221
    v_mul_f32 v226, v218, v226
    v_mul_f32 v222, v218, v222
    ds_read_b128 v[60:63], v2 offset:34816
    v_mul_f32 v227, v219, v227
    v_mul_f32 v223, v219, v223
    v_cvt_pk_f16_f32 v244, v224, v220
    v_cvt_pk_f16_f32 v245, v225, v221
    v_cvt_pk_f16_f32 v246, v226, v222
    s_waitcnt lgkmcnt(5)
    v_mfma_f32_16x16x32_bf16 v[24:27], v[132:135], v[80:83], v[24:27]
    v_cvt_pk_f16_f32 v247, v227, v223
    s_nop 1
    v_mfma_f32_16x16x32_f16 v[96:99], v[244:247], v[236:239], v[96:99]
    v_mul_f32_dpp v216, v104, v110 row_newbcast:4 row_mask:0xf bank_mask:0xf
    v_mul_f32_dpp v224, v105, v110 row_newbcast:4 row_mask:0xf bank_mask:0xf
    v_mul_f32_dpp v217, v104, v110 row_newbcast:5 row_mask:0xf bank_mask:0xf
    ds_read_b128 v[64:67], v2 offset:51200
    v_mul_f32_dpp v225, v105, v110 row_newbcast:5 row_mask:0xf bank_mask:0xf
    v_mul_f32_dpp v218, v104, v110 row_newbcast:6 row_mask:0xf bank_mask:0xf
    v_mul_f32_dpp v226, v105, v110 row_newbcast:6 row_mask:0xf bank_mask:0xf
    v_mul_f32_dpp v219, v104, v110 row_newbcast:7 row_mask:0xf bank_mask:0xf
    v_mul_f32_dpp v227, v105, v110 row_newbcast:7 row_mask:0xf bank_mask:0xf
    v_mfma_f32_16x16x32_bf16 v[40:43], v[128:131], v[80:83], v[40:43]
    v_exp_f32 v216, v216
    v_fract_f32 v224, v224
    v_exp_f32 v217, v217
    v_fract_f32 v225, v225
    v_exp_f32 v218, v218
    ds_read_b128 v[68:71], v3 offset:2048
    v_fract_f32 v226, v226
    s_lshl_b32 m0, s28, 10
    s_add_u32 m0, m0, 73728
    s_add_u32 s38, s3, 49664
    buffer_load_dwordx4 v5, s[8:11], s38 offen lds
    v_exp_f32 v219, v219
    v_fract_f32 v227, v227
    v_sin_f32 v220, v224
    s_waitcnt lgkmcnt(6)
    v_mfma_f32_16x16x32_bf16 v[28:31], v[132:135], v[84:87], v[28:31]
    v_cos_f32 v224, v224
    v_sin_f32 v221, v225
    v_cos_f32 v225, v225
    v_sin_f32 v222, v226
    v_cos_f32 v226, v226
    v_mfma_f32_16x16x32_bf16 v[44:47], v[128:131], v[84:87], v[44:47]
    v_sin_f32 v223, v227
    v_cos_f32 v227, v227
    v_mul_f32 v224, v216, v224
    v_mul_f32 v220, v216, v220
    v_mul_f32 v225, v217, v225
    s_waitcnt lgkmcnt(5)
    v_mfma_f32_16x16x32_bf16 v[32:35], v[132:135], v[88:91], v[32:35]
    v_mul_f32 v221, v217, v221
    v_mul_f32 v226, v218, v226
    v_mul_f32 v222, v218, v222
    v_mul_f32 v227, v219, v227
    v_mul_f32 v223, v219, v223
    v_mfma_f32_16x16x32_bf16 v[48:51], v[128:131], v[88:91], v[48:51]
    v_cvt_pk_f16_f32 v240, v224, v220
    v_cvt_pk_f16_f32 v241, v225, v221
    v_cvt_pk_f16_f32 v242, v226, v222
    v_cvt_pk_f16_f32 v243, v227, v223
    s_nop 1
    v_mfma_f32_16x16x32_f16 v[100:103], v[240:243], v[236:239], v[100:103]
    s_waitcnt vmcnt(14)
    s_barrier
    ds_read_b64_tr_b16 v[152:153], v15 offset:0
    ds_read_b64_tr_b16 v[154:155], v15 offset:3072
    ds_read_b64_tr_b16 v[156:157], v15 offset:1024
    ds_read_b64_tr_b16 v[158:159], v15 offset:4096
    ds_read_b64_tr_b16 v[160:161], v15 offset:12288
    ds_read_b64_tr_b16 v[162:163], v15 offset:15360
    ds_read_b64_tr_b16 v[164:165], v15 offset:13312
    ds_read_b64_tr_b16 v[166:167], v15 offset:16384
    s_cmp_eq_u32 s28, 0
    s_cselect_b64 exec, 1, 0
    buffer_load_dword v9, off, s[24:27], 0 sc1
    s_mov_b64 exec, -1
    s_add_u32 m0, s69, 24576
    s_mov_b32 s38, 786432
    buffer_load_dwordx4 v4, s[12:15], s38 offen offset:0 lds
    s_add_u32 m0, s69, 24576
    s_mov_b32 s38, 786432
    buffer_load_dwordx4 v4, s[12:15], s38 offen offset:1024 lds
    s_add_u32 m0, s69, 24576
    s_mov_b32 s38, 786432
    buffer_load_dwordx4 v4, s[12:15], s38 offen offset:2048 lds
    s_waitcnt lgkmcnt(12)
    v_mfma_f32_16x16x32_bf16 v[16:19], v[140:143], v[52:55], v[16:19]
    v_lshrrev_b32 v216, 4, v1
    v_and_b32 v217, 15, v1
    v_lshrrev_b32 v218, 5, v1
    v_mfma_f32_16x16x32_bf16 v[248:251], v[136:139], v[52:55], v[248:251]
    v_and_b32 v219, 1, v216
    v_lshl_add_u32 v218, v218, 5, v219
    v_lshlrev_b32 v218, 2, v218
    ds_read_b128 v[72:75], v10 offset:2048
    v_lshl_add_u32 v218, v217, 3, v218
    s_mul_i32 s46, s28, 2624
    s_add_u32 s46, s46, 131072
    s_waitcnt lgkmcnt(12)
    v_mfma_f32_16x16x32_bf16 v[20:23], v[140:143], v[56:59], v[20:23]
    v_cvt_f32_u32 v232, v218
    v_lshl_add_u32 v108, v218, 2, s46
    v_lshlrev_b32 v218, 7, v216
    ds_read_b128 v[76:79], v10 offset:18432
    v_add_u32 v218, 256, v218
    v_lshlrev_b32 v219, 8, v216
    v_max_u32 v218, v218, v219
    v_mfma_f32_16x16x32_bf16 v[36:39], v[136:139], v[56:59], v[36:39]
    v_cvt_f32_u32 v236, v218
    v_add_f32 v236, v236, v111
    v_lshlrev_b32 v218, 9, v216
    ds_read_b128 v[80:83], v10 offset:34816
    v_add_u32 v218, 1024, v218
    v_cvt_f32_u32 v240, v218
    v_add_f32 v240, v240, v111
    s_waitcnt lgkmcnt(13)
    v_mfma_f32_16x16x32_bf16 v[24:27], v[140:143], v[60:63], v[24:27]
    v_cmp_gt_u32 s[44:45], 32, v1
    s_mov_b32 s47, 0x43000000
    v_mov_b32 v220, 4.0
    ds_read_b128 v[84:87], v10 offset:51200
    v_mov_b32 v221, s47
    v_cndmask_b32 v221, v221, v220, s[44:45]
    v_cndmask_b32 v220, v220, 2.0, s[44:45]
    v_mfma_f32_16x16x32_bf16 v[40:43], v[136:139], v[60:63], v[40:43]
    v_add_u32 v110, s46, v219
    v_lshlrev_b32 v218, 3, v217
    v_lshlrev_b32 v222, 4, v217
    ds_read_b128 v[88:91], v11 offset:2048
    v_cndmask_b32 v218, v218, v222, s[44:45]
    v_add_u32 v109, v110, v218
    v_mov_b32 v222, 128
    s_waitcnt lgkmcnt(14)
    v_mfma_f32_16x16x32_bf16 v[28:31], v[140:143], v[64:67], v[28:31]
    v_cndmask_b32 v222, v222, 8, s[44:45]
    v_add_u32 v105, v109, v222
    v_lshl_add_u32 v110, v217, 2, v110
    v_mfma_f32_16x16x32_bf16 v[44:47], v[136:139], v[64:67], v[44:47]
    v_mul_f32 v222, s47, v112
    s_lshr_b32 s39, s2, 3
    v_lshlrev_b32 v12, 7, v1
    s_lshl_b32 s38, s39, 2
    s_add_u32 s38, s38, s29
    s_lshl_b32 s38, s38, 12
    s_mov_b32 exec_hi, 0
    buffer_load_dword v13, v12, s[16:19], s38 offen
    s_mov_b32 exec_hi, -1
    v_fma_f32 v232, v232, v112, v113
    s_waitcnt lgkmcnt(13)
    v_mfma_f32_16x16x32_bf16 v[32:35], v[140:143], v[68:71], v[32:35]
    v_fma_f32 v236, v236, v112, v113
    v_fma_f32 v240, v240, v112, v113
    v_add_f32 v233, v232, v112
    v_mfma_f32_16x16x32_bf16 v[48:51], v[136:139], v[68:71], v[48:51]
    v_fma_f32 v234, 2.0, v112, v232
    v_fma_f32 v237, v220, v112, v236
    s_waitcnt lgkmcnt(4)
    v_mfma_f32_16x16x32_bf16 v[16:19], v[148:151], v[72:75], v[16:19]
    v_fma_f32 v238, v221, v112, v236
    v_add_f32 v241, v240, v222
    v_mfma_f32_16x16x32_bf16 v[248:251], v[144:147], v[72:75], v[248:251]
    v_fma_f32 v242, 2.0, v222, v240
    v_add_f32 v235, v234, v112
    ds_read_b128 v[52:55], v2 offset:4096
    v_fma_f32 v239, v220, v112, v238
    v_add_f32 v243, v242, v222
    s_waitcnt lgkmcnt(4)
    v_mfma_f32_16x16x32_bf16 v[20:23], v[148:151], v[76:79], v[20:23]
    v_exp_f32 v232, v232
    v_exp_f32 v233, v233
    ds_read_b128 v[56:59], v2 offset:20480
    v_exp_f32 v234, v234
    v_exp_f32 v235, v235
    v_mfma_f32_16x16x32_bf16 v[36:39], v[144:147], v[76:79], v[36:39]
    v_exp_f32 v236, v236
    v_exp_f32 v237, v237
    ds_read_b128 v[60:63], v2 offset:36864
    v_exp_f32 v238, v238
    v_exp_f32 v239, v239
    s_waitcnt lgkmcnt(5)
    v_mfma_f32_16x16x32_bf16 v[24:27], v[148:151], v[80:83], v[24:27]
    v_exp_f32 v240, v240
    v_exp_f32 v241, v241
    ds_read_b128 v[64:67], v2 offset:53248
    v_exp_f32 v242, v242
    v_exp_f32 v243, v243
    v_mfma_f32_16x16x32_bf16 v[40:43], v[144:147], v[80:83], v[40:43]
    v_mul_f32 v92, v92, v232
    v_mul_f32 v93, v93, v233
    ds_read_b128 v[68:71], v3 offset:4096
    v_mul_f32 v94, v94, v234
    v_mul_f32 v95, v95, v235
    s_waitcnt lgkmcnt(6)
    v_mfma_f32_16x16x32_bf16 v[28:31], v[148:151], v[84:87], v[28:31]
    v_mul_f32 v96, v96, v236
    v_mul_f32 v97, v97, v237
    v_mfma_f32_16x16x32_bf16 v[44:47], v[144:147], v[84:87], v[44:47]
    v_mul_f32 v98, v98, v238
    v_mul_f32 v99, v99, v239
    s_waitcnt lgkmcnt(5)
    v_mfma_f32_16x16x32_bf16 v[32:35], v[148:151], v[88:91], v[32:35]
    v_mul_f32 v100, v100, v240
    v_mul_f32 v101, v101, v241
    v_mfma_f32_16x16x32_bf16 v[48:51], v[144:147], v[88:91], v[48:51]
    v_mul_f32 v102, v102, v242
    v_mul_f32 v103, v103, v243
    s_waitcnt vmcnt(10)
    s_barrier
    ds_read_b64_tr_b16 v[168:169], v14 offset:0
    ds_read_b64_tr_b16 v[170:171], v14 offset:3072
    ds_read_b64_tr_b16 v[172:173], v14 offset:1024
    ds_read_b64_tr_b16 v[174:175], v14 offset:4096
    ds_read_b64_tr_b16 v[176:177], v14 offset:12288
    ds_read_b64_tr_b16 v[178:179], v14 offset:15360
    ds_read_b64_tr_b16 v[180:181], v14 offset:13312
    ds_read_b64_tr_b16 v[182:183], v14 offset:16384
    s_add_u32 m0, s69, 49152
    s_mov_b32 s38, 983040
    buffer_load_dwordx4 v4, s[12:15], s38 offen offset:0 lds
    s_add_u32 m0, s69, 49152
    s_mov_b32 s38, 983040
    buffer_load_dwordx4 v4, s[12:15], s38 offen offset:1024 lds
    s_add_u32 m0, s69, 49152
    s_mov_b32 s38, 983040
    buffer_load_dwordx4 v4, s[12:15], s38 offen offset:2048 lds
    s_waitcnt lgkmcnt(12)
    v_mfma_f32_16x16x32_bf16 v[16:19], v[156:159], v[52:55], v[16:19]
    v_mfma_f32_16x16x32_bf16 v[248:251], v[152:155], v[52:55], v[248:251]
    ds_read_b128 v[72:75], v10 offset:4096
    s_waitcnt lgkmcnt(12)
    v_mfma_f32_16x16x32_bf16 v[20:23], v[156:159], v[56:59], v[20:23]
    ds_read_b128 v[76:79], v10 offset:20480
    v_mfma_f32_16x16x32_bf16 v[36:39], v[152:155], v[56:59], v[36:39]
    ds_read_b128 v[80:83], v10 offset:36864
    s_waitcnt lgkmcnt(13)
    v_mfma_f32_16x16x32_bf16 v[24:27], v[156:159], v[60:63], v[24:27]
    ds_read_b128 v[84:87], v10 offset:53248
    v_mfma_f32_16x16x32_bf16 v[40:43], v[152:155], v[60:63], v[40:43]
    ds_read_b128 v[88:91], v11 offset:4096
    s_waitcnt lgkmcnt(14)
    v_mfma_f32_16x16x32_bf16 v[28:31], v[156:159], v[64:67], v[28:31]
    v_mfma_f32_16x16x32_bf16 v[44:47], v[152:155], v[64:67], v[44:47]
    s_waitcnt lgkmcnt(13)
    v_mfma_f32_16x16x32_bf16 v[32:35], v[156:159], v[68:71], v[32:35]
    v_mfma_f32_16x16x32_bf16 v[48:51], v[152:155], v[68:71], v[48:51]
    s_waitcnt lgkmcnt(4)
    v_mfma_f32_16x16x32_bf16 v[16:19], v[164:167], v[72:75], v[16:19]
    v_mfma_f32_16x16x32_bf16 v[248:251], v[160:163], v[72:75], v[248:251]
    ds_read_b128 v[52:55], v2 offset:6144
    s_waitcnt lgkmcnt(4)
    v_mfma_f32_16x16x32_bf16 v[20:23], v[164:167], v[76:79], v[20:23]
    ds_read_b128 v[56:59], v2 offset:22528
    v_mfma_f32_16x16x32_bf16 v[36:39], v[160:163], v[76:79], v[36:39]
    ds_read_b128 v[60:63], v2 offset:38912
    s_waitcnt lgkmcnt(5)
    v_mfma_f32_16x16x32_bf16 v[24:27], v[164:167], v[80:83], v[24:27]
    ds_read_b128 v[64:67], v2 offset:55296
    v_mfma_f32_16x16x32_bf16 v[40:43], v[160:163], v[80:83], v[40:43]
    ds_read_b128 v[68:71], v3 offset:6144
    s_waitcnt lgkmcnt(6)
    v_mfma_f32_16x16x32_bf16 v[28:31], v[164:167], v[84:87], v[28:31]
    v_mfma_f32_16x16x32_bf16 v[44:47], v[160:163], v[84:87], v[44:47]
    s_waitcnt lgkmcnt(5)
    v_mfma_f32_16x16x32_bf16 v[32:35], v[164:167], v[88:91], v[32:35]
    v_mfma_f32_16x16x32_bf16 v[48:51], v[160:163], v[88:91], v[48:51]
    s_waitcnt vmcnt(4)
    s_barrier
    ds_read_b64_tr_b16 v[184:185], v14 offset:24576
    ds_read_b64_tr_b16 v[186:187], v14 offset:27648
    ds_read_b64_tr_b16 v[188:189], v14 offset:25600
    ds_read_b64_tr_b16 v[190:191], v14 offset:28672
    ds_read_b64_tr_b16 v[192:193], v14 offset:36864
    ds_read_b64_tr_b16 v[194:195], v14 offset:39936
    ds_read_b64_tr_b16 v[196:197], v14 offset:37888
    ds_read_b64_tr_b16 v[198:199], v14 offset:40960
    v_readfirstlane_b32 s38, v9
    s_or_b32 s38, s38, s28
    s_cbranch_scc1 p_go_x
p_go:
    s_sleep 4
    buffer_load_dword v9, off, s[24:27], 0 sc1
    s_add_u32 s38, s38, 1
    s_waitcnt vmcnt(0)
    v_cmp_eq_u32 vcc, 0, v9
    s_cmp_gt_u32 s38, 131072
    s_cbranch_scc1 p_go_x
    s_cbranch_vccnz p_go
    s_nop 1
p_go_x:
    s_cmp_eq_u32 s28, 0
    s_cselect_b64 exec, 1, 0
    s_lshr_b32 s38, s2, 3
    s_lshl_b32 s38, s38, 5
    s_and_b32 s39, s2, 7
    s_add_u32 s38, s38, s39
    s_lshl_b32 s38, s38, 2
    s_add_u32 s38, s38, 0x00d00000
    v_mov_b32 v8, 1
    buffer_store_dword v8, off, s[4:7], s38 sc1
    s_mov_b64 exec, -1
    s_add_u32 m0, s69, 0
    s_mov_b32 s38, 1179648
    buffer_load_dwordx4 v4, s[12:15], s38 offen offset:0 lds
    s_add_u32 m0, s69, 0
    s_mov_b32 s38, 1179648
    buffer_load_dwordx4 v4, s[12:15], s38 offen offset:1024 lds
    s_add_u32 m0, s69, 0
    s_mov_b32 s38, 1179648
    buffer_load_dwordx4 v4, s[12:15], s38 offen offset:2048 lds
    s_waitcnt lgkmcnt(12)
    v_mfma_f32_16x16x32_bf16 v[16:19], v[172:175], v[52:55], v[16:19]
    v_mfma_f32_16x16x32_bf16 v[248:251], v[168:171], v[52:55], v[248:251]
    ds_read_b128 v[72:75], v10 offset:6144
    s_waitcnt lgkmcnt(12)
    v_mfma_f32_16x16x32_bf16 v[20:23], v[172:175], v[56:59], v[20:23]
    ds_read_b128 v[76:79], v10 offset:22528
    v_mfma_f32_16x16x32_bf16 v[36:39], v[168:171], v[56:59], v[36:39]
    ds_read_b128 v[80:83], v10 offset:38912
    s_waitcnt lgkmcnt(13)
    v_mfma_f32_16x16x32_bf16 v[24:27], v[172:175], v[60:63], v[24:27]
    ds_read_b128 v[84:87], v10 offset:55296
    v_mfma_f32_16x16x32_bf16 v[40:43], v[168:171], v[60:63], v[40:43]
    ds_read_b128 v[88:91], v11 offset:6144
    s_waitcnt lgkmcnt(14)
    v_mfma_f32_16x16x32_bf16 v[28:31], v[172:175], v[64:67], v[28:31]
    v_mfma_f32_16x16x32_bf16 v[44:47], v[168:171], v[64:67], v[44:47]
    s_waitcnt lgkmcnt(13)
    v_mfma_f32_16x16x32_bf16 v[32:35], v[172:175], v[68:71], v[32:35]
    v_mfma_f32_16x16x32_bf16 v[48:51], v[168:171], v[68:71], v[48:51]
    s_waitcnt lgkmcnt(4)
    v_mfma_f32_16x16x32_bf16 v[16:19], v[180:183], v[72:75], v[16:19]
    v_mfma_f32_16x16x32_bf16 v[248:251], v[176:179], v[72:75], v[248:251]
    ds_read_b128 v[52:55], v2 offset:8192
    s_waitcnt lgkmcnt(4)
    v_mfma_f32_16x16x32_bf16 v[20:23], v[180:183], v[76:79], v[20:23]
    ds_read_b128 v[56:59], v2 offset:24576
    v_mfma_f32_16x16x32_bf16 v[36:39], v[176:179], v[76:79], v[36:39]
    ds_read_b128 v[60:63], v2 offset:40960
    s_waitcnt lgkmcnt(5)
    v_mfma_f32_16x16x32_bf16 v[24:27], v[180:183], v[80:83], v[24:27]
    ds_read_b128 v[64:67], v2 offset:57344
    v_mfma_f32_16x16x32_bf16 v[40:43], v[176:179], v[80:83], v[40:43]
    ds_read_b128 v[68:71], v3 offset:8192
    s_waitcnt lgkmcnt(6)
    v_mfma_f32_16x16x32_bf16 v[28:31], v[180:183], v[84:87], v[28:31]
    v_mfma_f32_16x16x32_bf16 v[44:47], v[176:179], v[84:87], v[44:47]
    s_waitcnt lgkmcnt(5)
    v_mfma_f32_16x16x32_bf16 v[32:35], v[180:183], v[88:91], v[32:35]
    v_mfma_f32_16x16x32_bf16 v[48:51], v[176:179], v[88:91], v[48:51]
    s_waitcnt vmcnt(4)
    s_barrier
    ds_read_b64_tr_b16 v[200:201], v15 offset:0
    ds_read_b64_tr_b16 v[202:203], v15 offset:3072
    ds_read_b64_tr_b16 v[204:205], v15 offset:1024
    ds_read_b64_tr_b16 v[206:207], v15 offset:4096
    ds_read_b64_tr_b16 v[208:209], v15 offset:12288
    ds_read_b64_tr_b16 v[210:211], v15 offset:15360
    ds_read_b64_tr_b16 v[212:213], v15 offset:13312
    ds_read_b64_tr_b16 v[214:215], v15 offset:16384
    s_add_u32 m0, s69, 24576
    s_mov_b32 s38, 1376256
    buffer_load_dwordx4 v4, s[12:15], s38 offen offset:0 lds
    s_add_u32 m0, s69, 24576
    s_mov_b32 s38, 1376256
    buffer_load_dwordx4 v4, s[12:15], s38 offen offset:1024 lds
    s_add_u32 m0, s69, 24576
    s_mov_b32 s38, 1376256
    buffer_load_dwordx4 v4, s[12:15], s38 offen offset:2048 lds
    s_waitcnt lgkmcnt(12)
    v_mfma_f32_16x16x32_bf16 v[16:19], v[188:191], v[52:55], v[16:19]
    v_mfma_f32_16x16x32_bf16 v[248:251], v[184:187], v[52:55], v[248:251]
    ds_read_b128 v[72:75], v10 offset:8192
    s_waitcnt lgkmcnt(12)
    v_mfma_f32_16x16x32_bf16 v[20:23], v[188:191], v[56:59], v[20:23]
    ds_read_b128 v[76:79], v10 offset:24576
    v_mfma_f32_16x16x32_bf16 v[36:39], v[184:187], v[56:59], v[36:39]
    ds_read_b128 v[80:83], v10 offset:40960
    s_waitcnt lgkmcnt(13)
    v_mfma_f32_16x16x32_bf16 v[24:27], v[188:191], v[60:63], v[24:27]
    ds_read_b128 v[84:87], v10 offset:57344
    v_mfma_f32_16x16x32_bf16 v[40:43], v[184:187], v[60:63], v[40:43]
    ds_read_b128 v[88:91], v11 offset:8192
    s_waitcnt lgkmcnt(14)
    v_mfma_f32_16x16x32_bf16 v[28:31], v[188:191], v[64:67], v[28:31]
    v_mfma_f32_16x16x32_bf16 v[44:47], v[184:187], v[64:67], v[44:47]
    s_waitcnt lgkmcnt(13)
    v_mfma_f32_16x16x32_bf16 v[32:35], v[188:191], v[68:71], v[32:35]
    v_mfma_f32_16x16x32_bf16 v[48:51], v[184:187], v[68:71], v[48:51]
    s_waitcnt lgkmcnt(4)
    v_mfma_f32_16x16x32_bf16 v[16:19], v[196:199], v[72:75], v[16:19]
    v_mfma_f32_16x16x32_bf16 v[248:251], v[192:195], v[72:75], v[248:251]
    ds_read_b128 v[52:55], v2 offset:10240
    s_waitcnt lgkmcnt(4)
    v_mfma_f32_16x16x32_bf16 v[20:23], v[196:199], v[76:79], v[20:23]
    ds_read_b128 v[56:59], v2 offset:26624
    v_mfma_f32_16x16x32_bf16 v[36:39], v[192:195], v[76:79], v[36:39]
    ds_read_b128 v[60:63], v2 offset:43008
    s_waitcnt lgkmcnt(5)
    v_mfma_f32_16x16x32_bf16 v[24:27], v[196:199], v[80:83], v[24:27]
    ds_read_b128 v[64:67], v2 offset:59392
    v_mfma_f32_16x16x32_bf16 v[40:43], v[192:195], v[80:83], v[40:43]
    ds_read_b128 v[68:71], v3 offset:10240
    s_waitcnt lgkmcnt(6)
    v_mfma_f32_16x16x32_bf16 v[28:31], v[196:199], v[84:87], v[28:31]
    v_mfma_f32_16x16x32_bf16 v[44:47], v[192:195], v[84:87], v[44:47]
    s_waitcnt lgkmcnt(5)
    v_mfma_f32_16x16x32_bf16 v[32:35], v[196:199], v[88:91], v[32:35]
    v_mfma_f32_16x16x32_bf16 v[48:51], v[192:195], v[88:91], v[48:51]
    s_waitcnt vmcnt(3)
    s_barrier
    ds_read_b64_tr_b16 v[216:217], v14 offset:0
    ds_read_b64_tr_b16 v[218:219], v14 offset:3072
    ds_read_b64_tr_b16 v[220:221], v14 offset:1024
    ds_read_b64_tr_b16 v[222:223], v14 offset:4096
    ds_read_b64_tr_b16 v[224:225], v14 offset:12288
    ds_read_b64_tr_b16 v[226:227], v14 offset:15360
    ds_read_b64_tr_b16 v[228:229], v14 offset:13312
    ds_read_b64_tr_b16 v[230:231], v14 offset:16384
    s_waitcnt lgkmcnt(12)
    v_mfma_f32_16x16x32_bf16 v[16:19], v[204:207], v[52:55], v[16:19]
    ds_write_b128 v108, v[92:95]
    ds_write_b64 v109, v[96:97] offset:1024
    ds_write_b64 v105, v[98:99] offset:1024
    s_mov_b32 exec_hi, 1
    ds_write_b32 v110, v100 offset:2048
    s_mov_b32 exec_hi, 0
    ds_write_b32 v110, v101 offset:2112
    ds_write_b32 v110, v102 offset:2176
    ds_write_b32 v110, v103 offset:2240
    s_mov_b32 exec_hi, -1
    v_mfma_f32_16x16x32_bf16 v[248:251], v[200:203], v[52:55], v[248:251]
    ds_read_b128 v[72:75], v10 offset:10240
    s_waitcnt lgkmcnt(15)
    v_mfma_f32_16x16x32_bf16 v[20:23], v[204:207], v[56:59], v[20:23]
    ds_read_b128 v[76:79], v10 offset:26624
    v_mfma_f32_16x16x32_bf16 v[36:39], v[200:203], v[56:59], v[36:39]
    ds_read_b128 v[80:83], v10 offset:43008
    v_mfma_f32_16x16x32_bf16 v[24:27], v[204:207], v[60:63], v[24:27]
    ds_read_b128 v[84:87], v10 offset:59392
    v_mfma_f32_16x16x32_bf16 v[40:43], v[200:203], v[60:63], v[40:43]
    ds_read_b128 v[88:91], v11 offset:10240
    v_mfma_f32_16x16x32_bf16 v[28:31], v[204:207], v[64:67], v[28:31]
    v_mfma_f32_16x16x32_bf16 v[44:47], v[200:203], v[64:67], v[44:47]
    v_mfma_f32_16x16x32_bf16 v[32:35], v[204:207], v[68:71], v[32:35]
    v_mfma_f32_16x16x32_bf16 v[48:51], v[200:203], v[68:71], v[48:51]
    s_waitcnt lgkmcnt(4)
    v_mfma_f32_16x16x32_bf16 v[16:19], v[212:215], v[72:75], v[16:19]
    v_mfma_f32_16x16x32_bf16 v[248:251], v[208:211], v[72:75], v[248:251]
    ds_read_b128 v[52:55], v2 offset:12288
    s_waitcnt lgkmcnt(4)
    v_mfma_f32_16x16x32_bf16 v[20:23], v[212:215], v[76:79], v[20:23]
    ds_read_b128 v[56:59], v2 offset:28672
    v_mfma_f32_16x16x32_bf16 v[36:39], v[208:211], v[76:79], v[36:39]
    ds_read_b128 v[60:63], v2 offset:45056
    s_waitcnt lgkmcnt(5)
    v_mfma_f32_16x16x32_bf16 v[24:27], v[212:215], v[80:83], v[24:27]
    ds_read_b128 v[64:67], v2 offset:61440
    v_mfma_f32_16x16x32_bf16 v[40:43], v[208:211], v[80:83], v[40:43]
    ds_read_b128 v[68:71], v3 offset:12288
    s_waitcnt lgkmcnt(6)
    v_mfma_f32_16x16x32_bf16 v[28:31], v[212:215], v[84:87], v[28:31]
    v_mfma_f32_16x16x32_bf16 v[44:47], v[208:211], v[84:87], v[44:47]
    s_waitcnt lgkmcnt(5)
    v_mfma_f32_16x16x32_bf16 v[32:35], v[212:215], v[88:91], v[32:35]
    v_mfma_f32_16x16x32_bf16 v[48:51], v[208:211], v[88:91], v[48:51]
    s_waitcnt lgkmcnt(0)
    s_waitcnt vmcnt(0)
    s_barrier
    ds_read_b64_tr_b16 v[232:233], v14 offset:24576
    ds_read_b64_tr_b16 v[234:235], v14 offset:27648
    ds_read_b64_tr_b16 v[236:237], v14 offset:25600
    ds_read_b64_tr_b16 v[238:239], v14 offset:28672
    ds_read_b64_tr_b16 v[240:241], v14 offset:36864
    ds_read_b64_tr_b16 v[242:243], v14 offset:39936
    ds_read_b64_tr_b16 v[244:245], v14 offset:37888
    ds_read_b64_tr_b16 v[246:247], v14 offset:40960
    v_mfma_f32_16x16x32_bf16 v[16:19], v[220:223], v[52:55], v[16:19]
    s_lshr_b32 s38, s28, 1
    s_mul_i32 s39, s38, 10496
    s_and_b32 s40, s28, 1
    v_mfma_f32_16x16x32_bf16 v[248:251], v[216:219], v[52:55], v[248:251]
    s_mul_i32 s40, s40, 1312
    s_add_u32 s39, s39, s40
    s_add_u32 s39, s39, 131072
    ds_read_b128 v[72:75], v10 offset:12288
    v_add_u32 v112, s39, v0
    ds_read_b128 v[92:95], v112 offset:0
    ds_read_b128 v[96:99], v112 offset:2624
    v_mfma_f32_16x16x32_bf16 v[20:23], v[220:223], v[56:59], v[20:23]
    ds_read_b128 v[100:103], v112 offset:5248
    ds_read_b128 v[104:107], v112 offset:7872
    s_lshl_b32 s39, s32, 1
    ds_read_b128 v[76:79], v10 offset:28672
    s_add_u32 s39, s39, s33
    s_lshl_b32 s39, s39, 1
    s_add_u32 s39, s39, s38
    v_mfma_f32_16x16x32_bf16 v[36:39], v[216:219], v[56:59], v[36:39]
    s_mul_i32 s39, s39, 2624
    s_add_u32 s39, s39, s40
    s_add_u32 s44, s39, 11534336
    ds_read_b128 v[80:83], v10 offset:45056
    s_waitcnt lgkmcnt(2)
    v_add_f32 v92, v92, v96
    v_add_f32 v100, v100, v104
    v_mfma_f32_16x16x32_bf16 v[24:27], v[220:223], v[60:63], v[24:27]
    v_add_f32 v93, v93, v97
    v_add_f32 v101, v101, v105
    v_add_f32 v94, v94, v98
    ds_read_b128 v[84:87], v10 offset:61440
    v_add_f32 v102, v102, v106
    v_add_f32 v95, v95, v99
    v_add_f32 v103, v103, v107
    v_mfma_f32_16x16x32_bf16 v[40:43], v[216:219], v[60:63], v[40:43]
    v_add_f32 v92, v92, v100
    v_add_f32 v93, v93, v101
    v_add_f32 v94, v94, v102
    ds_read_b128 v[88:91], v11 offset:12288
    v_add_f32 v95, v95, v103
    buffer_store_dwordx4 v[92:95], v0, s[4:7], s44 offen offset:0 sc1
    v_mfma_f32_16x16x32_bf16 v[28:31], v[220:223], v[64:67], v[28:31]
    ds_read_b128 v[96:99], v112 offset:1024
    ds_read_b128 v[100:103], v112 offset:3648
    v_mfma_f32_16x16x32_bf16 v[44:47], v[216:219], v[64:67], v[44:47]
    ds_read_b128 v[104:107], v112 offset:6272
    ds_read_b128 v[108:111], v112 offset:8896
    v_mfma_f32_16x16x32_bf16 v[32:35], v[220:223], v[68:71], v[32:35]
    s_waitcnt lgkmcnt(0)
    v_add_f32 v96, v96, v100
    v_mfma_f32_16x16x32_bf16 v[48:51], v[216:219], v[68:71], v[48:51]
    v_add_f32 v104, v104, v108
    v_add_f32 v97, v97, v101
    v_mfma_f32_16x16x32_bf16 v[16:19], v[228:231], v[72:75], v[16:19]
    v_add_f32 v105, v105, v109
    v_add_f32 v98, v98, v102
    v_mfma_f32_16x16x32_bf16 v[248:251], v[224:227], v[72:75], v[248:251]
    v_add_f32 v106, v106, v110
    v_add_f32 v99, v99, v103
    ds_read_b128 v[52:55], v2 offset:14336
    v_add_f32 v107, v107, v111
    v_add_f32 v96, v96, v104
    v_mfma_f32_16x16x32_bf16 v[20:23], v[228:231], v[76:79], v[20:23]
    v_add_f32 v97, v97, v105
    v_add_f32 v98, v98, v106
    ds_read_b128 v[56:59], v2 offset:30720
    v_add_f32 v99, v99, v107
    s_mov_b64 exec, 262143
    buffer_store_dwordx4 v[96:99], v0, s[4:7], s44 offen offset:1024 sc1
    s_mov_b64 exec, -1
    v_mfma_f32_16x16x32_bf16 v[36:39], v[224:227], v[76:79], v[36:39]
    v_lshrrev_b32 v112, 5, v1
    v_bfe_u32 v113, v1, 3, 2
    v_lshl_add_u32 v4, v112, 3, v113
    v_lshlrev_b32 v4, 10, v4
    v_bfe_u32 v113, v1, 1, 2
    v_lshrrev_b32 v112, 4, v1
    v_xor_b32 v113, v113, v112
    v_lshl_add_u32 v4, v113, 5, v4
    v_and_b32 v113, 1, v1
    v_lshl_add_u32 v4, v113, 4, v4
    s_and_b32 s38, s31, 3
    s_lshl_b32 s38, s38, 8
    s_lshr_b32 s39, s29, 1
    s_lshl_b32 s39, s39, 14
    s_add_u32 s38, s38, s39
    s_and_b32 s39, s29, 1
    s_lshl_b32 s39, s39, 12
    s_add_u32 s38, s38, s39
    v_add_u32 v4, s38, v4
    s_lshl_b32 s48, s28, 1
    ds_read_b128 v[60:63], v2 offset:47104
    v_mov_b32 v116, -1
    v_mov_b32 v117, -1
    v_mfma_f32_16x16x32_bf16 v[24:27], v[228:231], v[80:83], v[24:27]
    v_mov_b32 v118, -1
    v_mov_b32 v119, -1
    ds_read_b128 v[64:67], v2 offset:63488
    v_lshrrev_b32 v13, 3, v1
    v_lshlrev_b32 v13, 14, v13
    v_mfma_f32_16x16x32_bf16 v[40:43], v[224:227], v[80:83], v[40:43]
    v_and_b32 v115, 7, v1
    v_lshl_add_u32 v13, v115, 4, v13
    ds_read_b128 v[68:71], v3 offset:14336
    s_and_b32 s49, s28, 1
    s_xor_b32 s49, s49, s33
    v_mfma_f32_16x16x32_bf16 v[28:31], v[228:231], v[84:87], v[28:31]
    s_add_u32 s49, s49, s48
    s_lshl_b32 s49, s49, 18
    v_mfma_f32_16x16x32_bf16 v[44:47], v[224:227], v[84:87], v[44:47]
    s_lshl_b32 s40, s32, 7
    s_add_u32 s49, s49, s40
    v_mfma_f32_16x16x32_bf16 v[32:35], v[228:231], v[88:91], v[32:35]
    s_add_u32 s49, s49, 8388608
    buffer_store_dwordx4 v[116:119], v13, s[4:7], s49 offen sc1
    v_mfma_f32_16x16x32_bf16 v[48:51], v[224:227], v[88:91], v[48:51]
    s_add_u32 s49, s49, 131072
    buffer_store_dwordx4 v[116:119], v13, s[4:7], s49 offen sc1
    s_waitcnt lgkmcnt(0)
    s_barrier
    v_mfma_f32_16x16x32_bf16 v[16:19], v[236:239], v[52:55], v[16:19]
    s_lshl_b32 m0, s29, 11
    s_add_u32 m0, m0, 98304
    s_mov_b32 s38, 0
    buffer_load_dwordx4 v4, s[16:19], s38 offen lds
    v_mfma_f32_16x16x32_bf16 v[248:251], v[232:235], v[52:55], v[248:251]
    s_add_u32 m0, m0, 1024
    s_mov_b32 s38, 128
    buffer_load_dwordx4 v4, s[16:19], s38 offen lds
    ds_read_b128 v[72:75], v10 offset:14336
    s_add_u32 m0, m0, 7168
    s_mov_b32 s38, 32768
    buffer_load_dwordx4 v4, s[16:19], s38 offen lds
    v_mfma_f32_16x16x32_bf16 v[20:23], v[236:239], v[56:59], v[20:23]
    s_add_u32 m0, m0, 1024
    s_mov_b32 s38, 32896
    buffer_load_dwordx4 v4, s[16:19], s38 offen lds
    ds_read_b128 v[76:79], v10 offset:30720
    s_add_u32 m0, m0, 7168
    s_mov_b32 s38, 65536
    buffer_load_dwordx4 v4, s[16:19], s38 offen lds
    v_mfma_f32_16x16x32_bf16 v[36:39], v[232:235], v[56:59], v[36:39]
    s_add_u32 m0, m0, 1024
    s_mov_b32 s38, 65664
    buffer_load_dwordx4 v4, s[16:19], s38 offen lds
    ds_read_b128 v[80:83], v10 offset:47104
    s_add_u32 m0, m0, 7168
    s_mov_b32 s38, 98304
    buffer_load_dwordx4 v4, s[16:19], s38 offen lds
    v_mfma_f32_16x16x32_bf16 v[24:27], v[236:239], v[60:63], v[24:27]
    s_add_u32 m0, m0, 1024
    s_mov_b32 s38, 98432
    buffer_load_dwordx4 v4, s[16:19], s38 offen lds
    ds_read_b128 v[84:87], v10 offset:63488
    s_add_u32 m0, m0, 7168
    s_mov_b32 s38, 131072
    buffer_load_dwordx4 v4, s[16:19], s38 offen lds
    v_mfma_f32_16x16x32_bf16 v[40:43], v[232:235], v[60:63], v[40:43]
    s_add_u32 m0, m0, 1024
    s_mov_b32 s38, 131200
    buffer_load_dwordx4 v4, s[16:19], s38 offen lds
    ds_read_b128 v[88:91], v11 offset:14336
    s_add_u32 m0, m0, 7168
    s_mov_b32 s38, 163840
    buffer_load_dwordx4 v4, s[16:19], s38 offen lds
    v_mfma_f32_16x16x32_bf16 v[28:31], v[236:239], v[64:67], v[28:31]
    s_add_u32 m0, m0, 1024
    s_mov_b32 s38, 163968
    buffer_load_dwordx4 v4, s[16:19], s38 offen lds
    v_mfma_f32_16x16x32_bf16 v[44:47], v[232:235], v[64:67], v[44:47]
    v_mfma_f32_16x16x32_bf16 v[32:35], v[236:239], v[68:71], v[32:35]
    v_mfma_f32_16x16x32_bf16 v[48:51], v[232:235], v[68:71], v[48:51]
    s_waitcnt lgkmcnt(4)
    v_mfma_f32_16x16x32_bf16 v[16:19], v[244:247], v[72:75], v[16:19]
    v_mfma_f32_16x16x32_bf16 v[248:251], v[240:243], v[72:75], v[248:251]
    s_waitcnt lgkmcnt(3)
    v_mfma_f32_16x16x32_bf16 v[20:23], v[244:247], v[76:79], v[20:23]
    v_mfma_f32_16x16x32_bf16 v[36:39], v[240:243], v[76:79], v[36:39]
    s_waitcnt lgkmcnt(2)
    v_mfma_f32_16x16x32_bf16 v[24:27], v[244:247], v[80:83], v[24:27]
    v_mfma_f32_16x16x32_bf16 v[40:43], v[240:243], v[80:83], v[40:43]
    s_waitcnt lgkmcnt(1)
    v_mfma_f32_16x16x32_bf16 v[28:31], v[244:247], v[84:87], v[28:31]
    v_mfma_f32_16x16x32_bf16 v[44:47], v[240:243], v[84:87], v[44:47]
    s_waitcnt lgkmcnt(0)
    v_mfma_f32_16x16x32_bf16 v[32:35], v[244:247], v[88:91], v[32:35]
    v_mfma_f32_16x16x32_bf16 v[48:51], v[240:243], v[88:91], v[48:51]
    v_mov_b32_dpp v248, v248 row_newbcast:0 row_mask:0xf bank_mask:0xf
    v_mov_b32_dpp v116, v16 row_newbcast:0 row_mask:0xf bank_mask:0xf
    v_mov_b32_dpp v249, v249 row_newbcast:0 row_mask:0xf bank_mask:0xf
    v_mov_b32_dpp v117, v17 row_newbcast:0 row_mask:0xf bank_mask:0xf
    v_mov_b32_dpp v250, v250 row_newbcast:0 row_mask:0xf bank_mask:0xf
    v_mov_b32_dpp v118, v18 row_newbcast:0 row_mask:0xf bank_mask:0xf
    v_mov_b32_dpp v251, v251 row_newbcast:0 row_mask:0xf bank_mask:0xf
    v_mov_b32_dpp v119, v19 row_newbcast:0 row_mask:0xf bank_mask:0xf
    v_and_b32 v10, 15, v1
    v_lshrrev_b32 v11, 4, v1
    v_and_b32 v8, 1, v10
    v_lshl_add_u32 v9, v11, 2, v8
    v_cmp_eq_u32 s[60:61], 1, v8
    v_cmp_le_u32 s[62:63], v9, v10
    v_add_u32 v9, 2, v9
    v_cmp_le_u32 s[64:65], v9, v10
    v_mov_b32 v8, 0x0c0c0100
    v_mov_b32 v9, 0x01000c0c
    v_mov_b32 v7, 0x0c0c0c0c
    v_cndmask_b32 v8, v8, v9, s[60:61]
    v_cndmask_b32 v12, v8, v7, s[62:63]
    v_cndmask_b32 v14, v7, v8, s[62:63]
    v_mov_b32 v8, 0x0c0c0302
    v_mov_b32 v9, 0x03020c0c
    v_cndmask_b32 v8, v8, v9, s[60:61]
    v_cndmask_b32 v13, v8, v7, s[64:65]
    v_cndmask_b32 v15, v7, v8, s[64:65]
    v_and_b32 v7, 1, v10
    v_lshlrev_b32 v7, 4, v7
    v_lshrrev_b32 v8, 1, v10
    v_add_u32 v7, v7, v8
    v_and_b32 v8, 1, v11
    v_lshl_add_u32 v7, v8, 3, v7
    v_lshlrev_b32 v7, 4, v7
    v_lshrrev_b32 v8, 1, v11
    v_lshl_add_u32 v7, v8, 9, v7
    v_lshlrev_b32 v8, 3, v10
    v_add_u32 v8, 155648, v8
    s_mul_i32 s38, s28, 2560
    s_add_u32 s38, s38, 81920
    v_lshl_add_u32 v9, v1, 3, s38
    s_waitcnt vmcnt(0)
    s_nop 1
p_common:
    s_barrier
    ds_read_b64 v[52:53], v8 offset:0
    ds_read_b64 v[54:55], v8 offset:128
    ds_read_b64 v[56:57], v8 offset:256
    ds_read_b64 v[58:59], v8 offset:384
    ds_read_b64 v[60:61], v8 offset:512
    ds_read_b64 v[88:89], v9 offset:0
    ds_read_b64 v[90:91], v9 offset:512
    ds_read_b64 v[92:93], v9 offset:1024
    ds_read_b64 v[94:95], v9 offset:1536
    ds_read_b64 v[96:97], v9 offset:2048
    s_cmp_eq_u32 s30, 0
    s_cselect_b64 s[66:67], -1, 0
    s_waitcnt lgkmcnt(9)
    v_pk_fma_f32 v[16:17], v[116:117], v[52:53], v[16:17] op_sel_hi:[1,0,1] neg_lo:[0,1,0] neg_hi:[0,1,0]
    v_pk_fma_f32 v[18:19], v[118:119], v[52:53], v[18:19] op_sel_hi:[1,0,1] neg_lo:[0,1,0] neg_hi:[0,1,0]
    s_waitcnt lgkmcnt(8)
    v_pk_fma_f32 v[20:21], v[116:117], v[54:55], v[20:21] op_sel_hi:[1,0,1] neg_lo:[0,1,0] neg_hi:[0,1,0]
    v_pk_fma_f32 v[22:23], v[118:119], v[54:55], v[22:23] op_sel_hi:[1,0,1] neg_lo:[0,1,0] neg_hi:[0,1,0]
    v_pk_fma_f32 v[36:37], v[248:249], v[54:55], v[36:37] op_sel_hi:[1,0,1] neg_lo:[0,1,0] neg_hi:[0,1,0]
    v_pk_fma_f32 v[38:39], v[250:251], v[54:55], v[38:39] op_sel_hi:[1,0,1] neg_lo:[0,1,0] neg_hi:[0,1,0]
    s_waitcnt lgkmcnt(7)
    v_pk_fma_f32 v[24:25], v[116:117], v[56:57], v[24:25] op_sel_hi:[1,0,1] neg_lo:[0,1,0] neg_hi:[0,1,0]
    v_pk_fma_f32 v[26:27], v[118:119], v[56:57], v[26:27] op_sel_hi:[1,0,1] neg_lo:[0,1,0] neg_hi:[0,1,0]
    v_pk_fma_f32 v[40:41], v[248:249], v[56:57], v[40:41] op_sel_hi:[1,0,1] neg_lo:[0,1,0] neg_hi:[0,1,0]
    v_pk_fma_f32 v[42:43], v[250:251], v[56:57], v[42:43] op_sel_hi:[1,0,1] neg_lo:[0,1,0] neg_hi:[0,1,0]
    s_waitcnt lgkmcnt(6)
    v_pk_fma_f32 v[28:29], v[116:117], v[58:59], v[28:29] op_sel_hi:[1,0,1] neg_lo:[0,1,0] neg_hi:[0,1,0]
    v_pk_fma_f32 v[30:31], v[118:119], v[58:59], v[30:31] op_sel_hi:[1,0,1] neg_lo:[0,1,0] neg_hi:[0,1,0]
    v_pk_fma_f32 v[44:45], v[248:249], v[58:59], v[44:45] op_sel_hi:[1,0,1] neg_lo:[0,1,0] neg_hi:[0,1,0]
    v_pk_fma_f32 v[46:47], v[250:251], v[58:59], v[46:47] op_sel_hi:[1,0,1] neg_lo:[0,1,0] neg_hi:[0,1,0]
    s_waitcnt lgkmcnt(5)
    v_pk_fma_f32 v[32:33], v[116:117], v[60:61], v[32:33] op_sel_hi:[1,0,1] neg_lo:[0,1,0] neg_hi:[0,1,0]
    v_pk_fma_f32 v[34:35], v[118:119], v[60:61], v[34:35] op_sel_hi:[1,0,1] neg_lo:[0,1,0] neg_hi:[0,1,0]
    v_pk_fma_f32 v[48:49], v[248:249], v[60:61], v[48:49] op_sel_hi:[1,0,1] neg_lo:[0,1,0] neg_hi:[0,1,0]
    v_pk_fma_f32 v[50:51], v[250:251], v[60:61], v[50:51] op_sel_hi:[1,0,1] neg_lo:[0,1,0] neg_hi:[0,1,0]
    v_pk_mul_f32 v[16:17], v[16:17], v[52:53] op_sel:[0,1] op_sel_hi:[1,1]
    v_pk_mul_f32 v[18:19], v[18:19], v[52:53] op_sel:[0,1] op_sel_hi:[1,1]
    v_pk_mul_f32 v[20:21], v[20:21], v[54:55] op_sel:[0,1] op_sel_hi:[1,1]
    v_pk_mul_f32 v[22:23], v[22:23], v[54:55] op_sel:[0,1] op_sel_hi:[1,1]
    v_pk_mul_f32 v[36:37], v[36:37], v[54:55] op_sel:[0,1] op_sel_hi:[1,1]
    v_pk_mul_f32 v[38:39], v[38:39], v[54:55] op_sel:[0,1] op_sel_hi:[1,1]
    v_pk_mul_f32 v[24:25], v[24:25], v[56:57] op_sel:[0,1] op_sel_hi:[1,1]
    v_pk_mul_f32 v[26:27], v[26:27], v[56:57] op_sel:[0,1] op_sel_hi:[1,1]
    v_pk_mul_f32 v[40:41], v[40:41], v[56:57] op_sel:[0,1] op_sel_hi:[1,1]
    v_pk_mul_f32 v[42:43], v[42:43], v[56:57] op_sel:[0,1] op_sel_hi:[1,1]
    v_pk_mul_f32 v[28:29], v[28:29], v[58:59] op_sel:[0,1] op_sel_hi:[1,1]
    v_pk_mul_f32 v[30:31], v[30:31], v[58:59] op_sel:[0,1] op_sel_hi:[1,1]
    v_pk_mul_f32 v[44:45], v[44:45], v[58:59] op_sel:[0,1] op_sel_hi:[1,1]
    v_pk_mul_f32 v[46:47], v[46:47], v[58:59] op_sel:[0,1] op_sel_hi:[1,1]
    v_pk_mul_f32 v[32:33], v[32:33], v[60:61] op_sel:[0,1] op_sel_hi:[1,1]
    v_pk_mul_f32 v[34:35], v[34:35], v[60:61] op_sel:[0,1] op_sel_hi:[1,1]
    v_pk_mul_f32 v[48:49], v[48:49], v[60:61] op_sel:[0,1] op_sel_hi:[1,1]
    v_pk_mul_f32 v[50:51], v[50:51], v[60:61] op_sel:[0,1] op_sel_hi:[1,1]
    v_cvt_pk_bf16_f32 v16, v16, v17
    v_cvt_pk_bf16_f32 v17, v18, v19
    v_cvt_pk_bf16_f32 v20, v20, v21
    v_cvt_pk_bf16_f32 v21, v22, v23
    v_cvt_pk_bf16_f32 v62, v36, v37
    v_cvt_pk_bf16_f32 v63, v38, v39
    v_cvt_pk_bf16_f32 v24, v24, v25
    v_cvt_pk_bf16_f32 v25, v26, v27
    v_cvt_pk_bf16_f32 v64, v40, v41
    v_cvt_pk_bf16_f32 v65, v42, v43
    v_cvt_pk_bf16_f32 v28, v28, v29
    v_cvt_pk_bf16_f32 v29, v30, v31
    v_cvt_pk_bf16_f32 v66, v44, v45
    v_cvt_pk_bf16_f32 v67, v46, v47
    v_cvt_pk_bf16_f32 v32, v32, v33
    v_cvt_pk_bf16_f32 v33, v34, v35
    v_cvt_pk_bf16_f32 v68, v48, v49
    v_cvt_pk_bf16_f32 v69, v50, v51
    v_mfma_f32_16x16x16_bf16 v[36:39], v[20:21], v[62:63], 0
    v_mfma_f32_16x16x16_bf16 v[72:75], v[16:17], v[62:63], 0
    v_mfma_f32_16x16x16_bf16 v[40:43], v[24:25], v[64:65], 0
    v_mfma_f32_16x16x16_bf16 v[76:79], v[20:21], v[64:65], 0
    v_mfma_f32_16x16x16_bf16 v[44:47], v[28:29], v[66:67], 0
    v_mfma_f32_16x16x16_bf16 v[80:83], v[24:25], v[66:67], 0
    v_mfma_f32_16x16x16_bf16 v[48:51], v[32:33], v[68:69], 0
    v_mfma_f32_16x16x16_bf16 v[84:87], v[28:29], v[68:69], 0
    v_mov_b32 v10, 0xcf6e6b28
    s_mov_b32 s38, 0xffff0000
    s_mov_b32 s39, 0x3eb8aa3b
    v_cndmask_b32 v98, v36, v37, s[60:61]
    v_cndmask_b32 v99, v38, v39, s[60:61]
    v_cndmask_b32 v100, v72, v73, s[60:61]
    v_cndmask_b32 v101, v74, v75, s[60:61]
    v_cndmask_b32 v100, v100, v10, s[66:67]
    v_cndmask_b32 v101, v101, v10, s[66:67]
    v_cndmask_b32 v102, v40, v41, s[60:61]
    v_cndmask_b32 v103, v42, v43, s[60:61]
    v_cndmask_b32 v104, v76, v77, s[60:61]
    v_cndmask_b32 v105, v78, v79, s[60:61]
    v_cndmask_b32 v106, v44, v45, s[60:61]
    v_cndmask_b32 v107, v46, v47, s[60:61]
    v_cndmask_b32 v108, v80, v81, s[60:61]
    v_cndmask_b32 v109, v82, v83, s[60:61]
    v_cndmask_b32 v110, v48, v49, s[60:61]
    v_cndmask_b32 v111, v50, v51, s[60:61]
    v_cndmask_b32 v112, v84, v85, s[60:61]
    v_cndmask_b32 v113, v86, v87, s[60:61]
    v_cndmask_b32 v98, v100, v98, s[62:63]
    v_cndmask_b32 v99, v101, v99, s[64:65]
    v_cndmask_b32 v102, v104, v102, s[62:63]
    v_cndmask_b32 v103, v105, v103, s[64:65]
    v_cndmask_b32 v106, v108, v106, s[62:63]
    v_cndmask_b32 v107, v109, v107, s[64:65]
    v_cndmask_b32 v110, v112, v110, s[62:63]
    v_cndmask_b32 v111, v113, v111, s[64:65]
    v_cvt_pk_bf16_f32 v100, v98, v99
    v_cvt_pk_bf16_f32 v104, v102, v103
    v_cvt_pk_bf16_f32 v108, v106, v107
    v_cvt_pk_bf16_f32 v112, v110, v111
    v_lshlrev_b32 v98, 16, v100
    v_and_b32 v99, s38, v100
    v_lshlrev_b32 v102, 16, v104
    v_and_b32 v103, s38, v104
    v_lshlrev_b32 v106, 16, v108
    v_and_b32 v107, s38, v108
    v_lshlrev_b32 v110, 16, v112
    v_and_b32 v111, s38, v112
    v_max_f32 v100, v98, v99
    v_max_f32 v104, v102, v103
    v_max_f32 v108, v106, v107
    v_max_f32 v112, v110, v111
    s_lshr_b32 s40, s2, 6
    s_lshl_b32 s40, s40, 8
    s_and_b32 s41, s2, 7
    s_add_u32 s40, s40, s41
    s_lshl_b32 s40, s40, 2
    s_add_u32 s40, s40, 0x00d00000
    v_lshl_add_u32 v20, v1, 7, s40
    s_mov_b64 s[42:43], 0xff
    v_mov_b32 v16, -1
    s_cmp_eq_u32 s28, 0
    s_cselect_b64 exec, s[42:43], 0
    buffer_load_dword v16, v20, s[4:7], 0 offen sc1
    s_mov_b64 exec, -1
    v_mov_b32 v101, v100
    v_mov_b32 v105, v104
    v_mov_b32 v109, v108
    v_mov_b32 v113, v112
    v_permlane16_swap_b32 v100, v101
    v_permlane16_swap_b32 v104, v105
    v_permlane16_swap_b32 v108, v109
    v_permlane16_swap_b32 v112, v113
    v_max_f32 v100, v100, v101
    v_max_f32 v104, v104, v105
    v_max_f32 v108, v108, v109
    v_max_f32 v112, v112, v113
    v_mov_b32 v101, v100
    v_mov_b32 v105, v104
    v_mov_b32 v109, v108
    v_mov_b32 v113, v112
    v_permlane32_swap_b32 v100, v101
    v_permlane32_swap_b32 v104, v105
    v_permlane32_swap_b32 v108, v109
    v_permlane32_swap_b32 v112, v113
    v_max_f32 v100, v100, v101
    v_max_f32 v104, v104, v105
    v_max_f32 v108, v108, v109
    v_max_f32 v112, v112, v113
    v_sub_f32 v98, v98, v100
    v_sub_f32 v99, v99, v100
    v_sub_f32 v102, v102, v104
    v_sub_f32 v103, v103, v104
    v_sub_f32 v106, v106, v108
    v_sub_f32 v107, v107, v108
    v_sub_f32 v110, v110, v112
    v_sub_f32 v111, v111, v112
    v_mul_f32 v98, s39, v98
    v_mul_f32 v99, s39, v99
    v_mul_f32 v102, s39, v102
    v_mul_f32 v103, s39, v103
    v_mul_f32 v106, s39, v106
    v_mul_f32 v107, s39, v107
    v_mul_f32 v110, s39, v110
    v_mul_f32 v111, s39, v111
    v_exp_f32 v98, v98
    v_exp_f32 v99, v99
    v_exp_f32 v102, v102
    v_exp_f32 v103, v103
    v_exp_f32 v106, v106
    v_exp_f32 v107, v107
    v_exp_f32 v110, v110
    v_exp_f32 v111, v111
    v_add_f32 v100, v98, v99
    v_add_f32 v104, v102, v103
    v_add_f32 v108, v106, v107
    v_add_f32 v112, v110, v111
    v_mov_b32 v101, v100
    v_mov_b32 v105, v104
    v_mov_b32 v109, v108
    v_mov_b32 v113, v112
    v_permlane16_swap_b32 v100, v101
    v_permlane16_swap_b32 v104, v105
    v_permlane16_swap_b32 v108, v109
    v_permlane16_swap_b32 v112, v113
    v_add_f32 v100, v100, v101
    v_add_f32 v104, v104, v105
    v_add_f32 v108, v108, v109
    v_add_f32 v112, v112, v113
    v_mov_b32 v101, v100
    v_mov_b32 v105, v104
    v_mov_b32 v109, v108
    v_mov_b32 v113, v112
    v_permlane32_swap_b32 v100, v101
    v_permlane32_swap_b32 v104, v105
    v_permlane32_swap_b32 v108, v109
    v_permlane32_swap_b32 v112, v113
    v_add_f32 v100, v100, v101
    v_add_f32 v104, v104, v105
    v_add_f32 v108, v108, v109
    v_add_f32 v112, v112, v113
    v_rcp_f32 v100, v100
    v_rcp_f32 v104, v104
    v_rcp_f32 v108, v108
    v_rcp_f32 v112, v112
    v_mul_f32 v98, v98, v100
    v_mul_f32 v99, v99, v100
    v_mul_f32 v102, v102, v104
    v_mul_f32 v103, v103, v104
    v_mul_f32 v106, v106, v108
    v_mul_f32 v107, v107, v108
    v_mul_f32 v110, v110, v112
    v_mul_f32 v111, v111, v112
    v_cvt_pk_bf16_f32 v100, v98, v99
    v_cvt_pk_bf16_f32 v104, v102, v103
    v_cvt_pk_bf16_f32 v108, v106, v107
    v_cvt_pk_bf16_f32 v112, v110, v111
    s_lshl_b32 s40, s31, 2
    s_add_u32 s40, s40, s28
    s_lshl_b32 s40, s40, 10
    s_lshl_b32 s41, s30, 16
    s_add_u32 s40, s40, s41
    s_add_u32 s40, s40, s35
    v_perm_b32 v72, v100, v100, v12
    v_perm_b32 v73, v100, v100, v13
    v_perm_b32 v74, v100, v100, v14
    v_perm_b32 v75, v100, v100, v15
    v_perm_b32 v76, v104, v104, v12
    v_perm_b32 v77, v104, v104, v13
    v_perm_b32 v78, v104, v104, v14
    v_perm_b32 v79, v104, v104, v15
    v_perm_b32 v80, v108, v108, v12
    v_perm_b32 v81, v108, v108, v13
    v_perm_b32 v82, v108, v108, v14
    v_perm_b32 v83, v108, v108, v15
    v_perm_b32 v84, v112, v112, v12
    v_perm_b32 v85, v112, v112, v13
    v_perm_b32 v86, v112, v112, v14
    v_perm_b32 v87, v112, v112, v15
    s_waitcnt lgkmcnt(0)
    v_mfma_f32_16x16x32_bf16 v[36:39], v[88:91], v[72:75], 0
    v_mfma_f32_16x16x32_bf16 v[40:43], v[90:93], v[76:79], 0
    v_mfma_f32_16x16x32_bf16 v[44:47], v[92:95], v[80:83], 0
    v_mfma_f32_16x16x32_bf16 v[48:51], v[94:97], v[84:87], 0
    s_add_u32 s42, s40, 32768
    s_nop 3
    v_cvt_pk_bf16_f32 v52, v36, v37
    v_cvt_pk_bf16_f32 v53, v38, v39
    v_cvt_pk_bf16_f32 v54, v40, v41
    v_cvt_pk_bf16_f32 v55, v42, v43
    v_cvt_pk_bf16_f32 v56, v44, v45
    v_cvt_pk_bf16_f32 v57, v46, v47
    v_cvt_pk_bf16_f32 v58, v48, v49
    v_cvt_pk_bf16_f32 v59, v50, v51
    v_permlane16_swap_b32 v52, v54
    v_permlane16_swap_b32 v53, v55
    v_min_u32 v55, -2, v55
    buffer_store_dwordx4 v[52:55], v7, s[4:7], s40 offen sc1
    v_permlane16_swap_b32 v56, v58
    v_permlane16_swap_b32 v57, v59
    v_min_u32 v59, -2, v59
    buffer_store_dwordx4 v[56:59], v7, s[4:7], s42 offen sc1
    s_lshl_b32 s40, s30, 16
    s_lshr_b32 s41, s31, 2
    s_lshl_b32 s41, s41, 15
    s_add_u32 s40, s40, s41
    s_lshl_b32 s41, s28, 13
    s_add_u32 s40, s40, s41
    s_add_u32 s40, s40, s35
    s_add_u32 s42, s40, 4096
    s_add_u32 s41, s41, 81920
    v_add_u32 v10, s41, v0
    s_lshl_b32 s48, s28, 3
    s_lshr_b32 s48, 0x00050708, s48
    s_and_b32 s48, s48, 15
    s_lshl_b32 s48, s48, 8
    s_mul_i32 s49, s28, 8448
    s_add_u32 s49, s49, 114752
    s_waitcnt vmcnt(2)
    s_lshl_b32 s39, 1, s34
    v_and_b32 v16, s39, v16
    v_cmp_eq_u32 vcc, 0, v16
    s_cbranch_vccz p_flag1_x
    s_mov_b32 s38, 0
    s_mov_b64 s[46:47], s[42:43]
    s_mov_b64 s[42:43], 0xff
p_flag1:
    s_sleep 4
    s_cmp_eq_u32 s28, 0
    s_cselect_b64 exec, s[42:43], 0
    buffer_load_dword v16, v20, s[4:7], 0 offen sc1
    s_mov_b64 exec, -1
    s_add_u32 s38, s38, 1
    s_waitcnt vmcnt(0)
    s_lshl_b32 s39, 1, s34
    v_and_b32 v16, s39, v16
    v_cmp_eq_u32 vcc, 0, v16
    s_cmp_gt_u32 s38, 131072
    s_cbranch_scc1 p_flag1_y
    s_cbranch_vccnz p_flag1
p_flag1_y:
    s_mov_b64 s[42:43], s[46:47]
    s_nop 0
p_flag1_x:
    s_waitcnt vmcnt(0)
    s_barrier
    s_cmp_eq_u32 s34, 1
    s_cbranch_scc0 p_tap2
    s_mul_i32 s46, s32, 10496
    s_add_u32 s46, s46, 11534336
    s_add_u32 s46, s46, s48
    s_add_u32 m0, s49, 0
    s_add_u32 s47, s46, 0
    buffer_load_dwordx4 v0, s[4:7], s47 offen sc1 lds
    s_add_u32 m0, s49, 2112
    s_add_u32 s47, s46, 2624
    buffer_load_dwordx4 v0, s[4:7], s47 offen sc1 lds
    s_add_u32 m0, s49, 4224
    s_add_u32 s47, s46, 5248
    buffer_load_dwordx4 v0, s[4:7], s47 offen sc1 lds
    s_add_u32 m0, s49, 6336
    s_add_u32 s47, s46, 7872
    buffer_load_dwordx4 v0, s[4:7], s47 offen sc1 lds
    s_cmp_eq_u32 s28, 3
    s_cbranch_scc0 p_tap2
    s_add_u32 m0, s49, 0
    s_add_u32 s47, s46, 0
    buffer_load_dwordx4 v0, s[4:7], s47 offen offset:1024 sc1 lds
    s_add_u32 m0, s49, 2112
    s_add_u32 s47, s46, 2624
    buffer_load_dwordx4 v0, s[4:7], s47 offen offset:1024 sc1 lds
    s_add_u32 m0, s49, 4224
    s_add_u32 s47, s46, 5248
    buffer_load_dwordx4 v0, s[4:7], s47 offen offset:1024 sc1 lds
    s_add_u32 m0, s49, 6336
    s_add_u32 s47, s46, 7872
    buffer_load_dwordx4 v0, s[4:7], s47 offen offset:1024 sc1 lds
p_tap2:
    v_lshrrev_b32 v11, 1, v1
    v_lshlrev_b32 v11, 7, v11
    v_and_b32 v112, 1, v1
    v_lshl_add_u32 v11, v112, 4, v11
    v_add_u32 v11, 0x00d00000, v11
    v_mov_b32 v112, -1
    v_mov_b32 v113, -1
    v_mov_b32 v114, -1
    v_mov_b32 v115, -1
    s_cmp_eq_u32 s28, 0
    s_cselect_b64 exec, -1, 0
    buffer_load_dwordx4 v[112:115], v11, s[4:7], 0 offen sc1
    s_mov_b64 exec, -1
    s_mov_b32 s38, 0
p_opoll:
    buffer_load_dwordx4 v[16:19], v0, s[4:7], s40 offen offset:0 sc1
    buffer_load_dwordx4 v[20:23], v0, s[4:7], s40 offen offset:1024 sc1
    buffer_load_dwordx4 v[24:27], v0, s[4:7], s40 offen offset:2048 sc1
    buffer_load_dwordx4 v[28:31], v0, s[4:7], s40 offen offset:3072 sc1
    buffer_load_dwordx4 v[32:35], v0, s[4:7], s42 offen offset:0 sc1
    buffer_load_dwordx4 v[36:39], v0, s[4:7], s42 offen offset:1024 sc1
    buffer_load_dwordx4 v[40:43], v0, s[4:7], s42 offen offset:2048 sc1
    buffer_load_dwordx4 v[44:47], v0, s[4:7], s42 offen offset:3072 sc1
    s_add_u32 s38, s38, 1
    s_waitcnt vmcnt(0)
    v_max3_u32 v48, v19, v23, v27
    v_max3_u32 v48, v48, v31, v35
    v_max3_u32 v48, v48, v39, v43
    v_max_u32 v48, v48, v47
    v_cmp_eq_u32 vcc, -1, v48
    s_cmp_gt_u32 s38, 131072
    s_cbranch_scc1 p_opoll_x
    s_cbranch_vccnz p_opoll
p_opoll_x:
    s_lshl_b32 s39, 1, s34
    v_and_b32 v112, v112, v113
    v_and_b32 v114, v114, v115
    v_and_b32 v112, v112, v114
    v_and_b32 v112, s39, v112
    v_cmp_eq_u32 vcc, 0, v112
    s_cbranch_vccz p_flag2_x
    s_mov_b32 s38, 0
p_flag2:
    s_sleep 4
    s_cmp_eq_u32 s28, 0
    s_cselect_b64 exec, -1, 0
    buffer_load_dwordx4 v[112:115], v11, s[4:7], 0 offen sc1
    s_mov_b64 exec, -1
    s_add_u32 s38, s38, 1
    s_waitcnt vmcnt(0)
    s_lshl_b32 s39, 1, s34
    v_and_b32 v112, v112, v113
    v_and_b32 v114, v114, v115
    v_and_b32 v112, v112, v114
    v_and_b32 v112, s39, v112
    v_cmp_eq_u32 vcc, 0, v112
    s_cmp_gt_u32 s38, 131072
    s_cbranch_scc1 p_flag2_y
    s_cbranch_vccnz p_flag2
p_flag2_y:
    s_nop 1
p_flag2_x:
    ds_write_b128 v10, v[16:19] offset:0
    ds_write_b128 v10, v[20:23] offset:1024
    ds_write_b128 v10, v[24:27] offset:2048
    ds_write_b128 v10, v[28:31] offset:3072
    ds_write_b128 v10, v[32:35] offset:4096
    ds_write_b128 v10, v[36:39] offset:5120
    ds_write_b128 v10, v[40:43] offset:6144
    ds_write_b128 v10, v[44:47] offset:7168
    s_waitcnt lgkmcnt(0)
    s_barrier
    s_cmp_eq_u32 s34, 0
    s_cbranch_scc0 p_tap1
    s_mul_i32 s46, s32, 10496
    s_add_u32 s46, s46, 11534336
    s_add_u32 s46, s46, s48
    s_add_u32 m0, s49, 0
    s_add_u32 s47, s46, 0
    buffer_load_dwordx4 v0, s[4:7], s47 offen sc1 lds
    s_add_u32 m0, s49, 2112
    s_add_u32 s47, s46, 2624
    buffer_load_dwordx4 v0, s[4:7], s47 offen sc1 lds
    s_add_u32 m0, s49, 4224
    s_add_u32 s47, s46, 5248
    buffer_load_dwordx4 v0, s[4:7], s47 offen sc1 lds
    s_add_u32 m0, s49, 6336
    s_add_u32 s47, s46, 7872
    buffer_load_dwordx4 v0, s[4:7], s47 offen sc1 lds
    s_cmp_eq_u32 s28, 3
    s_cbranch_scc0 p_tap1
    s_add_u32 m0, s49, 0
    s_add_u32 s47, s46, 0
    buffer_load_dwordx4 v0, s[4:7], s47 offen offset:1024 sc1 lds
    s_add_u32 m0, s49, 2112
    s_add_u32 s47, s46, 2624
    buffer_load_dwordx4 v0, s[4:7], s47 offen offset:1024 sc1 lds
    s_add_u32 m0, s49, 4224
    s_add_u32 s47, s46, 5248
    buffer_load_dwordx4 v0, s[4:7], s47 offen offset:1024 sc1 lds
    s_add_u32 m0, s49, 6336
    s_add_u32 s47, s46, 7872
    buffer_load_dwordx4 v0, s[4:7], s47 offen offset:1024 sc1 lds
p_tap1:
    v_lshl_or_b32 v10, s28, 6, v1
    v_lshlrev_b32 v4, 4, v10
    s_lshl_b32 s45, s32, 14
    s_add_u32 s45, s45, s36
    v_lshl_or_b32 v108, s28, 6, v1
    v_lshlrev_b32 v108, 3, v108
    v_sub_u32 v108, 2047, v108
    s_sub_u32 s43, s49, s48
    s_sub_u32 s41, s43, 68096
    v_mov_b32 v76, 0
    v_mov_b32 v77, 0
    v_mov_b32 v78, 0
    v_mov_b32 v79, 0
    v_mul_u32_u24 v109, 2112, v1
    v_add3_u32 v109, v109, s43, -16
    v_lshrrev_b32 v110, 1, v1
    v_mul_u32_u24 v110, 4160, v110
    v_and_b32 v111, 1, v1
    v_lshl_add_u32 v110, v111, 4, v110
    s_cmp_eq_u32 s28, 3
    s_cselect_b64 exec, 15, 0
    ds_write_b128 v109, v[76:79]
    s_cselect_b32 exec_lo, 0, -1
    ds_write_b128 v110, v[76:79] offset:4096
    s_mov_b64 exec, -1
    v_subrev_u32 v28, 0, v108
    v_cvt_f32_i32 v80, v28
    v_subrev_u32 v29, 1, v108
    v_cvt_f32_i32 v81, v29
    v_cvt_pk_bf16_f32 v82, v80, v81
    v_and_b32 v80, 0xffff, v82
    v_lshrrev_b32 v81, 16, v82
    v_lshl_add_u32 v16, v80, 2, s41
    v_lshl_add_u32 v83, v28, 2, s43
    v_cmp_gt_i32 vcc, 0x80, v28
    s_nop 1
    v_cndmask_b32 v16, v16, v83, vcc
    v_lshl_add_u32 v17, v81, 2, s41
    v_lshl_add_u32 v83, v29, 2, s43
    v_cmp_gt_i32 vcc, 0x80, v29
    s_nop 1
    v_cndmask_b32 v17, v17, v83, vcc
    v_subrev_u32 v30, 2, v108
    v_cvt_f32_i32 v80, v30
    v_subrev_u32 v31, 3, v108
    v_cvt_f32_i32 v81, v31
    v_cvt_pk_bf16_f32 v82, v80, v81
    v_and_b32 v80, 0xffff, v82
    v_lshrrev_b32 v81, 16, v82
    v_lshl_add_u32 v18, v80, 2, s41
    v_lshl_add_u32 v83, v30, 2, s43
    v_cmp_gt_i32 vcc, 0x80, v30
    s_nop 1
    v_cndmask_b32 v18, v18, v83, vcc
    v_lshl_add_u32 v19, v81, 2, s41
    v_lshl_add_u32 v83, v31, 2, s43
    v_cmp_gt_i32 vcc, 0x80, v31
    s_nop 1
    v_cndmask_b32 v19, v19, v83, vcc
    v_subrev_u32 v32, 4, v108
    v_cvt_f32_i32 v80, v32
    v_subrev_u32 v33, 5, v108
    v_cvt_f32_i32 v81, v33
    v_cvt_pk_bf16_f32 v82, v80, v81
    v_and_b32 v80, 0xffff, v82
    v_lshrrev_b32 v81, 16, v82
    v_lshl_add_u32 v20, v80, 2, s41
    v_lshl_add_u32 v83, v32, 2, s43
    v_cmp_gt_i32 vcc, 0x80, v32
    s_nop 1
    v_cndmask_b32 v20, v20, v83, vcc
    v_lshl_add_u32 v21, v81, 2, s41
    v_lshl_add_u32 v83, v33, 2, s43
    v_cmp_gt_i32 vcc, 0x80, v33
    s_nop 1
    v_cndmask_b32 v21, v21, v83, vcc
    v_subrev_u32 v34, 6, v108
    v_cvt_f32_i32 v80, v34
    v_subrev_u32 v35, 7, v108
    v_cvt_f32_i32 v81, v35
    v_cvt_pk_bf16_f32 v82, v80, v81
    v_and_b32 v80, 0xffff, v82
    v_lshrrev_b32 v81, 16, v82
    v_lshl_add_u32 v22, v80, 2, s41
    v_lshl_add_u32 v83, v34, 2, s43
    v_cmp_gt_i32 vcc, 0x80, v34
    s_nop 1
    v_cndmask_b32 v22, v22, v83, vcc
    v_lshl_add_u32 v23, v81, 2, s41
    v_lshl_add_u32 v83, v35, 2, s43
    v_cmp_gt_i32 vcc, 0x80, v35
    s_nop 1
    v_cndmask_b32 v23, v23, v83, vcc
    v_subrev_u32 v36, 8, v108
    v_cvt_f32_i32 v80, v36
    v_subrev_u32 v37, 9, v108
    v_cvt_f32_i32 v81, v37
    v_cvt_pk_bf16_f32 v82, v80, v81
    v_and_b32 v80, 0xffff, v82
    v_lshrrev_b32 v81, 16, v82
    v_lshl_add_u32 v24, v80, 2, s41
    v_lshl_add_u32 v83, v36, 2, s43
    v_cmp_gt_i32 vcc, 0x80, v36
    s_nop 1
    v_cndmask_b32 v24, v24, v83, vcc
    v_lshl_add_u32 v25, v81, 2, s41
    v_lshl_add_u32 v83, v37, 2, s43
    v_cmp_gt_i32 vcc, 0x80, v37
    s_nop 1
    v_cndmask_b32 v25, v25, v83, vcc
    v_subrev_u32 v38, 10, v108
    v_cvt_f32_i32 v80, v38
    v_cvt_pk_bf16_f32 v82, v80, v81
    v_and_b32 v80, 0xffff, v82
    v_lshrrev_b32 v81, 16, v82
    v_lshl_add_u32 v26, v80, 2, s41
    v_lshl_add_u32 v83, v38, 2, s43
    v_cmp_gt_i32 vcc, 0x80, v38
    s_nop 1
    v_cndmask_b32 v26, v26, v83, vcc
    s_lshl_b32 s41, s28, 10
    v_add_u32 v108, s41, v0
    s_waitcnt vmcnt(0) lgkmcnt(0)
    ds_read_b32 v28, v16 offset:0
    ds_read_b32 v29, v17 offset:0
    ds_read_b32 v30, v18 offset:0
    ds_read_b32 v31, v19 offset:0
    ds_read_b32 v32, v20 offset:0
    ds_read_b32 v33, v21 offset:0
    ds_read_b32 v34, v22 offset:0
    ds_read_b32 v35, v23 offset:0
    ds_read_b32 v36, v24 offset:0
    ds_read_b32 v37, v25 offset:0
    ds_read_b32 v38, v26 offset:0
    ds_read_b32 v40, v16 offset:2112
    ds_read_b32 v41, v17 offset:2112
    ds_read_b32 v42, v18 offset:2112
    ds_read_b32 v43, v19 offset:2112
    ds_read_b32 v44, v20 offset:2112
    ds_read_b32 v45, v21 offset:2112
    ds_read_b32 v46, v22 offset:2112
    ds_read_b32 v47, v23 offset:2112
    ds_read_b32 v48, v24 offset:2112
    ds_read_b32 v49, v25 offset:2112
    ds_read_b32 v50, v26 offset:2112
    ds_read_b32 v52, v16 offset:4224
    ds_read_b32 v53, v17 offset:4224
    ds_read_b32 v54, v18 offset:4224
    ds_read_b32 v55, v19 offset:4224
    ds_read_b32 v56, v20 offset:4224
    ds_read_b32 v57, v21 offset:4224
    ds_read_b32 v58, v22 offset:4224
    ds_read_b32 v59, v23 offset:4224
    ds_read_b32 v60, v24 offset:4224
    ds_read_b32 v61, v25 offset:4224
    ds_read_b32 v62, v26 offset:4224
    ds_read_b32 v64, v16 offset:6336
    ds_read_b32 v65, v17 offset:6336
    ds_read_b32 v66, v18 offset:6336
    ds_read_b32 v67, v19 offset:6336
    ds_read_b32 v68, v20 offset:6336
    ds_read_b32 v69, v21 offset:6336
    ds_read_b32 v70, v22 offset:6336
    ds_read_b32 v71, v23 offset:6336
    ds_read_b32 v72, v24 offset:6336
    ds_read_b32 v73, v25 offset:6336
    ds_read_b32 v74, v26 offset:6336
    s_waitcnt lgkmcnt(15)
    v_cvt_pk_bf16_f32 v76, v31, v32
    v_cvt_pk_bf16_f32 v77, v33, v34
    v_cvt_pk_bf16_f32 v78, v35, v36
    v_cvt_pk_bf16_f32 v79, v37, v38
    ds_write_b128 v108, v[76:79] offset:0
    v_cvt_pk_bf16_f32 v80, v30, v31
    v_cvt_pk_bf16_f32 v81, v32, v33
    v_cvt_pk_bf16_f32 v82, v34, v35
    v_cvt_pk_bf16_f32 v83, v36, v37
    ds_write_b128 v108, v[80:83] offset:4160
    v_cvt_pk_bf16_f32 v84, v29, v30
    v_cvt_pk_bf16_f32 v85, v31, v32
    v_cvt_pk_bf16_f32 v86, v33, v34
    v_cvt_pk_bf16_f32 v87, v35, v36
    ds_write_b128 v108, v[84:87] offset:8320
    v_cvt_pk_bf16_f32 v88, v28, v29
    v_cvt_pk_bf16_f32 v89, v30, v31
    v_cvt_pk_bf16_f32 v90, v32, v33
    v_cvt_pk_bf16_f32 v91, v34, v35
    ds_write_b128 v108, v[88:91] offset:12480
    v_cvt_pk_bf16_f32 v92, v43, v44
    v_cvt_pk_bf16_f32 v93, v45, v46
    v_cvt_pk_bf16_f32 v94, v47, v48
    v_cvt_pk_bf16_f32 v95, v49, v50
    ds_write_b128 v108, v[92:95] offset:16640
    v_cvt_pk_bf16_f32 v96, v42, v43
    v_cvt_pk_bf16_f32 v97, v44, v45
    v_cvt_pk_bf16_f32 v98, v46, v47
    v_cvt_pk_bf16_f32 v99, v48, v49
    ds_write_b128 v108, v[96:99] offset:20800
    v_cvt_pk_bf16_f32 v100, v41, v42
    v_cvt_pk_bf16_f32 v101, v43, v44
    v_cvt_pk_bf16_f32 v102, v45, v46
    v_cvt_pk_bf16_f32 v103, v47, v48
    ds_write_b128 v108, v[100:103] offset:24960
    v_cvt_pk_bf16_f32 v104, v40, v41
    v_cvt_pk_bf16_f32 v105, v42, v43
    v_cvt_pk_bf16_f32 v106, v44, v45
    v_cvt_pk_bf16_f32 v107, v46, v47
    ds_write_b128 v108, v[104:107] offset:29120
    s_waitcnt lgkmcnt(4)
    v_cvt_pk_bf16_f32 v76, v55, v56
    v_cvt_pk_bf16_f32 v77, v57, v58
    v_cvt_pk_bf16_f32 v78, v59, v60
    v_cvt_pk_bf16_f32 v79, v61, v62
    ds_write_b128 v108, v[76:79] offset:33280
    v_cvt_pk_bf16_f32 v80, v54, v55
    v_cvt_pk_bf16_f32 v81, v56, v57
    v_cvt_pk_bf16_f32 v82, v58, v59
    v_cvt_pk_bf16_f32 v83, v60, v61
    ds_write_b128 v108, v[80:83] offset:37440
    v_cvt_pk_bf16_f32 v84, v53, v54
    v_cvt_pk_bf16_f32 v85, v55, v56
    v_cvt_pk_bf16_f32 v86, v57, v58
    v_cvt_pk_bf16_f32 v87, v59, v60
    ds_write_b128 v108, v[84:87] offset:41600
    v_cvt_pk_bf16_f32 v88, v52, v53
    v_cvt_pk_bf16_f32 v89, v54, v55
    v_cvt_pk_bf16_f32 v90, v56, v57
    v_cvt_pk_bf16_f32 v91, v58, v59
    ds_write_b128 v108, v[88:91] offset:45760
    s_waitcnt lgkmcnt(4)
    v_cvt_pk_bf16_f32 v92, v67, v68
    v_cvt_pk_bf16_f32 v93, v69, v70
    v_cvt_pk_bf16_f32 v94, v71, v72
    v_cvt_pk_bf16_f32 v95, v73, v74
    ds_write_b128 v108, v[92:95] offset:49920
    v_cvt_pk_bf16_f32 v96, v66, v67
    v_cvt_pk_bf16_f32 v97, v68, v69
    v_cvt_pk_bf16_f32 v98, v70, v71
    v_cvt_pk_bf16_f32 v99, v72, v73
    ds_write_b128 v108, v[96:99] offset:54080
    v_cvt_pk_bf16_f32 v100, v65, v66
    v_cvt_pk_bf16_f32 v101, v67, v68
    v_cvt_pk_bf16_f32 v102, v69, v70
    v_cvt_pk_bf16_f32 v103, v71, v72
    ds_write_b128 v108, v[100:103] offset:58240
    v_cvt_pk_bf16_f32 v104, v64, v65
    v_cvt_pk_bf16_f32 v105, v66, v67
    v_cvt_pk_bf16_f32 v106, v68, v69
    v_cvt_pk_bf16_f32 v107, v70, v71
    ds_write_b128 v108, v[104:107] offset:62400
    s_waitcnt lgkmcnt(4)
    v_lshl_add_u32 v5, v10, 2, 0
    v_add_u32 v5, 67072, v5
    v_and_b32 v6, 127, v10
    v_lshlrev_b32 v6, 2, v6
    v_add_u32 v6, 84992, v6
    s_cmp_eq_u32 s34, 0
    s_cbranch_scc0 p_oaddr2
    v_lshrrev_b32 v11, 3, v10
    v_lshlrev_b32 v11, 14, v11
    v_and_b32 v10, 7, v10
    v_lshl_add_u32 v11, v10, 4, v11
    s_lshl_b32 s44, s32, 7
    s_add_u32 s44, s44, 8388608
    s_branch p_oaddr3
p_oaddr2:
    v_lshlrev_b32 v11, 11, v10
    s_lshl_b32 s44, s32, 3
p_oaddr3:
    s_lshr_b32 s46, s28, 1
    s_xor_b32 s46, s46, s33
    s_lshr_b32 s47, s28, 1
    s_and_b32 s47, s47, s33
    s_mov_b32 s48, 0xffff0000
    s_mov_b32 s49, 0x3b000000
    v_mov_b32 v115, 0x3727c5ac
    v_mov_b32 v96, 0
    v_mov_b32 v97, 0
    v_mov_b32 v98, 0
    v_mov_b32 v99, 0
    s_mul_i32 s41, s28, 4608
    s_add_u32 s41, s41, 66560
    v_add_u32 v10, s41, v0
    s_waitcnt lgkmcnt(0)
    s_barrier
    s_mov_b32 exec_hi, 0
    ds_write_b128 v10, v[96:99]
    s_mov_b32 exec_hi, -1
    s_add_u32 s40, s45, 0
    buffer_load_dwordx4 v[16:19], v4, s[4:7], s40 offen sc1
    s_add_u32 s40, s37, 0
    buffer_load_dwordx4 v[32:35], v4, s[4:7], s40 offen sc1
    s_add_u32 s40, s40, 16384
    buffer_load_dwordx4 v[36:39], v4, s[4:7], s40 offen sc1
    s_add_u32 s40, s40, 16384
    buffer_load_dwordx4 v[40:43], v4, s[4:7], s40 offen sc1
    s_add_u32 s40, s40, 16384
    buffer_load_dwordx4 v[44:47], v4, s[4:7], s40 offen sc1
    s_add_u32 s40, s45, 4096
    buffer_load_dwordx4 v[20:23], v4, s[4:7], s40 offen sc1
    s_add_u32 s40, s37, 4096
    buffer_load_dwordx4 v[48:51], v4, s[4:7], s40 offen
    s_add_u32 s40, s40, 16384
    buffer_load_dwordx4 v[52:55], v4, s[4:7], s40 offen
    s_add_u32 s40, s40, 16384
    buffer_load_dwordx4 v[56:59], v4, s[4:7], s40 offen
    s_add_u32 s40, s40, 16384
    buffer_load_dwordx4 v[60:63], v4, s[4:7], s40 offen
    s_waitcnt vmcnt(5)
    v_max3_u32 v96, v19, v35, v39
    v_max3_u32 v96, v96, v43, v47
    v_cmp_eq_u32 vcc, -1, v96
    s_cbranch_vccz p_rdy0
    s_mov_b32 s38, 0
p_xpoll0:
    s_add_u32 s40, s45, 0
    buffer_load_dwordx4 v[16:19], v4, s[4:7], s40 offen sc1
    s_add_u32 s40, s37, 0
    buffer_load_dwordx4 v[32:35], v4, s[4:7], s40 offen sc1
    s_add_u32 s40, s40, 16384
    buffer_load_dwordx4 v[36:39], v4, s[4:7], s40 offen sc1
    s_add_u32 s40, s40, 16384
    buffer_load_dwordx4 v[40:43], v4, s[4:7], s40 offen sc1
    s_add_u32 s40, s40, 16384
    buffer_load_dwordx4 v[44:47], v4, s[4:7], s40 offen sc1
    s_add_u32 s38, s38, 1
    s_waitcnt vmcnt(0)
    v_max3_u32 v96, v19, v35, v39
    v_max3_u32 v96, v96, v43, v47
    v_cmp_eq_u32 vcc, -1, v96
    s_cmp_gt_u32 s38, 131072
    s_cbranch_scc1 p_xpoll0_x
    s_cbranch_vccnz p_xpoll0
p_xpoll0_x:
    s_nop 1
p_rdy0:
    v_add_f32 v32, v32, v36
    v_add_f32 v40, v40, v44
    v_add_f32 v33, v33, v37
    v_add_f32 v41, v41, v45
    v_add_f32 v34, v34, v38
    v_add_f32 v42, v42, v46
    v_add_f32 v35, v35, v39
    v_add_f32 v43, v43, v47
    v_add_f32 v32, v32, v40
    v_add_f32 v33, v33, v41
    v_add_f32 v34, v34, v42
    v_add_f32 v35, v35, v43
    v_mul_f32 v32, s49, v32
    v_fma_f32 v33, v33, s49, v115
    v_mul_f32 v34, s49, v34
    v_fma_f32 v35, v35, s49, v115
    v_fma_f32 v33, -v32, v32, v33
    v_fma_f32 v35, -v34, v34, v35
    v_max_f32 v33, v115, v33
    v_max_f32 v35, v115, v35
    v_sqrt_f32 v33, v33
    v_sqrt_f32 v35, v35
    v_lshlrev_b32 v64, 16, v16
    v_and_b32 v65, s48, v16
    v_lshlrev_b32 v66, 16, v17
    v_and_b32 v67, s48, v17
    v_lshlrev_b32 v68, 16, v18
    v_and_b32 v69, s48, v18
    v_lshlrev_b32 v70, 16, v19
    v_and_b32 v71, s48, v19
    v_cvt_pk_bf16_f32 v36, v33, v35
    v_lshlrev_b32 v33, 16, v36
    v_and_b32 v35, s48, v36
    v_rcp_f32 v33, v33
    v_rcp_f32 v35, v35
    v_sub_f32 v96, v64, v32
    v_sub_f32 v97, v65, v32
    v_sub_f32 v98, v66, v32
    v_sub_f32 v99, v67, v32
    v_sub_f32 v100, v68, v34
    v_sub_f32 v101, v69, v34
    v_sub_f32 v102, v70, v34
    v_sub_f32 v103, v71, v34
    v_mul_f32 v96, v96, v33
    v_mul_f32 v97, v97, v33
    v_mul_f32 v98, v98, v33
    v_mul_f32 v99, v99, v33
    v_mul_f32 v100, v100, v35
    v_mul_f32 v101, v101, v35
    v_mul_f32 v102, v102, v35
    v_mul_f32 v103, v103, v35
    v_cvt_pk_bf16_f32 v36, v96, v100
    v_cvt_pk_bf16_f32 v37, v97, v101
    v_cvt_pk_bf16_f32 v38, v98, v102
    v_cvt_pk_bf16_f32 v39, v99, v103
    ds_write_b32 v5, v36 offset:0
    ds_write_b32 v5, v37 offset:4608
    ds_write_b32 v5, v38 offset:9216
    ds_write_b32 v5, v39 offset:13824
    v_lshlrev_b32 v96, 16, v36
    v_and_b32 v100, s48, v36
    v_lshlrev_b32 v97, 16, v37
    v_and_b32 v101, s48, v37
    v_lshlrev_b32 v98, 16, v38
    v_and_b32 v102, s48, v38
    v_lshlrev_b32 v99, 16, v39
    v_and_b32 v103, s48, v39
    v_fma_f32 v64, v96, s56, v64
    v_fma_f32 v65, v97, s57, v65
    v_fma_f32 v66, v98, s58, v66
    v_fma_f32 v67, v99, s59, v67
    v_fma_f32 v68, v100, s56, v68
    v_fma_f32 v69, v101, s57, v69
    v_fma_f32 v70, v102, s58, v70
    v_fma_f32 v71, v103, s59, v71
    s_add_u32 s40, s45, 8192
    buffer_load_dwordx4 v[24:27], v4, s[4:7], s40 offen sc1
    s_add_u32 s40, s37, 8192
    buffer_load_dwordx4 v[32:35], v4, s[4:7], s40 offen
    s_add_u32 s40, s40, 16384
    buffer_load_dwordx4 v[36:39], v4, s[4:7], s40 offen
    s_add_u32 s40, s40, 16384
    buffer_load_dwordx4 v[40:43], v4, s[4:7], s40 offen
    s_add_u32 s40, s40, 16384
    buffer_load_dwordx4 v[44:47], v4, s[4:7], s40 offen
    s_waitcnt lgkmcnt(0)
    s_barrier
    s_waitcnt vmcnt(5)
    v_max3_u32 v96, v23, v51, v55
    v_max3_u32 v96, v96, v59, v63
    v_cmp_eq_u32 vcc, -1, v96
    s_cbranch_vccz p_rdy1
    s_mov_b32 s38, 0
p_xpoll1:
    s_add_u32 s40, s45, 4096
    buffer_load_dwordx4 v[20:23], v4, s[4:7], s40 offen sc1
    s_add_u32 s40, s37, 4096
    buffer_load_dwordx4 v[48:51], v4, s[4:7], s40 offen sc1
    s_add_u32 s40, s40, 16384
    buffer_load_dwordx4 v[52:55], v4, s[4:7], s40 offen sc1
    s_add_u32 s40, s40, 16384
    buffer_load_dwordx4 v[56:59], v4, s[4:7], s40 offen sc1
    s_add_u32 s40, s40, 16384
    buffer_load_dwordx4 v[60:63], v4, s[4:7], s40 offen sc1
    s_add_u32 s38, s38, 1
    s_waitcnt vmcnt(0)
    v_max3_u32 v96, v23, v51, v55
    v_max3_u32 v96, v96, v59, v63
    v_cmp_eq_u32 vcc, -1, v96
    s_cmp_gt_u32 s38, 131072
    s_cbranch_scc1 p_xpoll1_x
    s_cbranch_vccnz p_xpoll1
p_xpoll1_x:
    s_nop 1
p_rdy1:
    v_add_f32 v48, v48, v52
    v_add_f32 v56, v56, v60
    v_add_f32 v49, v49, v53
    v_add_f32 v57, v57, v61
    v_add_f32 v50, v50, v54
    v_add_f32 v58, v58, v62
    v_add_f32 v51, v51, v55
    v_add_f32 v59, v59, v63
    v_add_f32 v48, v48, v56
    v_add_f32 v49, v49, v57
    v_add_f32 v50, v50, v58
    v_add_f32 v51, v51, v59
    v_mul_f32 v48, s49, v48
    v_fma_f32 v49, v49, s49, v115
    v_mul_f32 v50, s49, v50
    v_fma_f32 v51, v51, s49, v115
    v_fma_f32 v49, -v48, v48, v49
    v_fma_f32 v51, -v50, v50, v51
    v_max_f32 v49, v115, v49
    v_max_f32 v51, v115, v51
    v_sqrt_f32 v49, v49
    v_sqrt_f32 v51, v51
    v_lshlrev_b32 v72, 16, v20
    v_and_b32 v73, s48, v20
    v_lshlrev_b32 v74, 16, v21
    v_and_b32 v75, s48, v21
    v_lshlrev_b32 v76, 16, v22
    v_and_b32 v77, s48, v22
    v_lshlrev_b32 v78, 16, v23
    v_and_b32 v79, s48, v23
    v_cvt_pk_bf16_f32 v52, v49, v51
    v_lshlrev_b32 v49, 16, v52
    v_and_b32 v51, s48, v52
    v_rcp_f32 v49, v49
    v_rcp_f32 v51, v51
    v_sub_f32 v96, v72, v48
    v_sub_f32 v97, v73, v48
    v_sub_f32 v98, v74, v48
    v_sub_f32 v99, v75, v48
    v_sub_f32 v100, v76, v50
    v_sub_f32 v101, v77, v50
    v_sub_f32 v102, v78, v50
    v_sub_f32 v103, v79, v50
    v_mul_f32 v96, v96, v49
    v_mul_f32 v97, v97, v49
    v_mul_f32 v98, v98, v49
    v_mul_f32 v99, v99, v49
    v_mul_f32 v100, v100, v51
    v_mul_f32 v101, v101, v51
    v_mul_f32 v102, v102, v51
    v_mul_f32 v103, v103, v51
    v_cvt_pk_bf16_f32 v52, v96, v100
    v_cvt_pk_bf16_f32 v53, v97, v101
    v_cvt_pk_bf16_f32 v54, v98, v102
    v_cvt_pk_bf16_f32 v55, v99, v103
    ds_write_b32 v5, v52 offset:1024
    ds_write_b32 v5, v53 offset:5632
    ds_write_b32 v5, v54 offset:10240
    ds_write_b32 v5, v55 offset:14848
    v_lshlrev_b32 v96, 16, v52
    v_and_b32 v100, s48, v52
    v_lshlrev_b32 v97, 16, v53
    v_and_b32 v101, s48, v53
    v_lshlrev_b32 v98, 16, v54
    v_and_b32 v102, s48, v54
    v_lshlrev_b32 v99, 16, v55
    v_and_b32 v103, s48, v55
    v_fma_f32 v72, v96, s56, v72
    v_fma_f32 v73, v97, s57, v73
    v_fma_f32 v74, v98, s58, v74
    v_fma_f32 v75, v99, s59, v75
    v_fma_f32 v76, v100, s56, v76
    v_fma_f32 v77, v101, s57, v77
    v_fma_f32 v78, v102, s58, v78
    v_fma_f32 v79, v103, s59, v79
    s_add_u32 s40, s45, 12288
    buffer_load_dwordx4 v[28:31], v4, s[4:7], s40 offen sc1
    s_add_u32 s40, s37, 12288
    buffer_load_dwordx4 v[48:51], v4, s[4:7], s40 offen
    s_add_u32 s40, s40, 16384
    buffer_load_dwordx4 v[52:55], v4, s[4:7], s40 offen
    s_add_u32 s40, s40, 16384
    buffer_load_dwordx4 v[56:59], v4, s[4:7], s40 offen
    s_add_u32 s40, s40, 16384
    buffer_load_dwordx4 v[60:63], v4, s[4:7], s40 offen
    s_waitcnt lgkmcnt(0)
    s_barrier
    s_waitcnt vmcnt(5)
    v_max3_u32 v96, v27, v35, v39
    v_max3_u32 v96, v96, v43, v47
    v_cmp_eq_u32 vcc, -1, v96
    s_cbranch_vccz p_rdy2
    s_mov_b32 s38, 0
p_xpoll2:
    s_add_u32 s40, s45, 8192
    buffer_load_dwordx4 v[24:27], v4, s[4:7], s40 offen sc1
    s_add_u32 s40, s37, 8192
    buffer_load_dwordx4 v[32:35], v4, s[4:7], s40 offen sc1
    s_add_u32 s40, s40, 16384
    buffer_load_dwordx4 v[36:39], v4, s[4:7], s40 offen sc1
    s_add_u32 s40, s40, 16384
    buffer_load_dwordx4 v[40:43], v4, s[4:7], s40 offen sc1
    s_add_u32 s40, s40, 16384
    buffer_load_dwordx4 v[44:47], v4, s[4:7], s40 offen sc1
    s_add_u32 s38, s38, 1
    s_waitcnt vmcnt(0)
    v_max3_u32 v96, v27, v35, v39
    v_max3_u32 v96, v96, v43, v47
    v_cmp_eq_u32 vcc, -1, v96
    s_cmp_gt_u32 s38, 131072
    s_cbranch_scc1 p_xpoll2_x
    s_cbranch_vccnz p_xpoll2
p_xpoll2_x:
    s_nop 1
p_rdy2:
    v_add_f32 v32, v32, v36
    v_add_f32 v40, v40, v44
    v_add_f32 v33, v33, v37
    v_add_f32 v41, v41, v45
    v_add_f32 v34, v34, v38
    v_add_f32 v42, v42, v46
    v_add_f32 v35, v35, v39
    v_add_f32 v43, v43, v47
    v_add_f32 v32, v32, v40
    v_add_f32 v33, v33, v41
    v_add_f32 v34, v34, v42
    v_add_f32 v35, v35, v43
    v_mul_f32 v32, s49, v32
    v_fma_f32 v33, v33, s49, v115
    v_mul_f32 v34, s49, v34
    v_fma_f32 v35, v35, s49, v115
    v_fma_f32 v33, -v32, v32, v33
    v_fma_f32 v35, -v34, v34, v35
    v_max_f32 v33, v115, v33
    v_max_f32 v35, v115, v35
    v_sqrt_f32 v33, v33
    v_sqrt_f32 v35, v35
    v_lshlrev_b32 v80, 16, v24
    v_and_b32 v81, s48, v24
    v_lshlrev_b32 v82, 16, v25
    v_and_b32 v83, s48, v25
    v_lshlrev_b32 v84, 16, v26
    v_and_b32 v85, s48, v26
    v_lshlrev_b32 v86, 16, v27
    v_and_b32 v87, s48, v27
    v_cvt_pk_bf16_f32 v36, v33, v35
    v_lshlrev_b32 v33, 16, v36
    v_and_b32 v35, s48, v36
    v_rcp_f32 v33, v33
    v_rcp_f32 v35, v35
    v_sub_f32 v96, v80, v32
    v_sub_f32 v97, v81, v32
    v_sub_f32 v98, v82, v32
    v_sub_f32 v99, v83, v32
    v_sub_f32 v100, v84, v34
    v_sub_f32 v101, v85, v34
    v_sub_f32 v102, v86, v34
    v_sub_f32 v103, v87, v34
    v_mul_f32 v96, v96, v33
    v_mul_f32 v97, v97, v33
    v_mul_f32 v98, v98, v33
    v_mul_f32 v99, v99, v33
    v_mul_f32 v100, v100, v35
    v_mul_f32 v101, v101, v35
    v_mul_f32 v102, v102, v35
    v_mul_f32 v103, v103, v35
    v_cvt_pk_bf16_f32 v36, v96, v100
    v_cvt_pk_bf16_f32 v37, v97, v101
    v_cvt_pk_bf16_f32 v38, v98, v102
    v_cvt_pk_bf16_f32 v39, v99, v103
    ds_write_b32 v5, v36 offset:2048
    ds_write_b32 v5, v37 offset:6656
    ds_write_b32 v5, v38 offset:11264
    ds_write_b32 v5, v39 offset:15872
    v_lshlrev_b32 v96, 16, v36
    v_and_b32 v100, s48, v36
    v_lshlrev_b32 v97, 16, v37
    v_and_b32 v101, s48, v37
    v_lshlrev_b32 v98, 16, v38
    v_and_b32 v102, s48, v38
    v_lshlrev_b32 v99, 16, v39
    v_and_b32 v103, s48, v39
    v_fma_f32 v80, v96, s56, v80
    v_fma_f32 v81, v97, s57, v81
    v_fma_f32 v82, v98, s58, v82
    v_fma_f32 v83, v99, s59, v83
    v_fma_f32 v84, v100, s56, v84
    v_fma_f32 v85, v101, s57, v85
    v_fma_f32 v86, v102, s58, v86
    v_fma_f32 v87, v103, s59, v87
    s_waitcnt vmcnt(0)
    s_xor_b32 s40, s46, 0
    s_bitcmp1_b32 s40, 0
    s_cbranch_scc1 p_noepi0
    ds_read_b32 v104, v6 offset:0
    ds_read_b32 v105, v6 offset:512
    ds_read_b32 v106, v6 offset:1024
    ds_read_b32 v107, v6 offset:1536
    s_add_u32 s40, s44, 0
    s_waitcnt lgkmcnt(0)
    v_lshlrev_b32 v96, 16, v104
    v_and_b32 v100, s48, v104
    v_lshlrev_b32 v97, 16, v105
    v_and_b32 v101, s48, v105
    v_lshlrev_b32 v98, 16, v106
    v_and_b32 v102, s48, v106
    v_lshlrev_b32 v99, 16, v107
    v_and_b32 v103, s48, v107
    v_add_f32 v96, v96, v64
    v_add_f32 v97, v97, v65
    v_add_f32 v98, v98, v66
    v_add_f32 v99, v99, v67
    v_add_f32 v100, v100, v68
    v_add_f32 v101, v101, v69
    v_add_f32 v102, v102, v70
    v_add_f32 v103, v103, v71
    v_cvt_pk_bf16_f32 v104, v96, v97
    v_cvt_pk_bf16_f32 v105, v98, v99
    v_cvt_pk_bf16_f32 v106, v100, v101
    v_cvt_pk_bf16_f32 v107, v102, v103
    s_cmp_eq_u32 s34, 0
    s_cbranch_scc0 p_epo0
    v_min_u32 v107, -2, v107
    buffer_store_dwordx4 v[104:107], v11, s[4:7], s40 offen sc1
    s_branch p_noepi0
p_epo0:
    buffer_store_dwordx2 v[104:105], v11, s[20:23], s40 offen
    buffer_store_dwordx2 v[106:107], v11, s[20:23], s40 offen offset:1024
p_noepi0:
    s_waitcnt lgkmcnt(0)
    s_barrier
    v_max3_u32 v96, v31, v51, v55
    v_max3_u32 v96, v96, v59, v63
    v_cmp_eq_u32 vcc, -1, v96
    s_cbranch_vccz p_rdy3
    s_mov_b32 s38, 0
p_xpoll3:
    s_add_u32 s40, s45, 12288
    buffer_load_dwordx4 v[28:31], v4, s[4:7], s40 offen sc1
    s_add_u32 s40, s37, 12288
    buffer_load_dwordx4 v[48:51], v4, s[4:7], s40 offen sc1
    s_add_u32 s40, s40, 16384
    buffer_load_dwordx4 v[52:55], v4, s[4:7], s40 offen sc1
    s_add_u32 s40, s40, 16384
    buffer_load_dwordx4 v[56:59], v4, s[4:7], s40 offen sc1
    s_add_u32 s40, s40, 16384
    buffer_load_dwordx4 v[60:63], v4, s[4:7], s40 offen sc1
    s_add_u32 s38, s38, 1
    s_waitcnt vmcnt(0)
    v_max3_u32 v96, v31, v51, v55
    v_max3_u32 v96, v96, v59, v63
    v_cmp_eq_u32 vcc, -1, v96
    s_cmp_gt_u32 s38, 131072
    s_cbranch_scc1 p_xpoll3_x
    s_cbranch_vccnz p_xpoll3
p_xpoll3_x:
    s_nop 1
p_rdy3:
    s_cmp_eq_u32 s47, 1
    s_cbranch_scc1 p_noq3b
    v_add_f32 v48, v48, v52
    v_add_f32 v56, v56, v60
    v_add_f32 v49, v49, v53
    v_add_f32 v57, v57, v61
    v_add_f32 v50, v50, v54
    v_add_f32 v58, v58, v62
    v_add_f32 v51, v51, v55
    v_add_f32 v59, v59, v63
    v_add_f32 v48, v48, v56
    v_add_f32 v49, v49, v57
    v_add_f32 v50, v50, v58
    v_add_f32 v51, v51, v59
    v_mul_f32 v48, s49, v48
    v_fma_f32 v49, v49, s49, v115
    v_mul_f32 v50, s49, v50
    v_fma_f32 v51, v51, s49, v115
    v_fma_f32 v49, -v48, v48, v49
    v_fma_f32 v51, -v50, v50, v51
    v_max_f32 v49, v115, v49
    v_max_f32 v51, v115, v51
    v_sqrt_f32 v49, v49
    v_sqrt_f32 v51, v51
    v_lshlrev_b32 v88, 16, v28
    v_and_b32 v89, s48, v28
    v_lshlrev_b32 v90, 16, v29
    v_and_b32 v91, s48, v29
    v_lshlrev_b32 v92, 16, v30
    v_and_b32 v93, s48, v30
    v_lshlrev_b32 v94, 16, v31
    v_and_b32 v95, s48, v31
    v_cvt_pk_bf16_f32 v52, v49, v51
    v_lshlrev_b32 v49, 16, v52
    v_and_b32 v51, s48, v52
    v_rcp_f32 v49, v49
    v_rcp_f32 v51, v51
    v_sub_f32 v96, v88, v48
    v_sub_f32 v97, v89, v48
    v_sub_f32 v98, v90, v48
    v_sub_f32 v99, v91, v48
    v_sub_f32 v100, v92, v50
    v_sub_f32 v101, v93, v50
    v_sub_f32 v102, v94, v50
    v_sub_f32 v103, v95, v50
    v_mul_f32 v96, v96, v49
    v_mul_f32 v97, v97, v49
    v_mul_f32 v98, v98, v49
    v_mul_f32 v99, v99, v49
    v_mul_f32 v100, v100, v51
    v_mul_f32 v101, v101, v51
    v_mul_f32 v102, v102, v51
    v_mul_f32 v103, v103, v51
    v_cvt_pk_bf16_f32 v52, v96, v100
    v_cvt_pk_bf16_f32 v53, v97, v101
    v_cvt_pk_bf16_f32 v54, v98, v102
    v_cvt_pk_bf16_f32 v55, v99, v103
    ds_write_b32 v5, v52 offset:3072
    ds_write_b32 v5, v53 offset:7680
    ds_write_b32 v5, v54 offset:12288
    ds_write_b32 v5, v55 offset:16896
    v_lshlrev_b32 v96, 16, v52
    v_and_b32 v100, s48, v52
    v_lshlrev_b32 v97, 16, v53
    v_and_b32 v101, s48, v53
    v_lshlrev_b32 v98, 16, v54
    v_and_b32 v102, s48, v54
    v_lshlrev_b32 v99, 16, v55
    v_and_b32 v103, s48, v55
    v_fma_f32 v88, v96, s56, v88
    v_fma_f32 v89, v97, s57, v89
    v_fma_f32 v90, v98, s58, v90
    v_fma_f32 v91, v99, s59, v91
    v_fma_f32 v92, v100, s56, v92
    v_fma_f32 v93, v101, s57, v93
    v_fma_f32 v94, v102, s58, v94
    v_fma_f32 v95, v103, s59, v95
    s_nop 2
p_noq3b:
    s_xor_b32 s40, s46, 1
    s_bitcmp1_b32 s40, 0
    s_cbranch_scc1 p_noepi1
    ds_read_b32 v104, v6 offset:2048
    ds_read_b32 v105, v6 offset:2560
    ds_read_b32 v106, v6 offset:3072
    ds_read_b32 v107, v6 offset:3584
    s_add_u32 s40, s44, 524288
    s_waitcnt lgkmcnt(0)
    v_lshlrev_b32 v96, 16, v104
    v_and_b32 v100, s48, v104
    v_lshlrev_b32 v97, 16, v105
    v_and_b32 v101, s48, v105
    v_lshlrev_b32 v98, 16, v106
    v_and_b32 v102, s48, v106
    v_lshlrev_b32 v99, 16, v107
    v_and_b32 v103, s48, v107
    v_add_f32 v96, v96, v72
    v_add_f32 v97, v97, v73
    v_add_f32 v98, v98, v74
    v_add_f32 v99, v99, v75
    v_add_f32 v100, v100, v76
    v_add_f32 v101, v101, v77
    v_add_f32 v102, v102, v78
    v_add_f32 v103, v103, v79
    v_cvt_pk_bf16_f32 v104, v96, v97
    v_cvt_pk_bf16_f32 v105, v98, v99
    v_cvt_pk_bf16_f32 v106, v100, v101
    v_cvt_pk_bf16_f32 v107, v102, v103
    s_cmp_eq_u32 s34, 0
    s_cbranch_scc0 p_epo1
    v_min_u32 v107, -2, v107
    buffer_store_dwordx4 v[104:107], v11, s[4:7], s40 offen sc1
    s_branch p_noepi1
p_epo1:
    buffer_store_dwordx2 v[104:105], v11, s[20:23], s40 offen
    buffer_store_dwordx2 v[106:107], v11, s[20:23], s40 offen offset:1024
p_noepi1:
    s_waitcnt lgkmcnt(0)
    s_barrier
    s_xor_b32 s40, s46, 0
    s_bitcmp1_b32 s40, 0
    s_cbranch_scc1 p_noepi2
    ds_read_b32 v104, v6 offset:4096
    ds_read_b32 v105, v6 offset:4608
    ds_read_b32 v106, v6 offset:5120
    ds_read_b32 v107, v6 offset:5632
    s_add_u32 s40, s44, 1048576
    s_waitcnt lgkmcnt(0)
    v_lshlrev_b32 v96, 16, v104
    v_and_b32 v100, s48, v104
    v_lshlrev_b32 v97, 16, v105
    v_and_b32 v101, s48, v105
    v_lshlrev_b32 v98, 16, v106
    v_and_b32 v102, s48, v106
    v_lshlrev_b32 v99, 16, v107
    v_and_b32 v103, s48, v107
    v_add_f32 v96, v96, v80
    v_add_f32 v97, v97, v81
    v_add_f32 v98, v98, v82
    v_add_f32 v99, v99, v83
    v_add_f32 v100, v100, v84
    v_add_f32 v101, v101, v85
    v_add_f32 v102, v102, v86
    v_add_f32 v103, v103, v87
    v_cvt_pk_bf16_f32 v104, v96, v97
    v_cvt_pk_bf16_f32 v105, v98, v99
    v_cvt_pk_bf16_f32 v106, v100, v101
    v_cvt_pk_bf16_f32 v107, v102, v103
    s_cmp_eq_u32 s34, 0
    s_cbranch_scc0 p_epo2
    v_min_u32 v107, -2, v107
    buffer_store_dwordx4 v[104:107], v11, s[4:7], s40 offen sc1
    s_branch p_noepi2
p_epo2:
    buffer_store_dwordx2 v[104:105], v11, s[20:23], s40 offen
    buffer_store_dwordx2 v[106:107], v11, s[20:23], s40 offen offset:1024
p_noepi2:
    s_barrier
    s_xor_b32 s40, s46, 1
    s_bitcmp1_b32 s40, 0
    s_cbranch_scc1 p_noepi3
    ds_read_b32 v104, v6 offset:6144
    ds_read_b32 v105, v6 offset:6656
    ds_read_b32 v106, v6 offset:7168
    ds_read_b32 v107, v6 offset:7680
    s_add_u32 s40, s44, 1572864
    s_waitcnt lgkmcnt(0)
    v_lshlrev_b32 v96, 16, v104
    v_and_b32 v100, s48, v104
    v_lshlrev_b32 v97, 16, v105
    v_and_b32 v101, s48, v105
    v_lshlrev_b32 v98, 16, v106
    v_and_b32 v102, s48, v106
    v_lshlrev_b32 v99, 16, v107
    v_and_b32 v103, s48, v107
    v_add_f32 v96, v96, v88
    v_add_f32 v97, v97, v89
    v_add_f32 v98, v98, v90
    v_add_f32 v99, v99, v91
    v_add_f32 v100, v100, v92
    v_add_f32 v101, v101, v93
    v_add_f32 v102, v102, v94
    v_add_f32 v103, v103, v95
    v_cvt_pk_bf16_f32 v104, v96, v97
    v_cvt_pk_bf16_f32 v105, v98, v99
    v_cvt_pk_bf16_f32 v106, v100, v101
    v_cvt_pk_bf16_f32 v107, v102, v103
    s_cmp_eq_u32 s34, 0
    s_cbranch_scc0 p_epo3
    v_min_u32 v107, -2, v107
    buffer_store_dwordx4 v[104:107], v11, s[4:7], s40 offen sc1
    s_branch p_noepi3
p_epo3:
    buffer_store_dwordx2 v[104:105], v11, s[20:23], s40 offen
    buffer_store_dwordx2 v[106:107], v11, s[20:23], s40 offen offset:1024
p_noepi3:
    s_cmp_eq_u32 s34, 1
    s_cbranch_scc1 k_done
    s_mov_b32 s34, 1
    s_mov_b32 s35, 2097152
    s_mov_b32 s36, 6291456
    s_mov_b32 s37, 10551296
    v_xor_b32 v10, 64, v2
    v_xor_b32 v11, 64, v3
    s_lshl_b32 s40, s30, 16
    s_lshl_b32 s41, s28, 10
    s_add_u32 s40, s40, s41
    s_add_u32 s40, s40, 8372224
    s_cmp_eq_u32 s30, 0
    s_cselect_b32 s42, 0x7f000000, 0
    v_add_u32 v56, s42, v0
    v_and_b32 v59, 7, v1
    s_and_b32 s43, s28, 1
    s_lshl_b32 s43, s43, 2
    v_lshrrev_b32 v58, 4, v1
    v_xor_b32 v58, v58, v59
    v_xor_b32 v58, s43, v58
    v_lshlrev_b32 v57, 8, v59
    v_lshl_add_u32 v57, v58, 4, v57
    v_bfe_u32 v58, v1, 3, 1
    v_lshl_add_u32 v57, v58, 3, v57
    s_lshr_b32 s43, s28, 1
    s_lshl_b32 s43, s43, 11
    v_add_u32 v57, s43, v57
    v_add_u32 v58, 0x10000, v57
    v_cmp_eq_u32 s[44:45], 0, v59
    s_waitcnt vmcnt(0)
    s_mov_b32 s38, 0
p_x2poll:
    s_add_u32 s43, s40, 0
    buffer_load_dwordx4 v[16:19], v56, s[4:7], s43 offen sc1
    s_add_u32 s43, s40, 16384
    buffer_load_dwordx4 v[20:23], v0, s[4:7], s43 offen sc1
    s_add_u32 s43, s40, 32768
    buffer_load_dwordx4 v[24:27], v0, s[4:7], s43 offen sc1
    s_add_u32 s43, s40, 49152
    buffer_load_dwordx4 v[28:31], v0, s[4:7], s43 offen sc1
    s_add_u32 s43, s40, 65536
    buffer_load_dwordx4 v[32:35], v0, s[4:7], s43 offen sc1
    s_add_u32 s43, s40, 8192
    buffer_load_dwordx4 v[36:39], v56, s[4:7], s43 offen sc1
    s_add_u32 s43, s40, 24576
    buffer_load_dwordx4 v[40:43], v0, s[4:7], s43 offen sc1
    s_add_u32 s43, s40, 40960
    buffer_load_dwordx4 v[44:47], v0, s[4:7], s43 offen sc1
    s_add_u32 s43, s40, 57344
    buffer_load_dwordx4 v[48:51], v0, s[4:7], s43 offen sc1
    s_add_u32 s43, s40, 73728
    buffer_load_dwordx4 v[52:55], v0, s[4:7], s43 offen sc1
    s_add_u32 s38, s38, 1
    s_waitcnt vmcnt(0)
    v_max3_u32 v59, v19, v23, v27
    v_max3_u32 v59, v59, v31, v35
    v_max3_u32 v59, v59, v39, v43
    v_max3_u32 v59, v59, v47, v51
    v_max_u32 v59, v59, v55
    v_cmp_eq_u32 vcc, -1, v59
    s_cmp_gt_u32 s38, 131072
    s_cbranch_scc1 p_x2poll_x
    s_cbranch_vccnz p_x2poll
p_x2poll_x:
    v_mov_b32 v59, 0x3f803f80
    v_cndmask_b32 v16, v16, v59, s[44:45]
    v_cndmask_b32 v17, v17, v59, s[44:45]
    v_cndmask_b32 v36, v36, v59, s[44:45]
    v_cndmask_b32 v37, v37, v59, s[44:45]
    ds_write_b64 v57, v[16:17] offset:0
    ds_write_b64 v57, v[18:19] offset:128
    ds_write_b64 v57, v[20:21] offset:16384
    ds_write_b64 v57, v[22:23] offset:16512
    ds_write_b64 v57, v[24:25] offset:32768
    ds_write_b64 v57, v[26:27] offset:32896
    ds_write_b64 v57, v[28:29] offset:49152
    ds_write_b64 v57, v[30:31] offset:49280
    ds_write_b64 v58, v[32:33] offset:0
    ds_write_b64 v58, v[34:35] offset:128
    ds_write_b64 v57, v[36:37] offset:8192
    ds_write_b64 v57, v[38:39] offset:8320
    ds_write_b64 v57, v[40:41] offset:24576
    ds_write_b64 v57, v[42:43] offset:24704
    ds_write_b64 v57, v[44:45] offset:40960
    ds_write_b64 v57, v[46:47] offset:41088
    ds_write_b64 v57, v[48:49] offset:57344
    ds_write_b64 v57, v[50:51] offset:57472
    ds_write_b64 v58, v[52:53] offset:8192
    ds_write_b64 v58, v[54:55] offset:8320
    s_waitcnt lgkmcnt(0)
    s_barrier
    s_lshl_b32 s48, s28, 1
    ds_read_b128 v[52:55], v2 offset:0
    v_mov_b32 v100, -1
    v_mov_b32 v101, -1
    v_mov_b32 v102, -1
    v_mov_b32 v103, -1
    v_lshrrev_b32 v104, 4, v1
    v_lshlrev_b32 v104, 14, v104
    v_and_b32 v105, 15, v1
    v_lshl_add_u32 v104, v105, 4, v104
    ds_read_b128 v[56:59], v2 offset:16384
    s_add_u32 s40, s48, 0
    s_lshr_b32 s42, s40, 2
    s_and_b32 s43, s40, 3
    s_lshl_b32 s39, s31, 2
    s_add_u32 s39, s39, s43
    s_lshl_b32 s39, s39, 10
    s_lshl_b32 s41, s30, 16
    s_add_u32 s39, s39, s41
    s_lshl_b32 s41, s42, 15
    s_add_u32 s39, s39, s41
    s_add_u32 s39, s39, 2097152
    buffer_store_dwordx4 v[100:103], v0, s[4:7], s39 offen sc1
    ds_read_b128 v[60:63], v2 offset:32768
    s_and_b32 s39, s31, 3
    s_lshl_b32 s39, s39, 19
    s_lshl_b32 s41, s30, 9
    s_add_u32 s39, s39, s41
    s_lshr_b32 s41, s31, 2
    s_lshl_b32 s41, s41, 8
    s_add_u32 s39, s39, s41
    s_add_u32 s39, s39, 6291456
    s_add_u32 s40, s48, 0
    s_lshl_b32 s42, s40, 16
    s_add_u32 s39, s39, s42
    buffer_store_dwordx4 v[100:103], v104, s[4:7], s39 offen sc1
    ds_read_b128 v[64:67], v2 offset:49152
    s_add_u32 s40, s48, 1
    s_lshr_b32 s42, s40, 2
    s_and_b32 s43, s40, 3
    s_lshl_b32 s39, s31, 2
    s_add_u32 s39, s39, s43
    s_lshl_b32 s39, s39, 10
    s_lshl_b32 s41, s30, 16
    s_add_u32 s39, s39, s41
    s_lshl_b32 s41, s42, 15
    s_add_u32 s39, s39, s41
    s_add_u32 s39, s39, 2097152
    buffer_store_dwordx4 v[100:103], v0, s[4:7], s39 offen sc1
    ds_read_b128 v[68:71], v3 offset:0
    s_and_b32 s39, s31, 3
    s_lshl_b32 s39, s39, 19
    s_lshl_b32 s41, s30, 9
    s_add_u32 s39, s39, s41
    s_lshr_b32 s41, s31, 2
    s_lshl_b32 s41, s41, 8
    s_add_u32 s39, s39, s41
    s_add_u32 s39, s39, 6291456
    s_add_u32 s40, s48, 1
    s_lshl_b32 s42, s40, 16
    s_add_u32 s39, s39, s42
    buffer_store_dwordx4 v[100:103], v104, s[4:7], s39 offen sc1
    s_waitcnt lgkmcnt(4)
    v_mfma_f32_16x16x32_bf16 v[16:19], v[124:127], v[52:55], 0
    s_and_b32 s39, s31, 3
    s_lshl_b32 s39, s39, 14
    s_lshl_b32 s41, s30, 9
    s_add_u32 s39, s39, s41
    s_lshr_b32 s41, s31, 2
    s_lshl_b32 s41, s41, 8
    s_add_u32 s39, s39, s41
    s_add_u32 s39, s39, 10551296
    s_lshl_b32 s42, s48, 5
    s_add_u32 s39, s39, s42
    s_mov_b64 exec, 15
    buffer_store_dwordx4 v[100:103], v0, s[4:7], s39 offen sc1
    s_mov_b64 exec, -1
    s_waitcnt lgkmcnt(3)
    v_mfma_f32_16x16x32_bf16 v[20:23], v[124:127], v[56:59], 0
    ds_read_b128 v[72:75], v10 offset:0
    v_mfma_f32_16x16x32_bf16 v[36:39], v[120:123], v[56:59], 0
    ds_read_b128 v[76:79], v10 offset:16384
    s_waitcnt lgkmcnt(4)
    v_mfma_f32_16x16x32_bf16 v[24:27], v[124:127], v[60:63], 0
    ds_read_b128 v[80:83], v10 offset:32768
    v_mfma_f32_16x16x32_bf16 v[40:43], v[120:123], v[60:63], 0
    ds_read_b128 v[84:87], v10 offset:49152
    s_waitcnt lgkmcnt(5)
    v_mfma_f32_16x16x32_bf16 v[28:31], v[124:127], v[64:67], 0
    ds_read_b128 v[88:91], v11 offset:0
    v_mfma_f32_16x16x32_bf16 v[44:47], v[120:123], v[64:67], 0
    s_waitcnt lgkmcnt(5)
    v_mfma_f32_16x16x32_bf16 v[32:35], v[124:127], v[68:71], 0
    v_mfma_f32_16x16x32_bf16 v[48:51], v[120:123], v[68:71], 0
    s_waitcnt lgkmcnt(4)
    v_mfma_f32_16x16x32_bf16 v[16:19], v[132:135], v[72:75], v[16:19]
    s_waitcnt lgkmcnt(3)
    v_mfma_f32_16x16x32_bf16 v[20:23], v[132:135], v[76:79], v[20:23]
    ds_read_b128 v[52:55], v2 offset:2048
    v_mfma_f32_16x16x32_bf16 v[36:39], v[128:131], v[76:79], v[36:39]
    ds_read_b128 v[56:59], v2 offset:18432
    s_waitcnt lgkmcnt(4)
    v_mfma_f32_16x16x32_bf16 v[24:27], v[132:135], v[80:83], v[24:27]
    ds_read_b128 v[60:63], v2 offset:34816
    v_mfma_f32_16x16x32_bf16 v[40:43], v[128:131], v[80:83], v[40:43]
    ds_read_b128 v[64:67], v2 offset:51200
    s_waitcnt lgkmcnt(5)
    v_mfma_f32_16x16x32_bf16 v[28:31], v[132:135], v[84:87], v[28:31]
    ds_read_b128 v[68:71], v3 offset:2048
    v_mfma_f32_16x16x32_bf16 v[44:47], v[128:131], v[84:87], v[44:47]
    s_waitcnt lgkmcnt(5)
    v_mfma_f32_16x16x32_bf16 v[32:35], v[132:135], v[88:91], v[32:35]
    v_mfma_f32_16x16x32_bf16 v[48:51], v[128:131], v[88:91], v[48:51]
    s_waitcnt lgkmcnt(4)
    v_mfma_f32_16x16x32_bf16 v[16:19], v[140:143], v[52:55], v[16:19]
    s_waitcnt lgkmcnt(3)
    v_mfma_f32_16x16x32_bf16 v[20:23], v[140:143], v[56:59], v[20:23]
    ds_read_b128 v[72:75], v10 offset:2048
    v_mfma_f32_16x16x32_bf16 v[36:39], v[136:139], v[56:59], v[36:39]
    ds_read_b128 v[76:79], v10 offset:18432
    s_waitcnt lgkmcnt(4)
    v_mfma_f32_16x16x32_bf16 v[24:27], v[140:143], v[60:63], v[24:27]
    ds_read_b128 v[80:83], v10 offset:34816
    v_mfma_f32_16x16x32_bf16 v[40:43], v[136:139], v[60:63], v[40:43]
    ds_read_b128 v[84:87], v10 offset:51200
    s_waitcnt lgkmcnt(5)
    v_mfma_f32_16x16x32_bf16 v[28:31], v[140:143], v[64:67], v[28:31]
    ds_read_b128 v[88:91], v11 offset:2048
    v_mfma_f32_16x16x32_bf16 v[44:47], v[136:139], v[64:67], v[44:47]
    s_waitcnt lgkmcnt(5)
    v_mfma_f32_16x16x32_bf16 v[32:35], v[140:143], v[68:71], v[32:35]
    v_mfma_f32_16x16x32_bf16 v[48:51], v[136:139], v[68:71], v[48:51]
    s_waitcnt lgkmcnt(4)
    v_mfma_f32_16x16x32_bf16 v[16:19], v[148:151], v[72:75], v[16:19]
    s_waitcnt lgkmcnt(3)
    v_mfma_f32_16x16x32_bf16 v[20:23], v[148:151], v[76:79], v[20:23]
    ds_read_b128 v[52:55], v2 offset:4096
    v_mfma_f32_16x16x32_bf16 v[36:39], v[144:147], v[76:79], v[36:39]
    ds_read_b128 v[56:59], v2 offset:20480
    s_waitcnt lgkmcnt(4)
    v_mfma_f32_16x16x32_bf16 v[24:27], v[148:151], v[80:83], v[24:27]
    ds_read_b128 v[60:63], v2 offset:36864
    v_mfma_f32_16x16x32_bf16 v[40:43], v[144:147], v[80:83], v[40:43]
    ds_read_b128 v[64:67], v2 offset:53248
    s_waitcnt lgkmcnt(5)
    v_mfma_f32_16x16x32_bf16 v[28:31], v[148:151], v[84:87], v[28:31]
    ds_read_b128 v[68:71], v3 offset:4096
    v_mfma_f32_16x16x32_bf16 v[44:47], v[144:147], v[84:87], v[44:47]
    s_waitcnt lgkmcnt(5)
    v_mfma_f32_16x16x32_bf16 v[32:35], v[148:151], v[88:91], v[32:35]
    v_mfma_f32_16x16x32_bf16 v[48:51], v[144:147], v[88:91], v[48:51]
    s_waitcnt lgkmcnt(4)
    v_mfma_f32_16x16x32_bf16 v[16:19], v[156:159], v[52:55], v[16:19]
    s_waitcnt lgkmcnt(3)
    v_mfma_f32_16x16x32_bf16 v[20:23], v[156:159], v[56:59], v[20:23]
    ds_read_b128 v[72:75], v10 offset:4096
    v_mfma_f32_16x16x32_bf16 v[36:39], v[152:155], v[56:59], v[36:39]
    ds_read_b128 v[76:79], v10 offset:20480
    s_waitcnt lgkmcnt(4)
    v_mfma_f32_16x16x32_bf16 v[24:27], v[156:159], v[60:63], v[24:27]
    ds_read_b128 v[80:83], v10 offset:36864
    v_mfma_f32_16x16x32_bf16 v[40:43], v[152:155], v[60:63], v[40:43]
    ds_read_b128 v[84:87], v10 offset:53248
    s_waitcnt lgkmcnt(5)
    v_mfma_f32_16x16x32_bf16 v[28:31], v[156:159], v[64:67], v[28:31]
    ds_read_b128 v[88:91], v11 offset:4096
    v_mfma_f32_16x16x32_bf16 v[44:47], v[152:155], v[64:67], v[44:47]
    s_waitcnt lgkmcnt(5)
    v_mfma_f32_16x16x32_bf16 v[32:35], v[156:159], v[68:71], v[32:35]
    v_mfma_f32_16x16x32_bf16 v[48:51], v[152:155], v[68:71], v[48:51]
    s_waitcnt lgkmcnt(4)
    v_mfma_f32_16x16x32_bf16 v[16:19], v[164:167], v[72:75], v[16:19]
    s_waitcnt lgkmcnt(3)
    v_mfma_f32_16x16x32_bf16 v[20:23], v[164:167], v[76:79], v[20:23]
    ds_read_b128 v[52:55], v2 offset:6144
    v_mfma_f32_16x16x32_bf16 v[36:39], v[160:163], v[76:79], v[36:39]
    ds_read_b128 v[56:59], v2 offset:22528
    s_waitcnt lgkmcnt(4)
    v_mfma_f32_16x16x32_bf16 v[24:27], v[164:167], v[80:83], v[24:27]
    ds_read_b128 v[60:63], v2 offset:38912
    v_mfma_f32_16x16x32_bf16 v[40:43], v[160:163], v[80:83], v[40:43]
    ds_read_b128 v[64:67], v2 offset:55296
    s_waitcnt lgkmcnt(5)
    v_mfma_f32_16x16x32_bf16 v[28:31], v[164:167], v[84:87], v[28:31]
    ds_read_b128 v[68:71], v3 offset:6144
    v_mfma_f32_16x16x32_bf16 v[44:47], v[160:163], v[84:87], v[44:47]
    s_waitcnt lgkmcnt(5)
    v_mfma_f32_16x16x32_bf16 v[32:35], v[164:167], v[88:91], v[32:35]
    v_mfma_f32_16x16x32_bf16 v[48:51], v[160:163], v[88:91], v[48:51]
    s_waitcnt lgkmcnt(4)
    v_mfma_f32_16x16x32_bf16 v[16:19], v[172:175], v[52:55], v[16:19]
    s_waitcnt lgkmcnt(3)
    v_mfma_f32_16x16x32_bf16 v[20:23], v[172:175], v[56:59], v[20:23]
    ds_read_b128 v[72:75], v10 offset:6144
    v_mfma_f32_16x16x32_bf16 v[36:39], v[168:171], v[56:59], v[36:39]
    ds_read_b128 v[76:79], v10 offset:22528
    s_waitcnt lgkmcnt(4)
    v_mfma_f32_16x16x32_bf16 v[24:27], v[172:175], v[60:63], v[24:27]
    ds_read_b128 v[80:83], v10 offset:38912
    v_mfma_f32_16x16x32_bf16 v[40:43], v[168:171], v[60:63], v[40:43]
    ds_read_b128 v[84:87], v10 offset:55296
    s_waitcnt lgkmcnt(5)
    v_mfma_f32_16x16x32_bf16 v[28:31], v[172:175], v[64:67], v[28:31]
    ds_read_b128 v[88:91], v11 offset:6144
    v_mfma_f32_16x16x32_bf16 v[44:47], v[168:171], v[64:67], v[44:47]
    s_waitcnt lgkmcnt(5)
    v_mfma_f32_16x16x32_bf16 v[32:35], v[172:175], v[68:71], v[32:35]
    v_mfma_f32_16x16x32_bf16 v[48:51], v[168:171], v[68:71], v[48:51]
    s_waitcnt lgkmcnt(4)
    v_mfma_f32_16x16x32_bf16 v[16:19], v[180:183], v[72:75], v[16:19]
    s_waitcnt lgkmcnt(3)
    v_mfma_f32_16x16x32_bf16 v[20:23], v[180:183], v[76:79], v[20:23]
    ds_read_b128 v[52:55], v2 offset:8192
    v_mfma_f32_16x16x32_bf16 v[36:39], v[176:179], v[76:79], v[36:39]
    ds_read_b128 v[56:59], v2 offset:24576
    s_waitcnt lgkmcnt(4)
    v_mfma_f32_16x16x32_bf16 v[24:27], v[180:183], v[80:83], v[24:27]
    ds_read_b128 v[60:63], v2 offset:40960
    v_mfma_f32_16x16x32_bf16 v[40:43], v[176:179], v[80:83], v[40:43]
    ds_read_b128 v[64:67], v2 offset:57344
    s_waitcnt lgkmcnt(5)
    v_mfma_f32_16x16x32_bf16 v[28:31], v[180:183], v[84:87], v[28:31]
    ds_read_b128 v[68:71], v3 offset:8192
    v_mfma_f32_16x16x32_bf16 v[44:47], v[176:179], v[84:87], v[44:47]
    s_waitcnt lgkmcnt(5)
    v_mfma_f32_16x16x32_bf16 v[32:35], v[180:183], v[88:91], v[32:35]
    v_mfma_f32_16x16x32_bf16 v[48:51], v[176:179], v[88:91], v[48:51]
    s_waitcnt lgkmcnt(4)
    v_mfma_f32_16x16x32_bf16 v[16:19], v[188:191], v[52:55], v[16:19]
    s_waitcnt lgkmcnt(3)
    v_mfma_f32_16x16x32_bf16 v[20:23], v[188:191], v[56:59], v[20:23]
    ds_read_b128 v[72:75], v10 offset:8192
    v_mfma_f32_16x16x32_bf16 v[36:39], v[184:187], v[56:59], v[36:39]
    ds_read_b128 v[76:79], v10 offset:24576
    s_waitcnt lgkmcnt(4)
    v_mfma_f32_16x16x32_bf16 v[24:27], v[188:191], v[60:63], v[24:27]
    ds_read_b128 v[80:83], v10 offset:40960
    v_mfma_f32_16x16x32_bf16 v[40:43], v[184:187], v[60:63], v[40:43]
    ds_read_b128 v[84:87], v10 offset:57344
    s_waitcnt lgkmcnt(5)
    v_mfma_f32_16x16x32_bf16 v[28:31], v[188:191], v[64:67], v[28:31]
    ds_read_b128 v[88:91], v11 offset:8192
    v_mfma_f32_16x16x32_bf16 v[44:47], v[184:187], v[64:67], v[44:47]
    s_waitcnt lgkmcnt(5)
    v_mfma_f32_16x16x32_bf16 v[32:35], v[188:191], v[68:71], v[32:35]
    v_mfma_f32_16x16x32_bf16 v[48:51], v[184:187], v[68:71], v[48:51]
    s_waitcnt lgkmcnt(4)
    v_mfma_f32_16x16x32_bf16 v[16:19], v[196:199], v[72:75], v[16:19]
    s_waitcnt lgkmcnt(3)
    v_mfma_f32_16x16x32_bf16 v[20:23], v[196:199], v[76:79], v[20:23]
    ds_read_b128 v[52:55], v2 offset:10240
    v_mfma_f32_16x16x32_bf16 v[36:39], v[192:195], v[76:79], v[36:39]
    ds_read_b128 v[56:59], v2 offset:26624
    s_waitcnt lgkmcnt(4)
    v_mfma_f32_16x16x32_bf16 v[24:27], v[196:199], v[80:83], v[24:27]
    ds_read_b128 v[60:63], v2 offset:43008
    v_mfma_f32_16x16x32_bf16 v[40:43], v[192:195], v[80:83], v[40:43]
    ds_read_b128 v[64:67], v2 offset:59392
    s_waitcnt lgkmcnt(5)
    v_mfma_f32_16x16x32_bf16 v[28:31], v[196:199], v[84:87], v[28:31]
    ds_read_b128 v[68:71], v3 offset:10240
    v_mfma_f32_16x16x32_bf16 v[44:47], v[192:195], v[84:87], v[44:47]
    s_waitcnt lgkmcnt(5)
    v_mfma_f32_16x16x32_bf16 v[32:35], v[196:199], v[88:91], v[32:35]
    v_mfma_f32_16x16x32_bf16 v[48:51], v[192:195], v[88:91], v[48:51]
    s_waitcnt lgkmcnt(4)
    v_mfma_f32_16x16x32_bf16 v[16:19], v[204:207], v[52:55], v[16:19]
    s_waitcnt lgkmcnt(3)
    v_mfma_f32_16x16x32_bf16 v[20:23], v[204:207], v[56:59], v[20:23]
    ds_read_b128 v[72:75], v10 offset:10240
    v_mfma_f32_16x16x32_bf16 v[36:39], v[200:203], v[56:59], v[36:39]
    ds_read_b128 v[76:79], v10 offset:26624
    s_waitcnt lgkmcnt(4)
    v_mfma_f32_16x16x32_bf16 v[24:27], v[204:207], v[60:63], v[24:27]
    ds_read_b128 v[80:83], v10 offset:43008
    v_mfma_f32_16x16x32_bf16 v[40:43], v[200:203], v[60:63], v[40:43]
    ds_read_b128 v[84:87], v10 offset:59392
    s_waitcnt lgkmcnt(5)
    v_mfma_f32_16x16x32_bf16 v[28:31], v[204:207], v[64:67], v[28:31]
    ds_read_b128 v[88:91], v11 offset:10240
    v_mfma_f32_16x16x32_bf16 v[44:47], v[200:203], v[64:67], v[44:47]
    s_waitcnt lgkmcnt(5)
    v_mfma_f32_16x16x32_bf16 v[32:35], v[204:207], v[68:71], v[32:35]
    v_mfma_f32_16x16x32_bf16 v[48:51], v[200:203], v[68:71], v[48:51]
    s_waitcnt lgkmcnt(4)
    v_mfma_f32_16x16x32_bf16 v[16:19], v[212:215], v[72:75], v[16:19]
    s_waitcnt lgkmcnt(3)
    v_mfma_f32_16x16x32_bf16 v[20:23], v[212:215], v[76:79], v[20:23]
    ds_read_b128 v[52:55], v2 offset:12288
    v_mfma_f32_16x16x32_bf16 v[36:39], v[208:211], v[76:79], v[36:39]
    ds_read_b128 v[56:59], v2 offset:28672
    s_waitcnt lgkmcnt(4)
    v_mfma_f32_16x16x32_bf16 v[24:27], v[212:215], v[80:83], v[24:27]
    ds_read_b128 v[60:63], v2 offset:45056
    v_mfma_f32_16x16x32_bf16 v[40:43], v[208:211], v[80:83], v[40:43]
    ds_read_b128 v[64:67], v2 offset:61440
    s_waitcnt lgkmcnt(5)
    v_mfma_f32_16x16x32_bf16 v[28:31], v[212:215], v[84:87], v[28:31]
    ds_read_b128 v[68:71], v3 offset:12288
    v_mfma_f32_16x16x32_bf16 v[44:47], v[208:211], v[84:87], v[44:47]
    s_waitcnt lgkmcnt(5)
    v_mfma_f32_16x16x32_bf16 v[32:35], v[212:215], v[88:91], v[32:35]
    v_mfma_f32_16x16x32_bf16 v[48:51], v[208:211], v[88:91], v[48:51]
    v_mov_b32 v100, 156936
    v_mov_b32 v101, 1
    s_waitcnt vmcnt(0)
    s_mov_b64 exec, 1
    ds_add_rtn_u32 v102, v100, v101
    s_mov_b64 exec, -1
    s_waitcnt lgkmcnt(5)
    v_mfma_f32_16x16x32_bf16 v[16:19], v[220:223], v[52:55], v[16:19]
    s_waitcnt lgkmcnt(4)
    v_mfma_f32_16x16x32_bf16 v[20:23], v[220:223], v[56:59], v[20:23]
    ds_read_b128 v[72:75], v10 offset:12288
    v_mfma_f32_16x16x32_bf16 v[36:39], v[216:219], v[56:59], v[36:39]
    ds_read_b128 v[76:79], v10 offset:28672
    s_waitcnt lgkmcnt(5)
    v_mfma_f32_16x16x32_bf16 v[24:27], v[220:223], v[60:63], v[24:27]
    ds_read_b128 v[80:83], v10 offset:45056
    v_mfma_f32_16x16x32_bf16 v[40:43], v[216:219], v[60:63], v[40:43]
    ds_read_b128 v[84:87], v10 offset:61440
    s_waitcnt lgkmcnt(6)
    v_mfma_f32_16x16x32_bf16 v[28:31], v[220:223], v[64:67], v[28:31]
    ds_read_b128 v[88:91], v11 offset:12288
    v_mfma_f32_16x16x32_bf16 v[44:47], v[216:219], v[64:67], v[44:47]
    s_waitcnt lgkmcnt(6)
    v_mfma_f32_16x16x32_bf16 v[32:35], v[220:223], v[68:71], v[32:35]
    v_mfma_f32_16x16x32_bf16 v[48:51], v[216:219], v[68:71], v[48:51]
    s_waitcnt lgkmcnt(5)
    v_readfirstlane_b32 s39, v102
    s_cmp_eq_u32 s39, 3
    s_cselect_b64 exec, 1, 0
    s_lshr_b32 s38, s2, 3
    s_lshl_b32 s38, s38, 5
    s_and_b32 s39, s2, 7
    s_add_u32 s38, s38, s39
    s_lshl_b32 s38, s38, 2
    s_add_u32 s38, s38, 0x00d00000
    v_mov_b32 v101, 3
    buffer_store_dword v101, off, s[4:7], s38 sc1
    s_mov_b64 exec, -1
    s_waitcnt lgkmcnt(4)
    v_mfma_f32_16x16x32_bf16 v[16:19], v[228:231], v[72:75], v[16:19]
    s_waitcnt lgkmcnt(3)
    v_mfma_f32_16x16x32_bf16 v[20:23], v[228:231], v[76:79], v[20:23]
    ds_read_b128 v[52:55], v2 offset:14336
    v_mfma_f32_16x16x32_bf16 v[36:39], v[224:227], v[76:79], v[36:39]
    ds_read_b128 v[56:59], v2 offset:30720
    s_waitcnt lgkmcnt(4)
    v_mfma_f32_16x16x32_bf16 v[24:27], v[228:231], v[80:83], v[24:27]
    ds_read_b128 v[60:63], v2 offset:47104
    v_mfma_f32_16x16x32_bf16 v[40:43], v[224:227], v[80:83], v[40:43]
    ds_read_b128 v[64:67], v2 offset:63488
    s_waitcnt lgkmcnt(5)
    v_mfma_f32_16x16x32_bf16 v[28:31], v[228:231], v[84:87], v[28:31]
    ds_read_b128 v[68:71], v3 offset:14336
    v_mfma_f32_16x16x32_bf16 v[44:47], v[224:227], v[84:87], v[44:47]
    s_waitcnt lgkmcnt(5)
    v_mfma_f32_16x16x32_bf16 v[32:35], v[228:231], v[88:91], v[32:35]
    v_mfma_f32_16x16x32_bf16 v[48:51], v[224:227], v[88:91], v[48:51]
    s_waitcnt lgkmcnt(4)
    v_mfma_f32_16x16x32_bf16 v[16:19], v[236:239], v[52:55], v[16:19]
    s_waitcnt lgkmcnt(3)
    v_mfma_f32_16x16x32_bf16 v[20:23], v[236:239], v[56:59], v[20:23]
    ds_read_b128 v[72:75], v10 offset:14336
    v_mfma_f32_16x16x32_bf16 v[36:39], v[232:235], v[56:59], v[36:39]
    ds_read_b128 v[76:79], v10 offset:30720
    s_waitcnt lgkmcnt(4)
    v_mfma_f32_16x16x32_bf16 v[24:27], v[236:239], v[60:63], v[24:27]
    ds_read_b128 v[80:83], v10 offset:47104
    v_mfma_f32_16x16x32_bf16 v[40:43], v[232:235], v[60:63], v[40:43]
    ds_read_b128 v[84:87], v10 offset:63488
    s_waitcnt lgkmcnt(5)
    v_mfma_f32_16x16x32_bf16 v[28:31], v[236:239], v[64:67], v[28:31]
    ds_read_b128 v[88:91], v11 offset:14336
    v_mfma_f32_16x16x32_bf16 v[44:47], v[232:235], v[64:67], v[44:47]
    s_waitcnt lgkmcnt(5)
    v_mfma_f32_16x16x32_bf16 v[32:35], v[236:239], v[68:71], v[32:35]
    v_mfma_f32_16x16x32_bf16 v[48:51], v[232:235], v[68:71], v[48:51]
    s_waitcnt lgkmcnt(4)
    v_mfma_f32_16x16x32_bf16 v[16:19], v[244:247], v[72:75], v[16:19]
    s_waitcnt lgkmcnt(3)
    v_mfma_f32_16x16x32_bf16 v[20:23], v[244:247], v[76:79], v[20:23]
    v_mfma_f32_16x16x32_bf16 v[36:39], v[240:243], v[76:79], v[36:39]
    s_waitcnt lgkmcnt(2)
    v_mfma_f32_16x16x32_bf16 v[24:27], v[244:247], v[80:83], v[24:27]
    v_mfma_f32_16x16x32_bf16 v[40:43], v[240:243], v[80:83], v[40:43]
    s_waitcnt lgkmcnt(1)
    v_mfma_f32_16x16x32_bf16 v[28:31], v[244:247], v[84:87], v[28:31]
    v_mfma_f32_16x16x32_bf16 v[44:47], v[240:243], v[84:87], v[44:47]
    s_waitcnt lgkmcnt(0)
    v_mfma_f32_16x16x32_bf16 v[32:35], v[244:247], v[88:91], v[32:35]
    v_mfma_f32_16x16x32_bf16 v[48:51], v[240:243], v[88:91], v[48:51]
    s_nop 7
    s_branch p_common
v_role:
    v_lshrrev_b32 v15, 5, v1
    v_mul_u32_u24 v15, 6144, v15
    v_bfe_u32 v8, v1, 2, 3
    v_lshl_add_u32 v15, v8, 7, v15
    v_bfe_u32 v8, v1, 3, 2
    v_xor_b32 v8, s29, v8
    v_lshl_add_u32 v15, v8, 5, v15
    v_and_b32 v8, 3, v1
    v_lshl_add_u32 v15, v8, 3, v15
    v_add_u32 v15, 81920, v15
    v_add_u32 v160, 49152, v15
    v_bfe_u32 v8, v1, 1, 3
    v_lshrrev_b32 v9, 4, v1
    v_xor_b32 v8, v8, v9
    v_and_b32 v9, 15, v1
    v_lshlrev_b32 v9, 7, v9
    v_lshl_add_u32 v2, v8, 4, v9
    s_add_u32 s38, s29, 0
    s_and_b32 s38, s38, 3
    s_add_u32 s38, s38, 1
    s_mov_b32 s52, s38
    s_lshl_b32 s38, s38, 14
    v_add_u32 v3, s38, v2
    s_add_u32 s38, s29, 1
    s_and_b32 s38, s38, 3
    s_add_u32 s38, s38, 1
    s_mov_b32 s53, s38
    s_lshl_b32 s38, s38, 14
    v_add_u32 v7, s38, v2
    s_add_u32 s38, s29, 2
    s_and_b32 s38, s38, 3
    s_add_u32 s38, s38, 1
    s_mov_b32 s54, s38
    s_lshl_b32 s38, s38, 14
    v_add_u32 v8, s38, v2
    s_add_u32 s38, s29, 3
    s_and_b32 s38, s38, 3
    s_add_u32 s38, s38, 1
    s_mov_b32 s55, s38
    s_lshl_b32 s38, s38, 14
    v_add_u32 v9, s38, v2
    v_xor_b32 v10, 64, v2
    v_xor_b32 v11, 64, v3
    v_xor_b32 v12, 64, v7
    v_xor_b32 v13, 64, v8
    v_xor_b32 v14, 64, v9
    v_mov_b32 v48, 0x3f803f80
    v_mov_b32 v49, 0x3f803f80
    v_mov_b32 v50, 0x3f803f80
    v_mov_b32 v51, 0x3f803f80
    s_waitcnt vmcnt(7)
    s_barrier
    ds_read_b64_tr_b16 v[188:189], v15 offset:2048
    ds_read_b64_tr_b16 v[190:191], v15 offset:5120
    ds_read_b64_tr_b16 v[192:193], v15 offset:14336
    ds_read_b64_tr_b16 v[194:195], v15 offset:17408
    ds_read_b128 v[52:55], v2 offset:0
    ds_read_b128 v[56:59], v3 offset:0
    ds_read_b128 v[60:63], v7 offset:0
    ds_read_b128 v[64:67], v8 offset:0
    ds_read_b128 v[68:71], v9 offset:0
    s_waitcnt lgkmcnt(5)
    s_waitcnt vmcnt(4)
    s_barrier
    ds_read_b64_tr_b16 v[196:197], v15 offset:26624
    ds_read_b64_tr_b16 v[198:199], v15 offset:29696
    ds_read_b64_tr_b16 v[200:201], v15 offset:38912
    ds_read_b64_tr_b16 v[202:203], v15 offset:41984
    s_add_u32 m0, s69, 0
    s_mov_b32 s38, 589824
    buffer_load_dwordx4 v4, s[12:15], s38 offen offset:0 lds
    s_add_u32 m0, s69, 0
    s_mov_b32 s38, 589824
    buffer_load_dwordx4 v4, s[12:15], s38 offen offset:1024 lds
    s_add_u32 m0, s69, 0
    s_mov_b32 s38, 589824
    buffer_load_dwordx4 v4, s[12:15], s38 offen offset:2048 lds
    s_waitcnt lgkmcnt(8)
    v_mfma_f32_16x16x32_bf16 v[16:19], v[52:55], v[188:191], 0
    v_mul_f32_dpp v116, v104, v111 row_newbcast:4 row_mask:0xf bank_mask:0xf
    v_mul_f32_dpp v124, v105, v111 row_newbcast:4 row_mask:0xf bank_mask:0xf
    v_mul_f32_dpp v117, v104, v111 row_newbcast:5 row_mask:0xf bank_mask:0xf
    v_mul_f32_dpp v125, v105, v111 row_newbcast:5 row_mask:0xf bank_mask:0xf
    v_mul_f32_dpp v118, v104, v111 row_newbcast:6 row_mask:0xf bank_mask:0xf
    v_mul_f32_dpp v126, v105, v111 row_newbcast:6 row_mask:0xf bank_mask:0xf
    v_mul_f32_dpp v119, v104, v111 row_newbcast:7 row_mask:0xf bank_mask:0xf
    v_mfma_f32_16x16x32_bf16 v[44:47], v[52:55], v[52:55], 0
    v_mul_f32_dpp v127, v105, v111 row_newbcast:7 row_mask:0xf bank_mask:0xf
    v_exp_f32 v116, v116
    v_fract_f32 v124, v124
    v_exp_f32 v117, v117
    v_fract_f32 v125, v125
    v_exp_f32 v118, v118
    v_fract_f32 v126, v126
    ds_read_b128 v[72:75], v10 offset:0
    v_exp_f32 v119, v119
    v_fract_f32 v127, v127
    v_sin_f32 v120, v124
    v_cos_f32 v124, v124
    v_sin_f32 v121, v125
    v_cos_f32 v125, v125
    v_sin_f32 v122, v126
    s_waitcnt lgkmcnt(8)
    v_mfma_f32_16x16x32_bf16 v[20:23], v[56:59], v[188:191], 0
    v_cos_f32 v126, v126
    v_sin_f32 v123, v127
    v_cos_f32 v127, v127
    v_mul_f32_dpp v128, v106, v116 row_newbcast:4 row_mask:0xf bank_mask:0xf
    v_mul_f32_dpp v132, v107, v116 row_newbcast:4 row_mask:0xf bank_mask:0xf
    v_mul_f32_dpp v129, v106, v117 row_newbcast:5 row_mask:0xf bank_mask:0xf
    v_mul_f32_dpp v133, v107, v117 row_newbcast:5 row_mask:0xf bank_mask:0xf
    ds_read_b128 v[76:79], v11 offset:0
    s_lshl_b32 m0, s28, 10
    s_add_u32 m0, m0, 8192
    s_add_u32 s38, s3, 512
    s_bitcmp1_b32 s28, 0
    s_cselect_b32 exec_lo, -1, 0xffffff00
    buffer_load_dwordx4 v6, s[8:11], s38 offen lds
    s_mov_b32 exec_lo, -1
    v_mul_f32_dpp v130, v106, v118 row_newbcast:6 row_mask:0xf bank_mask:0xf
    v_mul_f32_dpp v134, v107, v118 row_newbcast:6 row_mask:0xf bank_mask:0xf
    v_mul_f32_dpp v131, v106, v119 row_newbcast:7 row_mask:0xf bank_mask:0xf
    v_mul_f32_dpp v135, v107, v119 row_newbcast:7 row_mask:0xf bank_mask:0xf
    v_mul_f32 v116, v132, v120
    v_mul_f32 v132, v132, v124
    v_mfma_f32_16x16x32_bf16 v[36:39], v[56:59], v[56:59], 0
    v_mul_f32 v117, v133, v121
    v_mul_f32 v133, v133, v125
    v_mul_f32 v118, v134, v122
    v_mul_f32 v134, v134, v126
    v_mul_f32 v119, v135, v123
    v_mul_f32 v135, v135, v127
    v_fma_f32 v116, v128, v124, -v116
    ds_read_b128 v[80:83], v12 offset:0
    v_fma_f32 v132, -v128, v120, -v132
    v_fma_f32 v117, v129, v125, -v117
    v_fma_f32 v133, -v129, v121, -v133
    v_fma_f32 v118, v130, v126, -v118
    v_fma_f32 v134, -v130, v122, -v134
    v_fma_f32 v119, v131, v127, -v119
    v_fma_f32 v135, -v131, v123, -v135
    v_mfma_f32_16x16x32_bf16 v[40:43], v[48:51], v[56:59], 0
    v_cvt_pk_f16_f32 v136, v116, v132
    v_cvt_pk_f16_f32 v137, v117, v133
    v_cvt_pk_f16_f32 v138, v118, v134
    v_cvt_pk_f16_f32 v139, v119, v135
    v_mul_f32_dpp v116, v104, v108 row_newbcast:4 row_mask:0xf bank_mask:0xf
    v_mul_f32_dpp v124, v105, v108 row_newbcast:4 row_mask:0xf bank_mask:0xf
    v_mul_f32_dpp v117, v104, v108 row_newbcast:5 row_mask:0xf bank_mask:0xf
    ds_read_b128 v[84:87], v13 offset:0
    v_mul_f32_dpp v125, v105, v108 row_newbcast:5 row_mask:0xf bank_mask:0xf
    s_lshl_b32 m0, s28, 10
    s_add_u32 m0, m0, 24576
    s_add_u32 s38, s3, 512
    buffer_load_dwordx4 v5, s[8:11], s38 offen lds
    v_mul_f32_dpp v118, v104, v108 row_newbcast:6 row_mask:0xf bank_mask:0xf
    v_mul_f32_dpp v126, v105, v108 row_newbcast:6 row_mask:0xf bank_mask:0xf
    v_mul_f32_dpp v119, v104, v108 row_newbcast:7 row_mask:0xf bank_mask:0xf
    v_mul_f32_dpp v127, v105, v108 row_newbcast:7 row_mask:0xf bank_mask:0xf
    v_exp_f32 v116, v116
    s_waitcnt lgkmcnt(10)
    v_mfma_f32_16x16x32_bf16 v[24:27], v[60:63], v[188:191], 0
    v_fract_f32 v124, v124
    v_exp_f32 v117, v117
    v_fract_f32 v125, v125
    v_exp_f32 v118, v118
    v_fract_f32 v126, v126
    v_exp_f32 v119, v119
    v_fract_f32 v127, v127
    ds_read_b128 v[88:91], v14 offset:0
    v_sin_f32 v120, v124
    v_cos_f32 v124, v124
    v_sin_f32 v121, v125
    v_cos_f32 v125, v125
    v_sin_f32 v122, v126
    v_cos_f32 v126, v126
    v_sin_f32 v123, v127
    s_waitcnt lgkmcnt(10)
    v_mfma_f32_16x16x32_bf16 v[28:31], v[64:67], v[188:191], 0
    v_cos_f32 v127, v127
    v_mul_f32 v124, v116, v124
    v_mul_f32 v120, v116, v120
    v_mul_f32 v125, v117, v125
    v_mul_f32 v121, v117, v121
    v_mul_f32 v126, v118, v126
    v_mul_f32 v122, v118, v122
    s_waitcnt lgkmcnt(9)
    v_mfma_f32_16x16x32_bf16 v[32:35], v[68:71], v[188:191], 0
    v_mul_f32 v127, v119, v127
    v_mul_f32 v123, v119, v123
    s_lshl_b32 m0, s28, 10
    s_add_u32 m0, m0, 40960
    s_add_u32 s38, s3, 16896
    buffer_load_dwordx4 v5, s[8:11], s38 offen lds
    v_cvt_pk_f16_f32 v140, v124, v120
    v_cvt_pk_f16_f32 v141, v125, v121
    v_cvt_pk_f16_f32 v142, v126, v122
    s_waitcnt lgkmcnt(4)
    v_mfma_f32_16x16x32_bf16 v[16:19], v[72:75], v[192:195], v[16:19]
    v_cvt_pk_f16_f32 v143, v127, v123
    s_nop 1
    v_mfma_f32_16x16x32_f16 v[92:95], v[140:143], v[136:139], v[92:95]
    v_mul_f32_dpp v116, v104, v109 row_newbcast:4 row_mask:0xf bank_mask:0xf
    v_mul_f32_dpp v124, v105, v109 row_newbcast:4 row_mask:0xf bank_mask:0xf
    v_mul_f32_dpp v117, v104, v109 row_newbcast:5 row_mask:0xf bank_mask:0xf
    v_mul_f32_dpp v125, v105, v109 row_newbcast:5 row_mask:0xf bank_mask:0xf
    v_mfma_f32_16x16x32_bf16 v[44:47], v[72:75], v[72:75], v[44:47]
    v_mul_f32_dpp v118, v104, v109 row_newbcast:6 row_mask:0xf bank_mask:0xf
    v_mul_f32_dpp v126, v105, v109 row_newbcast:6 row_mask:0xf bank_mask:0xf
    v_mul_f32_dpp v119, v104, v109 row_newbcast:7 row_mask:0xf bank_mask:0xf
    v_mul_f32_dpp v127, v105, v109 row_newbcast:7 row_mask:0xf bank_mask:0xf
    v_exp_f32 v116, v116
    v_fract_f32 v124, v124
    ds_read_b128 v[52:55], v2 offset:2048
    v_exp_f32 v117, v117
    v_fract_f32 v125, v125
    v_exp_f32 v118, v118
    v_fract_f32 v126, v126
    v_exp_f32 v119, v119
    v_fract_f32 v127, v127
    s_waitcnt lgkmcnt(4)
    v_mfma_f32_16x16x32_bf16 v[20:23], v[76:79], v[192:195], v[20:23]
    v_sin_f32 v120, v124
    v_cos_f32 v124, v124
    v_sin_f32 v121, v125
    v_cos_f32 v125, v125
    v_sin_f32 v122, v126
    v_cos_f32 v126, v126
    ds_read_b128 v[56:59], v3 offset:2048
    v_sin_f32 v123, v127
    s_lshl_b32 m0, s28, 10
    s_add_u32 m0, m0, 57344
    s_add_u32 s38, s3, 33280
    buffer_load_dwordx4 v5, s[8:11], s38 offen lds
    v_cos_f32 v127, v127
    v_mul_f32 v124, v116, v124
    v_mul_f32 v120, v116, v120
    v_mul_f32 v125, v117, v125
    v_mfma_f32_16x16x32_bf16 v[36:39], v[76:79], v[76:79], v[36:39]
    v_mul_f32 v121, v117, v121
    v_mul_f32 v126, v118, v126
    v_mul_f32 v122, v118, v122
    v_mul_f32 v127, v119, v127
    v_mul_f32 v123, v119, v123
    v_cvt_pk_f16_f32 v144, v124, v120
    ds_read_b128 v[60:63], v7 offset:2048
    v_cvt_pk_f16_f32 v145, v125, v121
    v_cvt_pk_f16_f32 v146, v126, v122
    v_cvt_pk_f16_f32 v147, v127, v123
    s_nop 1
    v_mfma_f32_16x16x32_f16 v[96:99], v[144:147], v[136:139], v[96:99]
    v_mul_f32_dpp v116, v104, v110 row_newbcast:4 row_mask:0xf bank_mask:0xf
    v_mul_f32_dpp v124, v105, v110 row_newbcast:4 row_mask:0xf bank_mask:0xf
    v_mfma_f32_16x16x32_bf16 v[40:43], v[48:51], v[76:79], v[40:43]
    v_mul_f32_dpp v117, v104, v110 row_newbcast:5 row_mask:0xf bank_mask:0xf
    v_mul_f32_dpp v125, v105, v110 row_newbcast:5 row_mask:0xf bank_mask:0xf
    v_mul_f32_dpp v118, v104, v110 row_newbcast:6 row_mask:0xf bank_mask:0xf
    v_mul_f32_dpp v126, v105, v110 row_newbcast:6 row_mask:0xf bank_mask:0xf
    v_mul_f32_dpp v119, v104, v110 row_newbcast:7 row_mask:0xf bank_mask:0xf
    v_mul_f32_dpp v127, v105, v110 row_newbcast:7 row_mask:0xf bank_mask:0xf
    ds_read_b128 v[64:67], v8 offset:2048
    v_exp_f32 v116, v116
    v_fract_f32 v124, v124
    v_exp_f32 v117, v117
    v_fract_f32 v125, v125
    v_exp_f32 v118, v118
    v_fract_f32 v126, v126
    s_waitcnt lgkmcnt(6)
    v_mfma_f32_16x16x32_bf16 v[24:27], v[80:83], v[192:195], v[24:27]
    s_lshl_b32 m0, s28, 10
    s_add_u32 m0, m0, 73728
    s_add_u32 s38, s3, 49664
    buffer_load_dwordx4 v5, s[8:11], s38 offen lds
    v_exp_f32 v119, v119
    v_fract_f32 v127, v127
    v_sin_f32 v120, v124
    v_cos_f32 v124, v124
    v_sin_f32 v121, v125
    ds_read_b128 v[68:71], v9 offset:2048
    v_cos_f32 v125, v125
    v_sin_f32 v122, v126
    v_cos_f32 v126, v126
    v_sin_f32 v123, v127
    v_cos_f32 v127, v127
    v_mul_f32 v124, v116, v124
    s_waitcnt lgkmcnt(6)
    v_mfma_f32_16x16x32_bf16 v[28:31], v[84:87], v[192:195], v[28:31]
    v_mul_f32 v120, v116, v120
    v_mul_f32 v125, v117, v125
    v_mul_f32 v121, v117, v121
    v_mul_f32 v126, v118, v126
    v_mul_f32 v122, v118, v122
    v_mul_f32 v127, v119, v127
    s_waitcnt lgkmcnt(5)
    v_mfma_f32_16x16x32_bf16 v[32:35], v[88:91], v[192:195], v[32:35]
    v_mul_f32 v123, v119, v123
    v_cvt_pk_f16_f32 v140, v124, v120
    v_cvt_pk_f16_f32 v141, v125, v121
    v_cvt_pk_f16_f32 v142, v126, v122
    v_cvt_pk_f16_f32 v143, v127, v123
    s_nop 1
    v_mfma_f32_16x16x32_f16 v[100:103], v[140:143], v[136:139], v[100:103]
    s_waitcnt vmcnt(9)
    s_barrier
    ds_read_b64_tr_b16 v[204:205], v160 offset:2048
    ds_read_b64_tr_b16 v[206:207], v160 offset:5120
    ds_read_b64_tr_b16 v[208:209], v160 offset:14336
    ds_read_b64_tr_b16 v[210:211], v160 offset:17408
    s_add_u32 m0, s69, 24576
    s_mov_b32 s38, 786432
    buffer_load_dwordx4 v4, s[12:15], s38 offen offset:0 lds
    s_add_u32 m0, s69, 24576
    s_mov_b32 s38, 786432
    buffer_load_dwordx4 v4, s[12:15], s38 offen offset:1024 lds
    s_add_u32 m0, s69, 24576
    s_mov_b32 s38, 786432
    buffer_load_dwordx4 v4, s[12:15], s38 offen offset:2048 lds
    s_waitcnt lgkmcnt(8)
    v_mfma_f32_16x16x32_bf16 v[16:19], v[52:55], v[196:199], v[16:19]
    v_lshrrev_b32 v116, 4, v1
    v_and_b32 v117, 15, v1
    v_lshrrev_b32 v118, 5, v1
    v_mfma_f32_16x16x32_bf16 v[44:47], v[52:55], v[52:55], v[44:47]
    v_and_b32 v119, 1, v116
    v_lshl_add_u32 v118, v118, 5, v119
    v_lshlrev_b32 v118, 2, v118
    ds_read_b128 v[72:75], v10 offset:2048
    v_lshl_add_u32 v118, v117, 3, v118
    s_mul_i32 s46, s28, 2624
    s_add_u32 s46, s46, 131072
    s_waitcnt lgkmcnt(8)
    v_mfma_f32_16x16x32_bf16 v[20:23], v[56:59], v[196:199], v[20:23]
    v_cvt_f32_u32 v132, v118
    v_lshl_add_u32 v108, v118, 2, s46
    v_lshlrev_b32 v118, 7, v116
    ds_read_b128 v[76:79], v11 offset:2048
    v_add_u32 v118, 256, v118
    v_lshlrev_b32 v119, 8, v116
    v_max_u32 v118, v118, v119
    v_mfma_f32_16x16x32_bf16 v[36:39], v[56:59], v[56:59], v[36:39]
    v_cvt_f32_u32 v136, v118
    v_add_f32 v136, v136, v111
    v_lshlrev_b32 v118, 9, v116
    ds_read_b128 v[80:83], v12 offset:2048
    v_add_u32 v118, 1024, v118
    v_cvt_f32_u32 v140, v118
    v_add_f32 v140, v140, v111
    v_mfma_f32_16x16x32_bf16 v[40:43], v[48:51], v[56:59], v[40:43]
    v_cmp_gt_u32 s[44:45], 32, v1
    s_mov_b32 s47, 0x43000000
    v_mov_b32 v120, 4.0
    ds_read_b128 v[84:87], v13 offset:2048
    v_mov_b32 v121, s47
    v_cndmask_b32 v121, v121, v120, s[44:45]
    v_cndmask_b32 v120, v120, 2.0, s[44:45]
    s_waitcnt lgkmcnt(10)
    v_mfma_f32_16x16x32_bf16 v[24:27], v[60:63], v[196:199], v[24:27]
    v_add_u32 v110, s46, v119
    v_lshlrev_b32 v118, 3, v117
    v_lshlrev_b32 v122, 4, v117
    ds_read_b128 v[88:91], v14 offset:2048
    v_cndmask_b32 v118, v118, v122, s[44:45]
    v_add_u32 v109, v110, v118
    v_mov_b32 v122, 128
    s_waitcnt lgkmcnt(10)
    v_mfma_f32_16x16x32_bf16 v[28:31], v[64:67], v[196:199], v[28:31]
    v_cndmask_b32 v122, v122, 8, s[44:45]
    v_add_u32 v105, v109, v122
    v_lshl_add_u32 v110, v117, 2, v110
    s_waitcnt lgkmcnt(9)
    v_mfma_f32_16x16x32_bf16 v[32:35], v[68:71], v[196:199], v[32:35]
    v_mul_f32 v122, s47, v112
    v_fma_f32 v132, v132, v112, v113
    v_fma_f32 v136, v136, v112, v113
    s_waitcnt lgkmcnt(4)
    v_mfma_f32_16x16x32_bf16 v[16:19], v[72:75], v[200:203], v[16:19]
    v_fma_f32 v140, v140, v112, v113
    v_add_f32 v133, v132, v112
    v_fma_f32 v134, 2.0, v112, v132
    v_mfma_f32_16x16x32_bf16 v[44:47], v[72:75], v[72:75], v[44:47]
    v_fma_f32 v137, v120, v112, v136
    v_fma_f32 v138, v121, v112, v136
    v_add_f32 v141, v140, v122
    ds_read_b128 v[52:55], v2 offset:4096
    v_fma_f32 v142, 2.0, v122, v140
    v_add_f32 v135, v134, v112
    v_fma_f32 v139, v120, v112, v138
    s_waitcnt lgkmcnt(4)
    v_mfma_f32_16x16x32_bf16 v[20:23], v[76:79], v[200:203], v[20:23]
    v_add_f32 v143, v142, v122
    v_exp_f32 v132, v132
    v_exp_f32 v133, v133
    ds_read_b128 v[56:59], v3 offset:4096
    v_exp_f32 v134, v134
    v_exp_f32 v135, v135
    v_exp_f32 v136, v136
    v_mfma_f32_16x16x32_bf16 v[36:39], v[76:79], v[76:79], v[36:39]
    v_exp_f32 v137, v137
    v_exp_f32 v138, v138
    v_exp_f32 v139, v139
    ds_read_b128 v[60:63], v7 offset:4096
    v_exp_f32 v140, v140
    v_exp_f32 v141, v141
    v_exp_f32 v142, v142
    v_mfma_f32_16x16x32_bf16 v[40:43], v[48:51], v[76:79], v[40:43]
    v_exp_f32 v143, v143
    v_mul_f32 v92, v92, v132
    v_mul_f32 v93, v93, v133
    ds_read_b128 v[64:67], v8 offset:4096
    v_mul_f32 v94, v94, v134
    v_mul_f32 v95, v95, v135
    s_waitcnt lgkmcnt(6)
    v_mfma_f32_16x16x32_bf16 v[24:27], v[80:83], v[200:203], v[24:27]
    v_mul_f32 v96, v96, v136
    v_mul_f32 v97, v97, v137
    ds_read_b128 v[68:71], v9 offset:4096
    v_mul_f32 v98, v98, v138
    v_mul_f32 v99, v99, v139
    s_waitcnt lgkmcnt(6)
    v_mfma_f32_16x16x32_bf16 v[28:31], v[84:87], v[200:203], v[28:31]
    v_mul_f32 v100, v100, v140
    v_mul_f32 v101, v101, v141
    s_waitcnt lgkmcnt(5)
    v_mfma_f32_16x16x32_bf16 v[32:35], v[88:91], v[200:203], v[32:35]
    v_mul_f32 v102, v102, v142
    v_mul_f32 v103, v103, v143
    s_waitcnt vmcnt(8)
    s_barrier
    ds_read_b64_tr_b16 v[212:213], v15 offset:2048
    ds_read_b64_tr_b16 v[214:215], v15 offset:5120
    ds_read_b64_tr_b16 v[216:217], v15 offset:14336
    ds_read_b64_tr_b16 v[218:219], v15 offset:17408
    s_add_u32 m0, s69, 49152
    s_mov_b32 s38, 983040
    buffer_load_dwordx4 v4, s[12:15], s38 offen offset:0 lds
    s_add_u32 m0, s69, 49152
    s_mov_b32 s38, 983040
    buffer_load_dwordx4 v4, s[12:15], s38 offen offset:1024 lds
    s_add_u32 m0, s69, 49152
    s_mov_b32 s38, 983040
    buffer_load_dwordx4 v4, s[12:15], s38 offen offset:2048 lds
    s_waitcnt lgkmcnt(8)
    v_mfma_f32_16x16x32_bf16 v[16:19], v[52:55], v[204:207], v[16:19]
    v_mfma_f32_16x16x32_bf16 v[44:47], v[52:55], v[52:55], v[44:47]
    ds_read_b128 v[72:75], v10 offset:4096
    s_waitcnt lgkmcnt(8)
    v_mfma_f32_16x16x32_bf16 v[20:23], v[56:59], v[204:207], v[20:23]
    ds_read_b128 v[76:79], v11 offset:4096
    v_mfma_f32_16x16x32_bf16 v[36:39], v[56:59], v[56:59], v[36:39]
    ds_read_b128 v[80:83], v12 offset:4096
    v_mfma_f32_16x16x32_bf16 v[40:43], v[48:51], v[56:59], v[40:43]
    ds_read_b128 v[84:87], v13 offset:4096
    s_waitcnt lgkmcnt(10)
    v_mfma_f32_16x16x32_bf16 v[24:27], v[60:63], v[204:207], v[24:27]
    ds_read_b128 v[88:91], v14 offset:4096
    s_waitcnt lgkmcnt(10)
    v_mfma_f32_16x16x32_bf16 v[28:31], v[64:67], v[204:207], v[28:31]
    s_waitcnt lgkmcnt(9)
    v_mfma_f32_16x16x32_bf16 v[32:35], v[68:71], v[204:207], v[32:35]
    s_waitcnt lgkmcnt(4)
    v_mfma_f32_16x16x32_bf16 v[16:19], v[72:75], v[208:211], v[16:19]
    v_mfma_f32_16x16x32_bf16 v[44:47], v[72:75], v[72:75], v[44:47]
    ds_read_b128 v[52:55], v2 offset:6144
    s_waitcnt lgkmcnt(4)
    v_mfma_f32_16x16x32_bf16 v[20:23], v[76:79], v[208:211], v[20:23]
    ds_read_b128 v[56:59], v3 offset:6144
    v_mfma_f32_16x16x32_bf16 v[36:39], v[76:79], v[76:79], v[36:39]
    ds_read_b128 v[60:63], v7 offset:6144
    v_mfma_f32_16x16x32_bf16 v[40:43], v[48:51], v[76:79], v[40:43]
    ds_read_b128 v[64:67], v8 offset:6144
    s_waitcnt lgkmcnt(6)
    v_mfma_f32_16x16x32_bf16 v[24:27], v[80:83], v[208:211], v[24:27]
    ds_read_b128 v[68:71], v9 offset:6144
    s_waitcnt lgkmcnt(6)
    v_mfma_f32_16x16x32_bf16 v[28:31], v[84:87], v[208:211], v[28:31]
    s_waitcnt lgkmcnt(5)
    v_mfma_f32_16x16x32_bf16 v[32:35], v[88:91], v[208:211], v[32:35]
    s_waitcnt vmcnt(3)
    s_barrier
    ds_read_b64_tr_b16 v[220:221], v15 offset:26624
    ds_read_b64_tr_b16 v[222:223], v15 offset:29696
    ds_read_b64_tr_b16 v[224:225], v15 offset:38912
    ds_read_b64_tr_b16 v[226:227], v15 offset:41984
    s_add_u32 m0, s69, 0
    s_mov_b32 s38, 1179648
    buffer_load_dwordx4 v4, s[12:15], s38 offen offset:0 lds
    s_add_u32 m0, s69, 0
    s_mov_b32 s38, 1179648
    buffer_load_dwordx4 v4, s[12:15], s38 offen offset:1024 lds
    s_add_u32 m0, s69, 0
    s_mov_b32 s38, 1179648
    buffer_load_dwordx4 v4, s[12:15], s38 offen offset:2048 lds
    s_waitcnt lgkmcnt(8)
    v_mfma_f32_16x16x32_bf16 v[16:19], v[52:55], v[212:215], v[16:19]
    v_mfma_f32_16x16x32_bf16 v[44:47], v[52:55], v[52:55], v[44:47]
    ds_read_b128 v[72:75], v10 offset:6144
    s_waitcnt lgkmcnt(8)
    v_mfma_f32_16x16x32_bf16 v[20:23], v[56:59], v[212:215], v[20:23]
    ds_read_b128 v[76:79], v11 offset:6144
    v_mfma_f32_16x16x32_bf16 v[36:39], v[56:59], v[56:59], v[36:39]
    ds_read_b128 v[80:83], v12 offset:6144
    v_mfma_f32_16x16x32_bf16 v[40:43], v[48:51], v[56:59], v[40:43]
    ds_read_b128 v[84:87], v13 offset:6144
    s_waitcnt lgkmcnt(10)
    v_mfma_f32_16x16x32_bf16 v[24:27], v[60:63], v[212:215], v[24:27]
    ds_read_b128 v[88:91], v14 offset:6144
    s_waitcnt lgkmcnt(10)
    v_mfma_f32_16x16x32_bf16 v[28:31], v[64:67], v[212:215], v[28:31]
    s_waitcnt lgkmcnt(9)
    v_mfma_f32_16x16x32_bf16 v[32:35], v[68:71], v[212:215], v[32:35]
    s_waitcnt lgkmcnt(4)
    v_mfma_f32_16x16x32_bf16 v[16:19], v[72:75], v[216:219], v[16:19]
    v_mfma_f32_16x16x32_bf16 v[44:47], v[72:75], v[72:75], v[44:47]
    ds_read_b128 v[52:55], v2 offset:8192
    s_waitcnt lgkmcnt(4)
    v_mfma_f32_16x16x32_bf16 v[20:23], v[76:79], v[216:219], v[20:23]
    ds_read_b128 v[56:59], v3 offset:8192
    v_mfma_f32_16x16x32_bf16 v[36:39], v[76:79], v[76:79], v[36:39]
    ds_read_b128 v[60:63], v7 offset:8192
    v_mfma_f32_16x16x32_bf16 v[40:43], v[48:51], v[76:79], v[40:43]
    ds_read_b128 v[64:67], v8 offset:8192
    s_waitcnt lgkmcnt(6)
    v_mfma_f32_16x16x32_bf16 v[24:27], v[80:83], v[216:219], v[24:27]
    ds_read_b128 v[68:71], v9 offset:8192
    s_waitcnt lgkmcnt(6)
    v_mfma_f32_16x16x32_bf16 v[28:31], v[84:87], v[216:219], v[28:31]
    s_waitcnt lgkmcnt(5)
    v_mfma_f32_16x16x32_bf16 v[32:35], v[88:91], v[216:219], v[32:35]
    s_waitcnt vmcnt(3)
    s_barrier
    ds_read_b64_tr_b16 v[228:229], v160 offset:2048
    ds_read_b64_tr_b16 v[230:231], v160 offset:5120
    ds_read_b64_tr_b16 v[232:233], v160 offset:14336
    ds_read_b64_tr_b16 v[234:235], v160 offset:17408
    s_add_u32 m0, s69, 24576
    s_mov_b32 s38, 1376256
    buffer_load_dwordx4 v4, s[12:15], s38 offen offset:0 lds
    s_add_u32 m0, s69, 24576
    s_mov_b32 s38, 1376256
    buffer_load_dwordx4 v4, s[12:15], s38 offen offset:1024 lds
    s_add_u32 m0, s69, 24576
    s_mov_b32 s38, 1376256
    buffer_load_dwordx4 v4, s[12:15], s38 offen offset:2048 lds
    s_waitcnt lgkmcnt(8)
    v_mfma_f32_16x16x32_bf16 v[16:19], v[52:55], v[220:223], v[16:19]
    v_mfma_f32_16x16x32_bf16 v[44:47], v[52:55], v[52:55], v[44:47]
    ds_read_b128 v[72:75], v10 offset:8192
    s_waitcnt lgkmcnt(8)
    v_mfma_f32_16x16x32_bf16 v[20:23], v[56:59], v[220:223], v[20:23]
    ds_read_b128 v[76:79], v11 offset:8192
    v_mfma_f32_16x16x32_bf16 v[36:39], v[56:59], v[56:59], v[36:39]
    ds_read_b128 v[80:83], v12 offset:8192
    v_mfma_f32_16x16x32_bf16 v[40:43], v[48:51], v[56:59], v[40:43]
    ds_read_b128 v[84:87], v13 offset:8192
    s_waitcnt lgkmcnt(10)
    v_mfma_f32_16x16x32_bf16 v[24:27], v[60:63], v[220:223], v[24:27]
    ds_read_b128 v[88:91], v14 offset:8192
    s_waitcnt lgkmcnt(10)
    v_mfma_f32_16x16x32_bf16 v[28:31], v[64:67], v[220:223], v[28:31]
    s_waitcnt lgkmcnt(9)
    v_mfma_f32_16x16x32_bf16 v[32:35], v[68:71], v[220:223], v[32:35]
    s_waitcnt lgkmcnt(4)
    v_mfma_f32_16x16x32_bf16 v[16:19], v[72:75], v[224:227], v[16:19]
    v_mfma_f32_16x16x32_bf16 v[44:47], v[72:75], v[72:75], v[44:47]
    ds_read_b128 v[52:55], v2 offset:10240
    s_waitcnt lgkmcnt(4)
    v_mfma_f32_16x16x32_bf16 v[20:23], v[76:79], v[224:227], v[20:23]
    ds_read_b128 v[56:59], v3 offset:10240
    v_mfma_f32_16x16x32_bf16 v[36:39], v[76:79], v[76:79], v[36:39]
    ds_read_b128 v[60:63], v7 offset:10240
    v_mfma_f32_16x16x32_bf16 v[40:43], v[48:51], v[76:79], v[40:43]
    ds_read_b128 v[64:67], v8 offset:10240
    s_waitcnt lgkmcnt(6)
    v_mfma_f32_16x16x32_bf16 v[24:27], v[80:83], v[224:227], v[24:27]
    ds_read_b128 v[68:71], v9 offset:10240
    s_waitcnt lgkmcnt(6)
    v_mfma_f32_16x16x32_bf16 v[28:31], v[84:87], v[224:227], v[28:31]
    s_waitcnt lgkmcnt(5)
    v_mfma_f32_16x16x32_bf16 v[32:35], v[88:91], v[224:227], v[32:35]
    s_waitcnt vmcnt(3)
    s_barrier
    ds_read_b64_tr_b16 v[236:237], v15 offset:2048
    ds_read_b64_tr_b16 v[238:239], v15 offset:5120
    ds_read_b64_tr_b16 v[240:241], v15 offset:14336
    ds_read_b64_tr_b16 v[242:243], v15 offset:17408
    s_waitcnt lgkmcnt(8)
    v_mfma_f32_16x16x32_bf16 v[16:19], v[52:55], v[228:231], v[16:19]
    ds_write_b128 v108, v[92:95]
    ds_write_b64 v109, v[96:97] offset:1024
    ds_write_b64 v105, v[98:99] offset:1024
    s_mov_b32 exec_hi, 1
    ds_write_b32 v110, v100 offset:2048
    s_mov_b32 exec_hi, 0
    ds_write_b32 v110, v101 offset:2112
    ds_write_b32 v110, v102 offset:2176
    ds_write_b32 v110, v103 offset:2240
    s_mov_b32 exec_hi, -1
    v_mfma_f32_16x16x32_bf16 v[44:47], v[52:55], v[52:55], v[44:47]
    ds_read_b128 v[72:75], v10 offset:10240
    s_waitcnt lgkmcnt(15)
    v_mfma_f32_16x16x32_bf16 v[20:23], v[56:59], v[228:231], v[20:23]
    ds_read_b128 v[76:79], v11 offset:10240
    v_mfma_f32_16x16x32_bf16 v[36:39], v[56:59], v[56:59], v[36:39]
    ds_read_b128 v[80:83], v12 offset:10240
    v_mfma_f32_16x16x32_bf16 v[40:43], v[48:51], v[56:59], v[40:43]
    ds_read_b128 v[84:87], v13 offset:10240
    s_waitcnt lgkmcnt(15)
    v_mfma_f32_16x16x32_bf16 v[24:27], v[60:63], v[228:231], v[24:27]
    ds_read_b128 v[88:91], v14 offset:10240
    v_mfma_f32_16x16x32_bf16 v[28:31], v[64:67], v[228:231], v[28:31]
    v_mfma_f32_16x16x32_bf16 v[32:35], v[68:71], v[228:231], v[32:35]
    s_waitcnt lgkmcnt(4)
    v_mfma_f32_16x16x32_bf16 v[16:19], v[72:75], v[232:235], v[16:19]
    v_mfma_f32_16x16x32_bf16 v[44:47], v[72:75], v[72:75], v[44:47]
    ds_read_b128 v[52:55], v2 offset:12288
    s_waitcnt lgkmcnt(4)
    v_mfma_f32_16x16x32_bf16 v[20:23], v[76:79], v[232:235], v[20:23]
    ds_read_b128 v[56:59], v3 offset:12288
    v_mfma_f32_16x16x32_bf16 v[36:39], v[76:79], v[76:79], v[36:39]
    ds_read_b128 v[60:63], v7 offset:12288
    v_mfma_f32_16x16x32_bf16 v[40:43], v[48:51], v[76:79], v[40:43]
    ds_read_b128 v[64:67], v8 offset:12288
    s_waitcnt lgkmcnt(6)
    v_mfma_f32_16x16x32_bf16 v[24:27], v[80:83], v[232:235], v[24:27]
    ds_read_b128 v[68:71], v9 offset:12288
    s_waitcnt lgkmcnt(6)
    v_mfma_f32_16x16x32_bf16 v[28:31], v[84:87], v[232:235], v[28:31]
    s_waitcnt lgkmcnt(5)
    v_mfma_f32_16x16x32_bf16 v[32:35], v[88:91], v[232:235], v[32:35]
    s_waitcnt lgkmcnt(0)
    s_waitcnt vmcnt(0)
    s_barrier
    ds_read_b64_tr_b16 v[244:245], v15 offset:26624
    ds_read_b64_tr_b16 v[246:247], v15 offset:29696
    ds_read_b64_tr_b16 v[248:249], v15 offset:38912
    ds_read_b64_tr_b16 v[250:251], v15 offset:41984
    v_mfma_f32_16x16x32_bf16 v[16:19], v[52:55], v[236:239], v[16:19]
    v_mfma_f32_16x16x32_bf16 v[44:47], v[52:55], v[52:55], v[44:47]
    ds_read_b128 v[72:75], v10 offset:12288
    v_mfma_f32_16x16x32_bf16 v[20:23], v[56:59], v[236:239], v[20:23]
    ds_read_b128 v[76:79], v11 offset:12288
    v_mfma_f32_16x16x32_bf16 v[36:39], v[56:59], v[56:59], v[36:39]
    ds_read_b128 v[80:83], v12 offset:12288
    v_mfma_f32_16x16x32_bf16 v[40:43], v[48:51], v[56:59], v[40:43]
    ds_read_b128 v[84:87], v13 offset:12288
    v_mfma_f32_16x16x32_bf16 v[24:27], v[60:63], v[236:239], v[24:27]
    ds_read_b128 v[88:91], v14 offset:12288
    v_mfma_f32_16x16x32_bf16 v[28:31], v[64:67], v[236:239], v[28:31]
    v_mfma_f32_16x16x32_bf16 v[32:35], v[68:71], v[236:239], v[32:35]
    s_waitcnt lgkmcnt(4)
    v_mfma_f32_16x16x32_bf16 v[16:19], v[72:75], v[240:243], v[16:19]
    v_mfma_f32_16x16x32_bf16 v[44:47], v[72:75], v[72:75], v[44:47]
    ds_read_b128 v[52:55], v2 offset:14336
    s_waitcnt lgkmcnt(4)
    v_mfma_f32_16x16x32_bf16 v[20:23], v[76:79], v[240:243], v[20:23]
    ds_read_b128 v[56:59], v3 offset:14336
    v_mfma_f32_16x16x32_bf16 v[36:39], v[76:79], v[76:79], v[36:39]
    ds_read_b128 v[60:63], v7 offset:14336
    v_mfma_f32_16x16x32_bf16 v[40:43], v[48:51], v[76:79], v[40:43]
    ds_read_b128 v[64:67], v8 offset:14336
    s_waitcnt lgkmcnt(6)
    v_mfma_f32_16x16x32_bf16 v[24:27], v[80:83], v[240:243], v[24:27]
    ds_read_b128 v[68:71], v9 offset:14336
    s_waitcnt lgkmcnt(6)
    v_mfma_f32_16x16x32_bf16 v[28:31], v[84:87], v[240:243], v[28:31]
    s_waitcnt lgkmcnt(5)
    v_mfma_f32_16x16x32_bf16 v[32:35], v[88:91], v[240:243], v[32:35]
    s_waitcnt lgkmcnt(0)
    s_barrier
    v_mfma_f32_16x16x32_bf16 v[16:19], v[52:55], v[244:247], v[16:19]
    v_mfma_f32_16x16x32_bf16 v[44:47], v[52:55], v[52:55], v[44:47]
    ds_read_b128 v[72:75], v10 offset:14336
    v_mfma_f32_16x16x32_bf16 v[20:23], v[56:59], v[244:247], v[20:23]
    ds_read_b128 v[76:79], v11 offset:14336
    v_mfma_f32_16x16x32_bf16 v[36:39], v[56:59], v[56:59], v[36:39]
    ds_read_b128 v[80:83], v12 offset:14336
    v_mfma_f32_16x16x32_bf16 v[40:43], v[48:51], v[56:59], v[40:43]
    ds_read_b128 v[84:87], v13 offset:14336
    v_mfma_f32_16x16x32_bf16 v[24:27], v[60:63], v[244:247], v[24:27]
    ds_read_b128 v[88:91], v14 offset:14336
    v_mfma_f32_16x16x32_bf16 v[28:31], v[64:67], v[244:247], v[28:31]
    v_mfma_f32_16x16x32_bf16 v[32:35], v[68:71], v[244:247], v[32:35]
    s_waitcnt lgkmcnt(4)
    v_mfma_f32_16x16x32_bf16 v[16:19], v[72:75], v[248:251], v[16:19]
    v_mfma_f32_16x16x32_bf16 v[44:47], v[72:75], v[72:75], v[44:47]
    s_waitcnt lgkmcnt(3)
    v_mfma_f32_16x16x32_bf16 v[20:23], v[76:79], v[248:251], v[20:23]
    v_mfma_f32_16x16x32_bf16 v[36:39], v[76:79], v[76:79], v[36:39]
    v_mfma_f32_16x16x32_bf16 v[40:43], v[48:51], v[76:79], v[40:43]
    s_waitcnt lgkmcnt(2)
    v_mfma_f32_16x16x32_bf16 v[24:27], v[80:83], v[248:251], v[24:27]
    s_waitcnt lgkmcnt(1)
    v_mfma_f32_16x16x32_bf16 v[28:31], v[84:87], v[248:251], v[28:31]
    s_waitcnt lgkmcnt(0)
    v_mfma_f32_16x16x32_bf16 v[32:35], v[88:91], v[248:251], v[32:35]
    v_mov_b32 v252, v16
    v_mov_b32 v253, v16
    s_nop 1
    v_permlane16_swap_b32 v252, v253
    v_mov_b32 v253, v252
    s_nop 1
    v_permlane32_swap_b32 v252, v253
    s_nop 2
v_common:
    v_and_b32 v10, 15, v1
    v_lshrrev_b32 v11, 4, v1
    v_and_b32 v12, 1, v1
    v_cmp_eq_u32 s[40:41], 1, v12
    v_and_b32 v12, 2, v1
    v_cmp_eq_u32 s[42:43], 2, v12
    s_mov_b32 s44, 0x3b000000
    v_mov_b32 v13, 0x3727c5ac
    s_lshl_b32 s45, s52, 7
    s_add_u32 s45, s45, 155648
    v_lshl_add_u32 v14, v10, 3, s45
    s_lshl_b32 s45, s52, 6
    s_add_u32 s45, s45, 156288
    v_lshl_add_u32 v15, v10, 2, s45
    v_lshlrev_b32 v60, 3, v10
    v_lshlrev_b32 v61, 2, v10
    v_mov_b32 v54, v44
    v_mov_b32 v55, v44
    s_nop 1
    v_permlane16_swap_b32 v54, v55
    v_mov_b32 v55, v54
    s_nop 1
    v_permlane32_swap_b32 v54, v55
    v_cndmask_b32 v56, v36, v37, s[40:41]
    v_cndmask_b32 v57, v38, v39, s[40:41]
    v_cndmask_b32 v53, v56, v57, s[42:43]
    v_cndmask_b32 v56, v44, v45, s[40:41]
    v_cndmask_b32 v57, v46, v47, s[40:41]
    v_cndmask_b32 v55, v56, v57, s[42:43]
    v_mul_f32 v52, s44, v40
    v_mul_f32 v54, s44, v54
    v_fma_f32 v53, v53, s44, v13
    v_fma_f32 v55, v55, s44, v13
    v_fma_f32 v53, -v52, v52, v53
    v_fma_f32 v55, -v54, v54, v55
    v_max_f32 v53, v13, v53
    v_max_f32 v55, v13, v55
    v_sqrt_f32 v53, v53
    v_sqrt_f32 v55, v55
    v_cvt_pk_bf16_f32 v56, v52, v54
    v_cvt_pk_bf16_f32 v57, v53, v55
    v_lshlrev_b32 v52, 16, v56
    v_and_b32 v54, 0xffff0000, v56
    v_lshlrev_b32 v53, 16, v57
    v_and_b32 v55, 0xffff0000, v57
    v_rcp_f32 v53, v53
    v_rcp_f32 v55, v55
    s_mov_b32 exec_lo, 0x00f0000f
    s_mov_b32 exec_hi, 0xf0000f00
    ds_write_b64 v14, v[52:53]
    ds_write_b32 v15, v52
    ds_write_b32 v15, v53 offset:320
    v_add_u32 v60, 155648, v60
    v_add_u32 v61, 156288, v61
    ds_write_b64 v60, v[54:55]
    ds_write_b32 v61, v54
    ds_write_b32 v61, v55 offset:320
    s_mov_b64 exec, 1
    v_mov_b32 v12, 156928
    v_mov_b32 v13, 1
    ds_add_u32 v12, v13
    s_mov_b64 exec, -1
    v_mov_b32 v12, 156928
    s_and_b32 s45, s29, 1
    s_lshl_b32 s45, s45, 2
    v_lshrrev_b32 v15, 1, v11
    v_xor_b32 v15, v15, v10
    v_xor_b32 v15, s45, v15
    v_and_b32 v15, 7, v15
    v_and_b32 v14, 7, v10
    v_lshlrev_b32 v14, 8, v14
    v_lshl_add_u32 v14, v15, 4, v14
    v_lshrrev_b32 v15, 3, v10
    v_lshl_add_u32 v14, v15, 14, v14
    v_and_b32 v15, 1, v11
    v_lshl_add_u32 v14, v15, 3, v14
    s_lshr_b32 s45, s31, 2
    s_lshl_b32 s45, s45, 15
    s_and_b32 s46, s31, 3
    s_lshl_b32 s46, s46, 12
    s_add_u32 s45, s45, s46
    s_lshr_b32 s46, s29, 1
    s_lshl_b32 s46, s46, 11
    s_add_u32 s45, s45, s46
    s_add_u32 s45, s45, 16384
    v_add_u32 v14, s45, v14
    v_xor_b32 v15, 32, v14
    v_lshlrev_b32 v96, 4, v11
    v_add_u32 v96, 156288, v96
    s_mul_i32 s45, s29, 2560
    s_add_u32 s45, s45, 81920
    v_lshl_add_u32 v101, v1, 3, s45
    s_lshl_b32 s45, s52, 6
    v_add_u32 v97, s45, v96
    s_lshl_b32 s45, s52, 9
    v_add_u32 v102, s45, v101
    s_lshl_b32 s45, s53, 6
    v_add_u32 v98, s45, v96
    s_lshl_b32 s45, s53, 9
    v_add_u32 v103, s45, v101
    s_lshl_b32 s45, s54, 6
    v_add_u32 v99, s45, v96
    s_lshl_b32 s45, s54, 9
    v_add_u32 v104, s45, v101
    s_lshl_b32 s45, s55, 6
    v_add_u32 v100, s45, v96
    s_lshl_b32 s45, s55, 9
    v_add_u32 v105, s45, v101
    s_lshl_b32 s45, s34, 2
    s_add_u32 s45, s45, 4
    s_mov_b32 s38, 0
v_spin:
    ds_read_b32 v13, v12
    ds_read_b128 v[56:59], v96
    ds_read_b128 v[60:63], v96 offset:320
    ds_read_b128 v[64:67], v97
    ds_read_b128 v[68:71], v97 offset:320
    ds_read_b128 v[72:75], v98
    ds_read_b128 v[76:79], v98 offset:320
    ds_read_b128 v[80:83], v99
    ds_read_b128 v[84:87], v99 offset:320
    ds_read_b128 v[88:91], v100
    ds_read_b128 v[92:95], v100 offset:320
    s_add_u32 s38, s38, 1
    s_waitcnt lgkmcnt(10)
    v_cmp_gt_u32 vcc, s45, v13
    s_cmp_gt_u32 s38, 131072
    s_cbranch_scc1 v_spin_x
    s_cbranch_vccnz v_spin
v_spin_x:
    ds_read_b64 v[106:107], v14
    ds_read_b64 v[108:109], v14 offset:128
    ds_read_b64 v[110:111], v15
    ds_read_b64 v[112:113], v15 offset:128
    s_waitcnt lgkmcnt(4)
    v_pk_fma_f32 v[16:17], v[56:57], v[252:253], v[16:17] op_sel_hi:[1,0,1] neg_lo:[1,0,0] neg_hi:[1,0,0]
    v_pk_fma_f32 v[18:19], v[58:59], v[252:253], v[18:19] op_sel_hi:[1,0,1] neg_lo:[1,0,0] neg_hi:[1,0,0]
    v_pk_fma_f32 v[20:21], v[64:65], v[252:253], v[20:21] op_sel_hi:[1,0,1] neg_lo:[1,0,0] neg_hi:[1,0,0]
    v_pk_fma_f32 v[22:23], v[66:67], v[252:253], v[22:23] op_sel_hi:[1,0,1] neg_lo:[1,0,0] neg_hi:[1,0,0]
    v_pk_fma_f32 v[24:25], v[72:73], v[252:253], v[24:25] op_sel_hi:[1,0,1] neg_lo:[1,0,0] neg_hi:[1,0,0]
    v_pk_fma_f32 v[26:27], v[74:75], v[252:253], v[26:27] op_sel_hi:[1,0,1] neg_lo:[1,0,0] neg_hi:[1,0,0]
    v_pk_fma_f32 v[28:29], v[80:81], v[252:253], v[28:29] op_sel_hi:[1,0,1] neg_lo:[1,0,0] neg_hi:[1,0,0]
    v_pk_fma_f32 v[30:31], v[82:83], v[252:253], v[30:31] op_sel_hi:[1,0,1] neg_lo:[1,0,0] neg_hi:[1,0,0]
    v_pk_fma_f32 v[32:33], v[88:89], v[252:253], v[32:33] op_sel_hi:[1,0,1] neg_lo:[1,0,0] neg_hi:[1,0,0]
    v_pk_fma_f32 v[34:35], v[90:91], v[252:253], v[34:35] op_sel_hi:[1,0,1] neg_lo:[1,0,0] neg_hi:[1,0,0]
    v_pk_mul_f32 v[16:17], v[16:17], v[60:61]
    v_pk_mul_f32 v[18:19], v[18:19], v[62:63]
    v_pk_mul_f32 v[20:21], v[20:21], v[68:69]
    v_pk_mul_f32 v[22:23], v[22:23], v[70:71]
    v_pk_mul_f32 v[24:25], v[24:25], v[76:77]
    v_pk_mul_f32 v[26:27], v[26:27], v[78:79]
    v_pk_mul_f32 v[28:29], v[28:29], v[84:85]
    v_pk_mul_f32 v[30:31], v[30:31], v[86:87]
    v_pk_mul_f32 v[32:33], v[32:33], v[92:93]
    v_pk_mul_f32 v[34:35], v[34:35], v[94:95]
    v_cvt_pk_bf16_f32 v16, v16, v17
    v_cvt_pk_bf16_f32 v17, v18, v19
    ds_write_b64 v101, v[16:17]
    v_cvt_pk_bf16_f32 v20, v20, v21
    v_cvt_pk_bf16_f32 v21, v22, v23
    ds_write_b64 v102, v[20:21]
    v_cvt_pk_bf16_f32 v24, v24, v25
    v_cvt_pk_bf16_f32 v25, v26, v27
    ds_write_b64 v103, v[24:25]
    v_cvt_pk_bf16_f32 v28, v28, v29
    v_cvt_pk_bf16_f32 v29, v30, v31
    ds_write_b64 v104, v[28:29]
    v_cvt_pk_bf16_f32 v32, v32, v33
    v_cvt_pk_bf16_f32 v33, v34, v35
    ds_write_b64 v105, v[32:33]
    s_waitcnt lgkmcnt(0)
    v_mov_b32 v24, v106
    v_mov_b32 v25, v107
    v_mov_b32 v26, v108
    v_mov_b32 v27, v109
    v_mov_b32 v28, v110
    v_mov_b32 v29, v111
    v_mov_b32 v30, v112
    v_mov_b32 v31, v113
    s_waitcnt vmcnt(0)
    s_setprio 0
    s_barrier
    v_lshrrev_b32 v10, 5, v1
    v_bfe_u32 v11, v1, 3, 2
    v_lshl_add_u32 v4, v10, 3, v11
    v_lshlrev_b32 v4, 10, v4
    v_bfe_u32 v11, v1, 1, 2
    v_lshrrev_b32 v10, 4, v1
    v_xor_b32 v11, v11, v10
    v_lshl_add_u32 v4, v11, 5, v4
    v_and_b32 v11, 1, v1
    v_lshl_add_u32 v4, v11, 4, v4
    s_and_b32 s38, s31, 3
    s_lshl_b32 s38, s38, 8
    s_lshr_b32 s39, s29, 1
    s_lshl_b32 s39, s39, 14
    s_add_u32 s38, s38, s39
    s_and_b32 s39, s29, 1
    s_lshl_b32 s39, s39, 12
    s_add_u32 s38, s38, s39
    v_add_u32 v4, s38, v4
    v_lshrrev_b32 v14, 5, v1
    v_lshlrev_b32 v14, 12, v14
    v_bfe_u32 v10, v1, 2, 3
    v_lshl_add_u32 v14, v10, 7, v14
    s_and_b32 s38, s29, 1
    s_lshl_b32 s38, s38, 1
    v_bfe_u32 v10, v1, 3, 2
    v_xor_b32 v10, s38, v10
    v_lshl_add_u32 v14, v10, 5, v14
    v_and_b32 v10, 3, v1
    v_lshl_add_u32 v14, v10, 3, v14
    s_lshr_b32 s38, s29, 1
    s_lshl_b32 s38, s38, 10
    v_add_u32 v14, s38, v14
    v_xor_b32 v15, 32, v14
    v_add_u32 v12, 98304, v14
    v_add_u32 v13, 98304, v15
    s_lshl_b32 m0, s29, 11
    s_add_u32 m0, m0, 0
    s_mov_b32 s38, 196608
    buffer_load_dwordx4 v4, s[16:19], s38 offen lds
    ds_read_b64_tr_b16 v[48:49], v12 offset:0
    ds_read_b64_tr_b16 v[50:51], v12 offset:2048
    ds_read_b64_tr_b16 v[52:53], v13 offset:0
    ds_read_b64_tr_b16 v[54:55], v13 offset:2048
    s_add_u32 m0, m0, 1024
    s_mov_b32 s38, 196736
    buffer_load_dwordx4 v4, s[16:19], s38 offen lds
    ds_read_b64_tr_b16 v[56:57], v12 offset:8192
    ds_read_b64_tr_b16 v[58:59], v12 offset:10240
    ds_read_b64_tr_b16 v[60:61], v13 offset:8192
    ds_read_b64_tr_b16 v[62:63], v13 offset:10240
    s_add_u32 m0, m0, 7168
    s_mov_b32 s38, 229376
    buffer_load_dwordx4 v4, s[16:19], s38 offen lds
    ds_read_b64_tr_b16 v[64:65], v12 offset:16384
    ds_read_b64_tr_b16 v[66:67], v12 offset:18432
    ds_read_b64_tr_b16 v[68:69], v13 offset:16384
    ds_read_b64_tr_b16 v[70:71], v13 offset:18432
    s_add_u32 m0, m0, 1024
    s_mov_b32 s38, 229504
    buffer_load_dwordx4 v4, s[16:19], s38 offen lds
    ds_read_b64_tr_b16 v[72:73], v12 offset:24576
    ds_read_b64_tr_b16 v[74:75], v12 offset:26624
    ds_read_b64_tr_b16 v[76:77], v13 offset:24576
    ds_read_b64_tr_b16 v[78:79], v13 offset:26624
    s_add_u32 m0, m0, 7168
    s_mov_b32 s38, 262144
    buffer_load_dwordx4 v4, s[16:19], s38 offen lds
    ds_read_b64_tr_b16 v[80:81], v12 offset:32768
    ds_read_b64_tr_b16 v[82:83], v12 offset:34816
    ds_read_b64_tr_b16 v[84:85], v13 offset:32768
    ds_read_b64_tr_b16 v[86:87], v13 offset:34816
    s_add_u32 m0, m0, 1024
    s_mov_b32 s38, 262272
    buffer_load_dwordx4 v4, s[16:19], s38 offen lds
    ds_read_b64_tr_b16 v[88:89], v12 offset:40960
    ds_read_b64_tr_b16 v[90:91], v12 offset:43008
    ds_read_b64_tr_b16 v[92:93], v13 offset:40960
    ds_read_b64_tr_b16 v[94:95], v13 offset:43008
    s_add_u32 m0, m0, 7168
    s_mov_b32 s38, 294912
    buffer_load_dwordx4 v4, s[16:19], s38 offen lds
    s_add_u32 m0, m0, 1024
    s_mov_b32 s38, 295040
    buffer_load_dwordx4 v4, s[16:19], s38 offen lds
    s_add_u32 m0, m0, 7168
    s_mov_b32 s38, 327680
    buffer_load_dwordx4 v4, s[16:19], s38 offen lds
    s_add_u32 m0, m0, 1024
    s_mov_b32 s38, 327808
    buffer_load_dwordx4 v4, s[16:19], s38 offen lds
    s_add_u32 m0, m0, 7168
    s_mov_b32 s38, 360448
    buffer_load_dwordx4 v4, s[16:19], s38 offen lds
    s_add_u32 m0, m0, 1024
    s_mov_b32 s38, 360576
    buffer_load_dwordx4 v4, s[16:19], s38 offen lds
    s_add_u32 m0, m0, 7168
    s_mov_b32 s38, 393216
    buffer_load_dwordx4 v4, s[16:19], s38 offen lds
    s_add_u32 m0, m0, 1024
    s_mov_b32 s38, 393344
    buffer_load_dwordx4 v4, s[16:19], s38 offen lds
    s_add_u32 m0, m0, 7168
    s_mov_b32 s38, 425984
    buffer_load_dwordx4 v4, s[16:19], s38 offen lds
    s_add_u32 m0, m0, 1024
    s_mov_b32 s38, 426112
    buffer_load_dwordx4 v4, s[16:19], s38 offen lds
    s_add_u32 m0, m0, 7168
    s_mov_b32 s38, 458752
    buffer_load_dwordx4 v4, s[16:19], s38 offen lds
    s_add_u32 m0, m0, 1024
    s_mov_b32 s38, 458880
    buffer_load_dwordx4 v4, s[16:19], s38 offen lds
    s_add_u32 m0, m0, 7168
    s_mov_b32 s38, 491520
    buffer_load_dwordx4 v4, s[16:19], s38 offen lds
    s_add_u32 m0, m0, 1024
    s_mov_b32 s38, 491648
    buffer_load_dwordx4 v4, s[16:19], s38 offen lds
    s_waitcnt vmcnt(0) lgkmcnt(0)
    s_barrier
    ds_read_b64_tr_b16 v[96:97], v14 offset:0
    ds_read_b64_tr_b16 v[98:99], v14 offset:2048
    ds_read_b64_tr_b16 v[100:101], v15 offset:0
    ds_read_b64_tr_b16 v[102:103], v15 offset:2048
    ds_read_b64_tr_b16 v[104:105], v14 offset:8192
    ds_read_b64_tr_b16 v[106:107], v14 offset:10240
    ds_read_b64_tr_b16 v[108:109], v15 offset:8192
    ds_read_b64_tr_b16 v[110:111], v15 offset:10240
    ds_read_b64_tr_b16 v[112:113], v14 offset:16384
    ds_read_b64_tr_b16 v[114:115], v14 offset:18432
    ds_read_b64_tr_b16 v[116:117], v15 offset:16384
    ds_read_b64_tr_b16 v[118:119], v15 offset:18432
    ds_read_b64_tr_b16 v[120:121], v14 offset:24576
    ds_read_b64_tr_b16 v[122:123], v14 offset:26624
    ds_read_b64_tr_b16 v[124:125], v15 offset:24576
    ds_read_b64_tr_b16 v[126:127], v15 offset:26624
    ds_read_b64_tr_b16 v[128:129], v14 offset:32768
    ds_read_b64_tr_b16 v[130:131], v14 offset:34816
    ds_read_b64_tr_b16 v[132:133], v15 offset:32768
    ds_read_b64_tr_b16 v[134:135], v15 offset:34816
    ds_read_b64_tr_b16 v[136:137], v14 offset:40960
    ds_read_b64_tr_b16 v[138:139], v14 offset:43008
    ds_read_b64_tr_b16 v[140:141], v15 offset:40960
    ds_read_b64_tr_b16 v[142:143], v15 offset:43008
    ds_read_b64_tr_b16 v[144:145], v14 offset:49152
    ds_read_b64_tr_b16 v[146:147], v14 offset:51200
    ds_read_b64_tr_b16 v[148:149], v15 offset:49152
    ds_read_b64_tr_b16 v[150:151], v15 offset:51200
    ds_read_b64_tr_b16 v[152:153], v14 offset:57344
    ds_read_b64_tr_b16 v[154:155], v14 offset:59392
    ds_read_b64_tr_b16 v[156:157], v15 offset:57344
    ds_read_b64_tr_b16 v[158:159], v15 offset:59392
    v_add_u32 v14, 0x10000, v14
    v_add_u32 v15, 0x10000, v15
    ds_read_b64_tr_b16 v[160:161], v14 offset:0
    ds_read_b64_tr_b16 v[162:163], v14 offset:2048
    ds_read_b64_tr_b16 v[164:165], v15 offset:0
    ds_read_b64_tr_b16 v[166:167], v15 offset:2048
    ds_read_b64_tr_b16 v[168:169], v14 offset:8192
    ds_read_b64_tr_b16 v[170:171], v14 offset:10240
    ds_read_b64_tr_b16 v[172:173], v15 offset:8192
    ds_read_b64_tr_b16 v[174:175], v15 offset:10240
    v_and_b32 v6, 15, v1
    v_lshrrev_b32 v7, 4, v1
    v_lshlrev_b32 v5, 4, v6
    v_lshl_add_u32 v184, v7, 9, v5
    v_add_u32 v184, 81920, v184
    v_lshl_add_u32 v185, v7, 14, v5
    v_add_u32 v186, 157184, v5
    s_lshl_b32 s38, s29, 8
    v_add_u32 v187, s38, v186
    s_and_b32 s44, s31, 3
    s_lshl_b32 s44, s44, 19
    s_lshl_b32 s41, s30, 9
    s_add_u32 s44, s44, s41
    s_lshr_b32 s41, s31, 2
    s_lshl_b32 s41, s41, 8
    s_add_u32 s44, s44, s41
    s_add_u32 s44, s44, s36
    s_lshl_b32 s38, s29, 17
    s_add_u32 s44, s44, s38
    s_add_u32 s45, s44, 65536
    s_and_b32 s46, s31, 3
    s_lshl_b32 s46, s46, 14
    s_lshl_b32 s41, s30, 9
    s_add_u32 s46, s46, s41
    s_lshr_b32 s41, s31, 2
    s_lshl_b32 s41, s41, 8
    s_add_u32 s46, s46, s41
    s_add_u32 s46, s46, s37
    s_mov_b32 s47, 0xffff0000
    s_waitcnt lgkmcnt(0)
    s_barrier
    s_setprio 2
    ds_read_b128 v[8:11], v184 offset:0
    ds_read_b128 v[12:15], v184 offset:256
    ds_read_b128 v[16:19], v184 offset:2048
    ds_read_b128 v[20:23], v184 offset:2304
    s_waitcnt lgkmcnt(3)
    v_mfma_f32_16x16x32_bf16 v[32:35], v[48:51], v[8:11], 0
    ds_read_b128 v[176:179], v184 offset:4096
    ds_read_b128 v[180:183], v184 offset:4352
    v_mfma_f32_16x16x32_bf16 v[40:43], v[52:55], v[8:11], 0
    s_waitcnt lgkmcnt(4)
    v_mfma_f32_16x16x32_bf16 v[36:39], v[48:51], v[12:15], 0
    v_mfma_f32_16x16x32_bf16 v[44:47], v[52:55], v[12:15], 0
    s_waitcnt lgkmcnt(3)
    v_mfma_f32_16x16x32_bf16 v[32:35], v[56:59], v[16:19], v[32:35]
    ds_read_b128 v[8:11], v184 offset:6144
    ds_read_b128 v[12:15], v184 offset:6400
    v_mfma_f32_16x16x32_bf16 v[40:43], v[60:63], v[16:19], v[40:43]
    s_waitcnt lgkmcnt(4)
    v_mfma_f32_16x16x32_bf16 v[36:39], v[56:59], v[20:23], v[36:39]
    v_mfma_f32_16x16x32_bf16 v[44:47], v[60:63], v[20:23], v[44:47]
    s_waitcnt lgkmcnt(3)
    v_mfma_f32_16x16x32_bf16 v[32:35], v[64:67], v[176:179], v[32:35]
    ds_read_b128 v[16:19], v184 offset:8192
    ds_read_b128 v[20:23], v184 offset:8448
    v_mfma_f32_16x16x32_bf16 v[40:43], v[68:71], v[176:179], v[40:43]
    s_waitcnt lgkmcnt(4)
    v_mfma_f32_16x16x32_bf16 v[36:39], v[64:67], v[180:183], v[36:39]
    v_mfma_f32_16x16x32_bf16 v[44:47], v[68:71], v[180:183], v[44:47]
    s_waitcnt lgkmcnt(3)
    v_mfma_f32_16x16x32_bf16 v[32:35], v[72:75], v[8:11], v[32:35]
    ds_read_b128 v[176:179], v184 offset:10240
    ds_read_b128 v[180:183], v184 offset:10496
    v_mfma_f32_16x16x32_bf16 v[40:43], v[76:79], v[8:11], v[40:43]
    s_waitcnt lgkmcnt(4)
    v_mfma_f32_16x16x32_bf16 v[36:39], v[72:75], v[12:15], v[36:39]
    v_mfma_f32_16x16x32_bf16 v[44:47], v[76:79], v[12:15], v[44:47]
    s_waitcnt lgkmcnt(3)
    v_mfma_f32_16x16x32_bf16 v[32:35], v[80:83], v[16:19], v[32:35]
    ds_read_b128 v[8:11], v184 offset:12288
    ds_read_b128 v[12:15], v184 offset:12544
    v_mfma_f32_16x16x32_bf16 v[40:43], v[84:87], v[16:19], v[40:43]
    s_waitcnt lgkmcnt(4)
    v_mfma_f32_16x16x32_bf16 v[36:39], v[80:83], v[20:23], v[36:39]
    v_mfma_f32_16x16x32_bf16 v[44:47], v[84:87], v[20:23], v[44:47]
    s_waitcnt lgkmcnt(3)
    v_mfma_f32_16x16x32_bf16 v[32:35], v[88:91], v[176:179], v[32:35]
    ds_read_b128 v[16:19], v184 offset:14336
    ds_read_b128 v[20:23], v184 offset:14592
    v_mfma_f32_16x16x32_bf16 v[40:43], v[92:95], v[176:179], v[40:43]
    s_waitcnt lgkmcnt(4)
    v_mfma_f32_16x16x32_bf16 v[36:39], v[88:91], v[180:183], v[36:39]
    v_mfma_f32_16x16x32_bf16 v[44:47], v[92:95], v[180:183], v[44:47]
    s_waitcnt lgkmcnt(3)
    v_mfma_f32_16x16x32_bf16 v[32:35], v[96:99], v[8:11], v[32:35]
    ds_read_b128 v[176:179], v184 offset:16384
    ds_read_b128 v[180:183], v184 offset:16640
    v_mfma_f32_16x16x32_bf16 v[40:43], v[100:103], v[8:11], v[40:43]
    s_waitcnt lgkmcnt(4)
    v_mfma_f32_16x16x32_bf16 v[36:39], v[96:99], v[12:15], v[36:39]
    v_mfma_f32_16x16x32_bf16 v[44:47], v[100:103], v[12:15], v[44:47]
    s_waitcnt lgkmcnt(3)
    v_mfma_f32_16x16x32_bf16 v[32:35], v[104:107], v[16:19], v[32:35]
    ds_read_b128 v[8:11], v184 offset:18432
    ds_read_b128 v[12:15], v184 offset:18688
    v_mfma_f32_16x16x32_bf16 v[40:43], v[108:111], v[16:19], v[40:43]
    s_waitcnt lgkmcnt(4)
    v_mfma_f32_16x16x32_bf16 v[36:39], v[104:107], v[20:23], v[36:39]
    v_mfma_f32_16x16x32_bf16 v[44:47], v[108:111], v[20:23], v[44:47]
    s_waitcnt lgkmcnt(3)
    v_mfma_f32_16x16x32_bf16 v[32:35], v[112:115], v[176:179], v[32:35]
    ds_read_b128 v[16:19], v184 offset:20480
    ds_read_b128 v[20:23], v184 offset:20736
    v_mfma_f32_16x16x32_bf16 v[40:43], v[116:119], v[176:179], v[40:43]
    s_waitcnt lgkmcnt(4)
    v_mfma_f32_16x16x32_bf16 v[36:39], v[112:115], v[180:183], v[36:39]
    v_mfma_f32_16x16x32_bf16 v[44:47], v[116:119], v[180:183], v[44:47]
    s_waitcnt lgkmcnt(3)
    v_mfma_f32_16x16x32_bf16 v[32:35], v[120:123], v[8:11], v[32:35]
    ds_read_b128 v[176:179], v184 offset:22528
    ds_read_b128 v[180:183], v184 offset:22784
    v_mfma_f32_16x16x32_bf16 v[40:43], v[124:127], v[8:11], v[40:43]
    s_waitcnt lgkmcnt(4)
    v_mfma_f32_16x16x32_bf16 v[36:39], v[120:123], v[12:15], v[36:39]
    v_mfma_f32_16x16x32_bf16 v[44:47], v[124:127], v[12:15], v[44:47]
    s_waitcnt lgkmcnt(3)
    v_mfma_f32_16x16x32_bf16 v[32:35], v[128:131], v[16:19], v[32:35]
    ds_read_b128 v[8:11], v184 offset:24576
    ds_read_b128 v[12:15], v184 offset:24832
    v_mfma_f32_16x16x32_bf16 v[40:43], v[132:135], v[16:19], v[40:43]
    s_waitcnt lgkmcnt(4)
    v_mfma_f32_16x16x32_bf16 v[36:39], v[128:131], v[20:23], v[36:39]
    v_mfma_f32_16x16x32_bf16 v[44:47], v[132:135], v[20:23], v[44:47]
    s_waitcnt lgkmcnt(3)
    v_mfma_f32_16x16x32_bf16 v[32:35], v[136:139], v[176:179], v[32:35]
    ds_read_b128 v[16:19], v184 offset:26624
    ds_read_b128 v[20:23], v184 offset:26880
    v_mfma_f32_16x16x32_bf16 v[40:43], v[140:143], v[176:179], v[40:43]
    s_waitcnt lgkmcnt(4)
    v_mfma_f32_16x16x32_bf16 v[36:39], v[136:139], v[180:183], v[36:39]
    v_mfma_f32_16x16x32_bf16 v[44:47], v[140:143], v[180:183], v[44:47]
    s_waitcnt lgkmcnt(3)
    v_mfma_f32_16x16x32_bf16 v[32:35], v[144:147], v[8:11], v[32:35]
    ds_read_b128 v[176:179], v184 offset:28672
    ds_read_b128 v[180:183], v184 offset:28928
    v_mfma_f32_16x16x32_bf16 v[40:43], v[148:151], v[8:11], v[40:43]
    s_waitcnt lgkmcnt(4)
    v_mfma_f32_16x16x32_bf16 v[36:39], v[144:147], v[12:15], v[36:39]
    v_mfma_f32_16x16x32_bf16 v[44:47], v[148:151], v[12:15], v[44:47]
    s_waitcnt lgkmcnt(3)
    v_mfma_f32_16x16x32_bf16 v[32:35], v[152:155], v[16:19], v[32:35]
    ds_read_b128 v[8:11], v184 offset:30720
    ds_read_b128 v[12:15], v184 offset:30976
    v_mfma_f32_16x16x32_bf16 v[40:43], v[156:159], v[16:19], v[40:43]
    s_waitcnt lgkmcnt(4)
    v_mfma_f32_16x16x32_bf16 v[36:39], v[152:155], v[20:23], v[36:39]
    v_mfma_f32_16x16x32_bf16 v[44:47], v[156:159], v[20:23], v[44:47]
    s_waitcnt lgkmcnt(3)
    v_mfma_f32_16x16x32_bf16 v[32:35], v[160:163], v[176:179], v[32:35]
    v_mfma_f32_16x16x32_bf16 v[40:43], v[164:167], v[176:179], v[40:43]
    s_waitcnt lgkmcnt(2)
    v_mfma_f32_16x16x32_bf16 v[36:39], v[160:163], v[180:183], v[36:39]
    v_mfma_f32_16x16x32_bf16 v[44:47], v[164:167], v[180:183], v[44:47]
    s_waitcnt lgkmcnt(1)
    v_mfma_f32_16x16x32_bf16 v[32:35], v[168:171], v[8:11], v[32:35]
    v_mfma_f32_16x16x32_bf16 v[40:43], v[172:175], v[8:11], v[40:43]
    s_waitcnt lgkmcnt(0)
    v_mfma_f32_16x16x32_bf16 v[36:39], v[168:171], v[12:15], v[36:39]
    v_mfma_f32_16x16x32_bf16 v[44:47], v[172:175], v[12:15], v[44:47]
    s_nop 3
    v_cvt_pk_bf16_f32 v80, v32, v33
    v_cvt_pk_bf16_f32 v81, v34, v35
    s_nop 0
    v_cvt_pk_bf16_f32 v82, v36, v37
    v_cvt_pk_bf16_f32 v83, v38, v39
    v_cvt_pk_bf16_f32 v84, v40, v41
    v_cvt_pk_bf16_f32 v85, v42, v43
    v_cvt_pk_bf16_f32 v86, v44, v45
    v_cvt_pk_bf16_f32 v87, v46, v47
    v_lshlrev_b32 v64, 16, v24
    v_and_b32 v65, s47, v24
    v_lshlrev_b32 v66, 16, v25
    v_and_b32 v67, s47, v25
    v_lshlrev_b32 v68, 16, v26
    v_and_b32 v69, s47, v26
    v_lshlrev_b32 v70, 16, v27
    v_and_b32 v71, s47, v27
    v_lshlrev_b32 v72, 16, v28
    v_and_b32 v73, s47, v28
    v_lshlrev_b32 v74, 16, v29
    v_and_b32 v75, s47, v29
    v_lshlrev_b32 v76, 16, v30
    v_and_b32 v77, s47, v30
    v_lshlrev_b32 v78, 16, v31
    v_and_b32 v79, s47, v31
    v_lshlrev_b32 v48, 16, v80
    v_and_b32 v49, s47, v80
    v_lshlrev_b32 v50, 16, v81
    v_and_b32 v51, s47, v81
    v_lshlrev_b32 v52, 16, v82
    v_and_b32 v53, s47, v82
    v_lshlrev_b32 v54, 16, v83
    v_and_b32 v55, s47, v83
    v_lshlrev_b32 v56, 16, v84
    v_and_b32 v57, s47, v84
    v_lshlrev_b32 v58, 16, v85
    v_and_b32 v59, s47, v85
    v_lshlrev_b32 v60, 16, v86
    v_and_b32 v61, s47, v86
    v_lshlrev_b32 v62, 16, v87
    v_and_b32 v63, s47, v87
    v_add_f32 v48, v48, v64
    v_add_f32 v49, v49, v65
    v_add_f32 v50, v50, v66
    v_add_f32 v51, v51, v67
    v_add_f32 v52, v52, v68
    v_add_f32 v53, v53, v69
    v_add_f32 v54, v54, v70
    v_add_f32 v55, v55, v71
    v_add_f32 v56, v56, v72
    v_add_f32 v57, v57, v73
    v_add_f32 v58, v58, v74
    v_add_f32 v59, v59, v75
    v_add_f32 v60, v60, v76
    v_add_f32 v61, v61, v77
    v_add_f32 v62, v62, v78
    v_add_f32 v63, v63, v79
    v_cvt_pk_bf16_f32 v80, v48, v49
    v_cvt_pk_bf16_f32 v81, v50, v51
    v_cvt_pk_bf16_f32 v82, v52, v53
    v_cvt_pk_bf16_f32 v83, v54, v55
    v_cvt_pk_bf16_f32 v84, v56, v57
    v_cvt_pk_bf16_f32 v85, v58, v59
    v_cvt_pk_bf16_f32 v86, v60, v61
    v_cvt_pk_bf16_f32 v87, v62, v63
    v_min_u32 v83, -2, v83
    buffer_store_dwordx4 v[80:83], v185, s[4:7], s44 offen sc1
    v_min_u32 v87, -2, v87
    buffer_store_dwordx4 v[84:87], v185, s[4:7], s45 offen sc1
    v_mov_b32 v92, 0x3f803f80
    v_mov_b32 v88, 0
    v_mov_b32 v89, 0
    v_mov_b32 v90, 0
    v_mov_b32 v91, 0
    v_dot2c_f32_bf16 v88, v80, v92
    v_dot2c_f32_bf16 v89, v80, v80
    v_dot2c_f32_bf16 v90, v82, v92
    v_dot2c_f32_bf16 v91, v82, v82
    v_dot2c_f32_bf16 v88, v81, v92
    v_dot2c_f32_bf16 v89, v81, v81
    v_dot2c_f32_bf16 v90, v83, v92
    v_dot2c_f32_bf16 v91, v83, v83
    v_dot2c_f32_bf16 v88, v84, v92
    v_dot2c_f32_bf16 v89, v84, v84
    v_dot2c_f32_bf16 v90, v86, v92
    v_dot2c_f32_bf16 v91, v86, v86
    v_dot2c_f32_bf16 v88, v85, v92
    v_dot2c_f32_bf16 v89, v85, v85
    v_dot2c_f32_bf16 v90, v87, v92
    v_dot2c_f32_bf16 v91, v87, v87
    v_mov_b32 v92, v88
    v_mov_b32 v93, v89
    v_mov_b32 v94, v90
    v_mov_b32 v95, v91
    v_permlane16_swap_b32 v88, v92
    v_permlane16_swap_b32 v89, v93
    v_permlane16_swap_b32 v90, v94
    v_permlane16_swap_b32 v91, v95
    v_add_f32 v88, v88, v92
    v_add_f32 v89, v89, v93
    v_add_f32 v90, v90, v94
    v_add_f32 v91, v91, v95
    v_mov_b32 v92, v88
    v_mov_b32 v93, v89
    v_mov_b32 v94, v90
    v_mov_b32 v95, v91
    v_permlane32_swap_b32 v88, v92
    v_permlane32_swap_b32 v89, v93
    v_permlane32_swap_b32 v90, v94
    v_permlane32_swap_b32 v91, v95
    v_add_f32 v88, v88, v92
    v_add_f32 v89, v89, v93
    v_add_f32 v90, v90, v94
    v_add_f32 v91, v91, v95
    v_mov_b32 v92, 156932
    v_mov_b32 v93, 1
    s_mov_b64 exec, 0xffff
    ds_write_b128 v187, v[88:91]
    s_mov_b64 exec, 1
    ds_add_rtn_u32 v94, v92, v93
    s_mov_b64 exec, 0xffff
    ds_read_b128 v[48:51], v186 offset:0
    ds_read_b128 v[52:55], v186 offset:256
    ds_read_b128 v[56:59], v186 offset:512
    ds_read_b128 v[60:63], v186 offset:768
    s_waitcnt lgkmcnt(4)
    v_readfirstlane_b32 s38, v94
    s_and_b32 s38, s38, 3
    s_cmp_eq_u32 s38, 3
    s_cbranch_scc0 v_nolast
    s_waitcnt lgkmcnt(0)
    v_add_f32 v48, v48, v52
    v_add_f32 v56, v56, v60
    v_add_f32 v49, v49, v53
    v_add_f32 v57, v57, v61
    v_add_f32 v50, v50, v54
    v_add_f32 v58, v58, v62
    v_add_f32 v51, v51, v55
    v_add_f32 v59, v59, v63
    v_add_f32 v48, v48, v56
    v_add_f32 v49, v49, v57
    v_add_f32 v50, v50, v58
    v_add_f32 v51, v51, v59
    v_min_u32 v51, -2, v51
    buffer_store_dwordx4 v[48:51], v5, s[4:7], s46 offen sc1
v_nolast:
    s_setprio 0
    s_mov_b64 exec, -1
    v_and_b32 v10, 15, v1
    v_lshrrev_b32 v11, 4, v1
    v_and_b32 v12, 3, v1
    v_mul_u32_u24 v2, 4160, v12
    v_bfe_u32 v12, v1, 2, 2
    v_lshlrev_b32 v12, 3, v12
    v_sub_u32 v2, v2, v12
    v_lshl_add_u32 v2, v11, 4, v2
    s_mul_i32 s38, s29, 16640
    s_add_u32 s38, s38, 24
    v_add_u32 v2, s38, v2
    v_lshlrev_b32 v3, 5, v10
    v_lshl_add_u32 v7, v11, 3, v3
    v_lshl_add_u32 v3, v11, 4, v3
    s_mul_i32 s38, s29, 4608
    s_add_u32 s38, s38, 66592
    v_add_u32 v3, s38, v3
    s_lshl_b32 s38, s29, 9
    s_add_u32 s38, s38, 84992
    v_add_u32 v7, s38, v7
    s_waitcnt lgkmcnt(0)
    s_barrier
    s_cmp_eq_u32 s34, 0
    s_cbranch_scc0 v_nopre
    s_lshl_b32 m0, s29, 11
    s_add_u32 m0, m0, 98304
    s_mov_b32 s38, 0
    buffer_load_dwordx4 v4, s[16:19], s38 offen lds
    s_add_u32 m0, m0, 1024
    s_mov_b32 s38, 128
    buffer_load_dwordx4 v4, s[16:19], s38 offen lds
    s_add_u32 m0, m0, 7168
    s_mov_b32 s38, 32768
    buffer_load_dwordx4 v4, s[16:19], s38 offen lds
    s_add_u32 m0, m0, 1024
    s_mov_b32 s38, 32896
    buffer_load_dwordx4 v4, s[16:19], s38 offen lds
    s_add_u32 m0, m0, 7168
    s_mov_b32 s38, 65536
    buffer_load_dwordx4 v4, s[16:19], s38 offen lds
    s_add_u32 m0, m0, 1024
    s_mov_b32 s38, 65664
    buffer_load_dwordx4 v4, s[16:19], s38 offen lds
    s_add_u32 m0, m0, 7168
    s_mov_b32 s38, 98304
    buffer_load_dwordx4 v4, s[16:19], s38 offen lds
    s_add_u32 m0, m0, 1024
    s_mov_b32 s38, 98432
    buffer_load_dwordx4 v4, s[16:19], s38 offen lds
    s_add_u32 m0, m0, 7168
    s_mov_b32 s38, 131072
    buffer_load_dwordx4 v4, s[16:19], s38 offen lds
    s_add_u32 m0, m0, 1024
    s_mov_b32 s38, 131200
    buffer_load_dwordx4 v4, s[16:19], s38 offen lds
    s_add_u32 m0, m0, 7168
    s_mov_b32 s38, 163840
    buffer_load_dwordx4 v4, s[16:19], s38 offen lds
    s_add_u32 m0, m0, 1024
    s_mov_b32 s38, 163968
    buffer_load_dwordx4 v4, s[16:19], s38 offen lds
v_nopre:
    ds_read_b64 v[64:65], v2 offset:4032
    ds_read_b64 v[66:67], v2 offset:4040
    ds_read_b64 v[68:69], v2 offset:3968
    ds_read_b64 v[70:71], v2 offset:3976
    ds_read_b64 v[72:73], v2 offset:3904
    ds_read_b64 v[74:75], v2 offset:3912
    ds_read_b64 v[76:77], v2 offset:3840
    ds_read_b64 v[78:79], v2 offset:3848
    ds_read_b64 v[80:81], v2 offset:3776
    ds_read_b64 v[82:83], v2 offset:3784
    ds_read_b64 v[84:85], v2 offset:3712
    ds_read_b64 v[86:87], v2 offset:3720
    ds_read_b64 v[88:89], v2 offset:3648
    ds_read_b64 v[90:91], v2 offset:3656
    ds_read_b64 v[92:93], v2 offset:3584
    ds_read_b64 v[94:95], v2 offset:3592
    ds_read_b64 v[96:97], v2 offset:3520
    ds_read_b64 v[98:99], v2 offset:3528
    ds_read_b64 v[100:101], v2 offset:3456
    ds_read_b64 v[102:103], v2 offset:3464
    ds_read_b64 v[104:105], v2 offset:3392
    ds_read_b64 v[106:107], v2 offset:3400
    ds_read_b64 v[108:109], v2 offset:3328
    ds_read_b64 v[110:111], v2 offset:3336
    ds_read_b64 v[112:113], v2 offset:3264
    ds_read_b64 v[114:115], v2 offset:3272
    ds_read_b64 v[116:117], v2 offset:3200
    ds_read_b64 v[118:119], v2 offset:3208
    ds_read_b64 v[120:121], v2 offset:3136
    ds_read_b64 v[122:123], v2 offset:3144
    ds_read_b64 v[124:125], v2 offset:3072
    ds_read_b64 v[126:127], v2 offset:3080
    ds_read_b64 v[128:129], v2 offset:3008
    ds_read_b64 v[130:131], v2 offset:3016
    ds_read_b64 v[132:133], v2 offset:2944
    ds_read_b64 v[134:135], v2 offset:2952
    ds_read_b64 v[136:137], v2 offset:2880
    ds_read_b64 v[138:139], v2 offset:2888
    ds_read_b64 v[140:141], v2 offset:2816
    ds_read_b64 v[142:143], v2 offset:2824
    ds_read_b64 v[144:145], v2 offset:2752
    ds_read_b64 v[146:147], v2 offset:2760
    ds_read_b64 v[148:149], v2 offset:2688
    ds_read_b64 v[150:151], v2 offset:2696
    ds_read_b64 v[152:153], v2 offset:2624
    ds_read_b64 v[154:155], v2 offset:2632
    ds_read_b64 v[156:157], v2 offset:2560
    ds_read_b64 v[158:159], v2 offset:2568
    ds_read_b64 v[160:161], v2 offset:2496
    ds_read_b64 v[162:163], v2 offset:2504
    ds_read_b64 v[164:165], v2 offset:2432
    ds_read_b64 v[166:167], v2 offset:2440
    ds_read_b64 v[168:169], v2 offset:2368
    ds_read_b64 v[170:171], v2 offset:2376
    ds_read_b64 v[172:173], v2 offset:2304
    ds_read_b64 v[174:175], v2 offset:2312
    ds_read_b64 v[176:177], v2 offset:2240
    ds_read_b64 v[178:179], v2 offset:2248
    ds_read_b64 v[180:181], v2 offset:2176
    ds_read_b64 v[182:183], v2 offset:2184
    ds_read_b64 v[184:185], v2 offset:2112
    ds_read_b64 v[186:187], v2 offset:2120
    s_waitcnt lgkmcnt(0)
    s_barrier
    s_cmp_eq_u32 s33, 0
    s_cbranch_scc0 v_conv1
v_conv0:
    ds_read_b128 v[32:35], v3 offset:0
    ds_read_b128 v[36:39], v3 offset:64
    ds_read_b128 v[40:43], v3 offset:128
    ds_read_b128 v[44:47], v3 offset:192
    ds_read_b64 v[48:49], v2 offset:2048
    ds_read_b64 v[50:51], v2 offset:2056
    ds_read_b64 v[52:53], v2 offset:1536
    ds_read_b64 v[54:55], v2 offset:1544
    ds_read_b64 v[56:57], v2 offset:0
    ds_read_b64 v[58:59], v2 offset:8
    ds_read_b64 v[60:61], v2 offset:1600
    ds_read_b64 v[62:63], v2 offset:1608
    s_waitcnt lgkmcnt(11)
    v_mfma_f32_16x16x32_bf16 v[16:19], v[92:95], v[32:35], 0
    s_waitcnt lgkmcnt(6)
    v_mfma_f32_16x16x32_bf16 v[20:23], v[48:51], v[32:35], 0
    ds_read_b64 v[48:49], v2 offset:64
    ds_read_b64 v[50:51], v2 offset:72
    s_waitcnt lgkmcnt(6)
    v_mfma_f32_16x16x32_bf16 v[24:27], v[52:55], v[32:35], 0
    ds_read_b64 v[52:53], v2 offset:1664
    ds_read_b64 v[54:55], v2 offset:1672
    s_waitcnt lgkmcnt(6)
    v_mfma_f32_16x16x32_bf16 v[28:31], v[56:59], v[32:35], 0
    ds_read_b128 v[32:35], v3 offset:256
    ds_read_b64 v[56:57], v2 offset:128
    ds_read_b64 v[58:59], v2 offset:136
    v_mfma_f32_16x16x32_bf16 v[16:19], v[88:91], v[36:39], v[16:19]
    v_mfma_f32_16x16x32_bf16 v[20:23], v[184:187], v[36:39], v[20:23]
    s_waitcnt lgkmcnt(7)
    v_mfma_f32_16x16x32_bf16 v[24:27], v[60:63], v[36:39], v[24:27]
    ds_read_b64 v[60:61], v2 offset:1728
    ds_read_b64 v[62:63], v2 offset:1736
    s_waitcnt lgkmcnt(7)
    v_mfma_f32_16x16x32_bf16 v[28:31], v[48:51], v[36:39], v[28:31]
    ds_read_b128 v[36:39], v3 offset:320
    ds_read_b64 v[48:49], v2 offset:192
    ds_read_b64 v[50:51], v2 offset:200
    v_mfma_f32_16x16x32_bf16 v[16:19], v[84:87], v[40:43], v[16:19]
    v_mfma_f32_16x16x32_bf16 v[20:23], v[180:183], v[40:43], v[20:23]
    s_waitcnt lgkmcnt(8)
    v_mfma_f32_16x16x32_bf16 v[24:27], v[52:55], v[40:43], v[24:27]
    ds_read_b64 v[52:53], v2 offset:1792
    ds_read_b64 v[54:55], v2 offset:1800
    s_waitcnt lgkmcnt(7)
    v_mfma_f32_16x16x32_bf16 v[28:31], v[56:59], v[40:43], v[28:31]
    ds_read_b128 v[40:43], v3 offset:384
    ds_read_b64 v[56:57], v2 offset:256
    ds_read_b64 v[58:59], v2 offset:264
    v_mfma_f32_16x16x32_bf16 v[16:19], v[80:83], v[44:47], v[16:19]
    v_mfma_f32_16x16x32_bf16 v[20:23], v[176:179], v[44:47], v[20:23]
    s_waitcnt lgkmcnt(8)
    v_mfma_f32_16x16x32_bf16 v[24:27], v[60:63], v[44:47], v[24:27]
    ds_read_b64 v[60:61], v2 offset:1856
    ds_read_b64 v[62:63], v2 offset:1864
    s_waitcnt lgkmcnt(7)
    v_mfma_f32_16x16x32_bf16 v[28:31], v[48:51], v[44:47], v[28:31]
    ds_read_b128 v[44:47], v3 offset:448
    ds_read_b64 v[48:49], v2 offset:320
    ds_read_b64 v[50:51], v2 offset:328
    v_mfma_f32_16x16x32_bf16 v[16:19], v[76:79], v[32:35], v[16:19]
    v_mfma_f32_16x16x32_bf16 v[20:23], v[172:175], v[32:35], v[20:23]
    s_waitcnt lgkmcnt(8)
    v_mfma_f32_16x16x32_bf16 v[24:27], v[52:55], v[32:35], v[24:27]
    ds_read_b64 v[52:53], v2 offset:1920
    ds_read_b64 v[54:55], v2 offset:1928
    s_waitcnt lgkmcnt(7)
    v_mfma_f32_16x16x32_bf16 v[28:31], v[56:59], v[32:35], v[28:31]
    ds_read_b128 v[32:35], v3 offset:512
    ds_read_b64 v[56:57], v2 offset:384
    ds_read_b64 v[58:59], v2 offset:392
    v_mfma_f32_16x16x32_bf16 v[16:19], v[72:75], v[36:39], v[16:19]
    v_mfma_f32_16x16x32_bf16 v[20:23], v[168:171], v[36:39], v[20:23]
    s_waitcnt lgkmcnt(8)
    v_mfma_f32_16x16x32_bf16 v[24:27], v[60:63], v[36:39], v[24:27]
    ds_read_b64 v[60:61], v2 offset:1984
    ds_read_b64 v[62:63], v2 offset:1992
    s_waitcnt lgkmcnt(7)
    v_mfma_f32_16x16x32_bf16 v[28:31], v[48:51], v[36:39], v[28:31]
    ds_read_b128 v[36:39], v3 offset:576
    ds_read_b64 v[48:49], v2 offset:448
    ds_read_b64 v[50:51], v2 offset:456
    v_mfma_f32_16x16x32_bf16 v[16:19], v[68:71], v[40:43], v[16:19]
    v_mfma_f32_16x16x32_bf16 v[20:23], v[164:167], v[40:43], v[20:23]
    s_waitcnt lgkmcnt(8)
    v_mfma_f32_16x16x32_bf16 v[24:27], v[52:55], v[40:43], v[24:27]
    ds_read_b64 v[52:53], v2 offset:2048
    ds_read_b64 v[54:55], v2 offset:2056
    s_waitcnt lgkmcnt(7)
    v_mfma_f32_16x16x32_bf16 v[28:31], v[56:59], v[40:43], v[28:31]
    ds_read_b128 v[40:43], v3 offset:640
    ds_read_b64 v[56:57], v2 offset:512
    ds_read_b64 v[58:59], v2 offset:520
    v_mfma_f32_16x16x32_bf16 v[16:19], v[64:67], v[44:47], v[16:19]
    v_mfma_f32_16x16x32_bf16 v[20:23], v[160:163], v[44:47], v[20:23]
    s_waitcnt lgkmcnt(8)
    v_mfma_f32_16x16x32_bf16 v[24:27], v[60:63], v[44:47], v[24:27]
    s_nop 4
    v_cvt_pk_bf16_f32 v8, v16, v17
    v_cvt_pk_bf16_f32 v9, v18, v19
    ds_write_b64 v7, v[8:9] offset:0
    ds_read_b64 v[60:61], v2 offset:576
    ds_read_b64 v[62:63], v2 offset:584
    s_waitcnt lgkmcnt(8)
    v_mfma_f32_16x16x32_bf16 v[28:31], v[48:51], v[44:47], v[28:31]
    ds_read_b128 v[44:47], v3 offset:704
    ds_read_b64 v[48:49], v2 offset:640
    ds_read_b64 v[50:51], v2 offset:648
    v_mfma_f32_16x16x32_bf16 v[20:23], v[156:159], v[32:35], v[20:23]
    s_waitcnt lgkmcnt(9)
    v_mfma_f32_16x16x32_bf16 v[24:27], v[52:55], v[32:35], v[24:27]
    ds_read_b64 v[52:53], v2 offset:704
    ds_read_b64 v[54:55], v2 offset:712
    s_waitcnt lgkmcnt(8)
    v_mfma_f32_16x16x32_bf16 v[28:31], v[56:59], v[32:35], v[28:31]
    ds_read_b128 v[32:35], v3 offset:768
    ds_read_b64 v[56:57], v2 offset:768
    ds_read_b64 v[58:59], v2 offset:776
    v_mfma_f32_16x16x32_bf16 v[20:23], v[152:155], v[36:39], v[20:23]
    v_mfma_f32_16x16x32_bf16 v[24:27], v[184:187], v[36:39], v[24:27]
    s_waitcnt lgkmcnt(8)
    v_mfma_f32_16x16x32_bf16 v[28:31], v[60:63], v[36:39], v[28:31]
    ds_read_b128 v[36:39], v3 offset:832
    ds_read_b64 v[60:61], v2 offset:832
    ds_read_b64 v[62:63], v2 offset:840
    v_mfma_f32_16x16x32_bf16 v[20:23], v[148:151], v[40:43], v[20:23]
    v_mfma_f32_16x16x32_bf16 v[24:27], v[180:183], v[40:43], v[24:27]
    s_waitcnt lgkmcnt(8)
    v_mfma_f32_16x16x32_bf16 v[28:31], v[48:51], v[40:43], v[28:31]
    ds_read_b128 v[40:43], v3 offset:896
    ds_read_b64 v[48:49], v2 offset:896
    ds_read_b64 v[50:51], v2 offset:904
    v_mfma_f32_16x16x32_bf16 v[20:23], v[144:147], v[44:47], v[20:23]
    v_mfma_f32_16x16x32_bf16 v[24:27], v[176:179], v[44:47], v[24:27]
    s_waitcnt lgkmcnt(9)
    v_mfma_f32_16x16x32_bf16 v[28:31], v[52:55], v[44:47], v[28:31]
    ds_read_b128 v[44:47], v3 offset:960
    ds_read_b64 v[52:53], v2 offset:960
    ds_read_b64 v[54:55], v2 offset:968
    s_waitcnt lgkmcnt(11)
    v_mfma_f32_16x16x32_bf16 v[20:23], v[140:143], v[32:35], v[20:23]
    v_mfma_f32_16x16x32_bf16 v[24:27], v[172:175], v[32:35], v[24:27]
    s_waitcnt lgkmcnt(9)
    v_mfma_f32_16x16x32_bf16 v[28:31], v[56:59], v[32:35], v[28:31]
    ds_read_b64 v[56:57], v2 offset:1024
    ds_read_b64 v[58:59], v2 offset:1032
    s_waitcnt lgkmcnt(10)
    v_mfma_f32_16x16x32_bf16 v[20:23], v[136:139], v[36:39], v[20:23]
    v_mfma_f32_16x16x32_bf16 v[24:27], v[168:171], v[36:39], v[24:27]
    s_waitcnt lgkmcnt(8)
    v_mfma_f32_16x16x32_bf16 v[28:31], v[60:63], v[36:39], v[28:31]
    ds_read_b64 v[60:61], v2 offset:1088
    ds_read_b64 v[62:63], v2 offset:1096
    s_waitcnt lgkmcnt(9)
    v_mfma_f32_16x16x32_bf16 v[20:23], v[132:135], v[40:43], v[20:23]
    v_mfma_f32_16x16x32_bf16 v[24:27], v[164:167], v[40:43], v[24:27]
    s_waitcnt lgkmcnt(7)
    v_mfma_f32_16x16x32_bf16 v[28:31], v[48:51], v[40:43], v[28:31]
    ds_read_b64 v[48:49], v2 offset:1152
    ds_read_b64 v[50:51], v2 offset:1160
    s_waitcnt lgkmcnt(8)
    v_mfma_f32_16x16x32_bf16 v[20:23], v[128:131], v[44:47], v[20:23]
    v_mfma_f32_16x16x32_bf16 v[24:27], v[160:163], v[44:47], v[24:27]
    s_waitcnt lgkmcnt(6)
    v_mfma_f32_16x16x32_bf16 v[28:31], v[52:55], v[44:47], v[28:31]
    s_waitcnt lgkmcnt(0)
    s_barrier
    ds_read_b128 v[32:35], v3 offset:1024
    ds_read_b128 v[36:39], v3 offset:1088
    ds_read_b128 v[40:43], v3 offset:1152
    ds_read_b128 v[44:47], v3 offset:1216
    ds_read_b64 v[52:53], v2 offset:1216
    ds_read_b64 v[54:55], v2 offset:1224
    s_waitcnt lgkmcnt(5)
    v_mfma_f32_16x16x32_bf16 v[20:23], v[124:127], v[32:35], v[20:23]
    v_mfma_f32_16x16x32_bf16 v[24:27], v[156:159], v[32:35], v[24:27]
    v_mfma_f32_16x16x32_bf16 v[28:31], v[56:59], v[32:35], v[28:31]
    ds_read_b128 v[32:35], v3 offset:1280
    ds_read_b64 v[56:57], v2 offset:1280
    ds_read_b64 v[58:59], v2 offset:1288
    s_waitcnt lgkmcnt(7)
    v_mfma_f32_16x16x32_bf16 v[20:23], v[120:123], v[36:39], v[20:23]
    v_mfma_f32_16x16x32_bf16 v[24:27], v[152:155], v[36:39], v[24:27]
    v_mfma_f32_16x16x32_bf16 v[28:31], v[60:63], v[36:39], v[28:31]
    ds_read_b128 v[36:39], v3 offset:1344
    ds_read_b64 v[60:61], v2 offset:1344
    ds_read_b64 v[62:63], v2 offset:1352
    s_waitcnt lgkmcnt(9)
    v_mfma_f32_16x16x32_bf16 v[20:23], v[116:119], v[40:43], v[20:23]
    v_mfma_f32_16x16x32_bf16 v[24:27], v[148:151], v[40:43], v[24:27]
    v_mfma_f32_16x16x32_bf16 v[28:31], v[48:51], v[40:43], v[28:31]
    ds_read_b128 v[40:43], v3 offset:1408
    ds_read_b64 v[48:49], v2 offset:1408
    ds_read_b64 v[50:51], v2 offset:1416
    s_waitcnt lgkmcnt(11)
    v_mfma_f32_16x16x32_bf16 v[20:23], v[112:115], v[44:47], v[20:23]
    v_mfma_f32_16x16x32_bf16 v[24:27], v[144:147], v[44:47], v[24:27]
    s_waitcnt lgkmcnt(9)
    v_mfma_f32_16x16x32_bf16 v[28:31], v[52:55], v[44:47], v[28:31]
    ds_read_b128 v[44:47], v3 offset:1472
    ds_read_b64 v[52:53], v2 offset:1472
    ds_read_b64 v[54:55], v2 offset:1480
    s_waitcnt lgkmcnt(11)
    v_mfma_f32_16x16x32_bf16 v[20:23], v[108:111], v[32:35], v[20:23]
    v_mfma_f32_16x16x32_bf16 v[24:27], v[140:143], v[32:35], v[24:27]
    s_waitcnt lgkmcnt(9)
    v_mfma_f32_16x16x32_bf16 v[28:31], v[56:59], v[32:35], v[28:31]
    ds_read_b128 v[32:35], v3 offset:1536
    ds_read_b64 v[56:57], v2 offset:1536
    ds_read_b64 v[58:59], v2 offset:1544
    s_waitcnt lgkmcnt(11)
    v_mfma_f32_16x16x32_bf16 v[20:23], v[104:107], v[36:39], v[20:23]
    v_mfma_f32_16x16x32_bf16 v[24:27], v[136:139], v[36:39], v[24:27]
    s_waitcnt lgkmcnt(9)
    v_mfma_f32_16x16x32_bf16 v[28:31], v[60:63], v[36:39], v[28:31]
    ds_read_b128 v[36:39], v3 offset:1600
    ds_read_b64 v[60:61], v2 offset:1600
    ds_read_b64 v[62:63], v2 offset:1608
    s_waitcnt lgkmcnt(11)
    v_mfma_f32_16x16x32_bf16 v[20:23], v[100:103], v[40:43], v[20:23]
    v_mfma_f32_16x16x32_bf16 v[24:27], v[132:135], v[40:43], v[24:27]
    s_waitcnt lgkmcnt(9)
    v_mfma_f32_16x16x32_bf16 v[28:31], v[48:51], v[40:43], v[28:31]
    ds_read_b128 v[40:43], v3 offset:1664
    ds_read_b64 v[48:49], v2 offset:1664
    ds_read_b64 v[50:51], v2 offset:1672
    s_waitcnt lgkmcnt(11)
    v_mfma_f32_16x16x32_bf16 v[20:23], v[96:99], v[44:47], v[20:23]
    v_mfma_f32_16x16x32_bf16 v[24:27], v[128:131], v[44:47], v[24:27]
    s_waitcnt lgkmcnt(9)
    v_mfma_f32_16x16x32_bf16 v[28:31], v[52:55], v[44:47], v[28:31]
    ds_read_b128 v[44:47], v3 offset:1728
    ds_read_b64 v[52:53], v2 offset:1728
    ds_read_b64 v[54:55], v2 offset:1736
    s_waitcnt lgkmcnt(11)
    v_mfma_f32_16x16x32_bf16 v[20:23], v[92:95], v[32:35], v[20:23]
    v_mfma_f32_16x16x32_bf16 v[24:27], v[124:127], v[32:35], v[24:27]
    s_waitcnt lgkmcnt(9)
    v_mfma_f32_16x16x32_bf16 v[28:31], v[56:59], v[32:35], v[28:31]
    ds_read_b128 v[32:35], v3 offset:1792
    ds_read_b64 v[56:57], v2 offset:1792
    ds_read_b64 v[58:59], v2 offset:1800
    s_waitcnt lgkmcnt(11)
    v_mfma_f32_16x16x32_bf16 v[20:23], v[88:91], v[36:39], v[20:23]
    v_mfma_f32_16x16x32_bf16 v[24:27], v[120:123], v[36:39], v[24:27]
    s_waitcnt lgkmcnt(9)
    v_mfma_f32_16x16x32_bf16 v[28:31], v[60:63], v[36:39], v[28:31]
    ds_read_b128 v[36:39], v3 offset:1856
    ds_read_b64 v[60:61], v2 offset:1856
    ds_read_b64 v[62:63], v2 offset:1864
    s_waitcnt lgkmcnt(11)
    v_mfma_f32_16x16x32_bf16 v[20:23], v[84:87], v[40:43], v[20:23]
    v_mfma_f32_16x16x32_bf16 v[24:27], v[116:119], v[40:43], v[24:27]
    s_waitcnt lgkmcnt(9)
    v_mfma_f32_16x16x32_bf16 v[28:31], v[48:51], v[40:43], v[28:31]
    ds_read_b128 v[40:43], v3 offset:1920
    ds_read_b64 v[48:49], v2 offset:1920
    ds_read_b64 v[50:51], v2 offset:1928
    s_waitcnt lgkmcnt(11)
    v_mfma_f32_16x16x32_bf16 v[20:23], v[80:83], v[44:47], v[20:23]
    v_mfma_f32_16x16x32_bf16 v[24:27], v[112:115], v[44:47], v[24:27]
    s_waitcnt lgkmcnt(9)
    v_mfma_f32_16x16x32_bf16 v[28:31], v[52:55], v[44:47], v[28:31]
    ds_read_b128 v[44:47], v3 offset:1984
    ds_read_b64 v[52:53], v2 offset:1984
    ds_read_b64 v[54:55], v2 offset:1992
    s_waitcnt lgkmcnt(11)
    v_mfma_f32_16x16x32_bf16 v[20:23], v[76:79], v[32:35], v[20:23]
    v_mfma_f32_16x16x32_bf16 v[24:27], v[108:111], v[32:35], v[24:27]
    s_waitcnt lgkmcnt(9)
    v_mfma_f32_16x16x32_bf16 v[28:31], v[56:59], v[32:35], v[28:31]
    ds_read_b64 v[56:57], v2 offset:2048
    ds_read_b64 v[58:59], v2 offset:2056
    s_waitcnt lgkmcnt(10)
    v_mfma_f32_16x16x32_bf16 v[20:23], v[72:75], v[36:39], v[20:23]
    v_mfma_f32_16x16x32_bf16 v[24:27], v[104:107], v[36:39], v[24:27]
    s_waitcnt lgkmcnt(8)
    v_mfma_f32_16x16x32_bf16 v[28:31], v[60:63], v[36:39], v[28:31]
    s_waitcnt lgkmcnt(7)
    v_mfma_f32_16x16x32_bf16 v[20:23], v[68:71], v[40:43], v[20:23]
    v_mfma_f32_16x16x32_bf16 v[24:27], v[100:103], v[40:43], v[24:27]
    s_waitcnt lgkmcnt(5)
    v_mfma_f32_16x16x32_bf16 v[28:31], v[48:51], v[40:43], v[28:31]
    s_waitcnt lgkmcnt(4)
    v_mfma_f32_16x16x32_bf16 v[20:23], v[64:67], v[44:47], v[20:23]
    v_mfma_f32_16x16x32_bf16 v[24:27], v[96:99], v[44:47], v[24:27]
    s_waitcnt lgkmcnt(2)
    v_mfma_f32_16x16x32_bf16 v[28:31], v[52:55], v[44:47], v[28:31]
    s_nop 4
    v_cvt_pk_bf16_f32 v8, v20, v21
    v_cvt_pk_bf16_f32 v9, v22, v23
    ds_write_b64 v7, v[8:9] offset:2048
    s_waitcnt lgkmcnt(0)
    s_barrier
    ds_read_b128 v[32:35], v3 offset:2048
    ds_read_b128 v[36:39], v3 offset:2112
    ds_read_b128 v[40:43], v3 offset:2176
    ds_read_b128 v[44:47], v3 offset:2240
    s_waitcnt lgkmcnt(3)
    v_mfma_f32_16x16x32_bf16 v[24:27], v[92:95], v[32:35], v[24:27]
    v_mfma_f32_16x16x32_bf16 v[28:31], v[56:59], v[32:35], v[28:31]
    ds_read_b128 v[32:35], v3 offset:2304
    s_waitcnt lgkmcnt(3)
    v_mfma_f32_16x16x32_bf16 v[24:27], v[88:91], v[36:39], v[24:27]
    v_mfma_f32_16x16x32_bf16 v[28:31], v[184:187], v[36:39], v[28:31]
    ds_read_b128 v[36:39], v3 offset:2368
    s_waitcnt lgkmcnt(3)
    v_mfma_f32_16x16x32_bf16 v[24:27], v[84:87], v[40:43], v[24:27]
    v_mfma_f32_16x16x32_bf16 v[28:31], v[180:183], v[40:43], v[28:31]
    ds_read_b128 v[40:43], v3 offset:2432
    s_waitcnt lgkmcnt(3)
    v_mfma_f32_16x16x32_bf16 v[24:27], v[80:83], v[44:47], v[24:27]
    v_mfma_f32_16x16x32_bf16 v[28:31], v[176:179], v[44:47], v[28:31]
    ds_read_b128 v[44:47], v3 offset:2496
    s_waitcnt lgkmcnt(3)
    v_mfma_f32_16x16x32_bf16 v[24:27], v[76:79], v[32:35], v[24:27]
    v_mfma_f32_16x16x32_bf16 v[28:31], v[172:175], v[32:35], v[28:31]
    ds_read_b128 v[32:35], v3 offset:2560
    s_waitcnt lgkmcnt(3)
    v_mfma_f32_16x16x32_bf16 v[24:27], v[72:75], v[36:39], v[24:27]
    v_mfma_f32_16x16x32_bf16 v[28:31], v[168:171], v[36:39], v[28:31]
    ds_read_b128 v[36:39], v3 offset:2624
    s_waitcnt lgkmcnt(3)
    v_mfma_f32_16x16x32_bf16 v[24:27], v[68:71], v[40:43], v[24:27]
    v_mfma_f32_16x16x32_bf16 v[28:31], v[164:167], v[40:43], v[28:31]
    ds_read_b128 v[40:43], v3 offset:2688
    s_waitcnt lgkmcnt(3)
    v_mfma_f32_16x16x32_bf16 v[24:27], v[64:67], v[44:47], v[24:27]
    v_mfma_f32_16x16x32_bf16 v[28:31], v[160:163], v[44:47], v[28:31]
    ds_read_b128 v[44:47], v3 offset:2752
    s_waitcnt lgkmcnt(3)
    v_mfma_f32_16x16x32_bf16 v[28:31], v[156:159], v[32:35], v[28:31]
    s_nop 3
    v_cvt_pk_bf16_f32 v8, v24, v25
    v_cvt_pk_bf16_f32 v9, v26, v27
    ds_write_b64 v7, v[8:9] offset:4096
    ds_read_b128 v[32:35], v3 offset:2816
    s_waitcnt lgkmcnt(4)
    v_mfma_f32_16x16x32_bf16 v[28:31], v[152:155], v[36:39], v[28:31]
    ds_read_b128 v[36:39], v3 offset:2880
    s_waitcnt lgkmcnt(4)
    v_mfma_f32_16x16x32_bf16 v[28:31], v[148:151], v[40:43], v[28:31]
    ds_read_b128 v[40:43], v3 offset:2944
    s_waitcnt lgkmcnt(4)
    v_mfma_f32_16x16x32_bf16 v[28:31], v[144:147], v[44:47], v[28:31]
    ds_read_b128 v[44:47], v3 offset:3008
    s_waitcnt lgkmcnt(3)
    v_mfma_f32_16x16x32_bf16 v[28:31], v[140:143], v[32:35], v[28:31]
    s_waitcnt lgkmcnt(2)
    v_mfma_f32_16x16x32_bf16 v[28:31], v[136:139], v[36:39], v[28:31]
    s_waitcnt lgkmcnt(1)
    v_mfma_f32_16x16x32_bf16 v[28:31], v[132:135], v[40:43], v[28:31]
    s_waitcnt lgkmcnt(0)
    v_mfma_f32_16x16x32_bf16 v[28:31], v[128:131], v[44:47], v[28:31]
    s_barrier
    ds_read_b128 v[32:35], v3 offset:3072
    ds_read_b128 v[36:39], v3 offset:3136
    ds_read_b128 v[40:43], v3 offset:3200
    ds_read_b128 v[44:47], v3 offset:3264
    s_waitcnt lgkmcnt(3)
    v_mfma_f32_16x16x32_bf16 v[28:31], v[124:127], v[32:35], v[28:31]
    ds_read_b128 v[32:35], v3 offset:3328
    s_waitcnt lgkmcnt(3)
    v_mfma_f32_16x16x32_bf16 v[28:31], v[120:123], v[36:39], v[28:31]
    ds_read_b128 v[36:39], v3 offset:3392
    s_waitcnt lgkmcnt(3)
    v_mfma_f32_16x16x32_bf16 v[28:31], v[116:119], v[40:43], v[28:31]
    ds_read_b128 v[40:43], v3 offset:3456
    s_waitcnt lgkmcnt(3)
    v_mfma_f32_16x16x32_bf16 v[28:31], v[112:115], v[44:47], v[28:31]
    ds_read_b128 v[44:47], v3 offset:3520
    s_waitcnt lgkmcnt(3)
    v_mfma_f32_16x16x32_bf16 v[28:31], v[108:111], v[32:35], v[28:31]
    ds_read_b128 v[32:35], v3 offset:3584
    s_waitcnt lgkmcnt(3)
    v_mfma_f32_16x16x32_bf16 v[28:31], v[104:107], v[36:39], v[28:31]
    ds_read_b128 v[36:39], v3 offset:3648
    s_waitcnt lgkmcnt(3)
    v_mfma_f32_16x16x32_bf16 v[28:31], v[100:103], v[40:43], v[28:31]
    ds_read_b128 v[40:43], v3 offset:3712
    s_waitcnt lgkmcnt(3)
    v_mfma_f32_16x16x32_bf16 v[28:31], v[96:99], v[44:47], v[28:31]
    ds_read_b128 v[44:47], v3 offset:3776
    s_waitcnt lgkmcnt(3)
    v_mfma_f32_16x16x32_bf16 v[28:31], v[92:95], v[32:35], v[28:31]
    ds_read_b128 v[32:35], v3 offset:3840
    s_waitcnt lgkmcnt(3)
    v_mfma_f32_16x16x32_bf16 v[28:31], v[88:91], v[36:39], v[28:31]
    ds_read_b128 v[36:39], v3 offset:3904
    s_waitcnt lgkmcnt(3)
    v_mfma_f32_16x16x32_bf16 v[28:31], v[84:87], v[40:43], v[28:31]
    ds_read_b128 v[40:43], v3 offset:3968
    s_waitcnt lgkmcnt(3)
    v_mfma_f32_16x16x32_bf16 v[28:31], v[80:83], v[44:47], v[28:31]
    ds_read_b128 v[44:47], v3 offset:4032
    s_waitcnt lgkmcnt(3)
    v_mfma_f32_16x16x32_bf16 v[28:31], v[76:79], v[32:35], v[28:31]
    s_waitcnt lgkmcnt(2)
    v_mfma_f32_16x16x32_bf16 v[28:31], v[72:75], v[36:39], v[28:31]
    s_waitcnt lgkmcnt(1)
    v_mfma_f32_16x16x32_bf16 v[28:31], v[68:71], v[40:43], v[28:31]
    s_waitcnt lgkmcnt(0)
    v_mfma_f32_16x16x32_bf16 v[28:31], v[64:67], v[44:47], v[28:31]
    s_nop 7
    v_cvt_pk_bf16_f32 v8, v28, v29
    v_cvt_pk_bf16_f32 v9, v30, v31
    ds_write_b64 v7, v[8:9] offset:6144
    s_waitcnt lgkmcnt(0)
    s_barrier
    s_branch v_conv_done
v_conv1:
    ds_read_b128 v[32:35], v3 offset:0
    ds_read_b128 v[36:39], v3 offset:64
    ds_read_b128 v[40:43], v3 offset:128
    ds_read_b128 v[44:47], v3 offset:192
    ds_read_b64 v[48:49], v2 offset:1024
    ds_read_b64 v[50:51], v2 offset:1032
    ds_read_b64 v[52:53], v2 offset:512
    ds_read_b64 v[54:55], v2 offset:520
    ds_read_b64 v[56:57], v2 offset:1088
    ds_read_b64 v[58:59], v2 offset:1096
    ds_read_b64 v[60:61], v2 offset:576
    ds_read_b64 v[62:63], v2 offset:584
    s_waitcnt lgkmcnt(11)
    v_mfma_f32_16x16x32_bf16 v[16:19], v[124:127], v[32:35], 0
    v_mfma_f32_16x16x32_bf16 v[20:23], v[156:159], v[32:35], 0
    s_waitcnt lgkmcnt(6)
    v_mfma_f32_16x16x32_bf16 v[24:27], v[48:51], v[32:35], 0
    ds_read_b64 v[48:49], v2 offset:1152
    ds_read_b64 v[50:51], v2 offset:1160
    s_waitcnt lgkmcnt(6)
    v_mfma_f32_16x16x32_bf16 v[28:31], v[52:55], v[32:35], 0
    ds_read_b128 v[32:35], v3 offset:256
    ds_read_b64 v[52:53], v2 offset:640
    ds_read_b64 v[54:55], v2 offset:648
    v_mfma_f32_16x16x32_bf16 v[16:19], v[120:123], v[36:39], v[16:19]
    v_mfma_f32_16x16x32_bf16 v[20:23], v[152:155], v[36:39], v[20:23]
    s_waitcnt lgkmcnt(7)
    v_mfma_f32_16x16x32_bf16 v[24:27], v[56:59], v[36:39], v[24:27]
    ds_read_b64 v[56:57], v2 offset:1216
    ds_read_b64 v[58:59], v2 offset:1224
    s_waitcnt lgkmcnt(7)
    v_mfma_f32_16x16x32_bf16 v[28:31], v[60:63], v[36:39], v[28:31]
    ds_read_b128 v[36:39], v3 offset:320
    ds_read_b64 v[60:61], v2 offset:704
    ds_read_b64 v[62:63], v2 offset:712
    v_mfma_f32_16x16x32_bf16 v[16:19], v[116:119], v[40:43], v[16:19]
    v_mfma_f32_16x16x32_bf16 v[20:23], v[148:151], v[40:43], v[20:23]
    s_waitcnt lgkmcnt(8)
    v_mfma_f32_16x16x32_bf16 v[24:27], v[48:51], v[40:43], v[24:27]
    ds_read_b64 v[48:49], v2 offset:1280
    ds_read_b64 v[50:51], v2 offset:1288
    s_waitcnt lgkmcnt(7)
    v_mfma_f32_16x16x32_bf16 v[28:31], v[52:55], v[40:43], v[28:31]
    ds_read_b128 v[40:43], v3 offset:384
    ds_read_b64 v[52:53], v2 offset:768
    ds_read_b64 v[54:55], v2 offset:776
    v_mfma_f32_16x16x32_bf16 v[16:19], v[112:115], v[44:47], v[16:19]
    v_mfma_f32_16x16x32_bf16 v[20:23], v[144:147], v[44:47], v[20:23]
    s_waitcnt lgkmcnt(8)
    v_mfma_f32_16x16x32_bf16 v[24:27], v[56:59], v[44:47], v[24:27]
    ds_read_b64 v[56:57], v2 offset:1344
    ds_read_b64 v[58:59], v2 offset:1352
    s_waitcnt lgkmcnt(7)
    v_mfma_f32_16x16x32_bf16 v[28:31], v[60:63], v[44:47], v[28:31]
    ds_read_b128 v[44:47], v3 offset:448
    ds_read_b64 v[60:61], v2 offset:832
    ds_read_b64 v[62:63], v2 offset:840
    v_mfma_f32_16x16x32_bf16 v[16:19], v[108:111], v[32:35], v[16:19]
    v_mfma_f32_16x16x32_bf16 v[20:23], v[140:143], v[32:35], v[20:23]
    s_waitcnt lgkmcnt(8)
    v_mfma_f32_16x16x32_bf16 v[24:27], v[48:51], v[32:35], v[24:27]
    ds_read_b64 v[48:49], v2 offset:1408
    ds_read_b64 v[50:51], v2 offset:1416
    s_waitcnt lgkmcnt(7)
    v_mfma_f32_16x16x32_bf16 v[28:31], v[52:55], v[32:35], v[28:31]
    ds_read_b128 v[32:35], v3 offset:512
    ds_read_b64 v[52:53], v2 offset:896
    ds_read_b64 v[54:55], v2 offset:904
    v_mfma_f32_16x16x32_bf16 v[16:19], v[104:107], v[36:39], v[16:19]
    v_mfma_f32_16x16x32_bf16 v[20:23], v[136:139], v[36:39], v[20:23]
    s_waitcnt lgkmcnt(8)
    v_mfma_f32_16x16x32_bf16 v[24:27], v[56:59], v[36:39], v[24:27]
    ds_read_b64 v[56:57], v2 offset:1472
    ds_read_b64 v[58:59], v2 offset:1480
    s_waitcnt lgkmcnt(7)
    v_mfma_f32_16x16x32_bf16 v[28:31], v[60:63], v[36:39], v[28:31]
    ds_read_b128 v[36:39], v3 offset:576
    ds_read_b64 v[60:61], v2 offset:960
    ds_read_b64 v[62:63], v2 offset:968
    v_mfma_f32_16x16x32_bf16 v[16:19], v[100:103], v[40:43], v[16:19]
    v_mfma_f32_16x16x32_bf16 v[20:23], v[132:135], v[40:43], v[20:23]
    s_waitcnt lgkmcnt(8)
    v_mfma_f32_16x16x32_bf16 v[24:27], v[48:51], v[40:43], v[24:27]
    ds_read_b64 v[48:49], v2 offset:1536
    ds_read_b64 v[50:51], v2 offset:1544
    s_waitcnt lgkmcnt(7)
    v_mfma_f32_16x16x32_bf16 v[28:31], v[52:55], v[40:43], v[28:31]
    ds_read_b128 v[40:43], v3 offset:640
    ds_read_b64 v[52:53], v2 offset:1024
    ds_read_b64 v[54:55], v2 offset:1032
    v_mfma_f32_16x16x32_bf16 v[16:19], v[96:99], v[44:47], v[16:19]
    v_mfma_f32_16x16x32_bf16 v[20:23], v[128:131], v[44:47], v[20:23]
    s_waitcnt lgkmcnt(8)
    v_mfma_f32_16x16x32_bf16 v[24:27], v[56:59], v[44:47], v[24:27]
    ds_read_b64 v[56:57], v2 offset:1600
    ds_read_b64 v[58:59], v2 offset:1608
    s_waitcnt lgkmcnt(7)
    v_mfma_f32_16x16x32_bf16 v[28:31], v[60:63], v[44:47], v[28:31]
    ds_read_b128 v[44:47], v3 offset:704
    ds_read_b64 v[60:61], v2 offset:1088
    ds_read_b64 v[62:63], v2 offset:1096
    v_mfma_f32_16x16x32_bf16 v[16:19], v[92:95], v[32:35], v[16:19]
    v_mfma_f32_16x16x32_bf16 v[20:23], v[124:127], v[32:35], v[20:23]
    s_waitcnt lgkmcnt(8)
    v_mfma_f32_16x16x32_bf16 v[24:27], v[48:51], v[32:35], v[24:27]
    ds_read_b64 v[48:49], v2 offset:1664
    ds_read_b64 v[50:51], v2 offset:1672
    s_waitcnt lgkmcnt(7)
    v_mfma_f32_16x16x32_bf16 v[28:31], v[52:55], v[32:35], v[28:31]
    ds_read_b128 v[32:35], v3 offset:768
    ds_read_b64 v[52:53], v2 offset:1152
    ds_read_b64 v[54:55], v2 offset:1160
    v_mfma_f32_16x16x32_bf16 v[16:19], v[88:91], v[36:39], v[16:19]
    v_mfma_f32_16x16x32_bf16 v[20:23], v[120:123], v[36:39], v[20:23]
    s_waitcnt lgkmcnt(8)
    v_mfma_f32_16x16x32_bf16 v[24:27], v[56:59], v[36:39], v[24:27]
    ds_read_b64 v[56:57], v2 offset:1728
    ds_read_b64 v[58:59], v2 offset:1736
    s_waitcnt lgkmcnt(7)
    v_mfma_f32_16x16x32_bf16 v[28:31], v[60:63], v[36:39], v[28:31]
    ds_read_b128 v[36:39], v3 offset:832
    ds_read_b64 v[60:61], v2 offset:1216
    ds_read_b64 v[62:63], v2 offset:1224
    v_mfma_f32_16x16x32_bf16 v[16:19], v[84:87], v[40:43], v[16:19]
    v_mfma_f32_16x16x32_bf16 v[20:23], v[116:119], v[40:43], v[20:23]
    s_waitcnt lgkmcnt(8)
    v_mfma_f32_16x16x32_bf16 v[24:27], v[48:51], v[40:43], v[24:27]
    ds_read_b64 v[48:49], v2 offset:1792
    ds_read_b64 v[50:51], v2 offset:1800
    s_waitcnt lgkmcnt(7)
    v_mfma_f32_16x16x32_bf16 v[28:31], v[52:55], v[40:43], v[28:31]
    ds_read_b128 v[40:43], v3 offset:896
    ds_read_b64 v[52:53], v2 offset:1280
    ds_read_b64 v[54:55], v2 offset:1288
    v_mfma_f32_16x16x32_bf16 v[16:19], v[80:83], v[44:47], v[16:19]
    v_mfma_f32_16x16x32_bf16 v[20:23], v[112:115], v[44:47], v[20:23]
    s_waitcnt lgkmcnt(8)
    v_mfma_f32_16x16x32_bf16 v[24:27], v[56:59], v[44:47], v[24:27]
    ds_read_b64 v[56:57], v2 offset:1856
    ds_read_b64 v[58:59], v2 offset:1864
    s_waitcnt lgkmcnt(7)
    v_mfma_f32_16x16x32_bf16 v[28:31], v[60:63], v[44:47], v[28:31]
    ds_read_b128 v[44:47], v3 offset:960
    ds_read_b64 v[60:61], v2 offset:1344
    ds_read_b64 v[62:63], v2 offset:1352
    v_mfma_f32_16x16x32_bf16 v[16:19], v[76:79], v[32:35], v[16:19]
    v_mfma_f32_16x16x32_bf16 v[20:23], v[108:111], v[32:35], v[20:23]
    s_waitcnt lgkmcnt(8)
    v_mfma_f32_16x16x32_bf16 v[24:27], v[48:51], v[32:35], v[24:27]
    ds_read_b64 v[48:49], v2 offset:1920
    ds_read_b64 v[50:51], v2 offset:1928
    s_waitcnt lgkmcnt(7)
    v_mfma_f32_16x16x32_bf16 v[28:31], v[52:55], v[32:35], v[28:31]
    ds_read_b64 v[52:53], v2 offset:1408
    ds_read_b64 v[54:55], v2 offset:1416
    v_mfma_f32_16x16x32_bf16 v[16:19], v[72:75], v[36:39], v[16:19]
    v_mfma_f32_16x16x32_bf16 v[20:23], v[104:107], v[36:39], v[20:23]
    s_waitcnt lgkmcnt(7)
    v_mfma_f32_16x16x32_bf16 v[24:27], v[56:59], v[36:39], v[24:27]
    ds_read_b64 v[56:57], v2 offset:1984
    ds_read_b64 v[58:59], v2 offset:1992
    s_waitcnt lgkmcnt(6)
    v_mfma_f32_16x16x32_bf16 v[28:31], v[60:63], v[36:39], v[28:31]
    ds_read_b64 v[60:61], v2 offset:1472
    ds_read_b64 v[62:63], v2 offset:1480
    v_mfma_f32_16x16x32_bf16 v[16:19], v[68:71], v[40:43], v[16:19]
    v_mfma_f32_16x16x32_bf16 v[20:23], v[100:103], v[40:43], v[20:23]
    s_waitcnt lgkmcnt(6)
    v_mfma_f32_16x16x32_bf16 v[24:27], v[48:51], v[40:43], v[24:27]
    ds_read_b64 v[48:49], v2 offset:2048
    ds_read_b64 v[50:51], v2 offset:2056
    s_waitcnt lgkmcnt(6)
    v_mfma_f32_16x16x32_bf16 v[28:31], v[52:55], v[40:43], v[28:31]
    ds_read_b64 v[52:53], v2 offset:1536
    ds_read_b64 v[54:55], v2 offset:1544
    v_mfma_f32_16x16x32_bf16 v[16:19], v[64:67], v[44:47], v[16:19]
    v_mfma_f32_16x16x32_bf16 v[20:23], v[96:99], v[44:47], v[20:23]
    s_waitcnt lgkmcnt(6)
    v_mfma_f32_16x16x32_bf16 v[24:27], v[56:59], v[44:47], v[24:27]
    s_nop 4
    v_cvt_pk_bf16_f32 v8, v16, v17
    v_cvt_pk_bf16_f32 v9, v18, v19
    ds_write_b64 v7, v[8:9] offset:0
    ds_read_b64 v[56:57], v2 offset:1600
    ds_read_b64 v[58:59], v2 offset:1608
    s_waitcnt lgkmcnt(7)
    v_mfma_f32_16x16x32_bf16 v[28:31], v[60:63], v[44:47], v[28:31]
    s_waitcnt lgkmcnt(0)
    s_barrier
    ds_read_b128 v[32:35], v3 offset:1024
    ds_read_b128 v[36:39], v3 offset:1088
    ds_read_b128 v[40:43], v3 offset:1152
    ds_read_b128 v[44:47], v3 offset:1216
    ds_read_b64 v[60:61], v2 offset:1664
    ds_read_b64 v[62:63], v2 offset:1672
    s_waitcnt lgkmcnt(5)
    v_mfma_f32_16x16x32_bf16 v[20:23], v[92:95], v[32:35], v[20:23]
    v_mfma_f32_16x16x32_bf16 v[24:27], v[48:51], v[32:35], v[24:27]
    ds_read_b64 v[48:49], v2 offset:1728
    ds_read_b64 v[50:51], v2 offset:1736
    v_mfma_f32_16x16x32_bf16 v[28:31], v[52:55], v[32:35], v[28:31]
    ds_read_b128 v[32:35], v3 offset:1280
    ds_read_b64 v[52:53], v2 offset:1792
    ds_read_b64 v[54:55], v2 offset:1800
    s_waitcnt lgkmcnt(9)
    v_mfma_f32_16x16x32_bf16 v[20:23], v[88:91], v[36:39], v[20:23]
    v_mfma_f32_16x16x32_bf16 v[24:27], v[184:187], v[36:39], v[24:27]
    v_mfma_f32_16x16x32_bf16 v[28:31], v[56:59], v[36:39], v[28:31]
    ds_read_b128 v[36:39], v3 offset:1344
    ds_read_b64 v[56:57], v2 offset:1856
    ds_read_b64 v[58:59], v2 offset:1864
    s_waitcnt lgkmcnt(11)
    v_mfma_f32_16x16x32_bf16 v[20:23], v[84:87], v[40:43], v[20:23]
    v_mfma_f32_16x16x32_bf16 v[24:27], v[180:183], v[40:43], v[24:27]
    s_waitcnt lgkmcnt(8)
    v_mfma_f32_16x16x32_bf16 v[28:31], v[60:63], v[40:43], v[28:31]
    ds_read_b128 v[40:43], v3 offset:1408
    ds_read_b64 v[60:61], v2 offset:1920
    ds_read_b64 v[62:63], v2 offset:1928
    v_mfma_f32_16x16x32_bf16 v[20:23], v[80:83], v[44:47], v[20:23]
    v_mfma_f32_16x16x32_bf16 v[24:27], v[176:179], v[44:47], v[24:27]
    s_waitcnt lgkmcnt(9)
    v_mfma_f32_16x16x32_bf16 v[28:31], v[48:51], v[44:47], v[28:31]
    ds_read_b128 v[44:47], v3 offset:1472
    ds_read_b64 v[48:49], v2 offset:1984
    ds_read_b64 v[50:51], v2 offset:1992
    s_waitcnt lgkmcnt(11)
    v_mfma_f32_16x16x32_bf16 v[20:23], v[76:79], v[32:35], v[20:23]
    v_mfma_f32_16x16x32_bf16 v[24:27], v[172:175], v[32:35], v[24:27]
    s_waitcnt lgkmcnt(9)
    v_mfma_f32_16x16x32_bf16 v[28:31], v[52:55], v[32:35], v[28:31]
    ds_read_b128 v[32:35], v3 offset:1536
    ds_read_b64 v[52:53], v2 offset:2048
    ds_read_b64 v[54:55], v2 offset:2056
    s_waitcnt lgkmcnt(11)
    v_mfma_f32_16x16x32_bf16 v[20:23], v[72:75], v[36:39], v[20:23]
    v_mfma_f32_16x16x32_bf16 v[24:27], v[168:171], v[36:39], v[24:27]
    s_waitcnt lgkmcnt(9)
    v_mfma_f32_16x16x32_bf16 v[28:31], v[56:59], v[36:39], v[28:31]
    ds_read_b128 v[36:39], v3 offset:1600
    s_waitcnt lgkmcnt(9)
    v_mfma_f32_16x16x32_bf16 v[20:23], v[68:71], v[40:43], v[20:23]
    v_mfma_f32_16x16x32_bf16 v[24:27], v[164:167], v[40:43], v[24:27]
    s_waitcnt lgkmcnt(7)
    v_mfma_f32_16x16x32_bf16 v[28:31], v[60:63], v[40:43], v[28:31]
    ds_read_b128 v[40:43], v3 offset:1664
    s_waitcnt lgkmcnt(7)
    v_mfma_f32_16x16x32_bf16 v[20:23], v[64:67], v[44:47], v[20:23]
    v_mfma_f32_16x16x32_bf16 v[24:27], v[160:163], v[44:47], v[24:27]
    s_waitcnt lgkmcnt(5)
    v_mfma_f32_16x16x32_bf16 v[28:31], v[48:51], v[44:47], v[28:31]
    s_nop 4
    v_cvt_pk_bf16_f32 v8, v20, v21
    v_cvt_pk_bf16_f32 v9, v22, v23
    ds_write_b64 v7, v[8:9] offset:2048
    ds_read_b128 v[44:47], v3 offset:1728
    s_waitcnt lgkmcnt(6)
    v_mfma_f32_16x16x32_bf16 v[24:27], v[156:159], v[32:35], v[24:27]
    s_waitcnt lgkmcnt(4)
    v_mfma_f32_16x16x32_bf16 v[28:31], v[52:55], v[32:35], v[28:31]
    ds_read_b128 v[32:35], v3 offset:1792
    s_waitcnt lgkmcnt(4)
    v_mfma_f32_16x16x32_bf16 v[24:27], v[152:155], v[36:39], v[24:27]
    v_mfma_f32_16x16x32_bf16 v[28:31], v[184:187], v[36:39], v[28:31]
    ds_read_b128 v[36:39], v3 offset:1856
    s_waitcnt lgkmcnt(4)
    v_mfma_f32_16x16x32_bf16 v[24:27], v[148:151], v[40:43], v[24:27]
    v_mfma_f32_16x16x32_bf16 v[28:31], v[180:183], v[40:43], v[28:31]
    ds_read_b128 v[40:43], v3 offset:1920
    s_waitcnt lgkmcnt(3)
    v_mfma_f32_16x16x32_bf16 v[24:27], v[144:147], v[44:47], v[24:27]
    v_mfma_f32_16x16x32_bf16 v[28:31], v[176:179], v[44:47], v[28:31]
    ds_read_b128 v[44:47], v3 offset:1984
    s_waitcnt lgkmcnt(3)
    v_mfma_f32_16x16x32_bf16 v[24:27], v[140:143], v[32:35], v[24:27]
    v_mfma_f32_16x16x32_bf16 v[28:31], v[172:175], v[32:35], v[28:31]
    s_waitcnt lgkmcnt(2)
    v_mfma_f32_16x16x32_bf16 v[24:27], v[136:139], v[36:39], v[24:27]
    v_mfma_f32_16x16x32_bf16 v[28:31], v[168:171], v[36:39], v[28:31]
    s_waitcnt lgkmcnt(1)
    v_mfma_f32_16x16x32_bf16 v[24:27], v[132:135], v[40:43], v[24:27]
    v_mfma_f32_16x16x32_bf16 v[28:31], v[164:167], v[40:43], v[28:31]
    s_waitcnt lgkmcnt(0)
    v_mfma_f32_16x16x32_bf16 v[24:27], v[128:131], v[44:47], v[24:27]
    v_mfma_f32_16x16x32_bf16 v[28:31], v[160:163], v[44:47], v[28:31]
    s_barrier
    ds_read_b128 v[32:35], v3 offset:2048
    ds_read_b128 v[36:39], v3 offset:2112
    ds_read_b128 v[40:43], v3 offset:2176
    ds_read_b128 v[44:47], v3 offset:2240
    s_waitcnt lgkmcnt(3)
    v_mfma_f32_16x16x32_bf16 v[24:27], v[124:127], v[32:35], v[24:27]
    v_mfma_f32_16x16x32_bf16 v[28:31], v[156:159], v[32:35], v[28:31]
    ds_read_b128 v[32:35], v3 offset:2304
    s_waitcnt lgkmcnt(3)
    v_mfma_f32_16x16x32_bf16 v[24:27], v[120:123], v[36:39], v[24:27]
    v_mfma_f32_16x16x32_bf16 v[28:31], v[152:155], v[36:39], v[28:31]
    ds_read_b128 v[36:39], v3 offset:2368
    s_waitcnt lgkmcnt(3)
    v_mfma_f32_16x16x32_bf16 v[24:27], v[116:119], v[40:43], v[24:27]
    v_mfma_f32_16x16x32_bf16 v[28:31], v[148:151], v[40:43], v[28:31]
    ds_read_b128 v[40:43], v3 offset:2432
    s_waitcnt lgkmcnt(3)
    v_mfma_f32_16x16x32_bf16 v[24:27], v[112:115], v[44:47], v[24:27]
    v_mfma_f32_16x16x32_bf16 v[28:31], v[144:147], v[44:47], v[28:31]
    ds_read_b128 v[44:47], v3 offset:2496
    s_waitcnt lgkmcnt(3)
    v_mfma_f32_16x16x32_bf16 v[24:27], v[108:111], v[32:35], v[24:27]
    v_mfma_f32_16x16x32_bf16 v[28:31], v[140:143], v[32:35], v[28:31]
    ds_read_b128 v[32:35], v3 offset:2560
    s_waitcnt lgkmcnt(3)
    v_mfma_f32_16x16x32_bf16 v[24:27], v[104:107], v[36:39], v[24:27]
    v_mfma_f32_16x16x32_bf16 v[28:31], v[136:139], v[36:39], v[28:31]
    ds_read_b128 v[36:39], v3 offset:2624
    s_waitcnt lgkmcnt(3)
    v_mfma_f32_16x16x32_bf16 v[24:27], v[100:103], v[40:43], v[24:27]
    v_mfma_f32_16x16x32_bf16 v[28:31], v[132:135], v[40:43], v[28:31]
    ds_read_b128 v[40:43], v3 offset:2688
    s_waitcnt lgkmcnt(3)
    v_mfma_f32_16x16x32_bf16 v[24:27], v[96:99], v[44:47], v[24:27]
    v_mfma_f32_16x16x32_bf16 v[28:31], v[128:131], v[44:47], v[28:31]
    ds_read_b128 v[44:47], v3 offset:2752
    s_waitcnt lgkmcnt(3)
    v_mfma_f32_16x16x32_bf16 v[24:27], v[92:95], v[32:35], v[24:27]
    v_mfma_f32_16x16x32_bf16 v[28:31], v[124:127], v[32:35], v[28:31]
    ds_read_b128 v[32:35], v3 offset:2816
    s_waitcnt lgkmcnt(3)
    v_mfma_f32_16x16x32_bf16 v[24:27], v[88:91], v[36:39], v[24:27]
    v_mfma_f32_16x16x32_bf16 v[28:31], v[120:123], v[36:39], v[28:31]
    ds_read_b128 v[36:39], v3 offset:2880
    s_waitcnt lgkmcnt(3)
    v_mfma_f32_16x16x32_bf16 v[24:27], v[84:87], v[40:43], v[24:27]
    v_mfma_f32_16x16x32_bf16 v[28:31], v[116:119], v[40:43], v[28:31]
    ds_read_b128 v[40:43], v3 offset:2944
    s_waitcnt lgkmcnt(3)
    v_mfma_f32_16x16x32_bf16 v[24:27], v[80:83], v[44:47], v[24:27]
    v_mfma_f32_16x16x32_bf16 v[28:31], v[112:115], v[44:47], v[28:31]
    ds_read_b128 v[44:47], v3 offset:3008
    s_waitcnt lgkmcnt(3)
    v_mfma_f32_16x16x32_bf16 v[24:27], v[76:79], v[32:35], v[24:27]
    v_mfma_f32_16x16x32_bf16 v[28:31], v[108:111], v[32:35], v[28:31]
    s_waitcnt lgkmcnt(2)
    v_mfma_f32_16x16x32_bf16 v[24:27], v[72:75], v[36:39], v[24:27]
    v_mfma_f32_16x16x32_bf16 v[28:31], v[104:107], v[36:39], v[28:31]
    s_waitcnt lgkmcnt(1)
    v_mfma_f32_16x16x32_bf16 v[24:27], v[68:71], v[40:43], v[24:27]
    v_mfma_f32_16x16x32_bf16 v[28:31], v[100:103], v[40:43], v[28:31]
    s_waitcnt lgkmcnt(0)
    v_mfma_f32_16x16x32_bf16 v[24:27], v[64:67], v[44:47], v[24:27]
    v_mfma_f32_16x16x32_bf16 v[28:31], v[96:99], v[44:47], v[28:31]
    s_nop 6
    v_cvt_pk_bf16_f32 v8, v24, v25
    v_cvt_pk_bf16_f32 v9, v26, v27
    ds_write_b64 v7, v[8:9] offset:4096
    s_waitcnt lgkmcnt(0)
    s_barrier
    ds_read_b128 v[32:35], v3 offset:3072
    ds_read_b128 v[36:39], v3 offset:3136
    ds_read_b128 v[40:43], v3 offset:3200
    ds_read_b128 v[44:47], v3 offset:3264
    s_waitcnt lgkmcnt(3)
    v_mfma_f32_16x16x32_bf16 v[28:31], v[92:95], v[32:35], v[28:31]
    ds_read_b128 v[32:35], v3 offset:3328
    s_waitcnt lgkmcnt(3)
    v_mfma_f32_16x16x32_bf16 v[28:31], v[88:91], v[36:39], v[28:31]
    ds_read_b128 v[36:39], v3 offset:3392
    s_waitcnt lgkmcnt(3)
    v_mfma_f32_16x16x32_bf16 v[28:31], v[84:87], v[40:43], v[28:31]
    ds_read_b128 v[40:43], v3 offset:3456
    s_waitcnt lgkmcnt(3)
    v_mfma_f32_16x16x32_bf16 v[28:31], v[80:83], v[44:47], v[28:31]
    ds_read_b128 v[44:47], v3 offset:3520
    s_waitcnt lgkmcnt(3)
    v_mfma_f32_16x16x32_bf16 v[28:31], v[76:79], v[32:35], v[28:31]
    s_waitcnt lgkmcnt(2)
    v_mfma_f32_16x16x32_bf16 v[28:31], v[72:75], v[36:39], v[28:31]
    s_waitcnt lgkmcnt(1)
    v_mfma_f32_16x16x32_bf16 v[28:31], v[68:71], v[40:43], v[28:31]
    s_waitcnt lgkmcnt(0)
    v_mfma_f32_16x16x32_bf16 v[28:31], v[64:67], v[44:47], v[28:31]
    s_nop 7
    v_cvt_pk_bf16_f32 v8, v28, v29
    v_cvt_pk_bf16_f32 v9, v30, v31
    ds_write_b64 v7, v[8:9] offset:6144
    s_waitcnt lgkmcnt(0)
    s_barrier
v_conv_done:
    s_cmp_eq_u32 s34, 1
    s_cbranch_scc1 k_done
    s_mov_b32 s34, 1
    s_mov_b32 s35, 2097152
    s_mov_b32 s36, 6291456
    s_mov_b32 s37, 10551296
    v_bfe_u32 v8, v1, 1, 3
    v_lshrrev_b32 v9, 4, v1
    v_xor_b32 v8, v8, v9
    v_and_b32 v9, 15, v1
    v_lshlrev_b32 v9, 7, v9
    v_lshl_add_u32 v2, v8, 4, v9
    s_add_u32 s38, s29, 0
    s_and_b32 s38, s38, 3
    s_add_u32 s38, s38, 1
    s_mov_b32 s52, s38
    s_lshl_b32 s38, s38, 14
    v_add_u32 v3, s38, v2
    s_add_u32 s38, s29, 1
    s_and_b32 s38, s38, 3
    s_add_u32 s38, s38, 1
    s_mov_b32 s53, s38
    s_lshl_b32 s38, s38, 14
    v_add_u32 v7, s38, v2
    s_add_u32 s38, s29, 2
    s_and_b32 s38, s38, 3
    s_add_u32 s38, s38, 1
    s_mov_b32 s54, s38
    s_lshl_b32 s38, s38, 14
    v_add_u32 v8, s38, v2
    s_add_u32 s38, s29, 3
    s_and_b32 s38, s38, 3
    s_add_u32 s38, s38, 1
    s_mov_b32 s55, s38
    s_lshl_b32 s38, s38, 14
    v_add_u32 v9, s38, v2
    v_xor_b32 v10, 64, v2
    v_xor_b32 v11, 64, v3
    v_xor_b32 v12, 64, v7
    v_xor_b32 v13, 64, v8
    v_xor_b32 v14, 64, v9
    v_mov_b32 v48, 0x3f803f80
    v_mov_b32 v49, 0x3f803f80
    v_mov_b32 v50, 0x3f803f80
    v_mov_b32 v51, 0x3f803f80
    s_lshl_b32 s40, s30, 16
    s_lshl_b32 s41, s28, 10
    s_add_u32 s40, s40, s41
    s_add_u32 s40, s40, 8372224
    s_cmp_eq_u32 s30, 0
    s_cselect_b32 s42, 0x7f000000, 0
    v_add_u32 v92, s42, v0
    v_and_b32 v95, 7, v1
    s_and_b32 s43, s28, 1
    s_lshl_b32 s43, s43, 2
    v_lshrrev_b32 v94, 4, v1
    v_xor_b32 v94, v94, v95
    v_xor_b32 v94, s43, v94
    v_lshlrev_b32 v93, 8, v95
    v_lshl_add_u32 v93, v94, 4, v93
    v_bfe_u32 v94, v1, 3, 1
    v_lshl_add_u32 v93, v94, 3, v93
    s_lshr_b32 s43, s28, 1
    s_lshl_b32 s43, s43, 11
    v_add_u32 v93, s43, v93
    v_add_u32 v94, 0x10000, v93
    v_cmp_eq_u32 s[44:45], 0, v95
    s_waitcnt vmcnt(0)
    s_mov_b32 s38, 0
v_x2poll:
    s_add_u32 s43, s40, 0
    buffer_load_dwordx4 v[52:55], v92, s[4:7], s43 offen sc1
    s_add_u32 s43, s40, 16384
    buffer_load_dwordx4 v[56:59], v0, s[4:7], s43 offen sc1
    s_add_u32 s43, s40, 32768
    buffer_load_dwordx4 v[60:63], v0, s[4:7], s43 offen sc1
    s_add_u32 s43, s40, 49152
    buffer_load_dwordx4 v[64:67], v0, s[4:7], s43 offen sc1
    s_add_u32 s43, s40, 65536
    buffer_load_dwordx4 v[68:71], v0, s[4:7], s43 offen sc1
    s_add_u32 s43, s40, 8192
    buffer_load_dwordx4 v[72:75], v92, s[4:7], s43 offen sc1
    s_add_u32 s43, s40, 24576
    buffer_load_dwordx4 v[76:79], v0, s[4:7], s43 offen sc1
    s_add_u32 s43, s40, 40960
    buffer_load_dwordx4 v[80:83], v0, s[4:7], s43 offen sc1
    s_add_u32 s43, s40, 57344
    buffer_load_dwordx4 v[84:87], v0, s[4:7], s43 offen sc1
    s_add_u32 s43, s40, 73728
    buffer_load_dwordx4 v[88:91], v0, s[4:7], s43 offen sc1
    s_add_u32 s38, s38, 1
    s_waitcnt vmcnt(0)
    v_max3_u32 v95, v55, v59, v63
    v_max3_u32 v95, v95, v67, v71
    v_max3_u32 v95, v95, v75, v79
    v_max3_u32 v95, v95, v83, v87
    v_max_u32 v95, v95, v91
    v_cmp_eq_u32 vcc, -1, v95
    s_cmp_gt_u32 s38, 131072
    s_cbranch_scc1 v_x2poll_x
    s_cbranch_vccnz v_x2poll
v_x2poll_x:
    v_mov_b32 v95, 0x3f803f80
    v_cndmask_b32 v52, v52, v95, s[44:45]
    v_cndmask_b32 v53, v53, v95, s[44:45]
    v_cndmask_b32 v72, v72, v95, s[44:45]
    v_cndmask_b32 v73, v73, v95, s[44:45]
    ds_write_b64 v93, v[52:53] offset:0
    ds_write_b64 v93, v[54:55] offset:128
    ds_write_b64 v93, v[56:57] offset:16384
    ds_write_b64 v93, v[58:59] offset:16512
    ds_write_b64 v93, v[60:61] offset:32768
    ds_write_b64 v93, v[62:63] offset:32896
    ds_write_b64 v93, v[64:65] offset:49152
    ds_write_b64 v93, v[66:67] offset:49280
    ds_write_b64 v94, v[68:69] offset:0
    ds_write_b64 v94, v[70:71] offset:128
    ds_write_b64 v93, v[72:73] offset:8192
    ds_write_b64 v93, v[74:75] offset:8320
    ds_write_b64 v93, v[76:77] offset:24576
    ds_write_b64 v93, v[78:79] offset:24704
    ds_write_b64 v93, v[80:81] offset:40960
    ds_write_b64 v93, v[82:83] offset:41088
    ds_write_b64 v93, v[84:85] offset:57344
    ds_write_b64 v93, v[86:87] offset:57472
    ds_write_b64 v94, v[88:89] offset:8192
    ds_write_b64 v94, v[90:91] offset:8320
    s_waitcnt lgkmcnt(0)
    s_barrier
    s_setprio 1
    ds_read_b128 v[52:55], v2 offset:0
    ds_read_b128 v[56:59], v3 offset:0
    ds_read_b128 v[60:63], v7 offset:0
    ds_read_b128 v[64:67], v8 offset:0
    ds_read_b128 v[68:71], v9 offset:0
    s_waitcnt lgkmcnt(4)
    v_mfma_f32_16x16x32_bf16 v[16:19], v[52:55], v[188:191], 0
    v_mfma_f32_16x16x32_bf16 v[44:47], v[52:55], v[52:55], 0
    ds_read_b128 v[72:75], v10 offset:0
    s_waitcnt lgkmcnt(4)
    v_mfma_f32_16x16x32_bf16 v[20:23], v[56:59], v[188:191], 0
    ds_read_b128 v[76:79], v11 offset:0
    v_mfma_f32_16x16x32_bf16 v[36:39], v[56:59], v[56:59], 0
    ds_read_b128 v[80:83], v12 offset:0
    v_mfma_f32_16x16x32_bf16 v[40:43], v[48:51], v[56:59], 0
    ds_read_b128 v[84:87], v13 offset:0
    s_waitcnt lgkmcnt(6)
    v_mfma_f32_16x16x32_bf16 v[24:27], v[60:63], v[188:191], 0
    ds_read_b128 v[88:91], v14 offset:0
    s_waitcnt lgkmcnt(6)
    v_mfma_f32_16x16x32_bf16 v[28:31], v[64:67], v[188:191], 0
    s_waitcnt lgkmcnt(5)
    v_mfma_f32_16x16x32_bf16 v[32:35], v[68:71], v[188:191], 0
    s_waitcnt lgkmcnt(4)
    v_mfma_f32_16x16x32_bf16 v[16:19], v[72:75], v[192:195], v[16:19]
    v_mfma_f32_16x16x32_bf16 v[44:47], v[72:75], v[72:75], v[44:47]
    ds_read_b128 v[52:55], v2 offset:2048
    s_waitcnt lgkmcnt(4)
    v_mfma_f32_16x16x32_bf16 v[20:23], v[76:79], v[192:195], v[20:23]
    ds_read_b128 v[56:59], v3 offset:2048
    v_mfma_f32_16x16x32_bf16 v[36:39], v[76:79], v[76:79], v[36:39]
    ds_read_b128 v[60:63], v7 offset:2048
    v_mfma_f32_16x16x32_bf16 v[40:43], v[48:51], v[76:79], v[40:43]
    ds_read_b128 v[64:67], v8 offset:2048
    s_waitcnt lgkmcnt(6)
    v_mfma_f32_16x16x32_bf16 v[24:27], v[80:83], v[192:195], v[24:27]
    ds_read_b128 v[68:71], v9 offset:2048
    s_waitcnt lgkmcnt(6)
    v_mfma_f32_16x16x32_bf16 v[28:31], v[84:87], v[192:195], v[28:31]
    s_waitcnt lgkmcnt(5)
    v_mfma_f32_16x16x32_bf16 v[32:35], v[88:91], v[192:195], v[32:35]
    s_waitcnt lgkmcnt(4)
    v_mfma_f32_16x16x32_bf16 v[16:19], v[52:55], v[196:199], v[16:19]
    v_mfma_f32_16x16x32_bf16 v[44:47], v[52:55], v[52:55], v[44:47]
    ds_read_b128 v[72:75], v10 offset:2048
    s_waitcnt lgkmcnt(4)
    v_mfma_f32_16x16x32_bf16 v[20:23], v[56:59], v[196:199], v[20:23]
    ds_read_b128 v[76:79], v11 offset:2048
    v_mfma_f32_16x16x32_bf16 v[36:39], v[56:59], v[56:59], v[36:39]
    ds_read_b128 v[80:83], v12 offset:2048
    v_mfma_f32_16x16x32_bf16 v[40:43], v[48:51], v[56:59], v[40:43]
    ds_read_b128 v[84:87], v13 offset:2048
    s_waitcnt lgkmcnt(6)
    v_mfma_f32_16x16x32_bf16 v[24:27], v[60:63], v[196:199], v[24:27]
    ds_read_b128 v[88:91], v14 offset:2048
    s_waitcnt lgkmcnt(6)
    v_mfma_f32_16x16x32_bf16 v[28:31], v[64:67], v[196:199], v[28:31]
    s_waitcnt lgkmcnt(5)
    v_mfma_f32_16x16x32_bf16 v[32:35], v[68:71], v[196:199], v[32:35]
    s_waitcnt lgkmcnt(4)
    v_mfma_f32_16x16x32_bf16 v[16:19], v[72:75], v[200:203], v[16:19]
    v_mfma_f32_16x16x32_bf16 v[44:47], v[72:75], v[72:75], v[44:47]
    ds_read_b128 v[52:55], v2 offset:4096
    s_waitcnt lgkmcnt(4)
    v_mfma_f32_16x16x32_bf16 v[20:23], v[76:79], v[200:203], v[20:23]
    ds_read_b128 v[56:59], v3 offset:4096
    v_mfma_f32_16x16x32_bf16 v[36:39], v[76:79], v[76:79], v[36:39]
    ds_read_b128 v[60:63], v7 offset:4096
    v_mfma_f32_16x16x32_bf16 v[40:43], v[48:51], v[76:79], v[40:43]
    ds_read_b128 v[64:67], v8 offset:4096
    s_waitcnt lgkmcnt(6)
    v_mfma_f32_16x16x32_bf16 v[24:27], v[80:83], v[200:203], v[24:27]
    ds_read_b128 v[68:71], v9 offset:4096
    s_waitcnt lgkmcnt(6)
    v_mfma_f32_16x16x32_bf16 v[28:31], v[84:87], v[200:203], v[28:31]
    s_waitcnt lgkmcnt(5)
    v_mfma_f32_16x16x32_bf16 v[32:35], v[88:91], v[200:203], v[32:35]
    s_waitcnt lgkmcnt(4)
    v_mfma_f32_16x16x32_bf16 v[16:19], v[52:55], v[204:207], v[16:19]
    v_mfma_f32_16x16x32_bf16 v[44:47], v[52:55], v[52:55], v[44:47]
    ds_read_b128 v[72:75], v10 offset:4096
    s_waitcnt lgkmcnt(4)
    v_mfma_f32_16x16x32_bf16 v[20:23], v[56:59], v[204:207], v[20:23]
    ds_read_b128 v[76:79], v11 offset:4096
    v_mfma_f32_16x16x32_bf16 v[36:39], v[56:59], v[56:59], v[36:39]
    ds_read_b128 v[80:83], v12 offset:4096
    v_mfma_f32_16x16x32_bf16 v[40:43], v[48:51], v[56:59], v[40:43]
    ds_read_b128 v[84:87], v13 offset:4096
    s_waitcnt lgkmcnt(6)
    v_mfma_f32_16x16x32_bf16 v[24:27], v[60:63], v[204:207], v[24:27]
    ds_read_b128 v[88:91], v14 offset:4096
    s_waitcnt lgkmcnt(6)
    v_mfma_f32_16x16x32_bf16 v[28:31], v[64:67], v[204:207], v[28:31]
    s_waitcnt lgkmcnt(5)
    v_mfma_f32_16x16x32_bf16 v[32:35], v[68:71], v[204:207], v[32:35]
    s_waitcnt lgkmcnt(4)
    v_mfma_f32_16x16x32_bf16 v[16:19], v[72:75], v[208:211], v[16:19]
    v_mfma_f32_16x16x32_bf16 v[44:47], v[72:75], v[72:75], v[44:47]
    ds_read_b128 v[52:55], v2 offset:6144
    s_waitcnt lgkmcnt(4)
    v_mfma_f32_16x16x32_bf16 v[20:23], v[76:79], v[208:211], v[20:23]
    ds_read_b128 v[56:59], v3 offset:6144
    v_mfma_f32_16x16x32_bf16 v[36:39], v[76:79], v[76:79], v[36:39]
    ds_read_b128 v[60:63], v7 offset:6144
    v_mfma_f32_16x16x32_bf16 v[40:43], v[48:51], v[76:79], v[40:43]
    ds_read_b128 v[64:67], v8 offset:6144
    s_waitcnt lgkmcnt(6)
    v_mfma_f32_16x16x32_bf16 v[24:27], v[80:83], v[208:211], v[24:27]
    ds_read_b128 v[68:71], v9 offset:6144
    s_waitcnt lgkmcnt(6)
    v_mfma_f32_16x16x32_bf16 v[28:31], v[84:87], v[208:211], v[28:31]
    s_waitcnt lgkmcnt(5)
    v_mfma_f32_16x16x32_bf16 v[32:35], v[88:91], v[208:211], v[32:35]
    s_waitcnt lgkmcnt(4)
    v_mfma_f32_16x16x32_bf16 v[16:19], v[52:55], v[212:215], v[16:19]
    v_mfma_f32_16x16x32_bf16 v[44:47], v[52:55], v[52:55], v[44:47]
    ds_read_b128 v[72:75], v10 offset:6144
    s_waitcnt lgkmcnt(4)
    v_mfma_f32_16x16x32_bf16 v[20:23], v[56:59], v[212:215], v[20:23]
    ds_read_b128 v[76:79], v11 offset:6144
    v_mfma_f32_16x16x32_bf16 v[36:39], v[56:59], v[56:59], v[36:39]
    ds_read_b128 v[80:83], v12 offset:6144
    v_mfma_f32_16x16x32_bf16 v[40:43], v[48:51], v[56:59], v[40:43]
    ds_read_b128 v[84:87], v13 offset:6144
    s_waitcnt lgkmcnt(6)
    v_mfma_f32_16x16x32_bf16 v[24:27], v[60:63], v[212:215], v[24:27]
    ds_read_b128 v[88:91], v14 offset:6144
    s_waitcnt lgkmcnt(6)
    v_mfma_f32_16x16x32_bf16 v[28:31], v[64:67], v[212:215], v[28:31]
    s_waitcnt lgkmcnt(5)
    v_mfma_f32_16x16x32_bf16 v[32:35], v[68:71], v[212:215], v[32:35]
    s_waitcnt lgkmcnt(4)
    v_mfma_f32_16x16x32_bf16 v[16:19], v[72:75], v[216:219], v[16:19]
    v_mfma_f32_16x16x32_bf16 v[44:47], v[72:75], v[72:75], v[44:47]
    ds_read_b128 v[52:55], v2 offset:8192
    s_waitcnt lgkmcnt(4)
    v_mfma_f32_16x16x32_bf16 v[20:23], v[76:79], v[216:219], v[20:23]
    ds_read_b128 v[56:59], v3 offset:8192
    v_mfma_f32_16x16x32_bf16 v[36:39], v[76:79], v[76:79], v[36:39]
    ds_read_b128 v[60:63], v7 offset:8192
    v_mfma_f32_16x16x32_bf16 v[40:43], v[48:51], v[76:79], v[40:43]
    ds_read_b128 v[64:67], v8 offset:8192
    s_waitcnt lgkmcnt(6)
    v_mfma_f32_16x16x32_bf16 v[24:27], v[80:83], v[216:219], v[24:27]
    ds_read_b128 v[68:71], v9 offset:8192
    s_waitcnt lgkmcnt(6)
    v_mfma_f32_16x16x32_bf16 v[28:31], v[84:87], v[216:219], v[28:31]
    s_waitcnt lgkmcnt(5)
    v_mfma_f32_16x16x32_bf16 v[32:35], v[88:91], v[216:219], v[32:35]
    s_waitcnt lgkmcnt(4)
    v_mfma_f32_16x16x32_bf16 v[16:19], v[52:55], v[220:223], v[16:19]
    v_mfma_f32_16x16x32_bf16 v[44:47], v[52:55], v[52:55], v[44:47]
    ds_read_b128 v[72:75], v10 offset:8192
    s_waitcnt lgkmcnt(4)
    v_mfma_f32_16x16x32_bf16 v[20:23], v[56:59], v[220:223], v[20:23]
    ds_read_b128 v[76:79], v11 offset:8192
    v_mfma_f32_16x16x32_bf16 v[36:39], v[56:59], v[56:59], v[36:39]
    ds_read_b128 v[80:83], v12 offset:8192
    v_mfma_f32_16x16x32_bf16 v[40:43], v[48:51], v[56:59], v[40:43]
    ds_read_b128 v[84:87], v13 offset:8192
    s_waitcnt lgkmcnt(6)
    v_mfma_f32_16x16x32_bf16 v[24:27], v[60:63], v[220:223], v[24:27]
    ds_read_b128 v[88:91], v14 offset:8192
    s_waitcnt lgkmcnt(6)
    v_mfma_f32_16x16x32_bf16 v[28:31], v[64:67], v[220:223], v[28:31]
    s_waitcnt lgkmcnt(5)
    v_mfma_f32_16x16x32_bf16 v[32:35], v[68:71], v[220:223], v[32:35]
    s_waitcnt lgkmcnt(4)
    v_mfma_f32_16x16x32_bf16 v[16:19], v[72:75], v[224:227], v[16:19]
    v_mfma_f32_16x16x32_bf16 v[44:47], v[72:75], v[72:75], v[44:47]
    ds_read_b128 v[52:55], v2 offset:10240
    s_waitcnt lgkmcnt(4)
    v_mfma_f32_16x16x32_bf16 v[20:23], v[76:79], v[224:227], v[20:23]
    ds_read_b128 v[56:59], v3 offset:10240
    v_mfma_f32_16x16x32_bf16 v[36:39], v[76:79], v[76:79], v[36:39]
    ds_read_b128 v[60:63], v7 offset:10240
    v_mfma_f32_16x16x32_bf16 v[40:43], v[48:51], v[76:79], v[40:43]
    ds_read_b128 v[64:67], v8 offset:10240
    s_waitcnt lgkmcnt(6)
    v_mfma_f32_16x16x32_bf16 v[24:27], v[80:83], v[224:227], v[24:27]
    ds_read_b128 v[68:71], v9 offset:10240
    s_waitcnt lgkmcnt(6)
    v_mfma_f32_16x16x32_bf16 v[28:31], v[84:87], v[224:227], v[28:31]
    s_waitcnt lgkmcnt(5)
    v_mfma_f32_16x16x32_bf16 v[32:35], v[88:91], v[224:227], v[32:35]
    s_waitcnt lgkmcnt(4)
    v_mfma_f32_16x16x32_bf16 v[16:19], v[52:55], v[228:231], v[16:19]
    v_mfma_f32_16x16x32_bf16 v[44:47], v[52:55], v[52:55], v[44:47]
    ds_read_b128 v[72:75], v10 offset:10240
    s_waitcnt lgkmcnt(4)
    v_mfma_f32_16x16x32_bf16 v[20:23], v[56:59], v[228:231], v[20:23]
    ds_read_b128 v[76:79], v11 offset:10240
    v_mfma_f32_16x16x32_bf16 v[36:39], v[56:59], v[56:59], v[36:39]
    ds_read_b128 v[80:83], v12 offset:10240
    v_mfma_f32_16x16x32_bf16 v[40:43], v[48:51], v[56:59], v[40:43]
    ds_read_b128 v[84:87], v13 offset:10240
    s_waitcnt lgkmcnt(6)
    v_mfma_f32_16x16x32_bf16 v[24:27], v[60:63], v[228:231], v[24:27]
    ds_read_b128 v[88:91], v14 offset:10240
    s_waitcnt lgkmcnt(6)
    v_mfma_f32_16x16x32_bf16 v[28:31], v[64:67], v[228:231], v[28:31]
    s_waitcnt lgkmcnt(5)
    v_mfma_f32_16x16x32_bf16 v[32:35], v[68:71], v[228:231], v[32:35]
    s_waitcnt lgkmcnt(4)
    v_mfma_f32_16x16x32_bf16 v[16:19], v[72:75], v[232:235], v[16:19]
    v_mfma_f32_16x16x32_bf16 v[44:47], v[72:75], v[72:75], v[44:47]
    ds_read_b128 v[52:55], v2 offset:12288
    s_waitcnt lgkmcnt(4)
    v_mfma_f32_16x16x32_bf16 v[20:23], v[76:79], v[232:235], v[20:23]
    ds_read_b128 v[56:59], v3 offset:12288
    v_mfma_f32_16x16x32_bf16 v[36:39], v[76:79], v[76:79], v[36:39]
    ds_read_b128 v[60:63], v7 offset:12288
    v_mfma_f32_16x16x32_bf16 v[40:43], v[48:51], v[76:79], v[40:43]
    ds_read_b128 v[64:67], v8 offset:12288
    s_waitcnt lgkmcnt(6)
    v_mfma_f32_16x16x32_bf16 v[24:27], v[80:83], v[232:235], v[24:27]
    ds_read_b128 v[68:71], v9 offset:12288
    s_waitcnt lgkmcnt(6)
    v_mfma_f32_16x16x32_bf16 v[28:31], v[84:87], v[232:235], v[28:31]
    s_waitcnt lgkmcnt(5)
    v_mfma_f32_16x16x32_bf16 v[32:35], v[88:91], v[232:235], v[32:35]
    s_waitcnt lgkmcnt(4)
    v_mfma_f32_16x16x32_bf16 v[16:19], v[52:55], v[236:239], v[16:19]
    v_mfma_f32_16x16x32_bf16 v[44:47], v[52:55], v[52:55], v[44:47]
    ds_read_b128 v[72:75], v10 offset:12288
    s_waitcnt lgkmcnt(4)
    v_mfma_f32_16x16x32_bf16 v[20:23], v[56:59], v[236:239], v[20:23]
    ds_read_b128 v[76:79], v11 offset:12288
    v_mfma_f32_16x16x32_bf16 v[36:39], v[56:59], v[56:59], v[36:39]
    ds_read_b128 v[80:83], v12 offset:12288
    v_mfma_f32_16x16x32_bf16 v[40:43], v[48:51], v[56:59], v[40:43]
    ds_read_b128 v[84:87], v13 offset:12288
    s_waitcnt lgkmcnt(6)
    v_mfma_f32_16x16x32_bf16 v[24:27], v[60:63], v[236:239], v[24:27]
    ds_read_b128 v[88:91], v14 offset:12288
    s_waitcnt lgkmcnt(6)
    v_mfma_f32_16x16x32_bf16 v[28:31], v[64:67], v[236:239], v[28:31]
    s_waitcnt lgkmcnt(5)
    v_mfma_f32_16x16x32_bf16 v[32:35], v[68:71], v[236:239], v[32:35]
    s_waitcnt lgkmcnt(4)
    v_mfma_f32_16x16x32_bf16 v[16:19], v[72:75], v[240:243], v[16:19]
    v_mfma_f32_16x16x32_bf16 v[44:47], v[72:75], v[72:75], v[44:47]
    ds_read_b128 v[52:55], v2 offset:14336
    s_waitcnt lgkmcnt(4)
    v_mfma_f32_16x16x32_bf16 v[20:23], v[76:79], v[240:243], v[20:23]
    ds_read_b128 v[56:59], v3 offset:14336
    v_mfma_f32_16x16x32_bf16 v[36:39], v[76:79], v[76:79], v[36:39]
    ds_read_b128 v[60:63], v7 offset:14336
    v_mfma_f32_16x16x32_bf16 v[40:43], v[48:51], v[76:79], v[40:43]
    ds_read_b128 v[64:67], v8 offset:14336
    s_waitcnt lgkmcnt(6)
    v_mfma_f32_16x16x32_bf16 v[24:27], v[80:83], v[240:243], v[24:27]
    ds_read_b128 v[68:71], v9 offset:14336
    s_waitcnt lgkmcnt(6)
    v_mfma_f32_16x16x32_bf16 v[28:31], v[84:87], v[240:243], v[28:31]
    s_waitcnt lgkmcnt(5)
    v_mfma_f32_16x16x32_bf16 v[32:35], v[88:91], v[240:243], v[32:35]
    s_waitcnt lgkmcnt(4)
    v_mfma_f32_16x16x32_bf16 v[16:19], v[52:55], v[244:247], v[16:19]
    v_mfma_f32_16x16x32_bf16 v[44:47], v[52:55], v[52:55], v[44:47]
    ds_read_b128 v[72:75], v10 offset:14336
    s_waitcnt lgkmcnt(4)
    v_mfma_f32_16x16x32_bf16 v[20:23], v[56:59], v[244:247], v[20:23]
    ds_read_b128 v[76:79], v11 offset:14336
    v_mfma_f32_16x16x32_bf16 v[36:39], v[56:59], v[56:59], v[36:39]
    ds_read_b128 v[80:83], v12 offset:14336
    v_mfma_f32_16x16x32_bf16 v[40:43], v[48:51], v[56:59], v[40:43]
    ds_read_b128 v[84:87], v13 offset:14336
    s_waitcnt lgkmcnt(6)
    v_mfma_f32_16x16x32_bf16 v[24:27], v[60:63], v[244:247], v[24:27]
    ds_read_b128 v[88:91], v14 offset:14336
    s_waitcnt lgkmcnt(6)
    v_mfma_f32_16x16x32_bf16 v[28:31], v[64:67], v[244:247], v[28:31]
    s_waitcnt lgkmcnt(5)
    v_mfma_f32_16x16x32_bf16 v[32:35], v[68:71], v[244:247], v[32:35]
    s_waitcnt lgkmcnt(4)
    v_mfma_f32_16x16x32_bf16 v[16:19], v[72:75], v[248:251], v[16:19]
    v_mfma_f32_16x16x32_bf16 v[44:47], v[72:75], v[72:75], v[44:47]
    s_waitcnt lgkmcnt(3)
    v_mfma_f32_16x16x32_bf16 v[20:23], v[76:79], v[248:251], v[20:23]
    v_mfma_f32_16x16x32_bf16 v[36:39], v[76:79], v[76:79], v[36:39]
    v_mfma_f32_16x16x32_bf16 v[40:43], v[48:51], v[76:79], v[40:43]
    s_waitcnt lgkmcnt(2)
    v_mfma_f32_16x16x32_bf16 v[24:27], v[80:83], v[248:251], v[24:27]
    s_waitcnt lgkmcnt(1)
    v_mfma_f32_16x16x32_bf16 v[28:31], v[84:87], v[248:251], v[28:31]
    s_waitcnt lgkmcnt(0)
    v_mfma_f32_16x16x32_bf16 v[32:35], v[88:91], v[248:251], v[32:35]
    s_nop 7
    s_branch v_common
k_done:
k_exit:
    s_endpgm
.section .rodata,"a"
.p2align 6
.amdhsa_kernel interleave_layers__sliding_local_dilated__ssm_conv_s4__prompt_kernel
  .amdhsa_next_free_vgpr 256
  .amdhsa_next_free_sgpr 102
  .amdhsa_accum_offset 256
  .amdhsa_group_segment_fixed_size 0
  .amdhsa_kernarg_size 120
  .amdhsa_user_sgpr_count 2
  .amdhsa_user_sgpr_kernarg_segment_ptr 1
  .amdhsa_system_sgpr_workgroup_id_x 1
.end_amdhsa_kernel
```
